```python
import torch

def _softmax(x, axis=-1):
    return torch.softmax(x, dim=axis)
def _gelu(x):
    return torch.nn.functional.gelu(x, approximate="tanh")
def _silu(x):
    return torch.nn.functional.silu(x)
def _sigmoid(x):
    return torch.sigmoid(x)
def _layernorm(x, axis=-1, eps=1e-5):
    m = x.mean(dim=axis, keepdim=True)
    v = x.var(dim=axis, keepdim=True, unbiased=False)
    return (x - m) / torch.sqrt(v + eps)
def _scatter_add(tgt, idx, src, axis=0):
    return tgt.clone().index_add_(axis, idx, src)
def _segment_sum(src, seg, n):
    out = torch.zeros((n,) + src.shape[1:], dtype=src.dtype)
    return out.index_add_(0, seg, src)
def _pad(x, pw):
    flat = tuple(v for pair in reversed(pw) for v in pair)
    return torch.nn.functional.pad(x, flat)

kernel_name = 'gated_mix__grouped_kv_mqa__glu_gated_glu__prompt'

def setup_inputs():

    _w = (lambda a: (lambda t: t.to(torch.bfloat16) if t.is_floating_point() else t)(torch.as_tensor(a)))
    def _A_setup():
        B, S, D, H = 1, 2048, 1024, 32
        Dh = D // H
        return {
            "x": _w((lambda *s: torch.randn(*s, dtype=torch.bfloat16) * 0.05)(B, S, D)),
            "wq": _w((lambda *s: torch.randn(*s, dtype=torch.bfloat16) * 0.8)(D, H * Dh)),
            "wk": _w((lambda *s: torch.randn(*s, dtype=torch.bfloat16) * 0.8)(D, Dh)),
            "wv": _w((lambda *s: torch.randn(*s, dtype=torch.bfloat16) * 0.2)(D, Dh)),
            "wo": _w((lambda *s: torch.randn(*s, dtype=torch.bfloat16) * 0.2)(H * Dh, D)),
        }
    _A_in = _A_setup()

    def _B_setup():
        B, S, D, F = 1, 2048, 1024, 3584
        return {
            "x": _w((lambda *s: torch.randn(*s, dtype=torch.bfloat16) * 0.05)(B, S, D)),
            "w_gate": _w((lambda *s: torch.randn(*s, dtype=torch.bfloat16) * 1.6)(D, F)),
            "w_up": _w((lambda *s: torch.randn(*s, dtype=torch.bfloat16) * 0.05)(D, F)),
            "w_down": _w((lambda *s: torch.randn(*s, dtype=torch.bfloat16) * 0.05)(F, D)),
        }
    _B_in = _B_setup()

    return {
        "A_x": _A_in["x"],
        "A_wq": _A_in["wq"],
        "A_wk": _A_in["wk"],
        "A_wv": _A_in["wv"],
        "A_wo": _A_in["wo"],
        "B_x": _B_in["x"],
        "B_w_gate": _B_in["w_gate"],
        "B_w_up": _B_in["w_up"],
        "B_w_down": _B_in["w_down"],
        "gate_w": _w((lambda *s: torch.randn(*s, dtype=torch.bfloat16) * 0.05)(1024) * 16.0),
    }

def reference(A_x, A_wq, A_wk, A_wv, A_wo, B_x, B_w_gate, B_w_up, B_w_down, gate_w):
    def _A_ref(x, wq, wk, wv, wo):
        B, S, D = x.shape
        H = 32
        Dh = D // H
        q = (lambda x, *d: x.permute(*d))((x @ wq).reshape(B, S, H, Dh), 0, 2, 1, 3)
        k = x @ wk
        v = x @ wv
        scores = torch.einsum("bhqd,bkd->bhqk", q, k) * (Dh ** -0.5)
        p = _softmax(scores, axis=-1)
        o = torch.einsum("bhqk,bkd->bhqd", p, v)
        return (lambda x, *d: x.permute(*d))(o, 0, 2, 1, 3).reshape(B, S, H * Dh) @ wo

    def _B_ref(x, w_gate, w_up, w_down):
        g = torch.einsum("bsd,df->bsf", x, w_gate)
        u = torch.einsum("bsd,df->bsf", x, w_up)
        h = _sigmoid(g) * u
        return torch.einsum("bsf,fd->bsd", h, w_down)

    x = A_x
    g = _sigmoid((x * gate_w).sum(-1, keepdims=True))
    a = _A_ref(x, A_wq, A_wk, A_wv, A_wo)
    b = _B_ref(x, B_w_gate, B_w_up, B_w_down)
    return g * a + (1 - g) * b
```

```asm
; @launch grid=(256,1,1) block=(512,1,1) lds=163840
.amdgcn_target "amdgcn-amd-amdhsa--gfx950"
.text
.globl gated_mix__grouped_kv_mqa__glu_gated_glu__prompt_kernel
.p2align 8
.type gated_mix__grouped_kv_mqa__glu_gated_glu__prompt_kernel,@function
gated_mix__grouped_kv_mqa__glu_gated_glu__prompt_kernel:
    s_load_dwordx4 s[28:31], s[0:1], 0
    s_load_dwordx4 s[36:39], s[0:1], 48
    s_load_dwordx4 s[32:35], s[0:1], 16
    s_load_dwordx2 s[40:41], s[0:1], 72
    s_load_dwordx2 s[42:43], s[0:1], 96
    s_cmp_ge_u32 s2, 16
    s_cbranch_scc1 p1_nocpf
    s_getpc_b64 s[4:5]
p1_pc:
    s_sub_u32 s4, s4, p1_pc-gated_mix__grouped_kv_mqa__glu_gated_glu__prompt_kernel
    s_subb_u32 s5, s5, 0
    v_lshlrev_b32 v2, 7, v0
    v_min_u32 v3, p2_end-gated_mix__grouped_kv_mqa__glu_gated_glu__prompt_kernel, v2
    global_load_dword v255, v3, s[4:5]
    v_add_u32 v2, 0x10000, v2
    v_min_u32 v3, p2_end-gated_mix__grouped_kv_mqa__glu_gated_glu__prompt_kernel, v2
    global_load_dword v255, v3, s[4:5]
p1_nocpf:
    s_cmp_ge_u32 s2, 256
    s_cbranch_scc1 p2_end
    v_lshrrev_b32 v1, 6, v0
    v_and_b32 v0, 63, v0
    v_readfirstlane_b32 s3, v1
    s_and_b32 s4, s2, 7
    s_lshr_b32 s5, s2, 3
    s_and_b32 s6, s4, 1
    s_lshl_b32 s6, s6, 2
    s_and_b32 s7, s5, 3
    s_add_u32 s56, s6, s7
    s_lshr_b32 s4, s4, 1
    s_lshr_b32 s5, s5, 2
    s_add_u32 s6, s4, 28
    s_mul_i32 s4, s4, 7
    s_add_u32 s4, s4, s5
    s_cmp_eq_u32 s5, 7
    s_cselect_b32 s57, s6, s4
    s_lshr_b32 s59, s3, 2
    s_and_b32 s60, s3, 3
    s_sub_u32 s58, s57, 28
    s_cselect_b32 s58, 0, s58
    s_cselect_b32 s4, 7168, 0
    s_cselect_b32 s5, 0, 2048
    s_add_u32 s4, s4, s5
    s_lshl_b32 s5, s57, 8
    s_lshl_b32 s6, s58, 9
    s_cmp_ge_u32 s57, 28
    s_cselect_b32 s5, s6, s5
    s_lshl_b32 s67, s4, 6
    s_mov_b32 s10, 0x400000
    s_mov_b32 s11, 0x20000
    s_mov_b32 s15, 0x20000
    s_mov_b32 s19, 0x20000
    s_mov_b32 s46, 0x2000000
    s_mov_b32 s47, 0x20000
    s_mov_b32 s76, 0x8000
    s_cmp_lt_u32 s3, 4
    s_cbranch_scc1 p1_cpro
    v_lshrrev_b32 v96, 3, v0
    v_lshrrev_b32 v97, 4, v0
    v_and_b32 v98, 7, v0
    v_lshlrev_b32 v96, 11, v96
    v_xor_b32 v98, v97, v98
    v_lshl_add_u32 v6, v98, 4, v96
    v_xor_b32 v7, 64, v6
    v_add_u32 v7, 0x4000, v7
    s_lshl_b32 s6, s60, 4
    v_add_u32 v99, s6, v97
    v_mul_lo_u32 v99, v99, s4
    v_bfe_u32 v98, v0, 1, 3
    v_xor_b32 v96, v97, v98
    v_lshlrev_b32 v96, 5, v96
    v_and_b32 v98, 1, v0
    v_lshl_add_u32 v96, v98, 4, v96
    v_add3_u32 v8, v96, v99, s5
    s_lshl_b32 s6, s4, 2
    v_add_u32 v9, s6, v8
    v_xor_b32 v96, 0x80, v96
    v_add3_u32 v10, v96, v99, s5
    s_lshl_b32 s7, s4, 3
    v_add_u32 v10, s7, v10
    v_add_u32 v11, s6, v10
    s_lshl_b32 s6, s60, 1
    s_and_b32 s7, s6, 2
    s_add_u32 s7, s7, s58
    s_and_b32 s6, s6, 4
    s_lshl_b32 s4, s56, 3
    s_add_u32 s6, s6, s4
    s_and_b32 s4, s7, 3
    s_add_u32 s4, s4, s6
    s_lshl_b32 s61, s4, 16
    s_add_u32 s7, s7, 1
    s_and_b32 s4, s7, 3
    s_add_u32 s4, s4, s6
    s_lshl_b32 s63, s4, 16
    s_add_u32 s62, s61, 0x8000
    s_add_u32 s64, s63, 0x8000
    s_lshl_b32 s68, s60, 13
    s_lshl_b32 s71, s60, 12
    s_add_u32 s71, s71, 0x18000
    s_lshl_b32 s72, s60, 10
    s_add_u32 s72, s72, 0x10000
    s_mov_b32 s65, 0
    s_mov_b32 s66, 0
    v_lshrrev_b32 v96, 2, v0
    s_lshl_b32 s6, s60, 4
    v_add_u32 v96, s6, v96
    v_lshlrev_b32 v96, 6, v96
    v_lshrrev_b32 v97, 5, v0
    v_lshlrev_b32 v97, 1, v97
    v_and_b32 v98, 3, v0
    v_xor_b32 v97, v97, v98
    v_lshl_add_u32 v12, v97, 4, v96
    s_mov_b32 s22, 0x10000
    s_mov_b32 s23, 0x20000
    s_mov_b32 s26, 0x10000
    s_mov_b32 s27, 0x20000
    s_waitcnt lgkmcnt(0)
    s_add_u32 s6, s30, 256
    s_addc_u32 s7, s31, 0
    s_cmp_ge_u32 s57, 28
    s_cselect_b32 s12, s30, s36
    s_cselect_b32 s13, s31, s37
    s_cselect_b32 s16, s6, s38
    s_cselect_b32 s17, s7, s39
    s_mov_b32 s6, 0x700000
    s_cselect_b32 s14, 0x200000, s6
    s_cselect_b32 s18, 0x1fff00, s6
    s_mov_b32 s8, s28
    s_mov_b32 s9, s29
    s_mov_b32 s20, s32
    s_mov_b32 s21, s33
    s_mov_b32 s24, s34
    s_mov_b32 s25, s35
    s_mov_b32 m0, s71
    s_nop 0
    buffer_load_dwordx4 v8, s[12:15], s65 offen lds
    s_add_u32 m0, s71, 0x4000
    s_nop 0
    buffer_load_dwordx4 v8, s[16:19], s65 offen lds
    s_add_u32 m0, s71, 0x400
    s_nop 0
    buffer_load_dwordx4 v9, s[12:15], s65 offen lds
    s_add_u32 m0, s71, 0x4400
    s_nop 0
    buffer_load_dwordx4 v9, s[16:19], s65 offen lds
    s_add_u32 m0, s71, 0x800
    s_nop 0
    buffer_load_dwordx4 v10, s[12:15], s65 offen lds
    s_add_u32 m0, s71, 0x4800
    s_nop 0
    buffer_load_dwordx4 v10, s[16:19], s65 offen lds
    s_add_u32 m0, s71, 0xc00
    s_nop 0
    buffer_load_dwordx4 v11, s[12:15], s65 offen lds
    s_add_u32 m0, s71, 0x4c00
    s_nop 0
    buffer_load_dwordx4 v11, s[16:19], s65 offen lds
    s_add_u32 s65, s65, s67
    s_mov_b32 m0, s68
    s_nop 0
    buffer_load_dwordx4 v6, s[8:11], s61 offen lds
    s_add_u32 m0, s68, 0x400
    s_nop 0
    buffer_load_dwordx4 v7, s[8:11], s61 offen lds
    s_add_u32 s61, s61, 128
    s_add_u32 m0, s68, 0x800
    s_nop 0
    buffer_load_dwordx4 v6, s[8:11], s62 offen lds
    s_add_u32 m0, s68, 0xc00
    s_nop 0
    buffer_load_dwordx4 v7, s[8:11], s62 offen lds
    s_add_u32 s62, s62, 128
    s_add_u32 m0, s68, 0x1000
    s_nop 0
    buffer_load_dwordx4 v6, s[8:11], s63 offen lds
    s_add_u32 m0, s68, 0x1400
    s_nop 0
    buffer_load_dwordx4 v7, s[8:11], s63 offen lds
    s_add_u32 s63, s63, 128
    s_add_u32 m0, s68, 0x1800
    s_nop 0
    buffer_load_dwordx4 v6, s[8:11], s64 offen lds
    s_add_u32 m0, s68, 0x1c00
    s_nop 0
    buffer_load_dwordx4 v7, s[8:11], s64 offen lds
    s_add_u32 s64, s64, 128
    v_and_b32 v96, 15, v0
    v_lshrrev_b32 v97, 4, v0
    s_lshl_b32 s6, s59, 14
    v_lshlrev_b32 v98, 7, v96
    v_add_u32 v98, s6, v98
    v_lshrrev_b32 v99, 1, v96
    v_xor_b32 v99, v99, v97
    v_lshl_add_u32 v1, v99, 4, v98
    v_xor_b32 v2, 64, v1
    v_bfe_u32 v98, v0, 2, 2
    v_and_b32 v99, 3, v0
    v_lshl_add_u32 v100, v97, 3, v98
    v_and_b32 v101, 1, v97
    v_lshl_or_b32 v102, v101, 2, v98
    s_lshl_b32 s6, s60, 1
    v_xor_b32 v102, s6, v102
    v_lshlrev_b32 v102, 5, v102
    v_lshl_add_u32 v102, v100, 8, v102
    v_lshl_add_u32 v102, v99, 3, v102
    v_add_u32 v3, 0x18000, v102
    v_xor_b32 v4, 32, v3
    s_and_b32 s6, s60, 1
    v_xor_b32 v101, s6, v101
    v_lshlrev_b32 v101, 5, v101
    v_lshl_add_u32 v101, v100, 6, v101
    v_lshl_add_u32 v101, v99, 3, v101
    s_lshr_b32 s6, s60, 1
    s_lshl_b32 s6, s6, 12
    s_add_u32 s6, s6, 0x10000
    v_add_u32 v5, s6, v101
    s_mov_b32 s44, s42
    s_mov_b32 s45, s43
    s_mov_b32 s69, 0x8000
    s_mov_b32 s70, 0x10000
    s_cmp_lt_u32 s57, 28
    s_cbranch_scc1 p1_FL
    s_cmp_lt_u32 s60, 2
    s_cbranch_scc1 p1_KL
    s_branch p1_VL
p1_cpro:
    s_setprio 1
    s_mov_b32 s50, 0x800
    s_mov_b32 s51, 0x20000
    s_lshl_b32 s4, s57, 2
    s_add_u32 s4, s4, s60
    s_lshl_b32 s4, s4, 1
    v_lshrrev_b32 v96, 5, v0
    v_add_u32 v96, s4, v96
    s_lshl_b32 s5, s58, 5
    v_subrev_u32 v97, s5, v96
    v_and_b32 v97, 127, v97
    v_and_b32 v96, 128, v96
    v_or_b32 v96, v96, v97
    v_bfe_u32 v97, v96, 1, 3
    v_bfe_u32 v98, v0, 2, 3
    v_xor_b32 v97, v97, v98
    v_lshlrev_b32 v96, 7, v96
    v_lshl_add_u32 v96, v97, 4, v96
    v_and_b32 v97, 3, v0
    v_lshl_add_u32 v8, v97, 2, v96
    v_and_b32 v9, 31, v0
    v_lshlrev_b32 v9, 2, v9
    v_mov_b32 v12, 0
    v_mov_b32 v13, 0
    s_mov_b32 s80, 0xffff0000
    s_mov_b32 s79, 0
    s_mov_b32 s68, 0
    s_waitcnt lgkmcnt(0)
    s_mov_b32 s48, s40
    s_mov_b32 s49, s41
    buffer_load_dword v11, v9, s[48:51], s79 offen
    s_add_u32 s79, s79, 128
    v_and_b32 v96, 15, v0
    v_lshrrev_b32 v97, 4, v0
    s_lshl_b32 s6, s59, 14
    v_lshlrev_b32 v98, 7, v96
    v_add_u32 v98, s6, v98
    v_lshrrev_b32 v99, 1, v96
    v_xor_b32 v99, v99, v97
    v_lshl_add_u32 v1, v99, 4, v98
    v_xor_b32 v2, 64, v1
    v_bfe_u32 v98, v0, 2, 2
    v_and_b32 v99, 3, v0
    v_lshl_add_u32 v100, v97, 3, v98
    v_and_b32 v101, 1, v97
    v_lshl_or_b32 v102, v101, 2, v98
    s_lshl_b32 s6, s60, 1
    v_xor_b32 v102, s6, v102
    v_lshlrev_b32 v102, 5, v102
    v_lshl_add_u32 v102, v100, 8, v102
    v_lshl_add_u32 v102, v99, 3, v102
    v_add_u32 v3, 0x18000, v102
    v_xor_b32 v4, 32, v3
    s_and_b32 s6, s60, 1
    v_xor_b32 v101, s6, v101
    v_lshlrev_b32 v101, 5, v101
    v_lshl_add_u32 v101, v100, 6, v101
    v_lshl_add_u32 v101, v99, 3, v101
    s_lshr_b32 s6, s60, 1
    s_lshl_b32 s6, s6, 12
    s_add_u32 s6, s6, 0x10000
    v_add_u32 v5, s6, v101
    s_mov_b32 s44, s42
    s_mov_b32 s45, s43
    s_mov_b32 s69, 0x8000
    s_mov_b32 s70, 0x10000
    v_mov_b32 v6, 0x7fffff00
    s_mov_b32 s73, 0
    s_mov_b32 s20, s42
    s_mov_b32 s21, s43
    s_mov_b32 s22, 0
    s_mov_b32 s23, 0x20000
    s_cmp_lg_u32 s3, 0
    s_cbranch_scc1 p1_noclr
    s_load_dwordx2 s[20:21], s[0:1], 88
    s_mov_b32 s22, 256
    s_mov_b32 s23, 0x20000
    s_lshl_b32 s4, s56, 2
    s_add_u32 s4, s4, s58
    s_lshl_b32 s4, s4, 2
    s_add_u32 s4, s4, 0x1c01f00
    v_lshl_add_u32 v7, v0, 7, s4
    s_cmp_ge_u32 s57, 28
    s_cselect_b32 s5, 34, 2
    v_mov_b32 v6, 0x7fffff00
    v_cmp_gt_u32 vcc, s5, v0
    s_lshl_b32 s4, s56, 5
    s_add_u32 s4, s4, s57
    v_cndmask_b32 v6, v6, v7, vcc
    s_lshl_b32 s4, s4, 2
    s_add_u32 s4, s4, 0x1c01000
    v_writelane_b32 v6, s4, 1
    s_and_b32 s4, s2, 7
    s_lshr_b32 s5, s2, 3
    s_lshr_b32 s6, s4, 1
    s_lshl_b32 s6, s6, 2
    s_and_b32 s7, s5, 3
    s_add_u32 s6, s6, s7
    s_and_b32 s4, s4, 1
    s_lshl_b32 s4, s4, 3
    s_lshr_b32 s5, s5, 2
    s_add_u32 s4, s4, s5
    s_lshl_b32 s6, s6, 5
    s_add_u32 s4, s4, s6
    s_lshl_b32 s4, s4, 2
    s_add_u32 s4, s4, 0x1c00000
    v_writelane_b32 v6, s4, 0
    s_lshr_b32 s73, s2, 3
    s_mul_i32 s73, s73, 6
    s_lshr_b32 s73, s73, 5
    s_add_u32 s73, s73, 1
    s_waitcnt lgkmcnt(0)
p1_noclr:
    s_cmp_lt_u32 s57, 28
    s_cbranch_scc1 p1_FC
    s_cmp_lt_u32 s60, 2
    s_cbranch_scc1 p1_KC
    s_branch p1_VC
p1_FC:
    v_lshrrev_b32 v18, 3, v0
    v_lshrrev_b32 v19, 4, v0
    v_and_b32 v20, 7, v0
    v_lshlrev_b32 v18, 11, v18
    v_xor_b32 v20, v19, v20
    v_lshl_add_u32 v16, v20, 4, v18
    v_xor_b32 v17, 64, v16
    v_add_u32 v17, 0x4000, v17
    s_lshl_b32 s4, s56, 2
    s_add_u32 s4, s4, s60
    s_lshl_b32 s4, s4, 17
    s_add_u32 s61, s4, 256
    s_add_u32 s62, s61, 0x8000
    s_add_u32 s63, s61, 0x10000
    s_add_u32 s64, s61, 0x18000
    s_lshl_b32 s71, s60, 13
    s_add_u32 s71, s71, 0x10000
    s_mov_b32 s8, s28
    s_mov_b32 s9, s29
    s_barrier
    ds_read_b128 v[96:99], v1 offset:0
    ds_read_b128 v[100:103], v2 offset:0
    ds_read_b64_tr_b16 v[32:33], v3 offset:0
    ds_read_b64_tr_b16 v[34:35], v3 offset:1024
    ds_read_b64_tr_b16 v[36:37], v3 offset:8192
    ds_read_b64_tr_b16 v[38:39], v3 offset:9216
    ds_read_b64_tr_b16 v[44:45], v4 offset:8192
    ds_read_b64_tr_b16 v[46:47], v4 offset:9216
    ds_read_b128 v[104:107], v1 offset:2048
    ds_read_b128 v[108:111], v2 offset:2048
    ds_read_b64_tr_b16 v[40:41], v4 offset:0
    ds_read_b64_tr_b16 v[42:43], v4 offset:1024
    ds_read_b64_tr_b16 v[48:49], v3 offset:16384
    ds_read_b64_tr_b16 v[50:51], v3 offset:17408
    ds_read_b64_tr_b16 v[52:53], v3 offset:24576
    ds_read_b64_tr_b16 v[54:55], v3 offset:25600
    ds_read_b128 v[112:115], v1 offset:4096
    ds_read_b128 v[116:119], v2 offset:4096
    ds_read_b64_tr_b16 v[60:61], v4 offset:24576
    ds_read_b64_tr_b16 v[62:63], v4 offset:25600
    ds_read_b64_tr_b16 v[56:57], v4 offset:16384
    ds_read_b64_tr_b16 v[58:59], v4 offset:17408
    s_mov_b32 s75, 5
    s_waitcnt lgkmcnt(15)
    v_mfma_f32_16x16x32_bf16 v[128:131], v[32:35], v[96:99], 0
    ds_read_b128 v[120:123], v1 offset:6144
    v_mfma_f32_16x16x32_bf16 v[128:131], v[36:39], v[100:103], v[128:131]
    ds_read_b128 v[124:127], v2 offset:6144
    s_waitcnt lgkmcnt(15)
    v_mfma_f32_16x16x32_bf16 v[132:135], v[44:47], v[100:103], 0
    s_waitcnt lgkmcnt(12)
    v_mfma_f32_16x16x32_bf16 v[132:135], v[40:43], v[96:99], v[132:135]
    s_waitcnt lgkmcnt(10)
    v_mfma_f32_16x16x32_bf16 v[136:139], v[48:51], v[96:99], 0
    s_waitcnt lgkmcnt(8)
    v_mfma_f32_16x16x32_bf16 v[136:139], v[52:55], v[100:103], v[136:139]
    s_waitcnt lgkmcnt(4)
    v_mfma_f32_16x16x32_bf16 v[140:143], v[60:63], v[100:103], 0
    s_waitcnt lgkmcnt(2)
    v_mfma_f32_16x16x32_bf16 v[140:143], v[56:59], v[96:99], v[140:143]
    v_mfma_f32_16x16x32_bf16 v[156:159], v[56:59], v[104:107], 0
    ds_read_b128 v[96:99], v1 offset:8192
    v_mfma_f32_16x16x32_bf16 v[156:159], v[60:63], v[108:111], v[156:159]
    ds_read_b128 v[100:103], v2 offset:8192
    v_mfma_f32_16x16x32_bf16 v[152:155], v[52:55], v[108:111], 0
    v_mfma_f32_16x16x32_bf16 v[152:155], v[48:51], v[104:107], v[152:155]
    v_mfma_f32_16x16x32_bf16 v[148:151], v[40:43], v[104:107], 0
    v_mfma_f32_16x16x32_bf16 v[148:151], v[44:47], v[108:111], v[148:151]
    v_mfma_f32_16x16x32_bf16 v[144:147], v[36:39], v[108:111], 0
    v_mfma_f32_16x16x32_bf16 v[144:147], v[32:35], v[104:107], v[144:147]
    v_mfma_f32_16x16x32_bf16 v[160:163], v[32:35], v[112:115], 0
    ds_read_b128 v[104:107], v1 offset:10240
    v_mfma_f32_16x16x32_bf16 v[160:163], v[36:39], v[116:119], v[160:163]
    ds_read_b128 v[108:111], v2 offset:10240
    v_mfma_f32_16x16x32_bf16 v[164:167], v[44:47], v[116:119], 0
    v_mfma_f32_16x16x32_bf16 v[164:167], v[40:43], v[112:115], v[164:167]
    v_mfma_f32_16x16x32_bf16 v[168:171], v[48:51], v[112:115], 0
    v_mfma_f32_16x16x32_bf16 v[168:171], v[52:55], v[116:119], v[168:171]
    v_mfma_f32_16x16x32_bf16 v[172:175], v[60:63], v[116:119], 0
    v_mfma_f32_16x16x32_bf16 v[172:175], v[56:59], v[112:115], v[172:175]
    s_waitcnt lgkmcnt(5)
    v_mfma_f32_16x16x32_bf16 v[188:191], v[56:59], v[120:123], 0
    ds_read_b128 v[112:115], v1 offset:12288
    s_waitcnt lgkmcnt(5)
    v_mfma_f32_16x16x32_bf16 v[188:191], v[60:63], v[124:127], v[188:191]
    ds_read_b128 v[116:119], v2 offset:12288
    v_mfma_f32_16x16x32_bf16 v[184:187], v[52:55], v[124:127], 0
    ds_read_b32 v10, v8 offset:0
    v_mfma_f32_16x16x32_bf16 v[184:187], v[48:51], v[120:123], v[184:187]
    v_mfma_f32_16x16x32_bf16 v[180:183], v[40:43], v[120:123], 0
    v_mfma_f32_16x16x32_bf16 v[180:183], v[44:47], v[124:127], v[180:183]
    v_mfma_f32_16x16x32_bf16 v[176:179], v[36:39], v[124:127], 0
    v_mfma_f32_16x16x32_bf16 v[176:179], v[32:35], v[120:123], v[176:179]
    s_waitcnt lgkmcnt(6)
    v_mfma_f32_16x16x32_bf16 v[192:195], v[32:35], v[96:99], 0
    ds_read_b128 v[120:123], v1 offset:14336
    s_waitcnt lgkmcnt(6)
    v_mfma_f32_16x16x32_bf16 v[192:195], v[36:39], v[100:103], v[192:195]
    ds_read_b128 v[124:127], v2 offset:14336
    v_mfma_f32_16x16x32_bf16 v[196:199], v[44:47], v[100:103], 0
    s_cmp_eq_u32 s68, s70
    s_cselect_b32 s74, 0xffff0000, s76
    v_mfma_f32_16x16x32_bf16 v[196:199], v[40:43], v[96:99], v[196:199]
    v_add_u32 v1, s74, v1
    v_mfma_f32_16x16x32_bf16 v[200:203], v[48:51], v[96:99], 0
    v_add_u32 v2, s74, v2
    v_mfma_f32_16x16x32_bf16 v[200:203], v[52:55], v[100:103], v[200:203]
    v_add_u32 v8, s74, v8
    v_mfma_f32_16x16x32_bf16 v[204:207], v[60:63], v[100:103], 0
    v_mfma_f32_16x16x32_bf16 v[204:207], v[56:59], v[96:99], v[204:207]
    s_waitcnt lgkmcnt(0)
    s_waitcnt vmcnt(0)
    v_lshlrev_b32 v14, 16, v10
    v_and_b32 v15, s80, v10
    v_lshlrev_b32 v10, 16, v11
    v_and_b32 v11, s80, v11
    v_mul_f32 v14, v14, v10
    v_mul_f32 v15, v15, v11
    v_cvt_pk_bf16_f32 v15, v14, v15
    v_lshlrev_b32 v14, 16, v15
    v_and_b32 v15, s80, v15
    v_add_f32 v12, v12, v14
    v_add_f32 v13, v13, v15
    buffer_load_dword v11, v9, s[48:51], s79 offen
    s_add_u32 s79, s79, 128
    s_lshl_b32 s4, s56, 3
    s_add_u32 s4, s4, s58
    s_lshl_b32 s4, s4, 12
    s_add_u32 s4, s4, 0x1400000
    v_and_b32 v14, 15, v0
    v_lshlrev_b32 v14, 7, v14
    v_bfe_u32 v15, v0, 4, 1
    v_lshl_add_u32 v14, v15, 14, v14
    v_add_u32 v14, s4, v14
    s_lshl_b32 s4, s56, 5
    s_add_u32 s4, s4, s57
    s_lshl_b32 s4, s4, 6
    s_add_u32 s4, s4, 0x1480000
    v_mov_b32 v15, s4
    v_cmp_gt_u32 vcc, 0, v0
    s_cmp_lg_u32 s3, 1
    s_cbranch_scc1 p1_F_nt
    v_cndmask_b32 v14, v15, v14, vcc
    buffer_load_dword v15, v14, s[44:47], 0 offen sc1
p1_F_nt:
    v_mov_b32 v7, 0
    buffer_store_dword v7, v6, s[44:47], 0 offen sc1
    s_mov_b32 m0, s71
    s_nop 0
    buffer_load_dwordx4 v16, s[8:11], s61 offen lds
    s_add_u32 m0, s71, 0x400
    s_nop 0
    buffer_load_dwordx4 v17, s[8:11], s61 offen lds
    s_add_u32 s61, s61, 128
    s_add_u32 m0, s71, 0x800
    s_nop 0
    buffer_load_dwordx4 v16, s[8:11], s62 offen lds
    s_add_u32 m0, s71, 0xc00
    s_nop 0
    buffer_load_dwordx4 v17, s[8:11], s62 offen lds
    s_add_u32 s62, s62, 128
    s_add_u32 m0, s71, 0x1000
    s_nop 0
    buffer_load_dwordx4 v16, s[8:11], s63 offen lds
    s_add_u32 m0, s71, 0x1400
    s_nop 0
    buffer_load_dwordx4 v17, s[8:11], s63 offen lds
    s_add_u32 s63, s63, 128
    s_add_u32 m0, s71, 0x1800
    s_nop 0
    buffer_load_dwordx4 v16, s[8:11], s64 offen lds
    s_add_u32 m0, s71, 0x1c00
    s_nop 0
    buffer_load_dwordx4 v17, s[8:11], s64 offen lds
    s_add_u32 s64, s64, 128
    s_add_u32 s71, s71, 0x8000
    s_cmp_ge_u32 s71, 0x18000
    s_cselect_b32 s4, 0x18000, 0
    s_sub_u32 s71, s71, s4
    s_barrier
    v_mfma_f32_16x16x32_bf16 v[220:223], v[56:59], v[104:107], 0
    ds_read_b128 v[96:99], v1 offset:0
    v_mfma_f32_16x16x32_bf16 v[220:223], v[60:63], v[108:111], v[220:223]
    ds_read_b128 v[100:103], v2 offset:0
    v_mfma_f32_16x16x32_bf16 v[216:219], v[52:55], v[108:111], 0
    ds_read_b64_tr_b16 v[64:65], v3 offset:32768
    v_mfma_f32_16x16x32_bf16 v[216:219], v[48:51], v[104:107], v[216:219]
    ds_read_b64_tr_b16 v[66:67], v3 offset:33792
    v_mfma_f32_16x16x32_bf16 v[212:215], v[40:43], v[104:107], 0
    ds_read_b64_tr_b16 v[68:69], v3 offset:40960
    v_mfma_f32_16x16x32_bf16 v[212:215], v[44:47], v[108:111], v[212:215]
    ds_read_b64_tr_b16 v[70:71], v3 offset:41984
    v_mfma_f32_16x16x32_bf16 v[208:211], v[36:39], v[108:111], 0
    ds_read_b64_tr_b16 v[76:77], v4 offset:40960
    v_mfma_f32_16x16x32_bf16 v[208:211], v[32:35], v[104:107], v[208:211]
    ds_read_b64_tr_b16 v[78:79], v4 offset:41984
    v_mfma_f32_16x16x32_bf16 v[224:227], v[32:35], v[112:115], 0
    ds_read_b128 v[104:107], v1 offset:2048
    v_mfma_f32_16x16x32_bf16 v[224:227], v[36:39], v[116:119], v[224:227]
    ds_read_b128 v[108:111], v2 offset:2048
    v_mfma_f32_16x16x32_bf16 v[228:231], v[44:47], v[116:119], 0
    ds_read_b64_tr_b16 v[72:73], v4 offset:32768
    v_mfma_f32_16x16x32_bf16 v[228:231], v[40:43], v[112:115], v[228:231]
    ds_read_b64_tr_b16 v[74:75], v4 offset:33792
    v_mfma_f32_16x16x32_bf16 v[232:235], v[48:51], v[112:115], 0
    ds_read_b64_tr_b16 v[80:81], v3 offset:49152
    v_mfma_f32_16x16x32_bf16 v[232:235], v[52:55], v[116:119], v[232:235]
    ds_read_b64_tr_b16 v[82:83], v3 offset:50176
    v_mfma_f32_16x16x32_bf16 v[236:239], v[60:63], v[116:119], 0
    ds_read_b64_tr_b16 v[84:85], v3 offset:57344
    v_mfma_f32_16x16x32_bf16 v[236:239], v[56:59], v[112:115], v[236:239]
    ds_read_b64_tr_b16 v[86:87], v3 offset:58368
    v_mfma_f32_16x16x32_bf16 v[252:255], v[56:59], v[120:123], 0
    ds_read_b128 v[112:115], v1 offset:4096
    v_mfma_f32_16x16x32_bf16 v[252:255], v[60:63], v[124:127], v[252:255]
    ds_read_b128 v[116:119], v2 offset:4096
    v_mfma_f32_16x16x32_bf16 v[248:251], v[52:55], v[124:127], 0
    ds_read_b64_tr_b16 v[92:93], v4 offset:57344
    v_mfma_f32_16x16x32_bf16 v[248:251], v[48:51], v[120:123], v[248:251]
    ds_read_b64_tr_b16 v[94:95], v4 offset:58368
    v_mfma_f32_16x16x32_bf16 v[244:247], v[40:43], v[120:123], 0
    ds_read_b64_tr_b16 v[88:89], v4 offset:49152
    v_mfma_f32_16x16x32_bf16 v[244:247], v[44:47], v[124:127], v[244:247]
    ds_read_b64_tr_b16 v[90:91], v4 offset:50176
    v_mfma_f32_16x16x32_bf16 v[240:243], v[36:39], v[124:127], 0
    s_add_u32 s68, s68, s74
    v_mfma_f32_16x16x32_bf16 v[240:243], v[32:35], v[120:123], v[240:243]
.p2align 6
p1_FC_loop:
    s_waitcnt lgkmcnt(15)
    v_mfma_f32_16x16x32_bf16 v[128:131], v[64:67], v[96:99], v[128:131]
    ds_read_b128 v[120:123], v1 offset:6144
    v_mfma_f32_16x16x32_bf16 v[128:131], v[68:71], v[100:103], v[128:131]
    ds_read_b128 v[124:127], v2 offset:6144
    s_waitcnt lgkmcnt(15)
    v_mfma_f32_16x16x32_bf16 v[132:135], v[76:79], v[100:103], v[132:135]
    s_waitcnt lgkmcnt(12)
    v_mfma_f32_16x16x32_bf16 v[132:135], v[72:75], v[96:99], v[132:135]
    s_waitcnt lgkmcnt(10)
    v_mfma_f32_16x16x32_bf16 v[136:139], v[80:83], v[96:99], v[136:139]
    s_waitcnt lgkmcnt(8)
    v_mfma_f32_16x16x32_bf16 v[136:139], v[84:87], v[100:103], v[136:139]
    s_waitcnt lgkmcnt(4)
    v_mfma_f32_16x16x32_bf16 v[140:143], v[92:95], v[100:103], v[140:143]
    s_waitcnt lgkmcnt(2)
    v_mfma_f32_16x16x32_bf16 v[140:143], v[88:91], v[96:99], v[140:143]
    v_mfma_f32_16x16x32_bf16 v[156:159], v[88:91], v[104:107], v[156:159]
    ds_read_b128 v[96:99], v1 offset:8192
    v_mfma_f32_16x16x32_bf16 v[156:159], v[92:95], v[108:111], v[156:159]
    ds_read_b128 v[100:103], v2 offset:8192
    v_mfma_f32_16x16x32_bf16 v[152:155], v[84:87], v[108:111], v[152:155]
    v_mfma_f32_16x16x32_bf16 v[152:155], v[80:83], v[104:107], v[152:155]
    v_mfma_f32_16x16x32_bf16 v[148:151], v[72:75], v[104:107], v[148:151]
    v_mfma_f32_16x16x32_bf16 v[148:151], v[76:79], v[108:111], v[148:151]
    v_mfma_f32_16x16x32_bf16 v[144:147], v[68:71], v[108:111], v[144:147]
    v_mfma_f32_16x16x32_bf16 v[144:147], v[64:67], v[104:107], v[144:147]
    v_mfma_f32_16x16x32_bf16 v[160:163], v[64:67], v[112:115], v[160:163]
    ds_read_b128 v[104:107], v1 offset:10240
    v_mfma_f32_16x16x32_bf16 v[160:163], v[68:71], v[116:119], v[160:163]
    ds_read_b128 v[108:111], v2 offset:10240
    v_mfma_f32_16x16x32_bf16 v[164:167], v[76:79], v[116:119], v[164:167]
    v_mfma_f32_16x16x32_bf16 v[164:167], v[72:75], v[112:115], v[164:167]
    v_mfma_f32_16x16x32_bf16 v[168:171], v[80:83], v[112:115], v[168:171]
    v_mfma_f32_16x16x32_bf16 v[168:171], v[84:87], v[116:119], v[168:171]
    v_mfma_f32_16x16x32_bf16 v[172:175], v[92:95], v[116:119], v[172:175]
    v_mfma_f32_16x16x32_bf16 v[172:175], v[88:91], v[112:115], v[172:175]
    s_waitcnt lgkmcnt(5)
    v_mfma_f32_16x16x32_bf16 v[188:191], v[88:91], v[120:123], v[188:191]
    ds_read_b128 v[112:115], v1 offset:12288
    s_waitcnt lgkmcnt(5)
    v_mfma_f32_16x16x32_bf16 v[188:191], v[92:95], v[124:127], v[188:191]
    ds_read_b128 v[116:119], v2 offset:12288
    v_mfma_f32_16x16x32_bf16 v[184:187], v[84:87], v[124:127], v[184:187]
    ds_read_b32 v10, v8 offset:0
    v_mfma_f32_16x16x32_bf16 v[184:187], v[80:83], v[120:123], v[184:187]
    v_mfma_f32_16x16x32_bf16 v[180:183], v[72:75], v[120:123], v[180:183]
    v_mfma_f32_16x16x32_bf16 v[180:183], v[76:79], v[124:127], v[180:183]
    v_mfma_f32_16x16x32_bf16 v[176:179], v[68:71], v[124:127], v[176:179]
    v_mfma_f32_16x16x32_bf16 v[176:179], v[64:67], v[120:123], v[176:179]
    s_waitcnt lgkmcnt(6)
    v_mfma_f32_16x16x32_bf16 v[192:195], v[64:67], v[96:99], v[192:195]
    ds_read_b128 v[120:123], v1 offset:14336
    s_waitcnt lgkmcnt(6)
    v_mfma_f32_16x16x32_bf16 v[192:195], v[68:71], v[100:103], v[192:195]
    ds_read_b128 v[124:127], v2 offset:14336
    v_mfma_f32_16x16x32_bf16 v[196:199], v[76:79], v[100:103], v[196:199]
    s_cmp_eq_u32 s68, s70
    s_cselect_b32 s74, 0xffff0000, s76
    v_mfma_f32_16x16x32_bf16 v[196:199], v[72:75], v[96:99], v[196:199]
    v_add_u32 v1, s74, v1
    v_mfma_f32_16x16x32_bf16 v[200:203], v[80:83], v[96:99], v[200:203]
    v_add_u32 v2, s74, v2
    v_mfma_f32_16x16x32_bf16 v[200:203], v[84:87], v[100:103], v[200:203]
    v_add_u32 v8, s74, v8
    v_mfma_f32_16x16x32_bf16 v[204:207], v[92:95], v[100:103], v[204:207]
    v_mfma_f32_16x16x32_bf16 v[204:207], v[88:91], v[96:99], v[204:207]
    s_waitcnt lgkmcnt(0)
    s_waitcnt vmcnt(0)
    v_lshlrev_b32 v14, 16, v10
    v_and_b32 v15, s80, v10
    v_lshlrev_b32 v10, 16, v11
    v_and_b32 v11, s80, v11
    v_mul_f32 v14, v14, v10
    v_mul_f32 v15, v15, v11
    v_cvt_pk_bf16_f32 v15, v14, v15
    v_lshlrev_b32 v14, 16, v15
    v_and_b32 v15, s80, v15
    v_add_f32 v12, v12, v14
    v_add_f32 v13, v13, v15
    buffer_load_dword v11, v9, s[48:51], s79 offen
    s_add_u32 s79, s79, 128
    s_sub_u32 s73, s73, 1
    s_cmp_lg_u32 s73, 0
    s_cbranch_scc1 p1_F_nb
    v_mov_b32 v14, 1
    v_mov_b32 v15, 0
    s_mov_b64 exec, 1
    buffer_store_byte v14, v15, s[20:23], s2 offen sc1
    s_mov_b64 exec, -1
p1_F_nb:
    s_mov_b32 m0, s71
    s_nop 0
    buffer_load_dwordx4 v16, s[8:11], s61 offen lds
    s_add_u32 m0, s71, 0x400
    s_nop 0
    buffer_load_dwordx4 v17, s[8:11], s61 offen lds
    s_add_u32 s61, s61, 128
    s_add_u32 m0, s71, 0x800
    s_nop 0
    buffer_load_dwordx4 v16, s[8:11], s62 offen lds
    s_add_u32 m0, s71, 0xc00
    s_nop 0
    buffer_load_dwordx4 v17, s[8:11], s62 offen lds
    s_add_u32 s62, s62, 128
    s_add_u32 m0, s71, 0x1000
    s_nop 0
    buffer_load_dwordx4 v16, s[8:11], s63 offen lds
    s_add_u32 m0, s71, 0x1400
    s_nop 0
    buffer_load_dwordx4 v17, s[8:11], s63 offen lds
    s_add_u32 s63, s63, 128
    s_add_u32 m0, s71, 0x1800
    s_nop 0
    buffer_load_dwordx4 v16, s[8:11], s64 offen lds
    s_add_u32 m0, s71, 0x1c00
    s_nop 0
    buffer_load_dwordx4 v17, s[8:11], s64 offen lds
    s_add_u32 s64, s64, 128
    s_add_u32 s71, s71, 0x8000
    s_cmp_ge_u32 s71, 0x18000
    s_cselect_b32 s4, 0x18000, 0
    s_sub_u32 s71, s71, s4
    s_barrier
    v_mfma_f32_16x16x32_bf16 v[220:223], v[88:91], v[104:107], v[220:223]
    ds_read_b128 v[96:99], v1 offset:0
    v_mfma_f32_16x16x32_bf16 v[220:223], v[92:95], v[108:111], v[220:223]
    ds_read_b128 v[100:103], v2 offset:0
    v_mfma_f32_16x16x32_bf16 v[216:219], v[84:87], v[108:111], v[216:219]
    ds_read_b64_tr_b16 v[32:33], v3 offset:0
    v_mfma_f32_16x16x32_bf16 v[216:219], v[80:83], v[104:107], v[216:219]
    ds_read_b64_tr_b16 v[34:35], v3 offset:1024
    v_mfma_f32_16x16x32_bf16 v[212:215], v[72:75], v[104:107], v[212:215]
    ds_read_b64_tr_b16 v[36:37], v3 offset:8192
    v_mfma_f32_16x16x32_bf16 v[212:215], v[76:79], v[108:111], v[212:215]
    ds_read_b64_tr_b16 v[38:39], v3 offset:9216
    v_mfma_f32_16x16x32_bf16 v[208:211], v[68:71], v[108:111], v[208:211]
    ds_read_b64_tr_b16 v[44:45], v4 offset:8192
    v_mfma_f32_16x16x32_bf16 v[208:211], v[64:67], v[104:107], v[208:211]
    ds_read_b64_tr_b16 v[46:47], v4 offset:9216
    v_mfma_f32_16x16x32_bf16 v[224:227], v[64:67], v[112:115], v[224:227]
    ds_read_b128 v[104:107], v1 offset:2048
    v_mfma_f32_16x16x32_bf16 v[224:227], v[68:71], v[116:119], v[224:227]
    ds_read_b128 v[108:111], v2 offset:2048
    v_mfma_f32_16x16x32_bf16 v[228:231], v[76:79], v[116:119], v[228:231]
    ds_read_b64_tr_b16 v[40:41], v4 offset:0
    v_mfma_f32_16x16x32_bf16 v[228:231], v[72:75], v[112:115], v[228:231]
    ds_read_b64_tr_b16 v[42:43], v4 offset:1024
    v_mfma_f32_16x16x32_bf16 v[232:235], v[80:83], v[112:115], v[232:235]
    ds_read_b64_tr_b16 v[48:49], v3 offset:16384
    v_mfma_f32_16x16x32_bf16 v[232:235], v[84:87], v[116:119], v[232:235]
    ds_read_b64_tr_b16 v[50:51], v3 offset:17408
    v_mfma_f32_16x16x32_bf16 v[236:239], v[92:95], v[116:119], v[236:239]
    ds_read_b64_tr_b16 v[52:53], v3 offset:24576
    v_mfma_f32_16x16x32_bf16 v[236:239], v[88:91], v[112:115], v[236:239]
    ds_read_b64_tr_b16 v[54:55], v3 offset:25600
    v_mfma_f32_16x16x32_bf16 v[252:255], v[88:91], v[120:123], v[252:255]
    ds_read_b128 v[112:115], v1 offset:4096
    v_mfma_f32_16x16x32_bf16 v[252:255], v[92:95], v[124:127], v[252:255]
    ds_read_b128 v[116:119], v2 offset:4096
    v_mfma_f32_16x16x32_bf16 v[248:251], v[84:87], v[124:127], v[248:251]
    ds_read_b64_tr_b16 v[60:61], v4 offset:24576
    v_mfma_f32_16x16x32_bf16 v[248:251], v[80:83], v[120:123], v[248:251]
    ds_read_b64_tr_b16 v[62:63], v4 offset:25600
    v_mfma_f32_16x16x32_bf16 v[244:247], v[72:75], v[120:123], v[244:247]
    ds_read_b64_tr_b16 v[56:57], v4 offset:16384
    v_mfma_f32_16x16x32_bf16 v[244:247], v[76:79], v[124:127], v[244:247]
    ds_read_b64_tr_b16 v[58:59], v4 offset:17408
    v_mfma_f32_16x16x32_bf16 v[240:243], v[68:71], v[124:127], v[240:243]
    s_add_u32 s68, s68, s74
    v_mfma_f32_16x16x32_bf16 v[240:243], v[64:67], v[120:123], v[240:243]
    s_waitcnt lgkmcnt(15)
    v_mfma_f32_16x16x32_bf16 v[128:131], v[32:35], v[96:99], v[128:131]
    ds_read_b128 v[120:123], v1 offset:6144
    v_mfma_f32_16x16x32_bf16 v[128:131], v[36:39], v[100:103], v[128:131]
    ds_read_b128 v[124:127], v2 offset:6144
    s_waitcnt lgkmcnt(15)
    v_mfma_f32_16x16x32_bf16 v[132:135], v[44:47], v[100:103], v[132:135]
    s_waitcnt lgkmcnt(12)
    v_mfma_f32_16x16x32_bf16 v[132:135], v[40:43], v[96:99], v[132:135]
    s_waitcnt lgkmcnt(10)
    v_mfma_f32_16x16x32_bf16 v[136:139], v[48:51], v[96:99], v[136:139]
    s_waitcnt lgkmcnt(8)
    v_mfma_f32_16x16x32_bf16 v[136:139], v[52:55], v[100:103], v[136:139]
    s_waitcnt lgkmcnt(4)
    v_mfma_f32_16x16x32_bf16 v[140:143], v[60:63], v[100:103], v[140:143]
    s_waitcnt lgkmcnt(2)
    v_mfma_f32_16x16x32_bf16 v[140:143], v[56:59], v[96:99], v[140:143]
    v_mfma_f32_16x16x32_bf16 v[156:159], v[56:59], v[104:107], v[156:159]
    ds_read_b128 v[96:99], v1 offset:8192
    v_mfma_f32_16x16x32_bf16 v[156:159], v[60:63], v[108:111], v[156:159]
    ds_read_b128 v[100:103], v2 offset:8192
    v_mfma_f32_16x16x32_bf16 v[152:155], v[52:55], v[108:111], v[152:155]
    v_mfma_f32_16x16x32_bf16 v[152:155], v[48:51], v[104:107], v[152:155]
    v_mfma_f32_16x16x32_bf16 v[148:151], v[40:43], v[104:107], v[148:151]
    v_mfma_f32_16x16x32_bf16 v[148:151], v[44:47], v[108:111], v[148:151]
    v_mfma_f32_16x16x32_bf16 v[144:147], v[36:39], v[108:111], v[144:147]
    v_mfma_f32_16x16x32_bf16 v[144:147], v[32:35], v[104:107], v[144:147]
    v_mfma_f32_16x16x32_bf16 v[160:163], v[32:35], v[112:115], v[160:163]
    ds_read_b128 v[104:107], v1 offset:10240
    v_mfma_f32_16x16x32_bf16 v[160:163], v[36:39], v[116:119], v[160:163]
    ds_read_b128 v[108:111], v2 offset:10240
    v_mfma_f32_16x16x32_bf16 v[164:167], v[44:47], v[116:119], v[164:167]
    v_mfma_f32_16x16x32_bf16 v[164:167], v[40:43], v[112:115], v[164:167]
    v_mfma_f32_16x16x32_bf16 v[168:171], v[48:51], v[112:115], v[168:171]
    v_mfma_f32_16x16x32_bf16 v[168:171], v[52:55], v[116:119], v[168:171]
    v_mfma_f32_16x16x32_bf16 v[172:175], v[60:63], v[116:119], v[172:175]
    v_mfma_f32_16x16x32_bf16 v[172:175], v[56:59], v[112:115], v[172:175]
    s_waitcnt lgkmcnt(5)
    v_mfma_f32_16x16x32_bf16 v[188:191], v[56:59], v[120:123], v[188:191]
    ds_read_b128 v[112:115], v1 offset:12288
    s_waitcnt lgkmcnt(5)
    v_mfma_f32_16x16x32_bf16 v[188:191], v[60:63], v[124:127], v[188:191]
    ds_read_b128 v[116:119], v2 offset:12288
    v_mfma_f32_16x16x32_bf16 v[184:187], v[52:55], v[124:127], v[184:187]
    ds_read_b32 v10, v8 offset:0
    v_mfma_f32_16x16x32_bf16 v[184:187], v[48:51], v[120:123], v[184:187]
    v_mfma_f32_16x16x32_bf16 v[180:183], v[40:43], v[120:123], v[180:183]
    v_mfma_f32_16x16x32_bf16 v[180:183], v[44:47], v[124:127], v[180:183]
    v_mfma_f32_16x16x32_bf16 v[176:179], v[36:39], v[124:127], v[176:179]
    v_mfma_f32_16x16x32_bf16 v[176:179], v[32:35], v[120:123], v[176:179]
    s_waitcnt lgkmcnt(6)
    v_mfma_f32_16x16x32_bf16 v[192:195], v[32:35], v[96:99], v[192:195]
    ds_read_b128 v[120:123], v1 offset:14336
    s_waitcnt lgkmcnt(6)
    v_mfma_f32_16x16x32_bf16 v[192:195], v[36:39], v[100:103], v[192:195]
    ds_read_b128 v[124:127], v2 offset:14336
    v_mfma_f32_16x16x32_bf16 v[196:199], v[44:47], v[100:103], v[196:199]
    s_cmp_eq_u32 s68, s70
    s_cselect_b32 s74, 0xffff0000, s76
    v_mfma_f32_16x16x32_bf16 v[196:199], v[40:43], v[96:99], v[196:199]
    v_add_u32 v1, s74, v1
    v_mfma_f32_16x16x32_bf16 v[200:203], v[48:51], v[96:99], v[200:203]
    v_add_u32 v2, s74, v2
    v_mfma_f32_16x16x32_bf16 v[200:203], v[52:55], v[100:103], v[200:203]
    v_add_u32 v8, s74, v8
    v_mfma_f32_16x16x32_bf16 v[204:207], v[60:63], v[100:103], v[204:207]
    v_mfma_f32_16x16x32_bf16 v[204:207], v[56:59], v[96:99], v[204:207]
    s_waitcnt lgkmcnt(0)
    s_waitcnt vmcnt(0)
    v_lshlrev_b32 v14, 16, v10
    v_and_b32 v15, s80, v10
    v_lshlrev_b32 v10, 16, v11
    v_and_b32 v11, s80, v11
    v_mul_f32 v14, v14, v10
    v_mul_f32 v15, v15, v11
    v_cvt_pk_bf16_f32 v15, v14, v15
    v_lshlrev_b32 v14, 16, v15
    v_and_b32 v15, s80, v15
    v_add_f32 v12, v12, v14
    v_add_f32 v13, v13, v15
    buffer_load_dword v11, v9, s[48:51], s79 offen
    s_add_u32 s79, s79, 128
    s_mov_b32 m0, s71
    s_nop 0
    buffer_load_dwordx4 v16, s[8:11], s61 offen lds
    s_add_u32 m0, s71, 0x400
    s_nop 0
    buffer_load_dwordx4 v17, s[8:11], s61 offen lds
    s_add_u32 s61, s61, 128
    s_add_u32 m0, s71, 0x800
    s_nop 0
    buffer_load_dwordx4 v16, s[8:11], s62 offen lds
    s_add_u32 m0, s71, 0xc00
    s_nop 0
    buffer_load_dwordx4 v17, s[8:11], s62 offen lds
    s_add_u32 s62, s62, 128
    s_add_u32 m0, s71, 0x1000
    s_nop 0
    buffer_load_dwordx4 v16, s[8:11], s63 offen lds
    s_add_u32 m0, s71, 0x1400
    s_nop 0
    buffer_load_dwordx4 v17, s[8:11], s63 offen lds
    s_add_u32 s63, s63, 128
    s_add_u32 m0, s71, 0x1800
    s_nop 0
    buffer_load_dwordx4 v16, s[8:11], s64 offen lds
    s_add_u32 m0, s71, 0x1c00
    s_nop 0
    buffer_load_dwordx4 v17, s[8:11], s64 offen lds
    s_add_u32 s64, s64, 128
    s_add_u32 s71, s71, 0x8000
    s_cmp_ge_u32 s71, 0x18000
    s_cselect_b32 s4, 0x18000, 0
    s_sub_u32 s71, s71, s4
    s_barrier
    v_mfma_f32_16x16x32_bf16 v[220:223], v[56:59], v[104:107], v[220:223]
    ds_read_b128 v[96:99], v1 offset:0
    v_mfma_f32_16x16x32_bf16 v[220:223], v[60:63], v[108:111], v[220:223]
    ds_read_b128 v[100:103], v2 offset:0
    v_mfma_f32_16x16x32_bf16 v[216:219], v[52:55], v[108:111], v[216:219]
    ds_read_b64_tr_b16 v[64:65], v3 offset:32768
    v_mfma_f32_16x16x32_bf16 v[216:219], v[48:51], v[104:107], v[216:219]
    ds_read_b64_tr_b16 v[66:67], v3 offset:33792
    v_mfma_f32_16x16x32_bf16 v[212:215], v[40:43], v[104:107], v[212:215]
    ds_read_b64_tr_b16 v[68:69], v3 offset:40960
    v_mfma_f32_16x16x32_bf16 v[212:215], v[44:47], v[108:111], v[212:215]
    ds_read_b64_tr_b16 v[70:71], v3 offset:41984
    v_mfma_f32_16x16x32_bf16 v[208:211], v[36:39], v[108:111], v[208:211]
    ds_read_b64_tr_b16 v[76:77], v4 offset:40960
    v_mfma_f32_16x16x32_bf16 v[208:211], v[32:35], v[104:107], v[208:211]
    ds_read_b64_tr_b16 v[78:79], v4 offset:41984
    v_mfma_f32_16x16x32_bf16 v[224:227], v[32:35], v[112:115], v[224:227]
    ds_read_b128 v[104:107], v1 offset:2048
    v_mfma_f32_16x16x32_bf16 v[224:227], v[36:39], v[116:119], v[224:227]
    ds_read_b128 v[108:111], v2 offset:2048
    v_mfma_f32_16x16x32_bf16 v[228:231], v[44:47], v[116:119], v[228:231]
    ds_read_b64_tr_b16 v[72:73], v4 offset:32768
    v_mfma_f32_16x16x32_bf16 v[228:231], v[40:43], v[112:115], v[228:231]
    ds_read_b64_tr_b16 v[74:75], v4 offset:33792
    v_mfma_f32_16x16x32_bf16 v[232:235], v[48:51], v[112:115], v[232:235]
    ds_read_b64_tr_b16 v[80:81], v3 offset:49152
    v_mfma_f32_16x16x32_bf16 v[232:235], v[52:55], v[116:119], v[232:235]
    ds_read_b64_tr_b16 v[82:83], v3 offset:50176
    v_mfma_f32_16x16x32_bf16 v[236:239], v[60:63], v[116:119], v[236:239]
    ds_read_b64_tr_b16 v[84:85], v3 offset:57344
    v_mfma_f32_16x16x32_bf16 v[236:239], v[56:59], v[112:115], v[236:239]
    ds_read_b64_tr_b16 v[86:87], v3 offset:58368
    v_mfma_f32_16x16x32_bf16 v[252:255], v[56:59], v[120:123], v[252:255]
    ds_read_b128 v[112:115], v1 offset:4096
    v_mfma_f32_16x16x32_bf16 v[252:255], v[60:63], v[124:127], v[252:255]
    ds_read_b128 v[116:119], v2 offset:4096
    v_mfma_f32_16x16x32_bf16 v[248:251], v[52:55], v[124:127], v[248:251]
    ds_read_b64_tr_b16 v[92:93], v4 offset:57344
    v_mfma_f32_16x16x32_bf16 v[248:251], v[48:51], v[120:123], v[248:251]
    ds_read_b64_tr_b16 v[94:95], v4 offset:58368
    v_mfma_f32_16x16x32_bf16 v[244:247], v[40:43], v[120:123], v[244:247]
    ds_read_b64_tr_b16 v[88:89], v4 offset:49152
    v_mfma_f32_16x16x32_bf16 v[244:247], v[44:47], v[124:127], v[244:247]
    ds_read_b64_tr_b16 v[90:91], v4 offset:50176
    v_mfma_f32_16x16x32_bf16 v[240:243], v[36:39], v[124:127], v[240:243]
    s_add_u32 s68, s68, s74
    v_mfma_f32_16x16x32_bf16 v[240:243], v[32:35], v[120:123], v[240:243]
    s_sub_u32 s75, s75, 1
    s_cbranch_scc0 p1_FC_loop
    s_waitcnt lgkmcnt(15)
    v_mfma_f32_16x16x32_bf16 v[128:131], v[64:67], v[96:99], v[128:131]
    ds_read_b128 v[120:123], v1 offset:6144
    v_mfma_f32_16x16x32_bf16 v[128:131], v[68:71], v[100:103], v[128:131]
    ds_read_b128 v[124:127], v2 offset:6144
    s_waitcnt lgkmcnt(15)
    v_mfma_f32_16x16x32_bf16 v[132:135], v[76:79], v[100:103], v[132:135]
    s_waitcnt lgkmcnt(12)
    v_mfma_f32_16x16x32_bf16 v[132:135], v[72:75], v[96:99], v[132:135]
    s_waitcnt lgkmcnt(10)
    v_mfma_f32_16x16x32_bf16 v[136:139], v[80:83], v[96:99], v[136:139]
    s_waitcnt lgkmcnt(8)
    v_mfma_f32_16x16x32_bf16 v[136:139], v[84:87], v[100:103], v[136:139]
    s_waitcnt lgkmcnt(4)
    v_mfma_f32_16x16x32_bf16 v[140:143], v[92:95], v[100:103], v[140:143]
    s_waitcnt lgkmcnt(2)
    v_mfma_f32_16x16x32_bf16 v[140:143], v[88:91], v[96:99], v[140:143]
    v_mfma_f32_16x16x32_bf16 v[156:159], v[88:91], v[104:107], v[156:159]
    ds_read_b128 v[96:99], v1 offset:8192
    v_mfma_f32_16x16x32_bf16 v[156:159], v[92:95], v[108:111], v[156:159]
    ds_read_b128 v[100:103], v2 offset:8192
    v_mfma_f32_16x16x32_bf16 v[152:155], v[84:87], v[108:111], v[152:155]
    v_mfma_f32_16x16x32_bf16 v[152:155], v[80:83], v[104:107], v[152:155]
    v_mfma_f32_16x16x32_bf16 v[148:151], v[72:75], v[104:107], v[148:151]
    v_mfma_f32_16x16x32_bf16 v[148:151], v[76:79], v[108:111], v[148:151]
    v_mfma_f32_16x16x32_bf16 v[144:147], v[68:71], v[108:111], v[144:147]
    v_mfma_f32_16x16x32_bf16 v[144:147], v[64:67], v[104:107], v[144:147]
    v_mfma_f32_16x16x32_bf16 v[160:163], v[64:67], v[112:115], v[160:163]
    ds_read_b128 v[104:107], v1 offset:10240
    v_mfma_f32_16x16x32_bf16 v[160:163], v[68:71], v[116:119], v[160:163]
    ds_read_b128 v[108:111], v2 offset:10240
    v_mfma_f32_16x16x32_bf16 v[164:167], v[76:79], v[116:119], v[164:167]
    v_mfma_f32_16x16x32_bf16 v[164:167], v[72:75], v[112:115], v[164:167]
    v_mfma_f32_16x16x32_bf16 v[168:171], v[80:83], v[112:115], v[168:171]
    v_mfma_f32_16x16x32_bf16 v[168:171], v[84:87], v[116:119], v[168:171]
    v_mfma_f32_16x16x32_bf16 v[172:175], v[92:95], v[116:119], v[172:175]
    v_mfma_f32_16x16x32_bf16 v[172:175], v[88:91], v[112:115], v[172:175]
    s_waitcnt lgkmcnt(5)
    v_mfma_f32_16x16x32_bf16 v[188:191], v[88:91], v[120:123], v[188:191]
    ds_read_b128 v[112:115], v1 offset:12288
    s_waitcnt lgkmcnt(5)
    v_mfma_f32_16x16x32_bf16 v[188:191], v[92:95], v[124:127], v[188:191]
    ds_read_b128 v[116:119], v2 offset:12288
    v_mfma_f32_16x16x32_bf16 v[184:187], v[84:87], v[124:127], v[184:187]
    ds_read_b32 v10, v8 offset:0
    v_mfma_f32_16x16x32_bf16 v[184:187], v[80:83], v[120:123], v[184:187]
    v_mfma_f32_16x16x32_bf16 v[180:183], v[72:75], v[120:123], v[180:183]
    v_mfma_f32_16x16x32_bf16 v[180:183], v[76:79], v[124:127], v[180:183]
    v_mfma_f32_16x16x32_bf16 v[176:179], v[68:71], v[124:127], v[176:179]
    v_mfma_f32_16x16x32_bf16 v[176:179], v[64:67], v[120:123], v[176:179]
    s_waitcnt lgkmcnt(6)
    v_mfma_f32_16x16x32_bf16 v[192:195], v[64:67], v[96:99], v[192:195]
    ds_read_b128 v[120:123], v1 offset:14336
    s_waitcnt lgkmcnt(6)
    v_mfma_f32_16x16x32_bf16 v[192:195], v[68:71], v[100:103], v[192:195]
    ds_read_b128 v[124:127], v2 offset:14336
    v_mfma_f32_16x16x32_bf16 v[196:199], v[76:79], v[100:103], v[196:199]
    s_cmp_eq_u32 s68, s70
    s_cselect_b32 s74, 0xffff0000, s76
    v_mfma_f32_16x16x32_bf16 v[196:199], v[72:75], v[96:99], v[196:199]
    v_add_u32 v1, s74, v1
    v_mfma_f32_16x16x32_bf16 v[200:203], v[80:83], v[96:99], v[200:203]
    v_add_u32 v2, s74, v2
    v_mfma_f32_16x16x32_bf16 v[200:203], v[84:87], v[100:103], v[200:203]
    v_add_u32 v8, s74, v8
    v_mfma_f32_16x16x32_bf16 v[204:207], v[92:95], v[100:103], v[204:207]
    v_mfma_f32_16x16x32_bf16 v[204:207], v[88:91], v[96:99], v[204:207]
    s_waitcnt lgkmcnt(0)
    s_waitcnt vmcnt(0)
    v_lshlrev_b32 v14, 16, v10
    v_and_b32 v15, s80, v10
    v_lshlrev_b32 v10, 16, v11
    v_and_b32 v11, s80, v11
    v_mul_f32 v14, v14, v10
    v_mul_f32 v15, v15, v11
    v_cvt_pk_bf16_f32 v15, v14, v15
    v_lshlrev_b32 v14, 16, v15
    v_and_b32 v15, s80, v15
    v_add_f32 v12, v12, v14
    v_add_f32 v13, v13, v15
    buffer_load_dword v11, v9, s[48:51], s79 offen
    s_add_u32 s79, s79, 128
    s_mov_b32 m0, s71
    s_nop 0
    buffer_load_dwordx4 v16, s[8:11], s61 offen lds
    s_add_u32 m0, s71, 0x400
    s_nop 0
    buffer_load_dwordx4 v17, s[8:11], s61 offen lds
    s_add_u32 s61, s61, 128
    s_add_u32 m0, s71, 0x800
    s_nop 0
    buffer_load_dwordx4 v16, s[8:11], s62 offen lds
    s_add_u32 m0, s71, 0xc00
    s_nop 0
    buffer_load_dwordx4 v17, s[8:11], s62 offen lds
    s_add_u32 s62, s62, 128
    s_add_u32 m0, s71, 0x1000
    s_nop 0
    buffer_load_dwordx4 v16, s[8:11], s63 offen lds
    s_add_u32 m0, s71, 0x1400
    s_nop 0
    buffer_load_dwordx4 v17, s[8:11], s63 offen lds
    s_add_u32 s63, s63, 128
    s_add_u32 m0, s71, 0x1800
    s_nop 0
    buffer_load_dwordx4 v16, s[8:11], s64 offen lds
    s_add_u32 m0, s71, 0x1c00
    s_nop 0
    buffer_load_dwordx4 v17, s[8:11], s64 offen lds
    s_add_u32 s64, s64, 128
    s_add_u32 s71, s71, 0x8000
    s_cmp_ge_u32 s71, 0x18000
    s_cselect_b32 s4, 0x18000, 0
    s_sub_u32 s71, s71, s4
    s_barrier
    v_mfma_f32_16x16x32_bf16 v[220:223], v[88:91], v[104:107], v[220:223]
    ds_read_b128 v[96:99], v1 offset:0
    v_mfma_f32_16x16x32_bf16 v[220:223], v[92:95], v[108:111], v[220:223]
    ds_read_b128 v[100:103], v2 offset:0
    v_mfma_f32_16x16x32_bf16 v[216:219], v[84:87], v[108:111], v[216:219]
    ds_read_b64_tr_b16 v[32:33], v3 offset:0
    v_mfma_f32_16x16x32_bf16 v[216:219], v[80:83], v[104:107], v[216:219]
    ds_read_b64_tr_b16 v[34:35], v3 offset:1024
    v_mfma_f32_16x16x32_bf16 v[212:215], v[72:75], v[104:107], v[212:215]
    ds_read_b64_tr_b16 v[36:37], v3 offset:8192
    v_mfma_f32_16x16x32_bf16 v[212:215], v[76:79], v[108:111], v[212:215]
    ds_read_b64_tr_b16 v[38:39], v3 offset:9216
    v_mfma_f32_16x16x32_bf16 v[208:211], v[68:71], v[108:111], v[208:211]
    ds_read_b64_tr_b16 v[44:45], v4 offset:8192
    v_mfma_f32_16x16x32_bf16 v[208:211], v[64:67], v[104:107], v[208:211]
    ds_read_b64_tr_b16 v[46:47], v4 offset:9216
    v_mfma_f32_16x16x32_bf16 v[224:227], v[64:67], v[112:115], v[224:227]
    ds_read_b128 v[104:107], v1 offset:2048
    v_mfma_f32_16x16x32_bf16 v[224:227], v[68:71], v[116:119], v[224:227]
    ds_read_b128 v[108:111], v2 offset:2048
    v_mfma_f32_16x16x32_bf16 v[228:231], v[76:79], v[116:119], v[228:231]
    ds_read_b64_tr_b16 v[40:41], v4 offset:0
    v_mfma_f32_16x16x32_bf16 v[228:231], v[72:75], v[112:115], v[228:231]
    ds_read_b64_tr_b16 v[42:43], v4 offset:1024
    v_mfma_f32_16x16x32_bf16 v[232:235], v[80:83], v[112:115], v[232:235]
    ds_read_b64_tr_b16 v[48:49], v3 offset:16384
    v_mfma_f32_16x16x32_bf16 v[232:235], v[84:87], v[116:119], v[232:235]
    ds_read_b64_tr_b16 v[50:51], v3 offset:17408
    v_mfma_f32_16x16x32_bf16 v[236:239], v[92:95], v[116:119], v[236:239]
    ds_read_b64_tr_b16 v[52:53], v3 offset:24576
    v_mfma_f32_16x16x32_bf16 v[236:239], v[88:91], v[112:115], v[236:239]
    ds_read_b64_tr_b16 v[54:55], v3 offset:25600
    v_mfma_f32_16x16x32_bf16 v[252:255], v[88:91], v[120:123], v[252:255]
    ds_read_b128 v[112:115], v1 offset:4096
    v_mfma_f32_16x16x32_bf16 v[252:255], v[92:95], v[124:127], v[252:255]
    ds_read_b128 v[116:119], v2 offset:4096
    v_mfma_f32_16x16x32_bf16 v[248:251], v[84:87], v[124:127], v[248:251]
    ds_read_b64_tr_b16 v[60:61], v4 offset:24576
    v_mfma_f32_16x16x32_bf16 v[248:251], v[80:83], v[120:123], v[248:251]
    ds_read_b64_tr_b16 v[62:63], v4 offset:25600
    v_mfma_f32_16x16x32_bf16 v[244:247], v[72:75], v[120:123], v[244:247]
    ds_read_b64_tr_b16 v[56:57], v4 offset:16384
    v_mfma_f32_16x16x32_bf16 v[244:247], v[76:79], v[124:127], v[244:247]
    ds_read_b64_tr_b16 v[58:59], v4 offset:17408
    v_mfma_f32_16x16x32_bf16 v[240:243], v[68:71], v[124:127], v[240:243]
    s_add_u32 s68, s68, s74
    v_mfma_f32_16x16x32_bf16 v[240:243], v[64:67], v[120:123], v[240:243]
    s_waitcnt lgkmcnt(15)
    v_mfma_f32_16x16x32_bf16 v[128:131], v[32:35], v[96:99], v[128:131]
    ds_read_b128 v[120:123], v1 offset:6144
    v_mfma_f32_16x16x32_bf16 v[128:131], v[36:39], v[100:103], v[128:131]
    ds_read_b128 v[124:127], v2 offset:6144
    s_waitcnt lgkmcnt(15)
    v_mfma_f32_16x16x32_bf16 v[132:135], v[44:47], v[100:103], v[132:135]
    s_waitcnt lgkmcnt(12)
    v_mfma_f32_16x16x32_bf16 v[132:135], v[40:43], v[96:99], v[132:135]
    s_waitcnt lgkmcnt(10)
    v_mfma_f32_16x16x32_bf16 v[136:139], v[48:51], v[96:99], v[136:139]
    s_waitcnt lgkmcnt(8)
    v_mfma_f32_16x16x32_bf16 v[136:139], v[52:55], v[100:103], v[136:139]
    s_waitcnt lgkmcnt(4)
    v_mfma_f32_16x16x32_bf16 v[140:143], v[60:63], v[100:103], v[140:143]
    s_waitcnt lgkmcnt(2)
    v_mfma_f32_16x16x32_bf16 v[140:143], v[56:59], v[96:99], v[140:143]
    v_mfma_f32_16x16x32_bf16 v[156:159], v[56:59], v[104:107], v[156:159]
    ds_read_b128 v[96:99], v1 offset:8192
    v_mfma_f32_16x16x32_bf16 v[156:159], v[60:63], v[108:111], v[156:159]
    ds_read_b128 v[100:103], v2 offset:8192
    v_mfma_f32_16x16x32_bf16 v[152:155], v[52:55], v[108:111], v[152:155]
    v_mfma_f32_16x16x32_bf16 v[152:155], v[48:51], v[104:107], v[152:155]
    v_mfma_f32_16x16x32_bf16 v[148:151], v[40:43], v[104:107], v[148:151]
    v_mfma_f32_16x16x32_bf16 v[148:151], v[44:47], v[108:111], v[148:151]
    v_mfma_f32_16x16x32_bf16 v[144:147], v[36:39], v[108:111], v[144:147]
    v_mfma_f32_16x16x32_bf16 v[144:147], v[32:35], v[104:107], v[144:147]
    v_mfma_f32_16x16x32_bf16 v[160:163], v[32:35], v[112:115], v[160:163]
    ds_read_b128 v[104:107], v1 offset:10240
    v_mfma_f32_16x16x32_bf16 v[160:163], v[36:39], v[116:119], v[160:163]
    ds_read_b128 v[108:111], v2 offset:10240
    v_mfma_f32_16x16x32_bf16 v[164:167], v[44:47], v[116:119], v[164:167]
    v_mfma_f32_16x16x32_bf16 v[164:167], v[40:43], v[112:115], v[164:167]
    v_mfma_f32_16x16x32_bf16 v[168:171], v[48:51], v[112:115], v[168:171]
    v_mfma_f32_16x16x32_bf16 v[168:171], v[52:55], v[116:119], v[168:171]
    v_mfma_f32_16x16x32_bf16 v[172:175], v[60:63], v[116:119], v[172:175]
    v_mfma_f32_16x16x32_bf16 v[172:175], v[56:59], v[112:115], v[172:175]
    s_waitcnt lgkmcnt(5)
    v_mfma_f32_16x16x32_bf16 v[188:191], v[56:59], v[120:123], v[188:191]
    ds_read_b128 v[112:115], v1 offset:12288
    s_waitcnt lgkmcnt(5)
    v_mfma_f32_16x16x32_bf16 v[188:191], v[60:63], v[124:127], v[188:191]
    ds_read_b128 v[116:119], v2 offset:12288
    v_mfma_f32_16x16x32_bf16 v[184:187], v[52:55], v[124:127], v[184:187]
    ds_read_b32 v10, v8 offset:0
    v_mfma_f32_16x16x32_bf16 v[184:187], v[48:51], v[120:123], v[184:187]
    v_mfma_f32_16x16x32_bf16 v[180:183], v[40:43], v[120:123], v[180:183]
    v_mfma_f32_16x16x32_bf16 v[180:183], v[44:47], v[124:127], v[180:183]
    v_mfma_f32_16x16x32_bf16 v[176:179], v[36:39], v[124:127], v[176:179]
    v_mfma_f32_16x16x32_bf16 v[176:179], v[32:35], v[120:123], v[176:179]
    s_waitcnt lgkmcnt(6)
    v_mfma_f32_16x16x32_bf16 v[192:195], v[32:35], v[96:99], v[192:195]
    ds_read_b128 v[120:123], v1 offset:14336
    s_waitcnt lgkmcnt(6)
    v_mfma_f32_16x16x32_bf16 v[192:195], v[36:39], v[100:103], v[192:195]
    ds_read_b128 v[124:127], v2 offset:14336
    v_mfma_f32_16x16x32_bf16 v[196:199], v[44:47], v[100:103], v[196:199]
    s_cmp_eq_u32 s68, s70
    s_cselect_b32 s74, 0xffff0000, s76
    v_mfma_f32_16x16x32_bf16 v[196:199], v[40:43], v[96:99], v[196:199]
    v_add_u32 v1, s74, v1
    v_mfma_f32_16x16x32_bf16 v[200:203], v[48:51], v[96:99], v[200:203]
    v_add_u32 v2, s74, v2
    v_mfma_f32_16x16x32_bf16 v[200:203], v[52:55], v[100:103], v[200:203]
    v_add_u32 v8, s74, v8
    v_mfma_f32_16x16x32_bf16 v[204:207], v[60:63], v[100:103], v[204:207]
    v_mfma_f32_16x16x32_bf16 v[204:207], v[56:59], v[96:99], v[204:207]
    s_waitcnt lgkmcnt(0)
    s_waitcnt vmcnt(0)
    v_lshlrev_b32 v14, 16, v10
    v_and_b32 v15, s80, v10
    v_lshlrev_b32 v10, 16, v11
    v_and_b32 v11, s80, v11
    v_mul_f32 v14, v14, v10
    v_mul_f32 v15, v15, v11
    v_cvt_pk_bf16_f32 v15, v14, v15
    v_lshlrev_b32 v14, 16, v15
    v_and_b32 v15, s80, v15
    v_add_f32 v12, v12, v14
    v_add_f32 v13, v13, v15
    buffer_load_dword v11, v9, s[48:51], s79 offen
    s_add_u32 s79, s79, 128
    s_barrier
    v_mfma_f32_16x16x32_bf16 v[220:223], v[56:59], v[104:107], v[220:223]
    ds_read_b128 v[96:99], v1 offset:0
    v_mfma_f32_16x16x32_bf16 v[220:223], v[60:63], v[108:111], v[220:223]
    ds_read_b128 v[100:103], v2 offset:0
    v_mfma_f32_16x16x32_bf16 v[216:219], v[52:55], v[108:111], v[216:219]
    ds_read_b64_tr_b16 v[64:65], v3 offset:32768
    v_mfma_f32_16x16x32_bf16 v[216:219], v[48:51], v[104:107], v[216:219]
    ds_read_b64_tr_b16 v[66:67], v3 offset:33792
    v_mfma_f32_16x16x32_bf16 v[212:215], v[40:43], v[104:107], v[212:215]
    ds_read_b64_tr_b16 v[68:69], v3 offset:40960
    v_mfma_f32_16x16x32_bf16 v[212:215], v[44:47], v[108:111], v[212:215]
    ds_read_b64_tr_b16 v[70:71], v3 offset:41984
    v_mfma_f32_16x16x32_bf16 v[208:211], v[36:39], v[108:111], v[208:211]
    ds_read_b64_tr_b16 v[76:77], v4 offset:40960
    v_mfma_f32_16x16x32_bf16 v[208:211], v[32:35], v[104:107], v[208:211]
    ds_read_b64_tr_b16 v[78:79], v4 offset:41984
    v_mfma_f32_16x16x32_bf16 v[224:227], v[32:35], v[112:115], v[224:227]
    ds_read_b128 v[104:107], v1 offset:2048
    v_mfma_f32_16x16x32_bf16 v[224:227], v[36:39], v[116:119], v[224:227]
    ds_read_b128 v[108:111], v2 offset:2048
    v_mfma_f32_16x16x32_bf16 v[228:231], v[44:47], v[116:119], v[228:231]
    ds_read_b64_tr_b16 v[72:73], v4 offset:32768
    v_mfma_f32_16x16x32_bf16 v[228:231], v[40:43], v[112:115], v[228:231]
    ds_read_b64_tr_b16 v[74:75], v4 offset:33792
    v_mfma_f32_16x16x32_bf16 v[232:235], v[48:51], v[112:115], v[232:235]
    ds_read_b64_tr_b16 v[80:81], v3 offset:49152
    v_mfma_f32_16x16x32_bf16 v[232:235], v[52:55], v[116:119], v[232:235]
    ds_read_b64_tr_b16 v[82:83], v3 offset:50176
    v_mfma_f32_16x16x32_bf16 v[236:239], v[60:63], v[116:119], v[236:239]
    ds_read_b64_tr_b16 v[84:85], v3 offset:57344
    v_mfma_f32_16x16x32_bf16 v[236:239], v[56:59], v[112:115], v[236:239]
    ds_read_b64_tr_b16 v[86:87], v3 offset:58368
    v_mfma_f32_16x16x32_bf16 v[252:255], v[56:59], v[120:123], v[252:255]
    ds_read_b128 v[112:115], v1 offset:4096
    v_mfma_f32_16x16x32_bf16 v[252:255], v[60:63], v[124:127], v[252:255]
    ds_read_b128 v[116:119], v2 offset:4096
    v_mfma_f32_16x16x32_bf16 v[248:251], v[52:55], v[124:127], v[248:251]
    ds_read_b64_tr_b16 v[92:93], v4 offset:57344
    v_mfma_f32_16x16x32_bf16 v[248:251], v[48:51], v[120:123], v[248:251]
    ds_read_b64_tr_b16 v[94:95], v4 offset:58368
    v_mfma_f32_16x16x32_bf16 v[244:247], v[40:43], v[120:123], v[244:247]
    ds_read_b64_tr_b16 v[88:89], v4 offset:49152
    v_mfma_f32_16x16x32_bf16 v[244:247], v[44:47], v[124:127], v[244:247]
    ds_read_b64_tr_b16 v[90:91], v4 offset:50176
    v_mfma_f32_16x16x32_bf16 v[240:243], v[36:39], v[124:127], v[240:243]
    s_add_u32 s68, s68, s74
    v_mfma_f32_16x16x32_bf16 v[240:243], v[32:35], v[120:123], v[240:243]
    s_waitcnt lgkmcnt(15)
    v_mfma_f32_16x16x32_bf16 v[128:131], v[64:67], v[96:99], v[128:131]
    ds_read_b128 v[120:123], v1 offset:6144
    v_lshlrev_b32 v14, 4, v0
    s_lshl_b32 s4, s56, 3
    s_lshl_b32 s5, s59, 2
    v_mfma_f32_16x16x32_bf16 v[128:131], v[68:71], v[100:103], v[128:131]
    ds_read_b128 v[124:127], v2 offset:6144
    s_add_u32 s84, s4, s5
    s_lshl_b32 s5, s57, 2
    s_add_u32 s5, s5, s60
    s_waitcnt lgkmcnt(15)
    v_mfma_f32_16x16x32_bf16 v[132:135], v[76:79], v[100:103], v[132:135]
    ds_read_b32 v10, v8 offset:0
    s_lshl_b32 s5, s5, 6
    s_add_u32 s4, s5, s84
    s_lshl_b32 s84, s4, 11
    s_waitcnt lgkmcnt(13)
    v_mfma_f32_16x16x32_bf16 v[132:135], v[72:75], v[96:99], v[132:135]
    s_mov_b32 s82, 0xbfb8aa3b
    s_mov_b32 s83, 0xbfb8aa3b
    s_waitcnt lgkmcnt(11)
    v_mfma_f32_16x16x32_bf16 v[136:139], v[80:83], v[96:99], v[136:139]
    s_waitcnt lgkmcnt(9)
    v_mfma_f32_16x16x32_bf16 v[136:139], v[84:87], v[100:103], v[136:139]
    s_waitcnt lgkmcnt(5)
    v_mfma_f32_16x16x32_bf16 v[140:143], v[92:95], v[100:103], v[140:143]
    s_waitcnt lgkmcnt(3)
    v_mfma_f32_16x16x32_bf16 v[140:143], v[88:91], v[96:99], v[140:143]
    v_mfma_f32_16x16x32_bf16 v[156:159], v[88:91], v[104:107], v[156:159]
    ds_read_b128 v[96:99], v1 offset:8192
    v_mfma_f32_16x16x32_bf16 v[156:159], v[92:95], v[108:111], v[156:159]
    ds_read_b128 v[100:103], v2 offset:8192
    v_mfma_f32_16x16x32_bf16 v[152:155], v[84:87], v[108:111], v[152:155]
    v_mfma_f32_16x16x32_bf16 v[152:155], v[80:83], v[104:107], v[152:155]
    v_mfma_f32_16x16x32_bf16 v[148:151], v[72:75], v[104:107], v[148:151]
    v_mul_f32 v128, s82, v128
    v_mul_f32 v129, s82, v129
    v_mul_f32 v130, s82, v130
    v_mul_f32 v131, s82, v131
    v_mul_f32 v132, s82, v132
    v_mul_f32 v133, s82, v133
    v_mfma_f32_16x16x32_bf16 v[148:151], v[76:79], v[108:111], v[148:151]
    v_mul_f32 v134, s82, v134
    v_mul_f32 v135, s82, v135
    v_exp_f32 v128, v128
    v_exp_f32 v129, v129
    v_exp_f32 v130, v130
    v_exp_f32 v131, v131
    v_mfma_f32_16x16x32_bf16 v[144:147], v[68:71], v[108:111], v[144:147]
    s_waitcnt vmcnt(0)
    v_exp_f32 v132, v132
    v_exp_f32 v133, v133
    v_exp_f32 v134, v134
    v_exp_f32 v135, v135
    v_add_f32 v128, 1.0, v128
    v_add_f32 v129, 1.0, v129
    v_mfma_f32_16x16x32_bf16 v[144:147], v[64:67], v[104:107], v[144:147]
    v_add_f32 v130, 1.0, v130
    v_add_f32 v131, 1.0, v131
    v_add_f32 v132, 1.0, v132
    v_add_f32 v133, 1.0, v133
    v_add_f32 v134, 1.0, v134
    v_add_f32 v135, 1.0, v135
    v_mfma_f32_16x16x32_bf16 v[160:163], v[64:67], v[112:115], v[160:163]
    ds_read_b128 v[104:107], v1 offset:10240
    v_rcp_f32 v128, v128
    v_rcp_f32 v129, v129
    v_rcp_f32 v130, v130
    v_rcp_f32 v131, v131
    v_rcp_f32 v132, v132
    v_rcp_f32 v133, v133
    v_mfma_f32_16x16x32_bf16 v[160:163], v[68:71], v[116:119], v[160:163]
    ds_read_b128 v[108:111], v2 offset:10240
    v_rcp_f32 v134, v134
    v_rcp_f32 v135, v135
    v_mul_f32 v136, v136, v128
    v_mul_f32 v137, v137, v129
    v_mul_f32 v138, v138, v130
    v_mul_f32 v139, v139, v131
    v_mfma_f32_16x16x32_bf16 v[164:167], v[76:79], v[116:119], v[164:167]
    v_mul_f32 v140, v140, v132
    v_mul_f32 v141, v141, v133
    v_mul_f32 v142, v142, v134
    v_mul_f32 v143, v143, v135
    v_cvt_pk_bf16_f32 v32, v136, v137
    v_cvt_pk_bf16_f32 v33, v138, v139
    v_mfma_f32_16x16x32_bf16 v[164:167], v[72:75], v[112:115], v[164:167]
    v_cvt_pk_bf16_f32 v34, v140, v141
    v_cvt_pk_bf16_f32 v35, v142, v143
    buffer_store_dwordx4 v[32:35], v14, s[44:47], s84 offen offset:0 sc1
    v_mul_f32 v144, s82, v144
    v_mul_f32 v145, s82, v145
    v_mul_f32 v146, s82, v146
    v_mul_f32 v147, s82, v147
    v_mul_f32 v148, s82, v148
    v_mul_f32 v149, s82, v149
    v_mfma_f32_16x16x32_bf16 v[168:171], v[80:83], v[112:115], v[168:171]
    v_mul_f32 v150, s82, v150
    v_mul_f32 v151, s82, v151
    v_exp_f32 v144, v144
    v_exp_f32 v145, v145
    v_exp_f32 v146, v146
    v_exp_f32 v147, v147
    v_mfma_f32_16x16x32_bf16 v[168:171], v[84:87], v[116:119], v[168:171]
    v_exp_f32 v148, v148
    v_exp_f32 v149, v149
    v_exp_f32 v150, v150
    v_exp_f32 v151, v151
    v_add_f32 v144, 1.0, v144
    v_add_f32 v145, 1.0, v145
    v_mfma_f32_16x16x32_bf16 v[172:175], v[92:95], v[116:119], v[172:175]
    v_add_f32 v146, 1.0, v146
    v_add_f32 v147, 1.0, v147
    v_add_f32 v148, 1.0, v148
    v_add_f32 v149, 1.0, v149
    v_add_f32 v150, 1.0, v150
    v_add_f32 v151, 1.0, v151
    v_mfma_f32_16x16x32_bf16 v[172:175], v[88:91], v[112:115], v[172:175]
    v_rcp_f32 v144, v144
    v_rcp_f32 v145, v145
    v_rcp_f32 v146, v146
    v_rcp_f32 v147, v147
    v_rcp_f32 v148, v148
    v_rcp_f32 v149, v149
    s_waitcnt lgkmcnt(6)
    v_mfma_f32_16x16x32_bf16 v[188:191], v[88:91], v[120:123], v[188:191]
    ds_read_b128 v[112:115], v1 offset:12288
    v_rcp_f32 v150, v150
    v_rcp_f32 v151, v151
    v_mul_f32 v152, v152, v144
    v_mul_f32 v153, v153, v145
    v_mul_f32 v154, v154, v146
    v_mul_f32 v155, v155, v147
    s_waitcnt lgkmcnt(6)
    v_mfma_f32_16x16x32_bf16 v[188:191], v[92:95], v[124:127], v[188:191]
    ds_read_b128 v[116:119], v2 offset:12288
    v_mul_f32 v156, v156, v148
    v_mul_f32 v157, v157, v149
    v_mul_f32 v158, v158, v150
    v_mul_f32 v159, v159, v151
    v_cvt_pk_bf16_f32 v36, v152, v153
    v_cvt_pk_bf16_f32 v37, v154, v155
    v_mfma_f32_16x16x32_bf16 v[184:187], v[84:87], v[124:127], v[184:187]
    v_cvt_pk_bf16_f32 v38, v156, v157
    v_cvt_pk_bf16_f32 v39, v158, v159
    buffer_store_dwordx4 v[36:39], v14, s[44:47], s84 offen offset:1024 sc1
    s_add_u32 s84, s84, 2048
    v_mfma_f32_16x16x32_bf16 v[184:187], v[80:83], v[120:123], v[184:187]
    v_mul_f32 v160, s82, v160
    v_mul_f32 v161, s82, v161
    v_mul_f32 v162, s82, v162
    v_mul_f32 v163, s82, v163
    v_mul_f32 v164, s82, v164
    v_mul_f32 v165, s82, v165
    v_mfma_f32_16x16x32_bf16 v[180:183], v[72:75], v[120:123], v[180:183]
    v_mul_f32 v166, s82, v166
    v_mul_f32 v167, s82, v167
    v_exp_f32 v160, v160
    v_exp_f32 v161, v161
    v_exp_f32 v162, v162
    v_exp_f32 v163, v163
    v_mfma_f32_16x16x32_bf16 v[180:183], v[76:79], v[124:127], v[180:183]
    v_exp_f32 v164, v164
    v_exp_f32 v165, v165
    v_exp_f32 v166, v166
    v_exp_f32 v167, v167
    v_add_f32 v160, 1.0, v160
    v_add_f32 v161, 1.0, v161
    v_mfma_f32_16x16x32_bf16 v[176:179], v[68:71], v[124:127], v[176:179]
    v_add_f32 v162, 1.0, v162
    v_add_f32 v163, 1.0, v163
    v_add_f32 v164, 1.0, v164
    v_add_f32 v165, 1.0, v165
    v_add_f32 v166, 1.0, v166
    v_add_f32 v167, 1.0, v167
    v_mfma_f32_16x16x32_bf16 v[176:179], v[64:67], v[120:123], v[176:179]
    v_rcp_f32 v160, v160
    v_rcp_f32 v161, v161
    v_rcp_f32 v162, v162
    v_rcp_f32 v163, v163
    v_rcp_f32 v164, v164
    v_rcp_f32 v165, v165
    s_waitcnt lgkmcnt(5)
    v_mfma_f32_16x16x32_bf16 v[192:195], v[64:67], v[96:99], v[192:195]
    ds_read_b128 v[120:123], v1 offset:14336
    v_rcp_f32 v166, v166
    v_rcp_f32 v167, v167
    v_mul_f32 v168, v168, v160
    v_mul_f32 v169, v169, v161
    v_mul_f32 v170, v170, v162
    v_mul_f32 v171, v171, v163
    s_waitcnt lgkmcnt(5)
    v_mfma_f32_16x16x32_bf16 v[192:195], v[68:71], v[100:103], v[192:195]
    ds_read_b128 v[124:127], v2 offset:14336
    v_mul_f32 v172, v172, v164
    v_mul_f32 v173, v173, v165
    v_mul_f32 v174, v174, v166
    v_mul_f32 v175, v175, v167
    v_cvt_pk_bf16_f32 v32, v168, v169
    v_cvt_pk_bf16_f32 v33, v170, v171
    v_mfma_f32_16x16x32_bf16 v[196:199], v[76:79], v[100:103], v[196:199]
    v_cvt_pk_bf16_f32 v34, v172, v173
    v_cvt_pk_bf16_f32 v35, v174, v175
    buffer_store_dwordx4 v[32:35], v14, s[44:47], s84 offen offset:0 sc1
    v_mfma_f32_16x16x32_bf16 v[196:199], v[72:75], v[96:99], v[196:199]
    v_mul_f32 v176, s82, v176
    v_mul_f32 v177, s82, v177
    v_mul_f32 v178, s82, v178
    v_mul_f32 v179, s82, v179
    v_mul_f32 v180, s82, v180
    v_mul_f32 v181, s82, v181
    v_mfma_f32_16x16x32_bf16 v[200:203], v[80:83], v[96:99], v[200:203]
    v_mul_f32 v182, s82, v182
    v_mul_f32 v183, s82, v183
    v_exp_f32 v176, v176
    v_exp_f32 v177, v177
    v_exp_f32 v178, v178
    v_exp_f32 v179, v179
    v_mfma_f32_16x16x32_bf16 v[200:203], v[84:87], v[100:103], v[200:203]
    v_exp_f32 v180, v180
    v_exp_f32 v181, v181
    v_exp_f32 v182, v182
    v_exp_f32 v183, v183
    v_add_f32 v176, 1.0, v176
    v_add_f32 v177, 1.0, v177
    v_mfma_f32_16x16x32_bf16 v[204:207], v[92:95], v[100:103], v[204:207]
    v_add_f32 v178, 1.0, v178
    v_add_f32 v179, 1.0, v179
    v_add_f32 v180, 1.0, v180
    v_add_f32 v181, 1.0, v181
    v_add_f32 v182, 1.0, v182
    v_add_f32 v183, 1.0, v183
    v_mfma_f32_16x16x32_bf16 v[204:207], v[88:91], v[96:99], v[204:207]
    v_rcp_f32 v176, v176
    v_rcp_f32 v177, v177
    v_rcp_f32 v178, v178
    v_rcp_f32 v179, v179
    v_rcp_f32 v180, v180
    v_rcp_f32 v181, v181
    s_waitcnt lgkmcnt(5)
    v_mfma_f32_16x16x32_bf16 v[220:223], v[88:91], v[104:107], v[220:223]
    v_rcp_f32 v182, v182
    v_rcp_f32 v183, v183
    v_mul_f32 v184, v184, v176
    v_mul_f32 v185, v185, v177
    v_mul_f32 v186, v186, v178
    v_mul_f32 v187, v187, v179
    s_waitcnt lgkmcnt(4)
    v_mfma_f32_16x16x32_bf16 v[220:223], v[92:95], v[108:111], v[220:223]
    v_mul_f32 v188, v188, v180
    v_mul_f32 v189, v189, v181
    v_mul_f32 v190, v190, v182
    v_mul_f32 v191, v191, v183
    v_cvt_pk_bf16_f32 v36, v184, v185
    v_cvt_pk_bf16_f32 v37, v186, v187
    v_mfma_f32_16x16x32_bf16 v[216:219], v[84:87], v[108:111], v[216:219]
    v_cvt_pk_bf16_f32 v38, v188, v189
    v_cvt_pk_bf16_f32 v39, v190, v191
    buffer_store_dwordx4 v[36:39], v14, s[44:47], s84 offen offset:1024 sc1
    s_add_u32 s84, s84, 2048
    v_mfma_f32_16x16x32_bf16 v[216:219], v[80:83], v[104:107], v[216:219]
    v_mul_f32 v192, s82, v192
    v_mul_f32 v193, s82, v193
    v_mul_f32 v194, s82, v194
    v_mul_f32 v195, s82, v195
    v_mul_f32 v196, s82, v196
    v_mul_f32 v197, s82, v197
    v_mfma_f32_16x16x32_bf16 v[212:215], v[72:75], v[104:107], v[212:215]
    v_mul_f32 v198, s82, v198
    v_mul_f32 v199, s82, v199
    v_exp_f32 v192, v192
    v_exp_f32 v193, v193
    v_exp_f32 v194, v194
    v_exp_f32 v195, v195
    v_mfma_f32_16x16x32_bf16 v[212:215], v[76:79], v[108:111], v[212:215]
    v_exp_f32 v196, v196
    v_exp_f32 v197, v197
    v_exp_f32 v198, v198
    v_exp_f32 v199, v199
    v_add_f32 v192, 1.0, v192
    v_add_f32 v193, 1.0, v193
    v_mfma_f32_16x16x32_bf16 v[208:211], v[68:71], v[108:111], v[208:211]
    v_add_f32 v194, 1.0, v194
    v_add_f32 v195, 1.0, v195
    v_add_f32 v196, 1.0, v196
    v_add_f32 v197, 1.0, v197
    v_add_f32 v198, 1.0, v198
    v_add_f32 v199, 1.0, v199
    v_mfma_f32_16x16x32_bf16 v[208:211], v[64:67], v[104:107], v[208:211]
    v_rcp_f32 v192, v192
    v_rcp_f32 v193, v193
    v_rcp_f32 v194, v194
    v_rcp_f32 v195, v195
    v_rcp_f32 v196, v196
    v_rcp_f32 v197, v197
    s_waitcnt lgkmcnt(3)
    v_mfma_f32_16x16x32_bf16 v[224:227], v[64:67], v[112:115], v[224:227]
    v_rcp_f32 v198, v198
    v_rcp_f32 v199, v199
    v_mul_f32 v200, v200, v192
    v_mul_f32 v201, v201, v193
    v_mul_f32 v202, v202, v194
    v_mul_f32 v203, v203, v195
    s_waitcnt lgkmcnt(2)
    v_mfma_f32_16x16x32_bf16 v[224:227], v[68:71], v[116:119], v[224:227]
    v_mul_f32 v204, v204, v196
    v_mul_f32 v205, v205, v197
    v_mul_f32 v206, v206, v198
    v_mul_f32 v207, v207, v199
    v_cvt_pk_bf16_f32 v32, v200, v201
    v_cvt_pk_bf16_f32 v33, v202, v203
    v_mfma_f32_16x16x32_bf16 v[228:231], v[76:79], v[116:119], v[228:231]
    v_cvt_pk_bf16_f32 v34, v204, v205
    v_cvt_pk_bf16_f32 v35, v206, v207
    buffer_store_dwordx4 v[32:35], v14, s[44:47], s84 offen offset:0 sc1
    v_mfma_f32_16x16x32_bf16 v[228:231], v[72:75], v[112:115], v[228:231]
    v_mul_f32 v208, s82, v208
    v_mul_f32 v209, s82, v209
    v_mul_f32 v210, s82, v210
    v_mul_f32 v211, s82, v211
    v_mul_f32 v212, s82, v212
    v_mul_f32 v213, s82, v213
    v_mfma_f32_16x16x32_bf16 v[232:235], v[80:83], v[112:115], v[232:235]
    v_mul_f32 v214, s82, v214
    v_mul_f32 v215, s82, v215
    v_exp_f32 v208, v208
    v_exp_f32 v209, v209
    v_exp_f32 v210, v210
    v_exp_f32 v211, v211
    v_mfma_f32_16x16x32_bf16 v[232:235], v[84:87], v[116:119], v[232:235]
    v_exp_f32 v212, v212
    v_exp_f32 v213, v213
    v_exp_f32 v214, v214
    v_exp_f32 v215, v215
    v_add_f32 v208, 1.0, v208
    v_add_f32 v209, 1.0, v209
    v_mfma_f32_16x16x32_bf16 v[236:239], v[92:95], v[116:119], v[236:239]
    v_add_f32 v210, 1.0, v210
    v_add_f32 v211, 1.0, v211
    v_add_f32 v212, 1.0, v212
    v_add_f32 v213, 1.0, v213
    v_add_f32 v214, 1.0, v214
    v_add_f32 v215, 1.0, v215
    v_mfma_f32_16x16x32_bf16 v[236:239], v[88:91], v[112:115], v[236:239]
    v_rcp_f32 v208, v208
    v_rcp_f32 v209, v209
    v_rcp_f32 v210, v210
    v_rcp_f32 v211, v211
    v_rcp_f32 v212, v212
    v_rcp_f32 v213, v213
    s_waitcnt lgkmcnt(1)
    v_mfma_f32_16x16x32_bf16 v[252:255], v[88:91], v[120:123], v[252:255]
    v_rcp_f32 v214, v214
    v_rcp_f32 v215, v215
    v_mul_f32 v216, v216, v208
    v_mul_f32 v217, v217, v209
    v_mul_f32 v218, v218, v210
    v_mul_f32 v219, v219, v211
    s_waitcnt lgkmcnt(0)
    v_mfma_f32_16x16x32_bf16 v[252:255], v[92:95], v[124:127], v[252:255]
    v_mul_f32 v220, v220, v212
    v_mul_f32 v221, v221, v213
    v_mul_f32 v222, v222, v214
    v_mul_f32 v223, v223, v215
    v_cvt_pk_bf16_f32 v36, v216, v217
    v_cvt_pk_bf16_f32 v37, v218, v219
    v_mfma_f32_16x16x32_bf16 v[248:251], v[84:87], v[124:127], v[248:251]
    v_cvt_pk_bf16_f32 v38, v220, v221
    v_cvt_pk_bf16_f32 v39, v222, v223
    buffer_store_dwordx4 v[36:39], v14, s[44:47], s84 offen offset:1024 sc1
    s_add_u32 s84, s84, 2048
    v_mfma_f32_16x16x32_bf16 v[248:251], v[80:83], v[120:123], v[248:251]
    v_mul_f32 v224, s82, v224
    v_mul_f32 v225, s82, v225
    v_mul_f32 v226, s82, v226
    v_mul_f32 v227, s82, v227
    v_mul_f32 v228, s82, v228
    v_mul_f32 v229, s82, v229
    v_mul_f32 v230, s82, v230
    v_mul_f32 v231, s82, v231
    v_exp_f32 v224, v224
    v_mfma_f32_16x16x32_bf16 v[244:247], v[72:75], v[120:123], v[244:247]
    v_exp_f32 v225, v225
    v_exp_f32 v226, v226
    v_exp_f32 v227, v227
    v_exp_f32 v228, v228
    v_exp_f32 v229, v229
    v_exp_f32 v230, v230
    v_exp_f32 v231, v231
    v_add_f32 v224, 1.0, v224
    v_add_f32 v225, 1.0, v225
    v_mfma_f32_16x16x32_bf16 v[244:247], v[76:79], v[124:127], v[244:247]
    v_add_f32 v226, 1.0, v226
    v_add_f32 v227, 1.0, v227
    v_add_f32 v228, 1.0, v228
    v_add_f32 v229, 1.0, v229
    v_add_f32 v230, 1.0, v230
    v_add_f32 v231, 1.0, v231
    v_rcp_f32 v224, v224
    v_rcp_f32 v225, v225
    v_rcp_f32 v226, v226
    v_mfma_f32_16x16x32_bf16 v[240:243], v[68:71], v[124:127], v[240:243]
    v_rcp_f32 v227, v227
    v_rcp_f32 v228, v228
    v_rcp_f32 v229, v229
    v_rcp_f32 v230, v230
    v_rcp_f32 v231, v231
    v_mul_f32 v232, v232, v224
    v_mul_f32 v233, v233, v225
    v_mul_f32 v234, v234, v226
    v_mul_f32 v235, v235, v227
    v_mfma_f32_16x16x32_bf16 v[240:243], v[64:67], v[120:123], v[240:243]
    v_mul_f32 v236, v236, v228
    v_mul_f32 v237, v237, v229
    v_mul_f32 v238, v238, v230
    v_mul_f32 v239, v239, v231
    v_cvt_pk_bf16_f32 v32, v232, v233
    v_cvt_pk_bf16_f32 v33, v234, v235
    v_cvt_pk_bf16_f32 v34, v236, v237
    v_cvt_pk_bf16_f32 v35, v238, v239
    buffer_store_dwordx4 v[32:35], v14, s[44:47], s84 offen offset:0 sc1
    s_nop 7
    v_pk_mul_f32 v[240:241], v[240:241], s[82:83]
    v_pk_mul_f32 v[242:243], v[242:243], s[82:83]
    v_pk_mul_f32 v[244:245], v[244:245], s[82:83]
    v_pk_mul_f32 v[246:247], v[246:247], s[82:83]
    v_exp_f32 v240, v240
    v_exp_f32 v241, v241
    v_exp_f32 v242, v242
    v_exp_f32 v243, v243
    v_exp_f32 v244, v244
    v_exp_f32 v245, v245
    v_exp_f32 v246, v246
    v_exp_f32 v247, v247
    v_pk_add_f32 v[240:241], v[240:241], 1.0 op_sel_hi:[1,0]
    v_pk_add_f32 v[242:243], v[242:243], 1.0 op_sel_hi:[1,0]
    v_pk_add_f32 v[244:245], v[244:245], 1.0 op_sel_hi:[1,0]
    v_pk_add_f32 v[246:247], v[246:247], 1.0 op_sel_hi:[1,0]
    v_rcp_f32 v240, v240
    v_rcp_f32 v241, v241
    v_rcp_f32 v242, v242
    v_rcp_f32 v243, v243
    v_rcp_f32 v244, v244
    v_rcp_f32 v245, v245
    v_rcp_f32 v246, v246
    v_rcp_f32 v247, v247
    v_pk_mul_f32 v[248:249], v[248:249], v[240:241]
    v_pk_mul_f32 v[250:251], v[250:251], v[242:243]
    v_pk_mul_f32 v[252:253], v[252:253], v[244:245]
    v_pk_mul_f32 v[254:255], v[254:255], v[246:247]
    v_cvt_pk_bf16_f32 v36, v248, v249
    v_cvt_pk_bf16_f32 v37, v250, v251
    v_cvt_pk_bf16_f32 v38, v252, v253
    v_cvt_pk_bf16_f32 v39, v254, v255
    buffer_store_dwordx4 v[36:39], v14, s[44:47], s84 offen offset:1024 sc1
    s_cmp_ge_u32 s3, 4
    s_cbranch_scc1 p1_fin
    v_lshlrev_b32 v56, 16, v10
    v_and_b32 v57, s80, v10
    v_lshlrev_b32 v10, 16, v11
    v_and_b32 v11, s80, v11
    v_mul_f32 v56, v56, v10
    v_mul_f32 v57, v57, v11
    v_cvt_pk_bf16_f32 v57, v56, v57
    v_lshlrev_b32 v56, 16, v57
    v_and_b32 v57, s80, v57
    v_add_f32 v12, v12, v56
    v_add_f32 v13, v13, v57
    v_add_f32 v12, v12, v13
    s_nop 1
    v_add_f32_dpp v12, v12, v12 row_shr:1 row_mask:0xf bank_mask:0xf bound_ctrl:1
    s_nop 1
    v_add_f32_dpp v12, v12, v12 row_shr:2 row_mask:0xf bank_mask:0xf bound_ctrl:1
    s_nop 1
    v_add_f32_dpp v12, v12, v12 row_shr:4 row_mask:0xf bank_mask:0xf bound_ctrl:1
    s_nop 1
    v_add_f32_dpp v12, v12, v12 row_shr:8 row_mask:0xf bank_mask:0xf bound_ctrl:1
    s_nop 1
    v_add_f32_dpp v12, v12, v12 row_bcast:15 row_mask:0xa bank_mask:0xf
    v_cvt_pk_bf16_f32 v10, v12, v12
    v_lshlrev_b32 v10, 16, v10
    v_mul_f32 v10, 0xbfb8aa3b, v10
    v_exp_f32 v10, v10
    s_lshl_b32 s4, s56, 5
    v_add_f32 v10, 1.0, v10
    v_rcp_f32 v10, v10
    s_add_u32 s4, s4, s57
    v_cvt_pk_bf16_f32 v10, v10, v10
    v_lshlrev_b32 v10, 16, v10
    v_sub_f32 v11, 1.0, v10
    v_cvt_pk_bf16_f32 v11, v11, v11
    v_lshlrev_b32 v11, 16, v11
    v_lshrrev_b32 v12, 5, v0
    v_lshlrev_b32 v12, 3, v12
    s_lshl_b32 s4, s4, 2
    s_add_u32 s4, s4, s60
    s_lshl_b32 s4, s4, 4
    s_add_u32 s4, s4, 0x1480000
    s_mov_b32 exec_lo, 0x80000000
    s_mov_b32 exec_hi, 0x80000000
    buffer_store_dwordx2 v[10:11], v12, s[44:47], s4 offen sc1
    s_mov_b64 exec, -1
    s_branch p1_fin
p1_FL:
    s_add_u32 s70, s70, s68
    s_add_u32 m0, s71, 0x8000
    s_nop 0
    buffer_load_dwordx4 v8, s[12:15], s65 offen lds
    s_add_u32 m0, s71, 0xc000
    s_nop 0
    buffer_load_dwordx4 v8, s[16:19], s65 offen lds
    s_add_u32 m0, s71, 0x8400
    s_nop 0
    buffer_load_dwordx4 v9, s[12:15], s65 offen lds
    s_add_u32 m0, s71, 0xc400
    s_nop 0
    buffer_load_dwordx4 v9, s[16:19], s65 offen lds
    s_add_u32 m0, s71, 0x8800
    s_nop 0
    buffer_load_dwordx4 v10, s[12:15], s65 offen lds
    s_add_u32 m0, s71, 0xc800
    s_nop 0
    buffer_load_dwordx4 v10, s[16:19], s65 offen lds
    s_add_u32 m0, s71, 0x8c00
    s_nop 0
    buffer_load_dwordx4 v11, s[12:15], s65 offen lds
    s_add_u32 m0, s71, 0xcc00
    s_nop 0
    buffer_load_dwordx4 v11, s[16:19], s65 offen lds
    s_add_u32 s65, s65, s67
    s_load_dwordx2 s[24:25], s[0:1], 64
    s_load_dwordx2 s[26:27], s[0:1], 32
    s_mul_i32 s6, s56, 28
    s_add_u32 s6, s6, s57
    v_lshrrev_b32 v20, 2, v0
    v_lshlrev_b32 v20, 7, v20
    s_lshl_b32 s7, s6, 11
    v_add_u32 v20, s7, v20
    v_min_u32 v21, 9, v0
    s_mul_i32 s7, s6, 10
    v_add_u32 v21, s7, v21
    v_min_u32 v21, 2047, v21
    v_lshlrev_b32 v21, 11, v21
    v_lshrrev_b32 v17, 3, v0
    v_lshlrev_b32 v17, 7, v17
    s_cmp_ge_u32 s6, 128
    s_cselect_b32 s7, 3, 127
    s_and_b32 s7, s7, s6
    s_lshl_b32 s7, s7, 10
    v_add_u32 v22, s7, v17
    s_cmp_ge_u32 s6, 128
    s_cselect_b32 s7, 1, 32
    s_lshl_b32 s7, s7, 12
    s_cmp_eq_u32 s60, 2
    s_cselect_b64 vcc, -1, 0
    s_cselect_b32 s78, 128, s67
    v_cndmask_b32 v16, v20, v21, vcc
    s_cselect_b32 s52, s8, s12
    s_cselect_b32 s53, s9, s13
    s_cselect_b32 s54, s10, s14
    s_cmp_eq_u32 s60, 1
    s_cselect_b32 s52, s16, s52
    s_cselect_b32 s53, s17, s53
    s_cmp_eq_u32 s60, 3
    s_cselect_b64 vcc, -1, 0
    s_cselect_b32 s78, s7, s78
    v_cndmask_b32 v16, v16, v22, vcc
    s_mul_i32 s77, s78, 2
    s_cmp_ge_u32 s6, 132
    s_cselect_b32 s4, s34, s32
    s_cselect_b32 s7, s35, s33
    s_cmp_ge_u32 s6, 136
    s_cselect_b32 s5, 0, 0x10000
    s_cmp_lt_u32 s6, 128
    s_cselect_b32 s4, s30, s4
    s_cselect_b32 s7, s31, s7
    s_cselect_b32 s5, 0x200000, s5
    s_cmp_eq_u32 s60, 3
    s_cselect_b32 s52, s4, s52
    s_cselect_b32 s53, s7, s53
    s_cselect_b32 s54, s5, s54
    s_mov_b32 s55, 0x20000
    s_mul_i32 s4, s6, 3
    s_add_u32 s4, s4, s60
    s_mov_b32 s5, 0x700000
    s_mov_b32 s7, 688128
    s_cmp_lt_u32 s60, 2
    s_cselect_b32 s73, 0, 1
    s_waitcnt lgkmcnt(0)
    s_cmp_eq_u32 s60, 3
    s_cselect_b32 s4, s6, s4
    s_cselect_b32 s20, s26, s24
    s_cselect_b32 s21, s27, s25
    s_cselect_b32 s22, 0x200000, s5
    s_cselect_b32 s66, 229376, s7
    s_lshl_b32 s72, s4, 10
    s_cmp_eq_u32 s60, 3
    s_cselect_b32 s22, 0, 0x280000
    s_waitcnt vmcnt(8)
    s_barrier
    s_add_u32 m0, s68, 0x8000
    s_nop 0
    buffer_load_dwordx4 v6, s[8:11], s61 offen lds
    s_add_u32 m0, s68, 0x8400
    s_nop 0
    buffer_load_dwordx4 v7, s[8:11], s61 offen lds
    s_add_u32 s61, s61, 128
    s_add_u32 m0, s68, 0x8800
    s_nop 0
    buffer_load_dwordx4 v6, s[8:11], s62 offen lds
    s_add_u32 m0, s68, 0x8c00
    s_nop 0
    buffer_load_dwordx4 v7, s[8:11], s62 offen lds
    s_add_u32 s62, s62, 128
    s_add_u32 m0, s68, 0x9000
    s_nop 0
    buffer_load_dwordx4 v6, s[8:11], s63 offen lds
    s_add_u32 m0, s68, 0x9400
    s_nop 0
    buffer_load_dwordx4 v7, s[8:11], s63 offen lds
    s_add_u32 s63, s63, 128
    s_add_u32 m0, s68, 0x9800
    s_nop 0
    buffer_load_dwordx4 v6, s[8:11], s64 offen lds
    s_add_u32 m0, s68, 0x9c00
    s_nop 0
    buffer_load_dwordx4 v7, s[8:11], s64 offen lds
    s_add_u32 s64, s64, 128
    s_nop 0
    s_nop 0
    buffer_load_dword v18, v16, s[52:55], s77 offen
    s_add_u32 s77, s77, s78
    ds_read_b128 v[96:99], v1 offset:0
    ds_read_b128 v[100:103], v2 offset:0
    ds_read_b64_tr_b16 v[32:33], v3 offset:0
    ds_read_b64_tr_b16 v[34:35], v3 offset:1024
    ds_read_b64_tr_b16 v[36:37], v3 offset:8192
    ds_read_b64_tr_b16 v[38:39], v3 offset:9216
    ds_read_b64_tr_b16 v[44:45], v4 offset:8192
    ds_read_b64_tr_b16 v[46:47], v4 offset:9216
    ds_read_b128 v[104:107], v1 offset:2048
    ds_read_b128 v[108:111], v2 offset:2048
    ds_read_b64_tr_b16 v[40:41], v4 offset:0
    ds_read_b64_tr_b16 v[42:43], v4 offset:1024
    ds_read_b64_tr_b16 v[48:49], v3 offset:16384
    ds_read_b64_tr_b16 v[50:51], v3 offset:17408
    ds_read_b64_tr_b16 v[52:53], v3 offset:24576
    ds_read_b64_tr_b16 v[54:55], v3 offset:25600
    ds_read_b128 v[112:115], v1 offset:4096
    ds_read_b128 v[116:119], v2 offset:4096
    ds_read_b64_tr_b16 v[60:61], v4 offset:24576
    ds_read_b64_tr_b16 v[62:63], v4 offset:25600
    ds_read_b64_tr_b16 v[56:57], v4 offset:16384
    ds_read_b64_tr_b16 v[58:59], v4 offset:17408
    s_mov_b32 s75, 5
    s_waitcnt lgkmcnt(15)
    v_mfma_f32_16x16x32_bf16 v[128:131], v[32:35], v[96:99], 0
    ds_read_b128 v[120:123], v1 offset:6144
    v_mfma_f32_16x16x32_bf16 v[128:131], v[36:39], v[100:103], v[128:131]
    ds_read_b128 v[124:127], v2 offset:6144
    s_waitcnt lgkmcnt(15)
    v_mfma_f32_16x16x32_bf16 v[132:135], v[44:47], v[100:103], 0
    s_waitcnt lgkmcnt(12)
    v_mfma_f32_16x16x32_bf16 v[132:135], v[40:43], v[96:99], v[132:135]
    s_waitcnt lgkmcnt(10)
    v_mfma_f32_16x16x32_bf16 v[136:139], v[48:51], v[96:99], 0
    s_waitcnt lgkmcnt(8)
    v_mfma_f32_16x16x32_bf16 v[136:139], v[52:55], v[100:103], v[136:139]
    s_waitcnt lgkmcnt(4)
    v_mfma_f32_16x16x32_bf16 v[140:143], v[60:63], v[100:103], 0
    s_waitcnt lgkmcnt(2)
    v_mfma_f32_16x16x32_bf16 v[140:143], v[56:59], v[96:99], v[140:143]
    v_mfma_f32_16x16x32_bf16 v[156:159], v[56:59], v[104:107], 0
    ds_read_b128 v[96:99], v1 offset:8192
    v_mfma_f32_16x16x32_bf16 v[156:159], v[60:63], v[108:111], v[156:159]
    ds_read_b128 v[100:103], v2 offset:8192
    v_mfma_f32_16x16x32_bf16 v[152:155], v[52:55], v[108:111], 0
    v_mfma_f32_16x16x32_bf16 v[152:155], v[48:51], v[104:107], v[152:155]
    v_mfma_f32_16x16x32_bf16 v[148:151], v[40:43], v[104:107], 0
    v_mfma_f32_16x16x32_bf16 v[148:151], v[44:47], v[108:111], v[148:151]
    v_mfma_f32_16x16x32_bf16 v[144:147], v[36:39], v[108:111], 0
    v_mfma_f32_16x16x32_bf16 v[144:147], v[32:35], v[104:107], v[144:147]
    v_mfma_f32_16x16x32_bf16 v[160:163], v[32:35], v[112:115], 0
    ds_read_b128 v[104:107], v1 offset:10240
    v_mfma_f32_16x16x32_bf16 v[160:163], v[36:39], v[116:119], v[160:163]
    ds_read_b128 v[108:111], v2 offset:10240
    v_mfma_f32_16x16x32_bf16 v[164:167], v[44:47], v[116:119], 0
    v_mfma_f32_16x16x32_bf16 v[164:167], v[40:43], v[112:115], v[164:167]
    v_mfma_f32_16x16x32_bf16 v[168:171], v[48:51], v[112:115], 0
    v_mfma_f32_16x16x32_bf16 v[168:171], v[52:55], v[116:119], v[168:171]
    v_mfma_f32_16x16x32_bf16 v[172:175], v[60:63], v[116:119], 0
    v_mfma_f32_16x16x32_bf16 v[172:175], v[56:59], v[112:115], v[172:175]
    s_waitcnt lgkmcnt(5)
    v_mfma_f32_16x16x32_bf16 v[188:191], v[56:59], v[120:123], 0
    ds_read_b128 v[112:115], v1 offset:12288
    s_waitcnt lgkmcnt(5)
    v_mfma_f32_16x16x32_bf16 v[188:191], v[60:63], v[124:127], v[188:191]
    ds_read_b128 v[116:119], v2 offset:12288
    v_mfma_f32_16x16x32_bf16 v[184:187], v[52:55], v[124:127], 0
    v_mfma_f32_16x16x32_bf16 v[184:187], v[48:51], v[120:123], v[184:187]
    v_mfma_f32_16x16x32_bf16 v[180:183], v[40:43], v[120:123], 0
    v_mfma_f32_16x16x32_bf16 v[180:183], v[44:47], v[124:127], v[180:183]
    v_mfma_f32_16x16x32_bf16 v[176:179], v[36:39], v[124:127], 0
    v_mfma_f32_16x16x32_bf16 v[176:179], v[32:35], v[120:123], v[176:179]
    s_waitcnt lgkmcnt(5)
    v_mfma_f32_16x16x32_bf16 v[192:195], v[32:35], v[96:99], 0
    ds_read_b128 v[120:123], v1 offset:14336
    s_waitcnt lgkmcnt(5)
    v_mfma_f32_16x16x32_bf16 v[192:195], v[36:39], v[100:103], v[192:195]
    ds_read_b128 v[124:127], v2 offset:14336
    v_mfma_f32_16x16x32_bf16 v[196:199], v[44:47], v[100:103], 0
    s_cmp_eq_u32 s68, s70
    s_cselect_b32 s74, 0xffff0000, s76
    v_mfma_f32_16x16x32_bf16 v[196:199], v[40:43], v[96:99], v[196:199]
    v_add_u32 v1, s74, v1
    v_mfma_f32_16x16x32_bf16 v[200:203], v[48:51], v[96:99], 0
    v_add_u32 v2, s74, v2
    v_mfma_f32_16x16x32_bf16 v[200:203], v[52:55], v[100:103], v[200:203]
    v_mfma_f32_16x16x32_bf16 v[204:207], v[60:63], v[100:103], 0
    v_mfma_f32_16x16x32_bf16 v[204:207], v[56:59], v[96:99], v[204:207]
    s_waitcnt vmcnt(1) lgkmcnt(0)
    s_barrier
    s_mov_b32 m0, s71
    s_nop 0
    buffer_load_dwordx4 v8, s[12:15], s65 offen lds
    s_add_u32 m0, s71, 0x4000
    s_nop 0
    buffer_load_dwordx4 v8, s[16:19], s65 offen lds
    s_add_u32 m0, s71, 0x400
    s_nop 0
    buffer_load_dwordx4 v9, s[12:15], s65 offen lds
    s_add_u32 m0, s71, 0x4400
    s_nop 0
    buffer_load_dwordx4 v9, s[16:19], s65 offen lds
    s_add_u32 m0, s71, 0x800
    s_nop 0
    buffer_load_dwordx4 v10, s[12:15], s65 offen lds
    s_add_u32 m0, s71, 0x4800
    s_nop 0
    buffer_load_dwordx4 v10, s[16:19], s65 offen lds
    s_add_u32 m0, s71, 0xc00
    s_nop 0
    buffer_load_dwordx4 v11, s[12:15], s65 offen lds
    s_add_u32 m0, s71, 0x4c00
    s_nop 0
    buffer_load_dwordx4 v11, s[16:19], s65 offen lds
    s_add_u32 s65, s65, s67
    s_nop 0
    s_nop 0
    buffer_load_dword v18, v16, s[52:55], s77 offen
    s_add_u32 s77, s77, s78
    s_nop 0
    s_nop 0
    buffer_load_dword v18, v17, s[20:23], s72 offen
    s_add_u32 s72, s72, s66
    v_mfma_f32_16x16x32_bf16 v[220:223], v[56:59], v[104:107], 0
    ds_read_b128 v[96:99], v1 offset:0
    v_mfma_f32_16x16x32_bf16 v[220:223], v[60:63], v[108:111], v[220:223]
    ds_read_b128 v[100:103], v2 offset:0
    v_mfma_f32_16x16x32_bf16 v[216:219], v[52:55], v[108:111], 0
    ds_read_b64_tr_b16 v[64:65], v3 offset:32768
    v_mfma_f32_16x16x32_bf16 v[216:219], v[48:51], v[104:107], v[216:219]
    ds_read_b64_tr_b16 v[66:67], v3 offset:33792
    v_mfma_f32_16x16x32_bf16 v[212:215], v[40:43], v[104:107], 0
    ds_read_b64_tr_b16 v[68:69], v3 offset:40960
    v_mfma_f32_16x16x32_bf16 v[212:215], v[44:47], v[108:111], v[212:215]
    ds_read_b64_tr_b16 v[70:71], v3 offset:41984
    v_mfma_f32_16x16x32_bf16 v[208:211], v[36:39], v[108:111], 0
    ds_read_b64_tr_b16 v[76:77], v4 offset:40960
    v_mfma_f32_16x16x32_bf16 v[208:211], v[32:35], v[104:107], v[208:211]
    ds_read_b64_tr_b16 v[78:79], v4 offset:41984
    v_mfma_f32_16x16x32_bf16 v[224:227], v[32:35], v[112:115], 0
    ds_read_b128 v[104:107], v1 offset:2048
    v_mfma_f32_16x16x32_bf16 v[224:227], v[36:39], v[116:119], v[224:227]
    ds_read_b128 v[108:111], v2 offset:2048
    v_mfma_f32_16x16x32_bf16 v[228:231], v[44:47], v[116:119], 0
    ds_read_b64_tr_b16 v[72:73], v4 offset:32768
    v_mfma_f32_16x16x32_bf16 v[228:231], v[40:43], v[112:115], v[228:231]
    ds_read_b64_tr_b16 v[74:75], v4 offset:33792
    v_mfma_f32_16x16x32_bf16 v[232:235], v[48:51], v[112:115], 0
    ds_read_b64_tr_b16 v[80:81], v3 offset:49152
    v_mfma_f32_16x16x32_bf16 v[232:235], v[52:55], v[116:119], v[232:235]
    ds_read_b64_tr_b16 v[82:83], v3 offset:50176
    v_mfma_f32_16x16x32_bf16 v[236:239], v[60:63], v[116:119], 0
    ds_read_b64_tr_b16 v[84:85], v3 offset:57344
    v_mfma_f32_16x16x32_bf16 v[236:239], v[56:59], v[112:115], v[236:239]
    ds_read_b64_tr_b16 v[86:87], v3 offset:58368
    v_mfma_f32_16x16x32_bf16 v[252:255], v[56:59], v[120:123], 0
    ds_read_b128 v[112:115], v1 offset:4096
    v_mfma_f32_16x16x32_bf16 v[252:255], v[60:63], v[124:127], v[252:255]
    ds_read_b128 v[116:119], v2 offset:4096
    v_mfma_f32_16x16x32_bf16 v[248:251], v[52:55], v[124:127], 0
    ds_read_b64_tr_b16 v[92:93], v4 offset:57344
    v_mfma_f32_16x16x32_bf16 v[248:251], v[48:51], v[120:123], v[248:251]
    ds_read_b64_tr_b16 v[94:95], v4 offset:58368
    v_mfma_f32_16x16x32_bf16 v[244:247], v[40:43], v[120:123], 0
    ds_read_b64_tr_b16 v[88:89], v4 offset:49152
    v_mfma_f32_16x16x32_bf16 v[244:247], v[44:47], v[124:127], v[244:247]
    ds_read_b64_tr_b16 v[90:91], v4 offset:50176
    v_mfma_f32_16x16x32_bf16 v[240:243], v[36:39], v[124:127], 0
    s_add_u32 s68, s68, s74
    v_mfma_f32_16x16x32_bf16 v[240:243], v[32:35], v[120:123], v[240:243]
.p2align 6
p1_FL_loop:
    s_waitcnt lgkmcnt(15)
    v_mfma_f32_16x16x32_bf16 v[128:131], v[64:67], v[96:99], v[128:131]
    ds_read_b128 v[120:123], v1 offset:6144
    v_mfma_f32_16x16x32_bf16 v[128:131], v[68:71], v[100:103], v[128:131]
    ds_read_b128 v[124:127], v2 offset:6144
    s_waitcnt lgkmcnt(15)
    v_mfma_f32_16x16x32_bf16 v[132:135], v[76:79], v[100:103], v[132:135]
    s_waitcnt lgkmcnt(12)
    v_mfma_f32_16x16x32_bf16 v[132:135], v[72:75], v[96:99], v[132:135]
    s_waitcnt lgkmcnt(10)
    v_mfma_f32_16x16x32_bf16 v[136:139], v[80:83], v[96:99], v[136:139]
    s_waitcnt lgkmcnt(8)
    v_mfma_f32_16x16x32_bf16 v[136:139], v[84:87], v[100:103], v[136:139]
    s_waitcnt lgkmcnt(4)
    v_mfma_f32_16x16x32_bf16 v[140:143], v[92:95], v[100:103], v[140:143]
    s_waitcnt lgkmcnt(2)
    v_mfma_f32_16x16x32_bf16 v[140:143], v[88:91], v[96:99], v[140:143]
    v_mfma_f32_16x16x32_bf16 v[156:159], v[88:91], v[104:107], v[156:159]
    ds_read_b128 v[96:99], v1 offset:8192
    v_mfma_f32_16x16x32_bf16 v[156:159], v[92:95], v[108:111], v[156:159]
    ds_read_b128 v[100:103], v2 offset:8192
    v_mfma_f32_16x16x32_bf16 v[152:155], v[84:87], v[108:111], v[152:155]
    v_mfma_f32_16x16x32_bf16 v[152:155], v[80:83], v[104:107], v[152:155]
    v_mfma_f32_16x16x32_bf16 v[148:151], v[72:75], v[104:107], v[148:151]
    v_mfma_f32_16x16x32_bf16 v[148:151], v[76:79], v[108:111], v[148:151]
    v_mfma_f32_16x16x32_bf16 v[144:147], v[68:71], v[108:111], v[144:147]
    v_mfma_f32_16x16x32_bf16 v[144:147], v[64:67], v[104:107], v[144:147]
    v_mfma_f32_16x16x32_bf16 v[160:163], v[64:67], v[112:115], v[160:163]
    ds_read_b128 v[104:107], v1 offset:10240
    v_mfma_f32_16x16x32_bf16 v[160:163], v[68:71], v[116:119], v[160:163]
    ds_read_b128 v[108:111], v2 offset:10240
    v_mfma_f32_16x16x32_bf16 v[164:167], v[76:79], v[116:119], v[164:167]
    v_mfma_f32_16x16x32_bf16 v[164:167], v[72:75], v[112:115], v[164:167]
    v_mfma_f32_16x16x32_bf16 v[168:171], v[80:83], v[112:115], v[168:171]
    v_mfma_f32_16x16x32_bf16 v[168:171], v[84:87], v[116:119], v[168:171]
    v_mfma_f32_16x16x32_bf16 v[172:175], v[92:95], v[116:119], v[172:175]
    v_mfma_f32_16x16x32_bf16 v[172:175], v[88:91], v[112:115], v[172:175]
    s_waitcnt lgkmcnt(5)
    v_mfma_f32_16x16x32_bf16 v[188:191], v[88:91], v[120:123], v[188:191]
    ds_read_b128 v[112:115], v1 offset:12288
    s_waitcnt lgkmcnt(5)
    v_mfma_f32_16x16x32_bf16 v[188:191], v[92:95], v[124:127], v[188:191]
    ds_read_b128 v[116:119], v2 offset:12288
    v_mfma_f32_16x16x32_bf16 v[184:187], v[84:87], v[124:127], v[184:187]
    v_mfma_f32_16x16x32_bf16 v[184:187], v[80:83], v[120:123], v[184:187]
    v_mfma_f32_16x16x32_bf16 v[180:183], v[72:75], v[120:123], v[180:183]
    v_mfma_f32_16x16x32_bf16 v[180:183], v[76:79], v[124:127], v[180:183]
    v_mfma_f32_16x16x32_bf16 v[176:179], v[68:71], v[124:127], v[176:179]
    v_mfma_f32_16x16x32_bf16 v[176:179], v[64:67], v[120:123], v[176:179]
    s_waitcnt lgkmcnt(5)
    v_mfma_f32_16x16x32_bf16 v[192:195], v[64:67], v[96:99], v[192:195]
    ds_read_b128 v[120:123], v1 offset:14336
    s_waitcnt lgkmcnt(5)
    v_mfma_f32_16x16x32_bf16 v[192:195], v[68:71], v[100:103], v[192:195]
    ds_read_b128 v[124:127], v2 offset:14336
    v_mfma_f32_16x16x32_bf16 v[196:199], v[76:79], v[100:103], v[196:199]
    s_cmp_eq_u32 s68, s70
    s_cselect_b32 s74, 0xffff0000, s76
    v_mfma_f32_16x16x32_bf16 v[196:199], v[72:75], v[96:99], v[196:199]
    v_add_u32 v1, s74, v1
    v_mfma_f32_16x16x32_bf16 v[200:203], v[80:83], v[96:99], v[200:203]
    v_add_u32 v2, s74, v2
    v_mfma_f32_16x16x32_bf16 v[200:203], v[84:87], v[100:103], v[200:203]
    v_mfma_f32_16x16x32_bf16 v[204:207], v[92:95], v[100:103], v[204:207]
    v_mfma_f32_16x16x32_bf16 v[204:207], v[88:91], v[96:99], v[204:207]
    s_waitcnt vmcnt(2) lgkmcnt(0)
    s_barrier
    s_add_u32 m0, s71, 0x8000
    s_nop 0
    buffer_load_dwordx4 v8, s[12:15], s65 offen lds
    s_add_u32 m0, s71, 0xc000
    s_nop 0
    buffer_load_dwordx4 v8, s[16:19], s65 offen lds
    s_add_u32 m0, s71, 0x8400
    s_nop 0
    buffer_load_dwordx4 v9, s[12:15], s65 offen lds
    s_add_u32 m0, s71, 0xc400
    s_nop 0
    buffer_load_dwordx4 v9, s[16:19], s65 offen lds
    s_add_u32 m0, s71, 0x8800
    s_nop 0
    buffer_load_dwordx4 v10, s[12:15], s65 offen lds
    s_add_u32 m0, s71, 0xc800
    s_nop 0
    buffer_load_dwordx4 v10, s[16:19], s65 offen lds
    s_add_u32 m0, s71, 0x8c00
    s_nop 0
    buffer_load_dwordx4 v11, s[12:15], s65 offen lds
    s_add_u32 m0, s71, 0xcc00
    s_nop 0
    buffer_load_dwordx4 v11, s[16:19], s65 offen lds
    s_add_u32 s65, s65, s67
    s_nop 0
    s_nop 0
    buffer_load_dword v18, v16, s[52:55], s77 offen
    s_add_u32 s77, s77, s78
    s_nop 0
    s_nop 0
    buffer_load_dword v18, v17, s[20:23], s72 offen
    s_add_u32 s72, s72, s66
    v_mfma_f32_16x16x32_bf16 v[220:223], v[88:91], v[104:107], v[220:223]
    ds_read_b128 v[96:99], v1 offset:0
    v_mfma_f32_16x16x32_bf16 v[220:223], v[92:95], v[108:111], v[220:223]
    ds_read_b128 v[100:103], v2 offset:0
    v_mfma_f32_16x16x32_bf16 v[216:219], v[84:87], v[108:111], v[216:219]
    ds_read_b64_tr_b16 v[32:33], v3 offset:0
    v_mfma_f32_16x16x32_bf16 v[216:219], v[80:83], v[104:107], v[216:219]
    ds_read_b64_tr_b16 v[34:35], v3 offset:1024
    v_mfma_f32_16x16x32_bf16 v[212:215], v[72:75], v[104:107], v[212:215]
    ds_read_b64_tr_b16 v[36:37], v3 offset:8192
    v_mfma_f32_16x16x32_bf16 v[212:215], v[76:79], v[108:111], v[212:215]
    ds_read_b64_tr_b16 v[38:39], v3 offset:9216
    v_mfma_f32_16x16x32_bf16 v[208:211], v[68:71], v[108:111], v[208:211]
    ds_read_b64_tr_b16 v[44:45], v4 offset:8192
    v_mfma_f32_16x16x32_bf16 v[208:211], v[64:67], v[104:107], v[208:211]
    ds_read_b64_tr_b16 v[46:47], v4 offset:9216
    v_mfma_f32_16x16x32_bf16 v[224:227], v[64:67], v[112:115], v[224:227]
    ds_read_b128 v[104:107], v1 offset:2048
    v_mfma_f32_16x16x32_bf16 v[224:227], v[68:71], v[116:119], v[224:227]
    ds_read_b128 v[108:111], v2 offset:2048
    v_mfma_f32_16x16x32_bf16 v[228:231], v[76:79], v[116:119], v[228:231]
    ds_read_b64_tr_b16 v[40:41], v4 offset:0
    v_mfma_f32_16x16x32_bf16 v[228:231], v[72:75], v[112:115], v[228:231]
    ds_read_b64_tr_b16 v[42:43], v4 offset:1024
    v_mfma_f32_16x16x32_bf16 v[232:235], v[80:83], v[112:115], v[232:235]
    ds_read_b64_tr_b16 v[48:49], v3 offset:16384
    v_mfma_f32_16x16x32_bf16 v[232:235], v[84:87], v[116:119], v[232:235]
    ds_read_b64_tr_b16 v[50:51], v3 offset:17408
    v_mfma_f32_16x16x32_bf16 v[236:239], v[92:95], v[116:119], v[236:239]
    ds_read_b64_tr_b16 v[52:53], v3 offset:24576
    v_mfma_f32_16x16x32_bf16 v[236:239], v[88:91], v[112:115], v[236:239]
    ds_read_b64_tr_b16 v[54:55], v3 offset:25600
    v_mfma_f32_16x16x32_bf16 v[252:255], v[88:91], v[120:123], v[252:255]
    ds_read_b128 v[112:115], v1 offset:4096
    v_mfma_f32_16x16x32_bf16 v[252:255], v[92:95], v[124:127], v[252:255]
    ds_read_b128 v[116:119], v2 offset:4096
    v_mfma_f32_16x16x32_bf16 v[248:251], v[84:87], v[124:127], v[248:251]
    ds_read_b64_tr_b16 v[60:61], v4 offset:24576
    v_mfma_f32_16x16x32_bf16 v[248:251], v[80:83], v[120:123], v[248:251]
    ds_read_b64_tr_b16 v[62:63], v4 offset:25600
    v_mfma_f32_16x16x32_bf16 v[244:247], v[72:75], v[120:123], v[244:247]
    ds_read_b64_tr_b16 v[56:57], v4 offset:16384
    v_mfma_f32_16x16x32_bf16 v[244:247], v[76:79], v[124:127], v[244:247]
    ds_read_b64_tr_b16 v[58:59], v4 offset:17408
    v_mfma_f32_16x16x32_bf16 v[240:243], v[68:71], v[124:127], v[240:243]
    s_add_u32 s68, s68, s74
    v_mfma_f32_16x16x32_bf16 v[240:243], v[64:67], v[120:123], v[240:243]
    s_waitcnt lgkmcnt(15)
    v_mfma_f32_16x16x32_bf16 v[128:131], v[32:35], v[96:99], v[128:131]
    ds_read_b128 v[120:123], v1 offset:6144
    v_mfma_f32_16x16x32_bf16 v[128:131], v[36:39], v[100:103], v[128:131]
    ds_read_b128 v[124:127], v2 offset:6144
    s_waitcnt lgkmcnt(15)
    v_mfma_f32_16x16x32_bf16 v[132:135], v[44:47], v[100:103], v[132:135]
    s_waitcnt lgkmcnt(12)
    v_mfma_f32_16x16x32_bf16 v[132:135], v[40:43], v[96:99], v[132:135]
    s_waitcnt lgkmcnt(10)
    v_mfma_f32_16x16x32_bf16 v[136:139], v[48:51], v[96:99], v[136:139]
    s_waitcnt lgkmcnt(8)
    v_mfma_f32_16x16x32_bf16 v[136:139], v[52:55], v[100:103], v[136:139]
    s_waitcnt lgkmcnt(4)
    v_mfma_f32_16x16x32_bf16 v[140:143], v[60:63], v[100:103], v[140:143]
    s_waitcnt lgkmcnt(2)
    v_mfma_f32_16x16x32_bf16 v[140:143], v[56:59], v[96:99], v[140:143]
    v_mfma_f32_16x16x32_bf16 v[156:159], v[56:59], v[104:107], v[156:159]
    ds_read_b128 v[96:99], v1 offset:8192
    v_mfma_f32_16x16x32_bf16 v[156:159], v[60:63], v[108:111], v[156:159]
    ds_read_b128 v[100:103], v2 offset:8192
    v_mfma_f32_16x16x32_bf16 v[152:155], v[52:55], v[108:111], v[152:155]
    v_mfma_f32_16x16x32_bf16 v[152:155], v[48:51], v[104:107], v[152:155]
    v_mfma_f32_16x16x32_bf16 v[148:151], v[40:43], v[104:107], v[148:151]
    v_mfma_f32_16x16x32_bf16 v[148:151], v[44:47], v[108:111], v[148:151]
    v_mfma_f32_16x16x32_bf16 v[144:147], v[36:39], v[108:111], v[144:147]
    v_mfma_f32_16x16x32_bf16 v[144:147], v[32:35], v[104:107], v[144:147]
    v_mfma_f32_16x16x32_bf16 v[160:163], v[32:35], v[112:115], v[160:163]
    ds_read_b128 v[104:107], v1 offset:10240
    v_mfma_f32_16x16x32_bf16 v[160:163], v[36:39], v[116:119], v[160:163]
    ds_read_b128 v[108:111], v2 offset:10240
    v_mfma_f32_16x16x32_bf16 v[164:167], v[44:47], v[116:119], v[164:167]
    v_mfma_f32_16x16x32_bf16 v[164:167], v[40:43], v[112:115], v[164:167]
    v_mfma_f32_16x16x32_bf16 v[168:171], v[48:51], v[112:115], v[168:171]
    v_mfma_f32_16x16x32_bf16 v[168:171], v[52:55], v[116:119], v[168:171]
    v_mfma_f32_16x16x32_bf16 v[172:175], v[60:63], v[116:119], v[172:175]
    v_mfma_f32_16x16x32_bf16 v[172:175], v[56:59], v[112:115], v[172:175]
    s_waitcnt lgkmcnt(5)
    v_mfma_f32_16x16x32_bf16 v[188:191], v[56:59], v[120:123], v[188:191]
    ds_read_b128 v[112:115], v1 offset:12288
    s_waitcnt lgkmcnt(5)
    v_mfma_f32_16x16x32_bf16 v[188:191], v[60:63], v[124:127], v[188:191]
    ds_read_b128 v[116:119], v2 offset:12288
    v_mfma_f32_16x16x32_bf16 v[184:187], v[52:55], v[124:127], v[184:187]
    v_mfma_f32_16x16x32_bf16 v[184:187], v[48:51], v[120:123], v[184:187]
    v_mfma_f32_16x16x32_bf16 v[180:183], v[40:43], v[120:123], v[180:183]
    v_mfma_f32_16x16x32_bf16 v[180:183], v[44:47], v[124:127], v[180:183]
    v_mfma_f32_16x16x32_bf16 v[176:179], v[36:39], v[124:127], v[176:179]
    v_mfma_f32_16x16x32_bf16 v[176:179], v[32:35], v[120:123], v[176:179]
    s_waitcnt lgkmcnt(5)
    v_mfma_f32_16x16x32_bf16 v[192:195], v[32:35], v[96:99], v[192:195]
    ds_read_b128 v[120:123], v1 offset:14336
    s_waitcnt lgkmcnt(5)
    v_mfma_f32_16x16x32_bf16 v[192:195], v[36:39], v[100:103], v[192:195]
    ds_read_b128 v[124:127], v2 offset:14336
    v_mfma_f32_16x16x32_bf16 v[196:199], v[44:47], v[100:103], v[196:199]
    s_cmp_eq_u32 s68, s70
    s_cselect_b32 s74, 0xffff0000, s76
    v_mfma_f32_16x16x32_bf16 v[196:199], v[40:43], v[96:99], v[196:199]
    v_add_u32 v1, s74, v1
    v_mfma_f32_16x16x32_bf16 v[200:203], v[48:51], v[96:99], v[200:203]
    v_add_u32 v2, s74, v2
    v_mfma_f32_16x16x32_bf16 v[200:203], v[52:55], v[100:103], v[200:203]
    v_mfma_f32_16x16x32_bf16 v[204:207], v[60:63], v[100:103], v[204:207]
    v_mfma_f32_16x16x32_bf16 v[204:207], v[56:59], v[96:99], v[204:207]
    s_waitcnt vmcnt(2) lgkmcnt(0)
    s_barrier
    s_mov_b32 m0, s71
    s_nop 0
    buffer_load_dwordx4 v8, s[12:15], s65 offen lds
    s_add_u32 m0, s71, 0x4000
    s_nop 0
    buffer_load_dwordx4 v8, s[16:19], s65 offen lds
    s_add_u32 m0, s71, 0x400
    s_nop 0
    buffer_load_dwordx4 v9, s[12:15], s65 offen lds
    s_add_u32 m0, s71, 0x4400
    s_nop 0
    buffer_load_dwordx4 v9, s[16:19], s65 offen lds
    s_add_u32 m0, s71, 0x800
    s_nop 0
    buffer_load_dwordx4 v10, s[12:15], s65 offen lds
    s_add_u32 m0, s71, 0x4800
    s_nop 0
    buffer_load_dwordx4 v10, s[16:19], s65 offen lds
    s_add_u32 m0, s71, 0xc00
    s_nop 0
    buffer_load_dwordx4 v11, s[12:15], s65 offen lds
    s_add_u32 m0, s71, 0x4c00
    s_nop 0
    buffer_load_dwordx4 v11, s[16:19], s65 offen lds
    s_add_u32 s65, s65, s67
    s_nop 0
    s_nop 0
    buffer_load_dword v18, v16, s[52:55], s77 offen
    s_add_u32 s77, s77, s78
    s_nop 0
    s_nop 0
    buffer_load_dword v18, v17, s[20:23], s72 offen
    s_add_u32 s72, s72, s66
    v_mfma_f32_16x16x32_bf16 v[220:223], v[56:59], v[104:107], v[220:223]
    ds_read_b128 v[96:99], v1 offset:0
    v_mfma_f32_16x16x32_bf16 v[220:223], v[60:63], v[108:111], v[220:223]
    ds_read_b128 v[100:103], v2 offset:0
    v_mfma_f32_16x16x32_bf16 v[216:219], v[52:55], v[108:111], v[216:219]
    ds_read_b64_tr_b16 v[64:65], v3 offset:32768
    v_mfma_f32_16x16x32_bf16 v[216:219], v[48:51], v[104:107], v[216:219]
    ds_read_b64_tr_b16 v[66:67], v3 offset:33792
    v_mfma_f32_16x16x32_bf16 v[212:215], v[40:43], v[104:107], v[212:215]
    ds_read_b64_tr_b16 v[68:69], v3 offset:40960
    v_mfma_f32_16x16x32_bf16 v[212:215], v[44:47], v[108:111], v[212:215]
    ds_read_b64_tr_b16 v[70:71], v3 offset:41984
    v_mfma_f32_16x16x32_bf16 v[208:211], v[36:39], v[108:111], v[208:211]
    ds_read_b64_tr_b16 v[76:77], v4 offset:40960
    v_mfma_f32_16x16x32_bf16 v[208:211], v[32:35], v[104:107], v[208:211]
    ds_read_b64_tr_b16 v[78:79], v4 offset:41984
    v_mfma_f32_16x16x32_bf16 v[224:227], v[32:35], v[112:115], v[224:227]
    ds_read_b128 v[104:107], v1 offset:2048
    v_mfma_f32_16x16x32_bf16 v[224:227], v[36:39], v[116:119], v[224:227]
    ds_read_b128 v[108:111], v2 offset:2048
    v_mfma_f32_16x16x32_bf16 v[228:231], v[44:47], v[116:119], v[228:231]
    ds_read_b64_tr_b16 v[72:73], v4 offset:32768
    v_mfma_f32_16x16x32_bf16 v[228:231], v[40:43], v[112:115], v[228:231]
    ds_read_b64_tr_b16 v[74:75], v4 offset:33792
    v_mfma_f32_16x16x32_bf16 v[232:235], v[48:51], v[112:115], v[232:235]
    ds_read_b64_tr_b16 v[80:81], v3 offset:49152
    v_mfma_f32_16x16x32_bf16 v[232:235], v[52:55], v[116:119], v[232:235]
    ds_read_b64_tr_b16 v[82:83], v3 offset:50176
    v_mfma_f32_16x16x32_bf16 v[236:239], v[60:63], v[116:119], v[236:239]
    ds_read_b64_tr_b16 v[84:85], v3 offset:57344
    v_mfma_f32_16x16x32_bf16 v[236:239], v[56:59], v[112:115], v[236:239]
    ds_read_b64_tr_b16 v[86:87], v3 offset:58368
    v_mfma_f32_16x16x32_bf16 v[252:255], v[56:59], v[120:123], v[252:255]
    ds_read_b128 v[112:115], v1 offset:4096
    v_mfma_f32_16x16x32_bf16 v[252:255], v[60:63], v[124:127], v[252:255]
    ds_read_b128 v[116:119], v2 offset:4096
    v_mfma_f32_16x16x32_bf16 v[248:251], v[52:55], v[124:127], v[248:251]
    ds_read_b64_tr_b16 v[92:93], v4 offset:57344
    v_mfma_f32_16x16x32_bf16 v[248:251], v[48:51], v[120:123], v[248:251]
    ds_read_b64_tr_b16 v[94:95], v4 offset:58368
    v_mfma_f32_16x16x32_bf16 v[244:247], v[40:43], v[120:123], v[244:247]
    ds_read_b64_tr_b16 v[88:89], v4 offset:49152
    v_mfma_f32_16x16x32_bf16 v[244:247], v[44:47], v[124:127], v[244:247]
    ds_read_b64_tr_b16 v[90:91], v4 offset:50176
    v_mfma_f32_16x16x32_bf16 v[240:243], v[36:39], v[124:127], v[240:243]
    s_add_u32 s68, s68, s74
    v_mfma_f32_16x16x32_bf16 v[240:243], v[32:35], v[120:123], v[240:243]
    s_sub_u32 s75, s75, 1
    s_cbranch_scc0 p1_FL_loop
    s_waitcnt lgkmcnt(15)
    v_mfma_f32_16x16x32_bf16 v[128:131], v[64:67], v[96:99], v[128:131]
    ds_read_b128 v[120:123], v1 offset:6144
    v_mfma_f32_16x16x32_bf16 v[128:131], v[68:71], v[100:103], v[128:131]
    ds_read_b128 v[124:127], v2 offset:6144
    s_waitcnt lgkmcnt(15)
    v_mfma_f32_16x16x32_bf16 v[132:135], v[76:79], v[100:103], v[132:135]
    s_waitcnt lgkmcnt(12)
    v_mfma_f32_16x16x32_bf16 v[132:135], v[72:75], v[96:99], v[132:135]
    s_waitcnt lgkmcnt(10)
    v_mfma_f32_16x16x32_bf16 v[136:139], v[80:83], v[96:99], v[136:139]
    s_waitcnt lgkmcnt(8)
    v_mfma_f32_16x16x32_bf16 v[136:139], v[84:87], v[100:103], v[136:139]
    s_waitcnt lgkmcnt(4)
    v_mfma_f32_16x16x32_bf16 v[140:143], v[92:95], v[100:103], v[140:143]
    s_waitcnt lgkmcnt(2)
    v_mfma_f32_16x16x32_bf16 v[140:143], v[88:91], v[96:99], v[140:143]
    v_mfma_f32_16x16x32_bf16 v[156:159], v[88:91], v[104:107], v[156:159]
    ds_read_b128 v[96:99], v1 offset:8192
    v_mfma_f32_16x16x32_bf16 v[156:159], v[92:95], v[108:111], v[156:159]
    ds_read_b128 v[100:103], v2 offset:8192
    v_mfma_f32_16x16x32_bf16 v[152:155], v[84:87], v[108:111], v[152:155]
    v_mfma_f32_16x16x32_bf16 v[152:155], v[80:83], v[104:107], v[152:155]
    v_mfma_f32_16x16x32_bf16 v[148:151], v[72:75], v[104:107], v[148:151]
    v_mfma_f32_16x16x32_bf16 v[148:151], v[76:79], v[108:111], v[148:151]
    v_mfma_f32_16x16x32_bf16 v[144:147], v[68:71], v[108:111], v[144:147]
    v_mfma_f32_16x16x32_bf16 v[144:147], v[64:67], v[104:107], v[144:147]
    v_mfma_f32_16x16x32_bf16 v[160:163], v[64:67], v[112:115], v[160:163]
    ds_read_b128 v[104:107], v1 offset:10240
    v_mfma_f32_16x16x32_bf16 v[160:163], v[68:71], v[116:119], v[160:163]
    ds_read_b128 v[108:111], v2 offset:10240
    v_mfma_f32_16x16x32_bf16 v[164:167], v[76:79], v[116:119], v[164:167]
    v_mfma_f32_16x16x32_bf16 v[164:167], v[72:75], v[112:115], v[164:167]
    v_mfma_f32_16x16x32_bf16 v[168:171], v[80:83], v[112:115], v[168:171]
    v_mfma_f32_16x16x32_bf16 v[168:171], v[84:87], v[116:119], v[168:171]
    v_mfma_f32_16x16x32_bf16 v[172:175], v[92:95], v[116:119], v[172:175]
    v_mfma_f32_16x16x32_bf16 v[172:175], v[88:91], v[112:115], v[172:175]
    s_waitcnt lgkmcnt(5)
    v_mfma_f32_16x16x32_bf16 v[188:191], v[88:91], v[120:123], v[188:191]
    ds_read_b128 v[112:115], v1 offset:12288
    s_waitcnt lgkmcnt(5)
    v_mfma_f32_16x16x32_bf16 v[188:191], v[92:95], v[124:127], v[188:191]
    ds_read_b128 v[116:119], v2 offset:12288
    v_mfma_f32_16x16x32_bf16 v[184:187], v[84:87], v[124:127], v[184:187]
    v_mfma_f32_16x16x32_bf16 v[184:187], v[80:83], v[120:123], v[184:187]
    v_mfma_f32_16x16x32_bf16 v[180:183], v[72:75], v[120:123], v[180:183]
    v_mfma_f32_16x16x32_bf16 v[180:183], v[76:79], v[124:127], v[180:183]
    v_mfma_f32_16x16x32_bf16 v[176:179], v[68:71], v[124:127], v[176:179]
    v_mfma_f32_16x16x32_bf16 v[176:179], v[64:67], v[120:123], v[176:179]
    s_waitcnt lgkmcnt(5)
    v_mfma_f32_16x16x32_bf16 v[192:195], v[64:67], v[96:99], v[192:195]
    ds_read_b128 v[120:123], v1 offset:14336
    s_waitcnt lgkmcnt(5)
    v_mfma_f32_16x16x32_bf16 v[192:195], v[68:71], v[100:103], v[192:195]
    ds_read_b128 v[124:127], v2 offset:14336
    v_mfma_f32_16x16x32_bf16 v[196:199], v[76:79], v[100:103], v[196:199]
    s_cmp_eq_u32 s68, s70
    s_cselect_b32 s74, 0xffff0000, s76
    v_mfma_f32_16x16x32_bf16 v[196:199], v[72:75], v[96:99], v[196:199]
    v_add_u32 v1, s74, v1
    v_mfma_f32_16x16x32_bf16 v[200:203], v[80:83], v[96:99], v[200:203]
    v_add_u32 v2, s74, v2
    v_mfma_f32_16x16x32_bf16 v[200:203], v[84:87], v[100:103], v[200:203]
    v_mfma_f32_16x16x32_bf16 v[204:207], v[92:95], v[100:103], v[204:207]
    v_mfma_f32_16x16x32_bf16 v[204:207], v[88:91], v[96:99], v[204:207]
    s_waitcnt vmcnt(2) lgkmcnt(0)
    s_barrier
    s_add_u32 m0, s71, 0x8000
    s_nop 0
    buffer_load_dwordx4 v8, s[12:15], s65 offen lds
    s_add_u32 m0, s71, 0xc000
    s_nop 0
    buffer_load_dwordx4 v8, s[16:19], s65 offen lds
    s_add_u32 m0, s71, 0x8400
    s_nop 0
    buffer_load_dwordx4 v9, s[12:15], s65 offen lds
    s_add_u32 m0, s71, 0xc400
    s_nop 0
    buffer_load_dwordx4 v9, s[16:19], s65 offen lds
    s_add_u32 m0, s71, 0x8800
    s_nop 0
    buffer_load_dwordx4 v10, s[12:15], s65 offen lds
    s_add_u32 m0, s71, 0xc800
    s_nop 0
    buffer_load_dwordx4 v10, s[16:19], s65 offen lds
    s_add_u32 m0, s71, 0x8c00
    s_nop 0
    buffer_load_dwordx4 v11, s[12:15], s65 offen lds
    s_add_u32 m0, s71, 0xcc00
    s_nop 0
    buffer_load_dwordx4 v11, s[16:19], s65 offen lds
    s_add_u32 s65, s65, s67
    v_mfma_f32_16x16x32_bf16 v[220:223], v[88:91], v[104:107], v[220:223]
    ds_read_b128 v[96:99], v1 offset:0
    v_mfma_f32_16x16x32_bf16 v[220:223], v[92:95], v[108:111], v[220:223]
    ds_read_b128 v[100:103], v2 offset:0
    v_mfma_f32_16x16x32_bf16 v[216:219], v[84:87], v[108:111], v[216:219]
    ds_read_b64_tr_b16 v[32:33], v3 offset:0
    v_mfma_f32_16x16x32_bf16 v[216:219], v[80:83], v[104:107], v[216:219]
    ds_read_b64_tr_b16 v[34:35], v3 offset:1024
    v_mfma_f32_16x16x32_bf16 v[212:215], v[72:75], v[104:107], v[212:215]
    ds_read_b64_tr_b16 v[36:37], v3 offset:8192
    v_mfma_f32_16x16x32_bf16 v[212:215], v[76:79], v[108:111], v[212:215]
    ds_read_b64_tr_b16 v[38:39], v3 offset:9216
    v_mfma_f32_16x16x32_bf16 v[208:211], v[68:71], v[108:111], v[208:211]
    ds_read_b64_tr_b16 v[44:45], v4 offset:8192
    v_mfma_f32_16x16x32_bf16 v[208:211], v[64:67], v[104:107], v[208:211]
    ds_read_b64_tr_b16 v[46:47], v4 offset:9216
    v_mfma_f32_16x16x32_bf16 v[224:227], v[64:67], v[112:115], v[224:227]
    ds_read_b128 v[104:107], v1 offset:2048
    v_mfma_f32_16x16x32_bf16 v[224:227], v[68:71], v[116:119], v[224:227]
    ds_read_b128 v[108:111], v2 offset:2048
    v_mfma_f32_16x16x32_bf16 v[228:231], v[76:79], v[116:119], v[228:231]
    ds_read_b64_tr_b16 v[40:41], v4 offset:0
    v_mfma_f32_16x16x32_bf16 v[228:231], v[72:75], v[112:115], v[228:231]
    ds_read_b64_tr_b16 v[42:43], v4 offset:1024
    v_mfma_f32_16x16x32_bf16 v[232:235], v[80:83], v[112:115], v[232:235]
    ds_read_b64_tr_b16 v[48:49], v3 offset:16384
    v_mfma_f32_16x16x32_bf16 v[232:235], v[84:87], v[116:119], v[232:235]
    ds_read_b64_tr_b16 v[50:51], v3 offset:17408
    v_mfma_f32_16x16x32_bf16 v[236:239], v[92:95], v[116:119], v[236:239]
    ds_read_b64_tr_b16 v[52:53], v3 offset:24576
    v_mfma_f32_16x16x32_bf16 v[236:239], v[88:91], v[112:115], v[236:239]
    ds_read_b64_tr_b16 v[54:55], v3 offset:25600
    v_mfma_f32_16x16x32_bf16 v[252:255], v[88:91], v[120:123], v[252:255]
    ds_read_b128 v[112:115], v1 offset:4096
    v_mfma_f32_16x16x32_bf16 v[252:255], v[92:95], v[124:127], v[252:255]
    ds_read_b128 v[116:119], v2 offset:4096
    v_mfma_f32_16x16x32_bf16 v[248:251], v[84:87], v[124:127], v[248:251]
    ds_read_b64_tr_b16 v[60:61], v4 offset:24576
    v_mfma_f32_16x16x32_bf16 v[248:251], v[80:83], v[120:123], v[248:251]
    ds_read_b64_tr_b16 v[62:63], v4 offset:25600
    v_mfma_f32_16x16x32_bf16 v[244:247], v[72:75], v[120:123], v[244:247]
    ds_read_b64_tr_b16 v[56:57], v4 offset:16384
    v_mfma_f32_16x16x32_bf16 v[244:247], v[76:79], v[124:127], v[244:247]
    ds_read_b64_tr_b16 v[58:59], v4 offset:17408
    v_mfma_f32_16x16x32_bf16 v[240:243], v[68:71], v[124:127], v[240:243]
    s_add_u32 s68, s68, s74
    v_mfma_f32_16x16x32_bf16 v[240:243], v[64:67], v[120:123], v[240:243]
    s_waitcnt lgkmcnt(15)
    v_mfma_f32_16x16x32_bf16 v[128:131], v[32:35], v[96:99], v[128:131]
    ds_read_b128 v[120:123], v1 offset:6144
    v_mfma_f32_16x16x32_bf16 v[128:131], v[36:39], v[100:103], v[128:131]
    ds_read_b128 v[124:127], v2 offset:6144
    s_waitcnt lgkmcnt(15)
    v_mfma_f32_16x16x32_bf16 v[132:135], v[44:47], v[100:103], v[132:135]
    s_waitcnt lgkmcnt(12)
    v_mfma_f32_16x16x32_bf16 v[132:135], v[40:43], v[96:99], v[132:135]
    s_waitcnt lgkmcnt(10)
    v_mfma_f32_16x16x32_bf16 v[136:139], v[48:51], v[96:99], v[136:139]
    s_waitcnt lgkmcnt(8)
    v_mfma_f32_16x16x32_bf16 v[136:139], v[52:55], v[100:103], v[136:139]
    s_waitcnt lgkmcnt(4)
    v_mfma_f32_16x16x32_bf16 v[140:143], v[60:63], v[100:103], v[140:143]
    s_waitcnt lgkmcnt(2)
    v_mfma_f32_16x16x32_bf16 v[140:143], v[56:59], v[96:99], v[140:143]
    v_mfma_f32_16x16x32_bf16 v[156:159], v[56:59], v[104:107], v[156:159]
    ds_read_b128 v[96:99], v1 offset:8192
    v_mfma_f32_16x16x32_bf16 v[156:159], v[60:63], v[108:111], v[156:159]
    ds_read_b128 v[100:103], v2 offset:8192
    v_mfma_f32_16x16x32_bf16 v[152:155], v[52:55], v[108:111], v[152:155]
    v_mfma_f32_16x16x32_bf16 v[152:155], v[48:51], v[104:107], v[152:155]
    v_mfma_f32_16x16x32_bf16 v[148:151], v[40:43], v[104:107], v[148:151]
    v_mfma_f32_16x16x32_bf16 v[148:151], v[44:47], v[108:111], v[148:151]
    v_mfma_f32_16x16x32_bf16 v[144:147], v[36:39], v[108:111], v[144:147]
    v_mfma_f32_16x16x32_bf16 v[144:147], v[32:35], v[104:107], v[144:147]
    v_mfma_f32_16x16x32_bf16 v[160:163], v[32:35], v[112:115], v[160:163]
    ds_read_b128 v[104:107], v1 offset:10240
    v_mfma_f32_16x16x32_bf16 v[160:163], v[36:39], v[116:119], v[160:163]
    ds_read_b128 v[108:111], v2 offset:10240
    v_mfma_f32_16x16x32_bf16 v[164:167], v[44:47], v[116:119], v[164:167]
    v_mfma_f32_16x16x32_bf16 v[164:167], v[40:43], v[112:115], v[164:167]
    v_mfma_f32_16x16x32_bf16 v[168:171], v[48:51], v[112:115], v[168:171]
    v_mfma_f32_16x16x32_bf16 v[168:171], v[52:55], v[116:119], v[168:171]
    v_mfma_f32_16x16x32_bf16 v[172:175], v[60:63], v[116:119], v[172:175]
    v_mfma_f32_16x16x32_bf16 v[172:175], v[56:59], v[112:115], v[172:175]
    s_waitcnt lgkmcnt(5)
    v_mfma_f32_16x16x32_bf16 v[188:191], v[56:59], v[120:123], v[188:191]
    ds_read_b128 v[112:115], v1 offset:12288
    s_waitcnt lgkmcnt(5)
    v_mfma_f32_16x16x32_bf16 v[188:191], v[60:63], v[124:127], v[188:191]
    ds_read_b128 v[116:119], v2 offset:12288
    v_mfma_f32_16x16x32_bf16 v[184:187], v[52:55], v[124:127], v[184:187]
    v_mfma_f32_16x16x32_bf16 v[184:187], v[48:51], v[120:123], v[184:187]
    v_mfma_f32_16x16x32_bf16 v[180:183], v[40:43], v[120:123], v[180:183]
    v_mfma_f32_16x16x32_bf16 v[180:183], v[44:47], v[124:127], v[180:183]
    v_mfma_f32_16x16x32_bf16 v[176:179], v[36:39], v[124:127], v[176:179]
    v_mfma_f32_16x16x32_bf16 v[176:179], v[32:35], v[120:123], v[176:179]
    s_waitcnt lgkmcnt(5)
    v_mfma_f32_16x16x32_bf16 v[192:195], v[32:35], v[96:99], v[192:195]
    ds_read_b128 v[120:123], v1 offset:14336
    s_waitcnt lgkmcnt(5)
    v_mfma_f32_16x16x32_bf16 v[192:195], v[36:39], v[100:103], v[192:195]
    ds_read_b128 v[124:127], v2 offset:14336
    v_mfma_f32_16x16x32_bf16 v[196:199], v[44:47], v[100:103], v[196:199]
    s_cmp_eq_u32 s68, s70
    s_cselect_b32 s74, 0xffff0000, s76
    v_mfma_f32_16x16x32_bf16 v[196:199], v[40:43], v[96:99], v[196:199]
    v_add_u32 v1, s74, v1
    v_mfma_f32_16x16x32_bf16 v[200:203], v[48:51], v[96:99], v[200:203]
    v_add_u32 v2, s74, v2
    v_mfma_f32_16x16x32_bf16 v[200:203], v[52:55], v[100:103], v[200:203]
    v_mfma_f32_16x16x32_bf16 v[204:207], v[60:63], v[100:103], v[204:207]
    v_mfma_f32_16x16x32_bf16 v[204:207], v[56:59], v[96:99], v[204:207]
    s_waitcnt vmcnt(0) lgkmcnt(0)
    s_barrier
    s_load_dwordx2 s[20:21], s[0:1], 64
    s_load_dwordx2 s[24:25], s[0:1], 88
    s_mov_b32 s22, 0x700000
    s_mov_b32 s26, 256
    s_mov_b32 s27, 0x20000
    v_lshrrev_b32 v9, 3, v0
    v_bfe_u32 v10, v0, 1, 2
    v_lshrrev_b32 v11, 4, v0
    v_xor_b32 v10, v10, v11
    v_lshlrev_b32 v9, 11, v9
    v_lshl_add_u32 v9, v10, 5, v9
    v_and_b32 v10, 1, v0
    v_lshl_add_u32 v9, v10, 4, v9
    s_and_b32 s4, s2, 1
    s_lshl_b32 s4, s4, 3
    s_lshr_b32 s5, s2, 5
    s_add_u32 s4, s4, s5
    s_lshl_b32 s4, s4, 7
    s_lshl_b32 s5, s60, 14
    s_add_u32 s5, s5, s4
    v_add_u32 v6, s5, v9
    v_add_u32 v7, 0x10000, v6
    v_add_u32 v8, 0x20000, v6
    s_lshl_b32 s6, s60, 10
    s_add_u32 s6, s6, 0x14000
    v_lshlrev_b32 v9, 2, v0
    s_waitcnt lgkmcnt(0)
    buffer_load_dword v10, v9, s[24:27], 0 offen sc1
    s_mov_b32 m0, s6
    s_mov_b32 s7, 0x0
    buffer_load_dwordx4 v6, s[20:23], s7 offen lds
    s_add_u32 m0, s6, 4096
    s_mov_b32 s7, 0x0
    buffer_load_dwordx4 v7, s[20:23], s7 offen lds
    s_add_u32 m0, s6, 8192
    s_mov_b32 s7, 0x0
    buffer_load_dwordx4 v8, s[20:23], s7 offen lds
    s_add_u32 m0, s6, 12288
    s_mov_b32 s7, 0x30000
    buffer_load_dwordx4 v6, s[20:23], s7 offen lds
    s_add_u32 m0, s6, 16384
    s_mov_b32 s7, 0x30000
    buffer_load_dwordx4 v7, s[20:23], s7 offen lds
    s_add_u32 m0, s6, 20480
    s_mov_b32 s7, 0x30000
    buffer_load_dwordx4 v8, s[20:23], s7 offen lds
    s_add_u32 m0, s6, 24576
    s_mov_b32 s7, 0x60000
    buffer_load_dwordx4 v6, s[20:23], s7 offen lds
    s_add_u32 m0, s6, 28672
    s_mov_b32 s7, 0x60000
    buffer_load_dwordx4 v7, s[20:23], s7 offen lds
    s_add_u32 m0, s6, 32768
    s_mov_b32 s7, 0x60000
    buffer_load_dwordx4 v8, s[20:23], s7 offen lds
    s_add_u32 m0, s6, 36864
    s_mov_b32 s7, 0x90000
    buffer_load_dwordx4 v6, s[20:23], s7 offen lds
    v_mfma_f32_16x16x32_bf16 v[220:223], v[56:59], v[104:107], v[220:223]
    ds_read_b128 v[96:99], v1 offset:0
    v_mfma_f32_16x16x32_bf16 v[220:223], v[60:63], v[108:111], v[220:223]
    ds_read_b128 v[100:103], v2 offset:0
    v_mfma_f32_16x16x32_bf16 v[216:219], v[52:55], v[108:111], v[216:219]
    ds_read_b64_tr_b16 v[64:65], v3 offset:32768
    v_mfma_f32_16x16x32_bf16 v[216:219], v[48:51], v[104:107], v[216:219]
    ds_read_b64_tr_b16 v[66:67], v3 offset:33792
    v_mfma_f32_16x16x32_bf16 v[212:215], v[40:43], v[104:107], v[212:215]
    ds_read_b64_tr_b16 v[68:69], v3 offset:40960
    v_mfma_f32_16x16x32_bf16 v[212:215], v[44:47], v[108:111], v[212:215]
    ds_read_b64_tr_b16 v[70:71], v3 offset:41984
    v_mfma_f32_16x16x32_bf16 v[208:211], v[36:39], v[108:111], v[208:211]
    ds_read_b64_tr_b16 v[76:77], v4 offset:40960
    v_mfma_f32_16x16x32_bf16 v[208:211], v[32:35], v[104:107], v[208:211]
    ds_read_b64_tr_b16 v[78:79], v4 offset:41984
    v_mfma_f32_16x16x32_bf16 v[224:227], v[32:35], v[112:115], v[224:227]
    ds_read_b128 v[104:107], v1 offset:2048
    v_mfma_f32_16x16x32_bf16 v[224:227], v[36:39], v[116:119], v[224:227]
    ds_read_b128 v[108:111], v2 offset:2048
    v_mfma_f32_16x16x32_bf16 v[228:231], v[44:47], v[116:119], v[228:231]
    ds_read_b64_tr_b16 v[72:73], v4 offset:32768
    v_mfma_f32_16x16x32_bf16 v[228:231], v[40:43], v[112:115], v[228:231]
    ds_read_b64_tr_b16 v[74:75], v4 offset:33792
    v_mfma_f32_16x16x32_bf16 v[232:235], v[48:51], v[112:115], v[232:235]
    ds_read_b64_tr_b16 v[80:81], v3 offset:49152
    v_mfma_f32_16x16x32_bf16 v[232:235], v[52:55], v[116:119], v[232:235]
    ds_read_b64_tr_b16 v[82:83], v3 offset:50176
    v_mfma_f32_16x16x32_bf16 v[236:239], v[60:63], v[116:119], v[236:239]
    ds_read_b64_tr_b16 v[84:85], v3 offset:57344
    v_mfma_f32_16x16x32_bf16 v[236:239], v[56:59], v[112:115], v[236:239]
    ds_read_b64_tr_b16 v[86:87], v3 offset:58368
    v_mfma_f32_16x16x32_bf16 v[252:255], v[56:59], v[120:123], v[252:255]
    ds_read_b128 v[112:115], v1 offset:4096
    v_mfma_f32_16x16x32_bf16 v[252:255], v[60:63], v[124:127], v[252:255]
    ds_read_b128 v[116:119], v2 offset:4096
    v_mfma_f32_16x16x32_bf16 v[248:251], v[52:55], v[124:127], v[248:251]
    ds_read_b64_tr_b16 v[92:93], v4 offset:57344
    v_mfma_f32_16x16x32_bf16 v[248:251], v[48:51], v[120:123], v[248:251]
    ds_read_b64_tr_b16 v[94:95], v4 offset:58368
    v_mfma_f32_16x16x32_bf16 v[244:247], v[40:43], v[120:123], v[244:247]
    ds_read_b64_tr_b16 v[88:89], v4 offset:49152
    v_mfma_f32_16x16x32_bf16 v[244:247], v[44:47], v[124:127], v[244:247]
    ds_read_b64_tr_b16 v[90:91], v4 offset:50176
    v_mfma_f32_16x16x32_bf16 v[240:243], v[36:39], v[124:127], v[240:243]
    s_add_u32 s68, s68, s74
    v_mfma_f32_16x16x32_bf16 v[240:243], v[32:35], v[120:123], v[240:243]
    s_waitcnt lgkmcnt(15)
    v_mfma_f32_16x16x32_bf16 v[128:131], v[64:67], v[96:99], v[128:131]
    ds_read_b128 v[120:123], v1 offset:6144
    v_lshlrev_b32 v14, 4, v0
    s_lshl_b32 s4, s56, 3
    s_lshl_b32 s5, s59, 2
    v_mfma_f32_16x16x32_bf16 v[128:131], v[68:71], v[100:103], v[128:131]
    ds_read_b128 v[124:127], v2 offset:6144
    s_add_u32 s84, s4, s5
    s_lshl_b32 s5, s57, 2
    s_add_u32 s5, s5, s60
    s_waitcnt lgkmcnt(15)
    v_mfma_f32_16x16x32_bf16 v[132:135], v[76:79], v[100:103], v[132:135]
    s_lshl_b32 s5, s5, 6
    s_add_u32 s4, s5, s84
    s_lshl_b32 s84, s4, 11
    s_waitcnt lgkmcnt(12)
    v_mfma_f32_16x16x32_bf16 v[132:135], v[72:75], v[96:99], v[132:135]
    s_mov_b32 s82, 0xbfb8aa3b
    s_mov_b32 s83, 0xbfb8aa3b
    s_waitcnt lgkmcnt(10)
    v_mfma_f32_16x16x32_bf16 v[136:139], v[80:83], v[96:99], v[136:139]
    s_waitcnt lgkmcnt(8)
    v_mfma_f32_16x16x32_bf16 v[136:139], v[84:87], v[100:103], v[136:139]
    s_waitcnt lgkmcnt(4)
    v_mfma_f32_16x16x32_bf16 v[140:143], v[92:95], v[100:103], v[140:143]
    s_waitcnt lgkmcnt(2)
    v_mfma_f32_16x16x32_bf16 v[140:143], v[88:91], v[96:99], v[140:143]
    v_mfma_f32_16x16x32_bf16 v[156:159], v[88:91], v[104:107], v[156:159]
    ds_read_b128 v[96:99], v1 offset:8192
    v_mfma_f32_16x16x32_bf16 v[156:159], v[92:95], v[108:111], v[156:159]
    ds_read_b128 v[100:103], v2 offset:8192
    v_mfma_f32_16x16x32_bf16 v[152:155], v[84:87], v[108:111], v[152:155]
    v_mfma_f32_16x16x32_bf16 v[152:155], v[80:83], v[104:107], v[152:155]
    v_mfma_f32_16x16x32_bf16 v[148:151], v[72:75], v[104:107], v[148:151]
    v_mul_f32 v128, s82, v128
    v_mul_f32 v129, s82, v129
    v_mul_f32 v130, s82, v130
    v_mul_f32 v131, s82, v131
    v_mul_f32 v132, s82, v132
    v_mul_f32 v133, s82, v133
    v_mfma_f32_16x16x32_bf16 v[148:151], v[76:79], v[108:111], v[148:151]
    v_mul_f32 v134, s82, v134
    v_mul_f32 v135, s82, v135
    v_exp_f32 v128, v128
    v_exp_f32 v129, v129
    v_exp_f32 v130, v130
    v_exp_f32 v131, v131
    v_mfma_f32_16x16x32_bf16 v[144:147], v[68:71], v[108:111], v[144:147]
    v_exp_f32 v132, v132
    v_exp_f32 v133, v133
    v_exp_f32 v134, v134
    v_exp_f32 v135, v135
    v_add_f32 v128, 1.0, v128
    v_add_f32 v129, 1.0, v129
    v_mfma_f32_16x16x32_bf16 v[144:147], v[64:67], v[104:107], v[144:147]
    v_add_f32 v130, 1.0, v130
    v_add_f32 v131, 1.0, v131
    v_add_f32 v132, 1.0, v132
    v_add_f32 v133, 1.0, v133
    v_add_f32 v134, 1.0, v134
    v_add_f32 v135, 1.0, v135
    v_mfma_f32_16x16x32_bf16 v[160:163], v[64:67], v[112:115], v[160:163]
    ds_read_b128 v[104:107], v1 offset:10240
    v_rcp_f32 v128, v128
    v_rcp_f32 v129, v129
    v_rcp_f32 v130, v130
    v_rcp_f32 v131, v131
    v_rcp_f32 v132, v132
    v_rcp_f32 v133, v133
    v_mfma_f32_16x16x32_bf16 v[160:163], v[68:71], v[116:119], v[160:163]
    ds_read_b128 v[108:111], v2 offset:10240
    v_rcp_f32 v134, v134
    v_rcp_f32 v135, v135
    v_mul_f32 v136, v136, v128
    v_mul_f32 v137, v137, v129
    v_mul_f32 v138, v138, v130
    v_mul_f32 v139, v139, v131
    v_mfma_f32_16x16x32_bf16 v[164:167], v[76:79], v[116:119], v[164:167]
    v_mul_f32 v140, v140, v132
    v_mul_f32 v141, v141, v133
    v_mul_f32 v142, v142, v134
    v_mul_f32 v143, v143, v135
    v_cvt_pk_bf16_f32 v32, v136, v137
    v_cvt_pk_bf16_f32 v33, v138, v139
    v_mfma_f32_16x16x32_bf16 v[164:167], v[72:75], v[112:115], v[164:167]
    v_cvt_pk_bf16_f32 v34, v140, v141
    v_cvt_pk_bf16_f32 v35, v142, v143
    buffer_store_dwordx4 v[32:35], v14, s[44:47], s84 offen offset:0 sc1
    v_mul_f32 v144, s82, v144
    v_mul_f32 v145, s82, v145
    v_mul_f32 v146, s82, v146
    v_mul_f32 v147, s82, v147
    v_mul_f32 v148, s82, v148
    v_mul_f32 v149, s82, v149
    v_mfma_f32_16x16x32_bf16 v[168:171], v[80:83], v[112:115], v[168:171]
    v_mul_f32 v150, s82, v150
    v_mul_f32 v151, s82, v151
    v_exp_f32 v144, v144
    v_exp_f32 v145, v145
    v_exp_f32 v146, v146
    v_exp_f32 v147, v147
    v_mfma_f32_16x16x32_bf16 v[168:171], v[84:87], v[116:119], v[168:171]
    v_exp_f32 v148, v148
    v_exp_f32 v149, v149
    v_exp_f32 v150, v150
    v_exp_f32 v151, v151
    v_add_f32 v144, 1.0, v144
    v_add_f32 v145, 1.0, v145
    v_mfma_f32_16x16x32_bf16 v[172:175], v[92:95], v[116:119], v[172:175]
    v_add_f32 v146, 1.0, v146
    v_add_f32 v147, 1.0, v147
    v_add_f32 v148, 1.0, v148
    v_add_f32 v149, 1.0, v149
    v_add_f32 v150, 1.0, v150
    v_add_f32 v151, 1.0, v151
    v_mfma_f32_16x16x32_bf16 v[172:175], v[88:91], v[112:115], v[172:175]
    v_rcp_f32 v144, v144
    v_rcp_f32 v145, v145
    v_rcp_f32 v146, v146
    v_rcp_f32 v147, v147
    v_rcp_f32 v148, v148
    v_rcp_f32 v149, v149
    s_waitcnt lgkmcnt(5)
    v_mfma_f32_16x16x32_bf16 v[188:191], v[88:91], v[120:123], v[188:191]
    ds_read_b128 v[112:115], v1 offset:12288
    v_rcp_f32 v150, v150
    v_rcp_f32 v151, v151
    v_mul_f32 v152, v152, v144
    v_mul_f32 v153, v153, v145
    v_mul_f32 v154, v154, v146
    v_mul_f32 v155, v155, v147
    s_waitcnt lgkmcnt(5)
    v_mfma_f32_16x16x32_bf16 v[188:191], v[92:95], v[124:127], v[188:191]
    ds_read_b128 v[116:119], v2 offset:12288
    v_mul_f32 v156, v156, v148
    v_mul_f32 v157, v157, v149
    v_mul_f32 v158, v158, v150
    v_mul_f32 v159, v159, v151
    v_cvt_pk_bf16_f32 v36, v152, v153
    v_cvt_pk_bf16_f32 v37, v154, v155
    v_mfma_f32_16x16x32_bf16 v[184:187], v[84:87], v[124:127], v[184:187]
    v_cvt_pk_bf16_f32 v38, v156, v157
    v_cvt_pk_bf16_f32 v39, v158, v159
    buffer_store_dwordx4 v[36:39], v14, s[44:47], s84 offen offset:1024 sc1
    s_add_u32 s84, s84, 2048
    v_mfma_f32_16x16x32_bf16 v[184:187], v[80:83], v[120:123], v[184:187]
    v_mul_f32 v160, s82, v160
    v_mul_f32 v161, s82, v161
    v_mul_f32 v162, s82, v162
    v_mul_f32 v163, s82, v163
    v_mul_f32 v164, s82, v164
    v_mul_f32 v165, s82, v165
    v_mfma_f32_16x16x32_bf16 v[180:183], v[72:75], v[120:123], v[180:183]
    v_mul_f32 v166, s82, v166
    v_mul_f32 v167, s82, v167
    v_exp_f32 v160, v160
    v_exp_f32 v161, v161
    v_exp_f32 v162, v162
    v_exp_f32 v163, v163
    v_mfma_f32_16x16x32_bf16 v[180:183], v[76:79], v[124:127], v[180:183]
    v_exp_f32 v164, v164
    v_exp_f32 v165, v165
    v_exp_f32 v166, v166
    v_exp_f32 v167, v167
    v_add_f32 v160, 1.0, v160
    v_add_f32 v161, 1.0, v161
    v_mfma_f32_16x16x32_bf16 v[176:179], v[68:71], v[124:127], v[176:179]
    v_add_f32 v162, 1.0, v162
    v_add_f32 v163, 1.0, v163
    v_add_f32 v164, 1.0, v164
    v_add_f32 v165, 1.0, v165
    v_add_f32 v166, 1.0, v166
    v_add_f32 v167, 1.0, v167
    v_mfma_f32_16x16x32_bf16 v[176:179], v[64:67], v[120:123], v[176:179]
    v_rcp_f32 v160, v160
    v_rcp_f32 v161, v161
    v_rcp_f32 v162, v162
    v_rcp_f32 v163, v163
    v_rcp_f32 v164, v164
    v_rcp_f32 v165, v165
    s_waitcnt lgkmcnt(5)
    v_mfma_f32_16x16x32_bf16 v[192:195], v[64:67], v[96:99], v[192:195]
    ds_read_b128 v[120:123], v1 offset:14336
    v_rcp_f32 v166, v166
    v_rcp_f32 v167, v167
    v_mul_f32 v168, v168, v160
    v_mul_f32 v169, v169, v161
    v_mul_f32 v170, v170, v162
    v_mul_f32 v171, v171, v163
    s_waitcnt lgkmcnt(5)
    v_mfma_f32_16x16x32_bf16 v[192:195], v[68:71], v[100:103], v[192:195]
    ds_read_b128 v[124:127], v2 offset:14336
    v_mul_f32 v172, v172, v164
    v_mul_f32 v173, v173, v165
    v_mul_f32 v174, v174, v166
    v_mul_f32 v175, v175, v167
    v_cvt_pk_bf16_f32 v32, v168, v169
    v_cvt_pk_bf16_f32 v33, v170, v171
    v_mfma_f32_16x16x32_bf16 v[196:199], v[76:79], v[100:103], v[196:199]
    v_cvt_pk_bf16_f32 v34, v172, v173
    v_cvt_pk_bf16_f32 v35, v174, v175
    buffer_store_dwordx4 v[32:35], v14, s[44:47], s84 offen offset:0 sc1
    v_mfma_f32_16x16x32_bf16 v[196:199], v[72:75], v[96:99], v[196:199]
    v_mul_f32 v176, s82, v176
    v_mul_f32 v177, s82, v177
    v_mul_f32 v178, s82, v178
    v_mul_f32 v179, s82, v179
    v_mul_f32 v180, s82, v180
    v_mul_f32 v181, s82, v181
    v_mfma_f32_16x16x32_bf16 v[200:203], v[80:83], v[96:99], v[200:203]
    v_mul_f32 v182, s82, v182
    v_mul_f32 v183, s82, v183
    v_exp_f32 v176, v176
    v_exp_f32 v177, v177
    v_exp_f32 v178, v178
    v_exp_f32 v179, v179
    v_mfma_f32_16x16x32_bf16 v[200:203], v[84:87], v[100:103], v[200:203]
    v_exp_f32 v180, v180
    v_exp_f32 v181, v181
    v_exp_f32 v182, v182
    v_exp_f32 v183, v183
    v_add_f32 v176, 1.0, v176
    v_add_f32 v177, 1.0, v177
    v_mfma_f32_16x16x32_bf16 v[204:207], v[92:95], v[100:103], v[204:207]
    v_add_f32 v178, 1.0, v178
    v_add_f32 v179, 1.0, v179
    v_add_f32 v180, 1.0, v180
    v_add_f32 v181, 1.0, v181
    v_add_f32 v182, 1.0, v182
    v_add_f32 v183, 1.0, v183
    v_mfma_f32_16x16x32_bf16 v[204:207], v[88:91], v[96:99], v[204:207]
    v_rcp_f32 v176, v176
    v_rcp_f32 v177, v177
    v_rcp_f32 v178, v178
    v_rcp_f32 v179, v179
    v_rcp_f32 v180, v180
    v_rcp_f32 v181, v181
    s_waitcnt lgkmcnt(5)
    v_mfma_f32_16x16x32_bf16 v[220:223], v[88:91], v[104:107], v[220:223]
    v_rcp_f32 v182, v182
    v_rcp_f32 v183, v183
    v_mul_f32 v184, v184, v176
    v_mul_f32 v185, v185, v177
    v_mul_f32 v186, v186, v178
    v_mul_f32 v187, v187, v179
    s_waitcnt lgkmcnt(4)
    v_mfma_f32_16x16x32_bf16 v[220:223], v[92:95], v[108:111], v[220:223]
    v_mul_f32 v188, v188, v180
    v_mul_f32 v189, v189, v181
    v_mul_f32 v190, v190, v182
    v_mul_f32 v191, v191, v183
    v_cvt_pk_bf16_f32 v36, v184, v185
    v_cvt_pk_bf16_f32 v37, v186, v187
    v_mfma_f32_16x16x32_bf16 v[216:219], v[84:87], v[108:111], v[216:219]
    v_cvt_pk_bf16_f32 v38, v188, v189
    v_cvt_pk_bf16_f32 v39, v190, v191
    buffer_store_dwordx4 v[36:39], v14, s[44:47], s84 offen offset:1024 sc1
    s_add_u32 s84, s84, 2048
    v_mfma_f32_16x16x32_bf16 v[216:219], v[80:83], v[104:107], v[216:219]
    v_mul_f32 v192, s82, v192
    v_mul_f32 v193, s82, v193
    v_mul_f32 v194, s82, v194
    v_mul_f32 v195, s82, v195
    v_mul_f32 v196, s82, v196
    v_mul_f32 v197, s82, v197
    v_mfma_f32_16x16x32_bf16 v[212:215], v[72:75], v[104:107], v[212:215]
    v_mul_f32 v198, s82, v198
    v_mul_f32 v199, s82, v199
    v_exp_f32 v192, v192
    v_exp_f32 v193, v193
    v_exp_f32 v194, v194
    v_exp_f32 v195, v195
    v_mfma_f32_16x16x32_bf16 v[212:215], v[76:79], v[108:111], v[212:215]
    v_exp_f32 v196, v196
    v_exp_f32 v197, v197
    v_exp_f32 v198, v198
    v_exp_f32 v199, v199
    v_add_f32 v192, 1.0, v192
    v_add_f32 v193, 1.0, v193
    v_mfma_f32_16x16x32_bf16 v[208:211], v[68:71], v[108:111], v[208:211]
    v_add_f32 v194, 1.0, v194
    v_add_f32 v195, 1.0, v195
    v_add_f32 v196, 1.0, v196
    v_add_f32 v197, 1.0, v197
    v_add_f32 v198, 1.0, v198
    v_add_f32 v199, 1.0, v199
    v_mfma_f32_16x16x32_bf16 v[208:211], v[64:67], v[104:107], v[208:211]
    v_rcp_f32 v192, v192
    v_rcp_f32 v193, v193
    v_rcp_f32 v194, v194
    v_rcp_f32 v195, v195
    v_rcp_f32 v196, v196
    v_rcp_f32 v197, v197
    s_waitcnt lgkmcnt(3)
    v_mfma_f32_16x16x32_bf16 v[224:227], v[64:67], v[112:115], v[224:227]
    v_rcp_f32 v198, v198
    v_rcp_f32 v199, v199
    v_mul_f32 v200, v200, v192
    v_mul_f32 v201, v201, v193
    v_mul_f32 v202, v202, v194
    v_mul_f32 v203, v203, v195
    s_waitcnt lgkmcnt(2)
    v_mfma_f32_16x16x32_bf16 v[224:227], v[68:71], v[116:119], v[224:227]
    v_mul_f32 v204, v204, v196
    v_mul_f32 v205, v205, v197
    v_mul_f32 v206, v206, v198
    v_mul_f32 v207, v207, v199
    v_cvt_pk_bf16_f32 v32, v200, v201
    v_cvt_pk_bf16_f32 v33, v202, v203
    v_mfma_f32_16x16x32_bf16 v[228:231], v[76:79], v[116:119], v[228:231]
    v_cvt_pk_bf16_f32 v34, v204, v205
    v_cvt_pk_bf16_f32 v35, v206, v207
    buffer_store_dwordx4 v[32:35], v14, s[44:47], s84 offen offset:0 sc1
    v_mfma_f32_16x16x32_bf16 v[228:231], v[72:75], v[112:115], v[228:231]
    v_mul_f32 v208, s82, v208
    v_mul_f32 v209, s82, v209
    v_mul_f32 v210, s82, v210
    v_mul_f32 v211, s82, v211
    v_mul_f32 v212, s82, v212
    v_mul_f32 v213, s82, v213
    v_mfma_f32_16x16x32_bf16 v[232:235], v[80:83], v[112:115], v[232:235]
    v_mul_f32 v214, s82, v214
    v_mul_f32 v215, s82, v215
    v_exp_f32 v208, v208
    v_exp_f32 v209, v209
    v_exp_f32 v210, v210
    v_exp_f32 v211, v211
    v_mfma_f32_16x16x32_bf16 v[232:235], v[84:87], v[116:119], v[232:235]
    v_exp_f32 v212, v212
    v_exp_f32 v213, v213
    v_exp_f32 v214, v214
    v_exp_f32 v215, v215
    v_add_f32 v208, 1.0, v208
    v_add_f32 v209, 1.0, v209
    v_mfma_f32_16x16x32_bf16 v[236:239], v[92:95], v[116:119], v[236:239]
    v_add_f32 v210, 1.0, v210
    v_add_f32 v211, 1.0, v211
    v_add_f32 v212, 1.0, v212
    v_add_f32 v213, 1.0, v213
    v_add_f32 v214, 1.0, v214
    v_add_f32 v215, 1.0, v215
    v_mfma_f32_16x16x32_bf16 v[236:239], v[88:91], v[112:115], v[236:239]
    v_rcp_f32 v208, v208
    v_rcp_f32 v209, v209
    v_rcp_f32 v210, v210
    v_rcp_f32 v211, v211
    v_rcp_f32 v212, v212
    v_rcp_f32 v213, v213
    s_waitcnt lgkmcnt(1)
    v_mfma_f32_16x16x32_bf16 v[252:255], v[88:91], v[120:123], v[252:255]
    v_rcp_f32 v214, v214
    v_rcp_f32 v215, v215
    v_mul_f32 v216, v216, v208
    v_mul_f32 v217, v217, v209
    v_mul_f32 v218, v218, v210
    v_mul_f32 v219, v219, v211
    s_waitcnt lgkmcnt(0)
    v_mfma_f32_16x16x32_bf16 v[252:255], v[92:95], v[124:127], v[252:255]
    v_mul_f32 v220, v220, v212
    v_mul_f32 v221, v221, v213
    v_mul_f32 v222, v222, v214
    v_mul_f32 v223, v223, v215
    v_cvt_pk_bf16_f32 v36, v216, v217
    v_cvt_pk_bf16_f32 v37, v218, v219
    v_mfma_f32_16x16x32_bf16 v[248:251], v[84:87], v[124:127], v[248:251]
    v_cvt_pk_bf16_f32 v38, v220, v221
    v_cvt_pk_bf16_f32 v39, v222, v223
    buffer_store_dwordx4 v[36:39], v14, s[44:47], s84 offen offset:1024 sc1
    s_add_u32 s84, s84, 2048
    v_mfma_f32_16x16x32_bf16 v[248:251], v[80:83], v[120:123], v[248:251]
    v_mul_f32 v224, s82, v224
    v_mul_f32 v225, s82, v225
    v_mul_f32 v226, s82, v226
    v_mul_f32 v227, s82, v227
    v_mul_f32 v228, s82, v228
    v_mul_f32 v229, s82, v229
    v_mul_f32 v230, s82, v230
    v_mul_f32 v231, s82, v231
    v_exp_f32 v224, v224
    v_mfma_f32_16x16x32_bf16 v[244:247], v[72:75], v[120:123], v[244:247]
    v_exp_f32 v225, v225
    v_exp_f32 v226, v226
    v_exp_f32 v227, v227
    v_exp_f32 v228, v228
    v_exp_f32 v229, v229
    v_exp_f32 v230, v230
    v_exp_f32 v231, v231
    v_add_f32 v224, 1.0, v224
    v_add_f32 v225, 1.0, v225
    v_mfma_f32_16x16x32_bf16 v[244:247], v[76:79], v[124:127], v[244:247]
    v_add_f32 v226, 1.0, v226
    v_add_f32 v227, 1.0, v227
    v_add_f32 v228, 1.0, v228
    v_add_f32 v229, 1.0, v229
    v_add_f32 v230, 1.0, v230
    v_add_f32 v231, 1.0, v231
    v_rcp_f32 v224, v224
    v_rcp_f32 v225, v225
    v_rcp_f32 v226, v226
    v_mfma_f32_16x16x32_bf16 v[240:243], v[68:71], v[124:127], v[240:243]
    v_rcp_f32 v227, v227
    v_rcp_f32 v228, v228
    v_rcp_f32 v229, v229
    v_rcp_f32 v230, v230
    v_rcp_f32 v231, v231
    v_mul_f32 v232, v232, v224
    v_mul_f32 v233, v233, v225
    v_mul_f32 v234, v234, v226
    v_mul_f32 v235, v235, v227
    v_mfma_f32_16x16x32_bf16 v[240:243], v[64:67], v[120:123], v[240:243]
    v_mul_f32 v236, v236, v228
    v_mul_f32 v237, v237, v229
    v_mul_f32 v238, v238, v230
    v_mul_f32 v239, v239, v231
    v_cvt_pk_bf16_f32 v32, v232, v233
    v_cvt_pk_bf16_f32 v33, v234, v235
    v_cvt_pk_bf16_f32 v34, v236, v237
    v_cvt_pk_bf16_f32 v35, v238, v239
    buffer_store_dwordx4 v[32:35], v14, s[44:47], s84 offen offset:0 sc1
    s_nop 7
    v_pk_mul_f32 v[240:241], v[240:241], s[82:83]
    v_pk_mul_f32 v[242:243], v[242:243], s[82:83]
    v_pk_mul_f32 v[244:245], v[244:245], s[82:83]
    v_pk_mul_f32 v[246:247], v[246:247], s[82:83]
    v_exp_f32 v240, v240
    v_exp_f32 v241, v241
    v_exp_f32 v242, v242
    v_exp_f32 v243, v243
    v_exp_f32 v244, v244
    v_exp_f32 v245, v245
    v_exp_f32 v246, v246
    v_exp_f32 v247, v247
    v_pk_add_f32 v[240:241], v[240:241], 1.0 op_sel_hi:[1,0]
    v_pk_add_f32 v[242:243], v[242:243], 1.0 op_sel_hi:[1,0]
    v_pk_add_f32 v[244:245], v[244:245], 1.0 op_sel_hi:[1,0]
    v_pk_add_f32 v[246:247], v[246:247], 1.0 op_sel_hi:[1,0]
    v_rcp_f32 v240, v240
    v_rcp_f32 v241, v241
    v_rcp_f32 v242, v242
    v_rcp_f32 v243, v243
    v_rcp_f32 v244, v244
    v_rcp_f32 v245, v245
    v_rcp_f32 v246, v246
    v_rcp_f32 v247, v247
    v_pk_mul_f32 v[248:249], v[248:249], v[240:241]
    v_pk_mul_f32 v[250:251], v[250:251], v[242:243]
    v_pk_mul_f32 v[252:253], v[252:253], v[244:245]
    v_pk_mul_f32 v[254:255], v[254:255], v[246:247]
    v_cvt_pk_bf16_f32 v36, v248, v249
    v_cvt_pk_bf16_f32 v37, v250, v251
    v_cvt_pk_bf16_f32 v38, v252, v253
    v_cvt_pk_bf16_f32 v39, v254, v255
    buffer_store_dwordx4 v[36:39], v14, s[44:47], s84 offen offset:1024 sc1
p1_F_last:
    s_branch p1_fin
p1_KC:
    s_barrier
    ds_read_b128 v[96:99], v1 offset:0
    ds_read_b128 v[100:103], v2 offset:0
    ds_read_b64_tr_b16 v[32:33], v3 offset:0
    ds_read_b64_tr_b16 v[34:35], v3 offset:1024
    ds_read_b64_tr_b16 v[36:37], v3 offset:8192
    ds_read_b64_tr_b16 v[38:39], v3 offset:9216
    ds_read_b64_tr_b16 v[44:45], v4 offset:8192
    ds_read_b64_tr_b16 v[46:47], v4 offset:9216
    ds_read_b128 v[104:107], v1 offset:2048
    ds_read_b64_tr_b16 v[16:17], v5 offset:0
    ds_read_b128 v[108:111], v2 offset:2048
    ds_read_b64_tr_b16 v[18:19], v5 offset:256
    ds_read_b64_tr_b16 v[40:41], v4 offset:0
    ds_read_b64_tr_b16 v[42:43], v4 offset:1024
    ds_read_b64_tr_b16 v[48:49], v3 offset:16384
    ds_read_b64_tr_b16 v[50:51], v3 offset:17408
    ds_read_b64_tr_b16 v[52:53], v3 offset:24576
    ds_read_b64_tr_b16 v[54:55], v3 offset:25600
    ds_read_b128 v[112:115], v1 offset:4096
    ds_read_b64_tr_b16 v[20:21], v5 offset:2048
    ds_read_b128 v[116:119], v2 offset:4096
    ds_read_b64_tr_b16 v[22:23], v5 offset:2304
    ds_read_b64_tr_b16 v[60:61], v4 offset:24576
    ds_read_b64_tr_b16 v[62:63], v4 offset:25600
    ds_read_b64_tr_b16 v[56:57], v4 offset:16384
    ds_read_b64_tr_b16 v[58:59], v4 offset:17408
    s_mov_b32 s75, 6
    s_waitcnt lgkmcnt(15)
    v_mfma_f32_16x16x32_bf16 v[128:131], v[32:35], v[96:99], 0
    ds_read_b128 v[120:123], v1 offset:6144
    v_mfma_f32_16x16x32_bf16 v[128:131], v[36:39], v[100:103], v[128:131]
    ds_read_b128 v[124:127], v2 offset:6144
    v_mfma_f32_16x16x32_bf16 v[132:135], v[44:47], v[100:103], 0
    s_waitcnt lgkmcnt(14)
    v_mfma_f32_16x16x32_bf16 v[132:135], v[40:43], v[96:99], v[132:135]
    s_waitcnt lgkmcnt(12)
    v_mfma_f32_16x16x32_bf16 v[136:139], v[48:51], v[96:99], 0
    s_waitcnt lgkmcnt(10)
    v_mfma_f32_16x16x32_bf16 v[136:139], v[52:55], v[100:103], v[136:139]
    s_waitcnt lgkmcnt(4)
    v_mfma_f32_16x16x32_bf16 v[140:143], v[60:63], v[100:103], 0
    s_waitcnt lgkmcnt(2)
    v_mfma_f32_16x16x32_bf16 v[140:143], v[56:59], v[96:99], v[140:143]
    v_mfma_f32_16x16x32_bf16 v[24:27], v[16:19], v[96:99], 0
    v_mfma_f32_16x16x32_bf16 v[24:27], v[20:23], v[100:103], v[24:27]
    v_mfma_f32_16x16x32_bf16 v[156:159], v[56:59], v[104:107], 0
    ds_read_b128 v[96:99], v1 offset:8192
    v_mfma_f32_16x16x32_bf16 v[156:159], v[60:63], v[108:111], v[156:159]
    ds_read_b128 v[100:103], v2 offset:8192
    v_mfma_f32_16x16x32_bf16 v[152:155], v[52:55], v[108:111], 0
    v_mfma_f32_16x16x32_bf16 v[152:155], v[48:51], v[104:107], v[152:155]
    v_mfma_f32_16x16x32_bf16 v[148:151], v[40:43], v[104:107], 0
    v_mfma_f32_16x16x32_bf16 v[148:151], v[44:47], v[108:111], v[148:151]
    v_mfma_f32_16x16x32_bf16 v[144:147], v[36:39], v[108:111], 0
    v_mfma_f32_16x16x32_bf16 v[144:147], v[32:35], v[104:107], v[144:147]
    v_mfma_f32_16x16x32_bf16 v[28:31], v[16:19], v[104:107], 0
    v_mfma_f32_16x16x32_bf16 v[28:31], v[20:23], v[108:111], v[28:31]
    v_mfma_f32_16x16x32_bf16 v[160:163], v[32:35], v[112:115], 0
    ds_read_b128 v[104:107], v1 offset:10240
    v_mfma_f32_16x16x32_bf16 v[160:163], v[36:39], v[116:119], v[160:163]
    ds_read_b128 v[108:111], v2 offset:10240
    v_mfma_f32_16x16x32_bf16 v[164:167], v[44:47], v[116:119], 0
    v_mfma_f32_16x16x32_bf16 v[164:167], v[40:43], v[112:115], v[164:167]
    v_mfma_f32_16x16x32_bf16 v[168:171], v[48:51], v[112:115], 0
    v_mfma_f32_16x16x32_bf16 v[168:171], v[52:55], v[116:119], v[168:171]
    v_mfma_f32_16x16x32_bf16 v[172:175], v[60:63], v[116:119], 0
    v_mfma_f32_16x16x32_bf16 v[172:175], v[56:59], v[112:115], v[172:175]
    s_waitcnt lgkmcnt(5)
    v_mfma_f32_16x16x32_bf16 v[188:191], v[56:59], v[120:123], 0
    ds_read_b128 v[112:115], v1 offset:12288
    s_waitcnt lgkmcnt(5)
    v_mfma_f32_16x16x32_bf16 v[188:191], v[60:63], v[124:127], v[188:191]
    ds_read_b128 v[116:119], v2 offset:12288
    v_mfma_f32_16x16x32_bf16 v[184:187], v[52:55], v[124:127], 0
    ds_read_b32 v10, v8 offset:0
    v_mfma_f32_16x16x32_bf16 v[184:187], v[48:51], v[120:123], v[184:187]
    v_mfma_f32_16x16x32_bf16 v[180:183], v[40:43], v[120:123], 0
    v_mfma_f32_16x16x32_bf16 v[180:183], v[44:47], v[124:127], v[180:183]
    v_mfma_f32_16x16x32_bf16 v[176:179], v[36:39], v[124:127], 0
    v_mfma_f32_16x16x32_bf16 v[176:179], v[32:35], v[120:123], v[176:179]
    s_waitcnt lgkmcnt(6)
    v_mfma_f32_16x16x32_bf16 v[192:195], v[32:35], v[96:99], 0
    ds_read_b128 v[120:123], v1 offset:14336
    s_waitcnt lgkmcnt(6)
    v_mfma_f32_16x16x32_bf16 v[192:195], v[36:39], v[100:103], v[192:195]
    ds_read_b128 v[124:127], v2 offset:14336
    v_mfma_f32_16x16x32_bf16 v[196:199], v[44:47], v[100:103], 0
    v_mfma_f32_16x16x32_bf16 v[196:199], v[40:43], v[96:99], v[196:199]
    v_mfma_f32_16x16x32_bf16 v[200:203], v[48:51], v[96:99], 0
    v_mfma_f32_16x16x32_bf16 v[200:203], v[52:55], v[100:103], v[200:203]
    v_mfma_f32_16x16x32_bf16 v[204:207], v[60:63], v[100:103], 0
    v_mfma_f32_16x16x32_bf16 v[204:207], v[56:59], v[96:99], v[204:207]
    s_waitcnt lgkmcnt(0)
    s_waitcnt vmcnt(0)
    v_lshlrev_b32 v14, 16, v10
    v_and_b32 v15, s80, v10
    v_lshlrev_b32 v10, 16, v11
    v_and_b32 v11, s80, v11
    v_mul_f32 v14, v14, v10
    v_mul_f32 v15, v15, v11
    v_cvt_pk_bf16_f32 v15, v14, v15
    v_lshlrev_b32 v14, 16, v15
    v_and_b32 v15, s80, v15
    v_add_f32 v12, v12, v14
    v_add_f32 v13, v13, v15
    buffer_load_dword v11, v9, s[48:51], s79 offen
    s_add_u32 s79, s79, 128
    s_lshl_b32 s4, s56, 3
    s_add_u32 s4, s4, s58
    s_lshl_b32 s4, s4, 12
    s_add_u32 s4, s4, 0x1400000
    v_and_b32 v14, 15, v0
    v_lshlrev_b32 v14, 7, v14
    v_bfe_u32 v15, v0, 4, 1
    v_lshl_add_u32 v14, v15, 14, v14
    v_add_u32 v14, s4, v14
    s_lshl_b32 s4, s56, 5
    s_add_u32 s4, s4, s57
    s_lshl_b32 s4, s4, 6
    s_add_u32 s4, s4, 0x1480000
    v_mov_b32 v15, s4
    v_cmp_gt_u32 vcc, 32, v0
    s_cmp_lg_u32 s3, 1
    s_cbranch_scc1 p1_K_nt
    v_cndmask_b32 v14, v15, v14, vcc
    buffer_load_dword v15, v14, s[44:47], 0 offen sc1
p1_K_nt:
    v_mov_b32 v7, 0
    buffer_store_dword v7, v6, s[44:47], 0 offen sc1
    v_lshrrev_b32 v14, 3, v0
    v_lshrrev_b32 v10, 4, v0
    v_and_b32 v7, 7, v0
    v_lshlrev_b32 v14, 11, v14
    v_xor_b32 v7, v10, v7
    v_lshl_add_u32 v6, v7, 4, v14
    v_xor_b32 v7, 64, v6
    v_add_u32 v7, 0x4000, v7
    s_lshl_b32 s6, s60, 1
    s_and_b32 s7, s6, 2
    s_add_u32 s7, s7, s58
    s_and_b32 s6, s6, 4
    s_lshl_b32 s4, s56, 3
    s_add_u32 s6, s6, s4
    s_and_b32 s4, s7, 3
    s_add_u32 s4, s4, s6
    s_lshl_b32 s4, s4, 16
    s_add_u32 s61, s4, 256
    s_add_u32 s62, s4, 0x8100
    s_add_u32 s7, s7, 1
    s_and_b32 s4, s7, 3
    s_add_u32 s4, s4, s6
    s_lshl_b32 s4, s4, 16
    s_add_u32 s63, s4, 256
    s_add_u32 s64, s4, 0x8100
    s_lshl_b32 s68, s60, 13
    s_mov_b32 s8, s28
    s_mov_b32 s9, s29
    s_barrier
    v_mfma_f32_16x16x32_bf16 v[220:223], v[56:59], v[104:107], 0
    ds_read_b128 v[96:99], v1 offset:32768
    v_mfma_f32_16x16x32_bf16 v[220:223], v[60:63], v[108:111], v[220:223]
    ds_read_b128 v[100:103], v2 offset:32768
    v_mfma_f32_16x16x32_bf16 v[216:219], v[52:55], v[108:111], 0
    ds_read_b64_tr_b16 v[64:65], v3 offset:32768
    v_mfma_f32_16x16x32_bf16 v[216:219], v[48:51], v[104:107], v[216:219]
    ds_read_b64_tr_b16 v[66:67], v3 offset:33792
    v_mfma_f32_16x16x32_bf16 v[212:215], v[40:43], v[104:107], 0
    ds_read_b64_tr_b16 v[68:69], v3 offset:40960
    v_mfma_f32_16x16x32_bf16 v[212:215], v[44:47], v[108:111], v[212:215]
    ds_read_b64_tr_b16 v[70:71], v3 offset:41984
    v_mfma_f32_16x16x32_bf16 v[208:211], v[36:39], v[108:111], 0
    ds_read_b64_tr_b16 v[76:77], v4 offset:40960
    v_mfma_f32_16x16x32_bf16 v[208:211], v[32:35], v[104:107], v[208:211]
    ds_read_b64_tr_b16 v[78:79], v4 offset:41984
    v_mfma_f32_16x16x32_bf16 v[224:227], v[32:35], v[112:115], 0
    ds_read_b128 v[104:107], v1 offset:34816
    ds_read_b64_tr_b16 v[16:17], v5 offset:8192
    v_mfma_f32_16x16x32_bf16 v[224:227], v[36:39], v[116:119], v[224:227]
    ds_read_b128 v[108:111], v2 offset:34816
    ds_read_b64_tr_b16 v[18:19], v5 offset:8448
    v_mfma_f32_16x16x32_bf16 v[228:231], v[44:47], v[116:119], 0
    ds_read_b64_tr_b16 v[72:73], v4 offset:32768
    v_mfma_f32_16x16x32_bf16 v[228:231], v[40:43], v[112:115], v[228:231]
    ds_read_b64_tr_b16 v[74:75], v4 offset:33792
    v_mfma_f32_16x16x32_bf16 v[232:235], v[48:51], v[112:115], 0
    ds_read_b64_tr_b16 v[80:81], v3 offset:49152
    v_mfma_f32_16x16x32_bf16 v[232:235], v[52:55], v[116:119], v[232:235]
    ds_read_b64_tr_b16 v[82:83], v3 offset:50176
    v_mfma_f32_16x16x32_bf16 v[236:239], v[60:63], v[116:119], 0
    ds_read_b64_tr_b16 v[84:85], v3 offset:57344
    v_mfma_f32_16x16x32_bf16 v[236:239], v[56:59], v[112:115], v[236:239]
    ds_read_b64_tr_b16 v[86:87], v3 offset:58368
    v_mfma_f32_16x16x32_bf16 v[252:255], v[56:59], v[120:123], 0
    ds_read_b128 v[112:115], v1 offset:36864
    ds_read_b64_tr_b16 v[20:21], v5 offset:10240
    v_mfma_f32_16x16x32_bf16 v[252:255], v[60:63], v[124:127], v[252:255]
    ds_read_b128 v[116:119], v2 offset:36864
    ds_read_b64_tr_b16 v[22:23], v5 offset:10496
    v_mfma_f32_16x16x32_bf16 v[248:251], v[52:55], v[124:127], 0
    ds_read_b64_tr_b16 v[92:93], v4 offset:57344
    v_mfma_f32_16x16x32_bf16 v[248:251], v[48:51], v[120:123], v[248:251]
    ds_read_b64_tr_b16 v[94:95], v4 offset:58368
    v_mfma_f32_16x16x32_bf16 v[244:247], v[40:43], v[120:123], 0
    ds_read_b64_tr_b16 v[88:89], v4 offset:49152
    v_mfma_f32_16x16x32_bf16 v[244:247], v[44:47], v[124:127], v[244:247]
    ds_read_b64_tr_b16 v[90:91], v4 offset:50176
    v_mfma_f32_16x16x32_bf16 v[240:243], v[36:39], v[124:127], 0
    v_mfma_f32_16x16x32_bf16 v[240:243], v[32:35], v[120:123], v[240:243]
.p2align 6
p1_KC_loop:
    s_waitcnt lgkmcnt(15)
    v_mfma_f32_16x16x32_bf16 v[128:131], v[64:67], v[96:99], v[128:131]
    ds_read_b128 v[120:123], v1 offset:38912
    v_mfma_f32_16x16x32_bf16 v[128:131], v[68:71], v[100:103], v[128:131]
    ds_read_b128 v[124:127], v2 offset:38912
    v_mfma_f32_16x16x32_bf16 v[132:135], v[76:79], v[100:103], v[132:135]
    s_waitcnt lgkmcnt(14)
    v_mfma_f32_16x16x32_bf16 v[132:135], v[72:75], v[96:99], v[132:135]
    s_waitcnt lgkmcnt(12)
    v_mfma_f32_16x16x32_bf16 v[136:139], v[80:83], v[96:99], v[136:139]
    s_waitcnt lgkmcnt(10)
    v_mfma_f32_16x16x32_bf16 v[136:139], v[84:87], v[100:103], v[136:139]
    s_waitcnt lgkmcnt(4)
    v_mfma_f32_16x16x32_bf16 v[140:143], v[92:95], v[100:103], v[140:143]
    s_waitcnt lgkmcnt(2)
    v_mfma_f32_16x16x32_bf16 v[140:143], v[88:91], v[96:99], v[140:143]
    v_mfma_f32_16x16x32_bf16 v[24:27], v[16:19], v[96:99], v[24:27]
    v_mfma_f32_16x16x32_bf16 v[24:27], v[20:23], v[100:103], v[24:27]
    v_mfma_f32_16x16x32_bf16 v[156:159], v[88:91], v[104:107], v[156:159]
    ds_read_b128 v[96:99], v1 offset:40960
    v_mfma_f32_16x16x32_bf16 v[156:159], v[92:95], v[108:111], v[156:159]
    ds_read_b128 v[100:103], v2 offset:40960
    v_mfma_f32_16x16x32_bf16 v[152:155], v[84:87], v[108:111], v[152:155]
    v_mfma_f32_16x16x32_bf16 v[152:155], v[80:83], v[104:107], v[152:155]
    v_mfma_f32_16x16x32_bf16 v[148:151], v[72:75], v[104:107], v[148:151]
    v_mfma_f32_16x16x32_bf16 v[148:151], v[76:79], v[108:111], v[148:151]
    v_mfma_f32_16x16x32_bf16 v[144:147], v[68:71], v[108:111], v[144:147]
    v_mfma_f32_16x16x32_bf16 v[144:147], v[64:67], v[104:107], v[144:147]
    v_mfma_f32_16x16x32_bf16 v[28:31], v[16:19], v[104:107], v[28:31]
    v_mfma_f32_16x16x32_bf16 v[28:31], v[20:23], v[108:111], v[28:31]
    v_mfma_f32_16x16x32_bf16 v[160:163], v[64:67], v[112:115], v[160:163]
    ds_read_b128 v[104:107], v1 offset:43008
    v_mfma_f32_16x16x32_bf16 v[160:163], v[68:71], v[116:119], v[160:163]
    ds_read_b128 v[108:111], v2 offset:43008
    v_mfma_f32_16x16x32_bf16 v[164:167], v[76:79], v[116:119], v[164:167]
    v_mfma_f32_16x16x32_bf16 v[164:167], v[72:75], v[112:115], v[164:167]
    v_mfma_f32_16x16x32_bf16 v[168:171], v[80:83], v[112:115], v[168:171]
    v_mfma_f32_16x16x32_bf16 v[168:171], v[84:87], v[116:119], v[168:171]
    v_mfma_f32_16x16x32_bf16 v[172:175], v[92:95], v[116:119], v[172:175]
    v_mfma_f32_16x16x32_bf16 v[172:175], v[88:91], v[112:115], v[172:175]
    s_waitcnt lgkmcnt(5)
    v_mfma_f32_16x16x32_bf16 v[188:191], v[88:91], v[120:123], v[188:191]
    ds_read_b128 v[112:115], v1 offset:45056
    s_waitcnt lgkmcnt(5)
    v_mfma_f32_16x16x32_bf16 v[188:191], v[92:95], v[124:127], v[188:191]
    ds_read_b128 v[116:119], v2 offset:45056
    v_mfma_f32_16x16x32_bf16 v[184:187], v[84:87], v[124:127], v[184:187]
    ds_read_b32 v10, v8 offset:32768
    v_mfma_f32_16x16x32_bf16 v[184:187], v[80:83], v[120:123], v[184:187]
    v_mfma_f32_16x16x32_bf16 v[180:183], v[72:75], v[120:123], v[180:183]
    v_mfma_f32_16x16x32_bf16 v[180:183], v[76:79], v[124:127], v[180:183]
    v_mfma_f32_16x16x32_bf16 v[176:179], v[68:71], v[124:127], v[176:179]
    v_mfma_f32_16x16x32_bf16 v[176:179], v[64:67], v[120:123], v[176:179]
    s_waitcnt lgkmcnt(6)
    v_mfma_f32_16x16x32_bf16 v[192:195], v[64:67], v[96:99], v[192:195]
    ds_read_b128 v[120:123], v1 offset:47104
    s_waitcnt lgkmcnt(6)
    v_mfma_f32_16x16x32_bf16 v[192:195], v[68:71], v[100:103], v[192:195]
    ds_read_b128 v[124:127], v2 offset:47104
    v_mfma_f32_16x16x32_bf16 v[196:199], v[76:79], v[100:103], v[196:199]
    v_mfma_f32_16x16x32_bf16 v[196:199], v[72:75], v[96:99], v[196:199]
    v_mfma_f32_16x16x32_bf16 v[200:203], v[80:83], v[96:99], v[200:203]
    v_mfma_f32_16x16x32_bf16 v[200:203], v[84:87], v[100:103], v[200:203]
    v_mfma_f32_16x16x32_bf16 v[204:207], v[92:95], v[100:103], v[204:207]
    v_mfma_f32_16x16x32_bf16 v[204:207], v[88:91], v[96:99], v[204:207]
    s_waitcnt lgkmcnt(0)
    s_waitcnt vmcnt(0)
    v_lshlrev_b32 v14, 16, v10
    v_and_b32 v15, s80, v10
    v_lshlrev_b32 v10, 16, v11
    v_and_b32 v11, s80, v11
    v_mul_f32 v14, v14, v10
    v_mul_f32 v15, v15, v11
    v_cvt_pk_bf16_f32 v15, v14, v15
    v_lshlrev_b32 v14, 16, v15
    v_and_b32 v15, s80, v15
    v_add_f32 v12, v12, v14
    v_add_f32 v13, v13, v15
    buffer_load_dword v11, v9, s[48:51], s79 offen
    s_add_u32 s79, s79, 128
    s_sub_u32 s73, s73, 1
    s_cmp_lg_u32 s73, 0
    s_cbranch_scc1 p1_K_nb
    v_mov_b32 v14, 1
    v_mov_b32 v15, 0
    s_mov_b64 exec, 1
    buffer_store_byte v14, v15, s[20:23], s2 offen sc1
    s_mov_b64 exec, -1
p1_K_nb:
    s_add_u32 m0, s68, 0x1000
    s_nop 0
    buffer_load_dwordx4 v6, s[8:11], s63 offen lds
    s_add_u32 m0, s68, 0x1400
    s_nop 0
    buffer_load_dwordx4 v7, s[8:11], s63 offen lds
    s_add_u32 s63, s63, 128
    s_add_u32 m0, s68, 0x1800
    s_nop 0
    buffer_load_dwordx4 v6, s[8:11], s64 offen lds
    s_add_u32 m0, s68, 0x1c00
    s_nop 0
    buffer_load_dwordx4 v7, s[8:11], s64 offen lds
    s_add_u32 s64, s64, 128
    s_waitcnt vmcnt(0)
    s_barrier
    v_mfma_f32_16x16x32_bf16 v[220:223], v[88:91], v[104:107], v[220:223]
    ds_read_b128 v[96:99], v1 offset:0
    v_mfma_f32_16x16x32_bf16 v[220:223], v[92:95], v[108:111], v[220:223]
    ds_read_b128 v[100:103], v2 offset:0
    v_mfma_f32_16x16x32_bf16 v[216:219], v[84:87], v[108:111], v[216:219]
    ds_read_b64_tr_b16 v[32:33], v3 offset:0
    v_mfma_f32_16x16x32_bf16 v[216:219], v[80:83], v[104:107], v[216:219]
    ds_read_b64_tr_b16 v[34:35], v3 offset:1024
    v_mfma_f32_16x16x32_bf16 v[212:215], v[72:75], v[104:107], v[212:215]
    ds_read_b64_tr_b16 v[36:37], v3 offset:8192
    v_mfma_f32_16x16x32_bf16 v[212:215], v[76:79], v[108:111], v[212:215]
    ds_read_b64_tr_b16 v[38:39], v3 offset:9216
    v_mfma_f32_16x16x32_bf16 v[208:211], v[68:71], v[108:111], v[208:211]
    ds_read_b64_tr_b16 v[44:45], v4 offset:8192
    v_mfma_f32_16x16x32_bf16 v[208:211], v[64:67], v[104:107], v[208:211]
    ds_read_b64_tr_b16 v[46:47], v4 offset:9216
    v_mfma_f32_16x16x32_bf16 v[224:227], v[64:67], v[112:115], v[224:227]
    ds_read_b128 v[104:107], v1 offset:2048
    ds_read_b64_tr_b16 v[16:17], v5 offset:0
    v_mfma_f32_16x16x32_bf16 v[224:227], v[68:71], v[116:119], v[224:227]
    ds_read_b128 v[108:111], v2 offset:2048
    ds_read_b64_tr_b16 v[18:19], v5 offset:256
    v_mfma_f32_16x16x32_bf16 v[228:231], v[76:79], v[116:119], v[228:231]
    ds_read_b64_tr_b16 v[40:41], v4 offset:0
    v_mfma_f32_16x16x32_bf16 v[228:231], v[72:75], v[112:115], v[228:231]
    ds_read_b64_tr_b16 v[42:43], v4 offset:1024
    v_mfma_f32_16x16x32_bf16 v[232:235], v[80:83], v[112:115], v[232:235]
    ds_read_b64_tr_b16 v[48:49], v3 offset:16384
    v_mfma_f32_16x16x32_bf16 v[232:235], v[84:87], v[116:119], v[232:235]
    ds_read_b64_tr_b16 v[50:51], v3 offset:17408
    v_mfma_f32_16x16x32_bf16 v[236:239], v[92:95], v[116:119], v[236:239]
    ds_read_b64_tr_b16 v[52:53], v3 offset:24576
    v_mfma_f32_16x16x32_bf16 v[236:239], v[88:91], v[112:115], v[236:239]
    ds_read_b64_tr_b16 v[54:55], v3 offset:25600
    v_mfma_f32_16x16x32_bf16 v[252:255], v[88:91], v[120:123], v[252:255]
    ds_read_b128 v[112:115], v1 offset:4096
    ds_read_b64_tr_b16 v[20:21], v5 offset:2048
    v_mfma_f32_16x16x32_bf16 v[252:255], v[92:95], v[124:127], v[252:255]
    ds_read_b128 v[116:119], v2 offset:4096
    ds_read_b64_tr_b16 v[22:23], v5 offset:2304
    v_mfma_f32_16x16x32_bf16 v[248:251], v[84:87], v[124:127], v[248:251]
    ds_read_b64_tr_b16 v[60:61], v4 offset:24576
    v_mfma_f32_16x16x32_bf16 v[248:251], v[80:83], v[120:123], v[248:251]
    ds_read_b64_tr_b16 v[62:63], v4 offset:25600
    v_mfma_f32_16x16x32_bf16 v[244:247], v[72:75], v[120:123], v[244:247]
    ds_read_b64_tr_b16 v[56:57], v4 offset:16384
    v_mfma_f32_16x16x32_bf16 v[244:247], v[76:79], v[124:127], v[244:247]
    ds_read_b64_tr_b16 v[58:59], v4 offset:17408
    v_mfma_f32_16x16x32_bf16 v[240:243], v[68:71], v[124:127], v[240:243]
    v_mfma_f32_16x16x32_bf16 v[240:243], v[64:67], v[120:123], v[240:243]
    s_cmp_eq_u32 s75, 0
    s_cbranch_scc1 p1_KC_tail
    s_waitcnt lgkmcnt(15)
    v_mfma_f32_16x16x32_bf16 v[128:131], v[32:35], v[96:99], v[128:131]
    ds_read_b128 v[120:123], v1 offset:6144
    v_mfma_f32_16x16x32_bf16 v[128:131], v[36:39], v[100:103], v[128:131]
    ds_read_b128 v[124:127], v2 offset:6144
    v_mfma_f32_16x16x32_bf16 v[132:135], v[44:47], v[100:103], v[132:135]
    s_waitcnt lgkmcnt(14)
    v_mfma_f32_16x16x32_bf16 v[132:135], v[40:43], v[96:99], v[132:135]
    s_waitcnt lgkmcnt(12)
    v_mfma_f32_16x16x32_bf16 v[136:139], v[48:51], v[96:99], v[136:139]
    s_waitcnt lgkmcnt(10)
    v_mfma_f32_16x16x32_bf16 v[136:139], v[52:55], v[100:103], v[136:139]
    s_waitcnt lgkmcnt(4)
    v_mfma_f32_16x16x32_bf16 v[140:143], v[60:63], v[100:103], v[140:143]
    s_waitcnt lgkmcnt(2)
    v_mfma_f32_16x16x32_bf16 v[140:143], v[56:59], v[96:99], v[140:143]
    v_mfma_f32_16x16x32_bf16 v[24:27], v[16:19], v[96:99], v[24:27]
    v_mfma_f32_16x16x32_bf16 v[24:27], v[20:23], v[100:103], v[24:27]
    v_mfma_f32_16x16x32_bf16 v[156:159], v[56:59], v[104:107], v[156:159]
    ds_read_b128 v[96:99], v1 offset:8192
    v_mfma_f32_16x16x32_bf16 v[156:159], v[60:63], v[108:111], v[156:159]
    ds_read_b128 v[100:103], v2 offset:8192
    v_mfma_f32_16x16x32_bf16 v[152:155], v[52:55], v[108:111], v[152:155]
    v_mfma_f32_16x16x32_bf16 v[152:155], v[48:51], v[104:107], v[152:155]
    v_mfma_f32_16x16x32_bf16 v[148:151], v[40:43], v[104:107], v[148:151]
    v_mfma_f32_16x16x32_bf16 v[148:151], v[44:47], v[108:111], v[148:151]
    v_mfma_f32_16x16x32_bf16 v[144:147], v[36:39], v[108:111], v[144:147]
    v_mfma_f32_16x16x32_bf16 v[144:147], v[32:35], v[104:107], v[144:147]
    v_mfma_f32_16x16x32_bf16 v[28:31], v[16:19], v[104:107], v[28:31]
    v_mfma_f32_16x16x32_bf16 v[28:31], v[20:23], v[108:111], v[28:31]
    v_mfma_f32_16x16x32_bf16 v[160:163], v[32:35], v[112:115], v[160:163]
    ds_read_b128 v[104:107], v1 offset:10240
    v_mfma_f32_16x16x32_bf16 v[160:163], v[36:39], v[116:119], v[160:163]
    ds_read_b128 v[108:111], v2 offset:10240
    v_mfma_f32_16x16x32_bf16 v[164:167], v[44:47], v[116:119], v[164:167]
    v_mfma_f32_16x16x32_bf16 v[164:167], v[40:43], v[112:115], v[164:167]
    v_mfma_f32_16x16x32_bf16 v[168:171], v[48:51], v[112:115], v[168:171]
    v_mfma_f32_16x16x32_bf16 v[168:171], v[52:55], v[116:119], v[168:171]
    v_mfma_f32_16x16x32_bf16 v[172:175], v[60:63], v[116:119], v[172:175]
    v_mfma_f32_16x16x32_bf16 v[172:175], v[56:59], v[112:115], v[172:175]
    s_waitcnt lgkmcnt(5)
    v_mfma_f32_16x16x32_bf16 v[188:191], v[56:59], v[120:123], v[188:191]
    ds_read_b128 v[112:115], v1 offset:12288
    s_waitcnt lgkmcnt(5)
    v_mfma_f32_16x16x32_bf16 v[188:191], v[60:63], v[124:127], v[188:191]
    ds_read_b128 v[116:119], v2 offset:12288
    v_mfma_f32_16x16x32_bf16 v[184:187], v[52:55], v[124:127], v[184:187]
    ds_read_b32 v10, v8 offset:0
    v_mfma_f32_16x16x32_bf16 v[184:187], v[48:51], v[120:123], v[184:187]
    v_mfma_f32_16x16x32_bf16 v[180:183], v[40:43], v[120:123], v[180:183]
    v_mfma_f32_16x16x32_bf16 v[180:183], v[44:47], v[124:127], v[180:183]
    v_mfma_f32_16x16x32_bf16 v[176:179], v[36:39], v[124:127], v[176:179]
    v_mfma_f32_16x16x32_bf16 v[176:179], v[32:35], v[120:123], v[176:179]
    s_waitcnt lgkmcnt(6)
    v_mfma_f32_16x16x32_bf16 v[192:195], v[32:35], v[96:99], v[192:195]
    ds_read_b128 v[120:123], v1 offset:14336
    s_waitcnt lgkmcnt(6)
    v_mfma_f32_16x16x32_bf16 v[192:195], v[36:39], v[100:103], v[192:195]
    ds_read_b128 v[124:127], v2 offset:14336
    v_mfma_f32_16x16x32_bf16 v[196:199], v[44:47], v[100:103], v[196:199]
    v_mfma_f32_16x16x32_bf16 v[196:199], v[40:43], v[96:99], v[196:199]
    v_mfma_f32_16x16x32_bf16 v[200:203], v[48:51], v[96:99], v[200:203]
    v_mfma_f32_16x16x32_bf16 v[200:203], v[52:55], v[100:103], v[200:203]
    v_mfma_f32_16x16x32_bf16 v[204:207], v[60:63], v[100:103], v[204:207]
    v_mfma_f32_16x16x32_bf16 v[204:207], v[56:59], v[96:99], v[204:207]
    s_waitcnt lgkmcnt(0)
    s_waitcnt vmcnt(0)
    v_lshlrev_b32 v14, 16, v10
    v_and_b32 v15, s80, v10
    v_lshlrev_b32 v10, 16, v11
    v_and_b32 v11, s80, v11
    v_mul_f32 v14, v14, v10
    v_mul_f32 v15, v15, v11
    v_cvt_pk_bf16_f32 v15, v14, v15
    v_lshlrev_b32 v14, 16, v15
    v_and_b32 v15, s80, v15
    v_add_f32 v12, v12, v14
    v_add_f32 v13, v13, v15
    buffer_load_dword v11, v9, s[48:51], s79 offen
    s_add_u32 s79, s79, 128
    s_add_u32 m0, s68, 0x9000
    s_nop 0
    buffer_load_dwordx4 v6, s[8:11], s63 offen lds
    s_add_u32 m0, s68, 0x9400
    s_nop 0
    buffer_load_dwordx4 v7, s[8:11], s63 offen lds
    s_add_u32 s63, s63, 128
    s_add_u32 m0, s68, 0x9800
    s_nop 0
    buffer_load_dwordx4 v6, s[8:11], s64 offen lds
    s_add_u32 m0, s68, 0x9c00
    s_nop 0
    buffer_load_dwordx4 v7, s[8:11], s64 offen lds
    s_add_u32 s64, s64, 128
    s_waitcnt vmcnt(0)
    s_barrier
    v_mfma_f32_16x16x32_bf16 v[220:223], v[56:59], v[104:107], v[220:223]
    ds_read_b128 v[96:99], v1 offset:32768
    v_mfma_f32_16x16x32_bf16 v[220:223], v[60:63], v[108:111], v[220:223]
    ds_read_b128 v[100:103], v2 offset:32768
    v_mfma_f32_16x16x32_bf16 v[216:219], v[52:55], v[108:111], v[216:219]
    ds_read_b64_tr_b16 v[64:65], v3 offset:32768
    v_mfma_f32_16x16x32_bf16 v[216:219], v[48:51], v[104:107], v[216:219]
    ds_read_b64_tr_b16 v[66:67], v3 offset:33792
    v_mfma_f32_16x16x32_bf16 v[212:215], v[40:43], v[104:107], v[212:215]
    ds_read_b64_tr_b16 v[68:69], v3 offset:40960
    v_mfma_f32_16x16x32_bf16 v[212:215], v[44:47], v[108:111], v[212:215]
    ds_read_b64_tr_b16 v[70:71], v3 offset:41984
    v_mfma_f32_16x16x32_bf16 v[208:211], v[36:39], v[108:111], v[208:211]
    ds_read_b64_tr_b16 v[76:77], v4 offset:40960
    v_mfma_f32_16x16x32_bf16 v[208:211], v[32:35], v[104:107], v[208:211]
    ds_read_b64_tr_b16 v[78:79], v4 offset:41984
    v_mfma_f32_16x16x32_bf16 v[224:227], v[32:35], v[112:115], v[224:227]
    ds_read_b128 v[104:107], v1 offset:34816
    ds_read_b64_tr_b16 v[16:17], v5 offset:8192
    v_mfma_f32_16x16x32_bf16 v[224:227], v[36:39], v[116:119], v[224:227]
    ds_read_b128 v[108:111], v2 offset:34816
    ds_read_b64_tr_b16 v[18:19], v5 offset:8448
    v_mfma_f32_16x16x32_bf16 v[228:231], v[44:47], v[116:119], v[228:231]
    ds_read_b64_tr_b16 v[72:73], v4 offset:32768
    v_mfma_f32_16x16x32_bf16 v[228:231], v[40:43], v[112:115], v[228:231]
    ds_read_b64_tr_b16 v[74:75], v4 offset:33792
    v_mfma_f32_16x16x32_bf16 v[232:235], v[48:51], v[112:115], v[232:235]
    ds_read_b64_tr_b16 v[80:81], v3 offset:49152
    v_mfma_f32_16x16x32_bf16 v[232:235], v[52:55], v[116:119], v[232:235]
    ds_read_b64_tr_b16 v[82:83], v3 offset:50176
    v_mfma_f32_16x16x32_bf16 v[236:239], v[60:63], v[116:119], v[236:239]
    ds_read_b64_tr_b16 v[84:85], v3 offset:57344
    v_mfma_f32_16x16x32_bf16 v[236:239], v[56:59], v[112:115], v[236:239]
    ds_read_b64_tr_b16 v[86:87], v3 offset:58368
    v_mfma_f32_16x16x32_bf16 v[252:255], v[56:59], v[120:123], v[252:255]
    ds_read_b128 v[112:115], v1 offset:36864
    ds_read_b64_tr_b16 v[20:21], v5 offset:10240
    v_mfma_f32_16x16x32_bf16 v[252:255], v[60:63], v[124:127], v[252:255]
    ds_read_b128 v[116:119], v2 offset:36864
    ds_read_b64_tr_b16 v[22:23], v5 offset:10496
    v_mfma_f32_16x16x32_bf16 v[248:251], v[52:55], v[124:127], v[248:251]
    ds_read_b64_tr_b16 v[92:93], v4 offset:57344
    v_mfma_f32_16x16x32_bf16 v[248:251], v[48:51], v[120:123], v[248:251]
    ds_read_b64_tr_b16 v[94:95], v4 offset:58368
    v_mfma_f32_16x16x32_bf16 v[244:247], v[40:43], v[120:123], v[244:247]
    ds_read_b64_tr_b16 v[88:89], v4 offset:49152
    v_mfma_f32_16x16x32_bf16 v[244:247], v[44:47], v[124:127], v[244:247]
    ds_read_b64_tr_b16 v[90:91], v4 offset:50176
    v_mfma_f32_16x16x32_bf16 v[240:243], v[36:39], v[124:127], v[240:243]
    v_mfma_f32_16x16x32_bf16 v[240:243], v[32:35], v[120:123], v[240:243]
    s_sub_u32 s75, s75, 1
    s_branch p1_KC_loop
p1_KC_tail:
    s_waitcnt lgkmcnt(15)
    v_mfma_f32_16x16x32_bf16 v[128:131], v[32:35], v[96:99], v[128:131]
    ds_read_b128 v[120:123], v1 offset:6144
    v_mfma_f32_16x16x32_bf16 v[128:131], v[36:39], v[100:103], v[128:131]
    ds_read_b128 v[124:127], v2 offset:6144
    v_mfma_f32_16x16x32_bf16 v[132:135], v[44:47], v[100:103], v[132:135]
    s_waitcnt lgkmcnt(14)
    v_mfma_f32_16x16x32_bf16 v[132:135], v[40:43], v[96:99], v[132:135]
    s_waitcnt lgkmcnt(12)
    v_mfma_f32_16x16x32_bf16 v[136:139], v[48:51], v[96:99], v[136:139]
    s_waitcnt lgkmcnt(10)
    v_mfma_f32_16x16x32_bf16 v[136:139], v[52:55], v[100:103], v[136:139]
    s_waitcnt lgkmcnt(4)
    v_mfma_f32_16x16x32_bf16 v[140:143], v[60:63], v[100:103], v[140:143]
    s_waitcnt lgkmcnt(2)
    v_mfma_f32_16x16x32_bf16 v[140:143], v[56:59], v[96:99], v[140:143]
    v_mfma_f32_16x16x32_bf16 v[24:27], v[16:19], v[96:99], v[24:27]
    v_mfma_f32_16x16x32_bf16 v[24:27], v[20:23], v[100:103], v[24:27]
    v_mfma_f32_16x16x32_bf16 v[156:159], v[56:59], v[104:107], v[156:159]
    ds_read_b128 v[96:99], v1 offset:8192
    v_mfma_f32_16x16x32_bf16 v[156:159], v[60:63], v[108:111], v[156:159]
    ds_read_b128 v[100:103], v2 offset:8192
    v_mfma_f32_16x16x32_bf16 v[152:155], v[52:55], v[108:111], v[152:155]
    v_mfma_f32_16x16x32_bf16 v[152:155], v[48:51], v[104:107], v[152:155]
    v_mfma_f32_16x16x32_bf16 v[148:151], v[40:43], v[104:107], v[148:151]
    v_mfma_f32_16x16x32_bf16 v[148:151], v[44:47], v[108:111], v[148:151]
    v_mfma_f32_16x16x32_bf16 v[144:147], v[36:39], v[108:111], v[144:147]
    v_mfma_f32_16x16x32_bf16 v[144:147], v[32:35], v[104:107], v[144:147]
    v_mfma_f32_16x16x32_bf16 v[28:31], v[16:19], v[104:107], v[28:31]
    v_mfma_f32_16x16x32_bf16 v[28:31], v[20:23], v[108:111], v[28:31]
    v_mfma_f32_16x16x32_bf16 v[160:163], v[32:35], v[112:115], v[160:163]
    ds_read_b128 v[104:107], v1 offset:10240
    v_mfma_f32_16x16x32_bf16 v[160:163], v[36:39], v[116:119], v[160:163]
    ds_read_b128 v[108:111], v2 offset:10240
    v_mfma_f32_16x16x32_bf16 v[164:167], v[44:47], v[116:119], v[164:167]
    v_mfma_f32_16x16x32_bf16 v[164:167], v[40:43], v[112:115], v[164:167]
    v_mfma_f32_16x16x32_bf16 v[168:171], v[48:51], v[112:115], v[168:171]
    v_mfma_f32_16x16x32_bf16 v[168:171], v[52:55], v[116:119], v[168:171]
    v_mfma_f32_16x16x32_bf16 v[172:175], v[60:63], v[116:119], v[172:175]
    v_mfma_f32_16x16x32_bf16 v[172:175], v[56:59], v[112:115], v[172:175]
    s_waitcnt lgkmcnt(5)
    v_mfma_f32_16x16x32_bf16 v[188:191], v[56:59], v[120:123], v[188:191]
    ds_read_b128 v[112:115], v1 offset:12288
    s_waitcnt lgkmcnt(5)
    v_mfma_f32_16x16x32_bf16 v[188:191], v[60:63], v[124:127], v[188:191]
    ds_read_b128 v[116:119], v2 offset:12288
    v_mfma_f32_16x16x32_bf16 v[184:187], v[52:55], v[124:127], v[184:187]
    ds_read_b32 v10, v8 offset:0
    v_mfma_f32_16x16x32_bf16 v[184:187], v[48:51], v[120:123], v[184:187]
    v_mfma_f32_16x16x32_bf16 v[180:183], v[40:43], v[120:123], v[180:183]
    v_mfma_f32_16x16x32_bf16 v[180:183], v[44:47], v[124:127], v[180:183]
    v_mfma_f32_16x16x32_bf16 v[176:179], v[36:39], v[124:127], v[176:179]
    v_mfma_f32_16x16x32_bf16 v[176:179], v[32:35], v[120:123], v[176:179]
    s_waitcnt lgkmcnt(6)
    v_mfma_f32_16x16x32_bf16 v[192:195], v[32:35], v[96:99], v[192:195]
    ds_read_b128 v[120:123], v1 offset:14336
    s_waitcnt lgkmcnt(6)
    v_mfma_f32_16x16x32_bf16 v[192:195], v[36:39], v[100:103], v[192:195]
    ds_read_b128 v[124:127], v2 offset:14336
    v_mfma_f32_16x16x32_bf16 v[196:199], v[44:47], v[100:103], v[196:199]
    v_mfma_f32_16x16x32_bf16 v[196:199], v[40:43], v[96:99], v[196:199]
    v_mfma_f32_16x16x32_bf16 v[200:203], v[48:51], v[96:99], v[200:203]
    v_mfma_f32_16x16x32_bf16 v[200:203], v[52:55], v[100:103], v[200:203]
    v_mfma_f32_16x16x32_bf16 v[204:207], v[60:63], v[100:103], v[204:207]
    v_mfma_f32_16x16x32_bf16 v[204:207], v[56:59], v[96:99], v[204:207]
    s_waitcnt lgkmcnt(0)
    s_waitcnt vmcnt(0)
    v_lshlrev_b32 v14, 16, v10
    v_and_b32 v15, s80, v10
    v_lshlrev_b32 v10, 16, v11
    v_and_b32 v11, s80, v11
    v_mul_f32 v14, v14, v10
    v_mul_f32 v15, v15, v11
    v_cvt_pk_bf16_f32 v15, v14, v15
    v_lshlrev_b32 v14, 16, v15
    v_and_b32 v15, s80, v15
    v_add_f32 v12, v12, v14
    v_add_f32 v13, v13, v15
    buffer_load_dword v11, v9, s[48:51], s79 offen
    s_add_u32 s79, s79, 128
    s_add_u32 m0, s68, 0x9000
    s_nop 0
    buffer_load_dwordx4 v6, s[8:11], s63 offen lds
    s_add_u32 m0, s68, 0x9400
    s_nop 0
    buffer_load_dwordx4 v7, s[8:11], s63 offen lds
    s_add_u32 s63, s63, 128
    s_add_u32 m0, s68, 0x9800
    s_nop 0
    buffer_load_dwordx4 v6, s[8:11], s64 offen lds
    s_add_u32 m0, s68, 0x9c00
    s_nop 0
    buffer_load_dwordx4 v7, s[8:11], s64 offen lds
    s_add_u32 s64, s64, 128
    s_waitcnt vmcnt(0)
    s_barrier
    v_mfma_f32_16x16x32_bf16 v[220:223], v[56:59], v[104:107], v[220:223]
    ds_read_b128 v[96:99], v1 offset:32768
    v_mfma_f32_16x16x32_bf16 v[220:223], v[60:63], v[108:111], v[220:223]
    ds_read_b128 v[100:103], v2 offset:32768
    v_mfma_f32_16x16x32_bf16 v[216:219], v[52:55], v[108:111], v[216:219]
    ds_read_b64_tr_b16 v[64:65], v3 offset:32768
    v_mfma_f32_16x16x32_bf16 v[216:219], v[48:51], v[104:107], v[216:219]
    ds_read_b64_tr_b16 v[66:67], v3 offset:33792
    v_mfma_f32_16x16x32_bf16 v[212:215], v[40:43], v[104:107], v[212:215]
    ds_read_b64_tr_b16 v[68:69], v3 offset:40960
    v_mfma_f32_16x16x32_bf16 v[212:215], v[44:47], v[108:111], v[212:215]
    ds_read_b64_tr_b16 v[70:71], v3 offset:41984
    v_mfma_f32_16x16x32_bf16 v[208:211], v[36:39], v[108:111], v[208:211]
    ds_read_b64_tr_b16 v[76:77], v4 offset:40960
    v_mfma_f32_16x16x32_bf16 v[208:211], v[32:35], v[104:107], v[208:211]
    ds_read_b64_tr_b16 v[78:79], v4 offset:41984
    v_mfma_f32_16x16x32_bf16 v[224:227], v[32:35], v[112:115], v[224:227]
    ds_read_b128 v[104:107], v1 offset:34816
    ds_read_b64_tr_b16 v[16:17], v5 offset:8192
    v_mfma_f32_16x16x32_bf16 v[224:227], v[36:39], v[116:119], v[224:227]
    ds_read_b128 v[108:111], v2 offset:34816
    ds_read_b64_tr_b16 v[18:19], v5 offset:8448
    v_mfma_f32_16x16x32_bf16 v[228:231], v[44:47], v[116:119], v[228:231]
    ds_read_b64_tr_b16 v[72:73], v4 offset:32768
    v_mfma_f32_16x16x32_bf16 v[228:231], v[40:43], v[112:115], v[228:231]
    ds_read_b64_tr_b16 v[74:75], v4 offset:33792
    v_mfma_f32_16x16x32_bf16 v[232:235], v[48:51], v[112:115], v[232:235]
    ds_read_b64_tr_b16 v[80:81], v3 offset:49152
    v_mfma_f32_16x16x32_bf16 v[232:235], v[52:55], v[116:119], v[232:235]
    ds_read_b64_tr_b16 v[82:83], v3 offset:50176
    v_mfma_f32_16x16x32_bf16 v[236:239], v[60:63], v[116:119], v[236:239]
    ds_read_b64_tr_b16 v[84:85], v3 offset:57344
    v_mfma_f32_16x16x32_bf16 v[236:239], v[56:59], v[112:115], v[236:239]
    ds_read_b64_tr_b16 v[86:87], v3 offset:58368
    v_mfma_f32_16x16x32_bf16 v[252:255], v[56:59], v[120:123], v[252:255]
    ds_read_b128 v[112:115], v1 offset:36864
    ds_read_b64_tr_b16 v[20:21], v5 offset:10240
    v_mfma_f32_16x16x32_bf16 v[252:255], v[60:63], v[124:127], v[252:255]
    ds_read_b128 v[116:119], v2 offset:36864
    ds_read_b64_tr_b16 v[22:23], v5 offset:10496
    v_mfma_f32_16x16x32_bf16 v[248:251], v[52:55], v[124:127], v[248:251]
    ds_read_b64_tr_b16 v[92:93], v4 offset:57344
    v_mfma_f32_16x16x32_bf16 v[248:251], v[48:51], v[120:123], v[248:251]
    ds_read_b64_tr_b16 v[94:95], v4 offset:58368
    v_mfma_f32_16x16x32_bf16 v[244:247], v[40:43], v[120:123], v[244:247]
    ds_read_b64_tr_b16 v[88:89], v4 offset:49152
    v_mfma_f32_16x16x32_bf16 v[244:247], v[44:47], v[124:127], v[244:247]
    ds_read_b64_tr_b16 v[90:91], v4 offset:50176
    v_mfma_f32_16x16x32_bf16 v[240:243], v[36:39], v[124:127], v[240:243]
    v_mfma_f32_16x16x32_bf16 v[240:243], v[32:35], v[120:123], v[240:243]
    s_waitcnt lgkmcnt(15)
    v_mfma_f32_16x16x32_bf16 v[128:131], v[64:67], v[96:99], v[128:131]
    ds_read_b128 v[120:123], v1 offset:38912
    v_lshlrev_b32 v14, 4, v0
    s_lshl_b32 s4, s56, 3
    s_lshl_b32 s5, s59, 2
    v_mfma_f32_16x16x32_bf16 v[128:131], v[68:71], v[100:103], v[128:131]
    ds_read_b128 v[124:127], v2 offset:38912
    s_add_u32 s84, s4, s5
    s_lshl_b32 s7, s58, 3
    s_add_u32 s7, s7, s60
    v_mfma_f32_16x16x32_bf16 v[132:135], v[76:79], v[100:103], v[132:135]
    ds_read_b32 v10, v8 offset:32768
    s_lshl_b32 s7, s7, 11
    s_add_u32 s85, s7, 0x1000000
    s_mov_b32 s82, 0x3e8293ee
    s_waitcnt lgkmcnt(15)
    v_mfma_f32_16x16x32_bf16 v[132:135], v[72:75], v[96:99], v[132:135]
    s_mov_b32 s83, 0x3e8293ee
    v_add_u32 v15, 0x2000, v14
    s_waitcnt lgkmcnt(13)
    v_mfma_f32_16x16x32_bf16 v[136:139], v[80:83], v[96:99], v[136:139]
    s_waitcnt lgkmcnt(11)
    v_mfma_f32_16x16x32_bf16 v[136:139], v[84:87], v[100:103], v[136:139]
    s_waitcnt lgkmcnt(5)
    v_mfma_f32_16x16x32_bf16 v[140:143], v[92:95], v[100:103], v[140:143]
    s_waitcnt lgkmcnt(3)
    v_mfma_f32_16x16x32_bf16 v[140:143], v[88:91], v[96:99], v[140:143]
    v_mfma_f32_16x16x32_bf16 v[24:27], v[16:19], v[96:99], v[24:27]
    v_mfma_f32_16x16x32_bf16 v[24:27], v[20:23], v[100:103], v[24:27]
    v_mfma_f32_16x16x32_bf16 v[156:159], v[88:91], v[104:107], v[156:159]
    ds_read_b128 v[96:99], v1 offset:40960
    v_mfma_f32_16x16x32_bf16 v[156:159], v[92:95], v[108:111], v[156:159]
    ds_read_b128 v[100:103], v2 offset:40960
    v_mfma_f32_16x16x32_bf16 v[152:155], v[84:87], v[108:111], v[152:155]
    v_mfma_f32_16x16x32_bf16 v[152:155], v[80:83], v[104:107], v[152:155]
    v_mfma_f32_16x16x32_bf16 v[148:151], v[72:75], v[104:107], v[148:151]
    s_add_u32 s4, s58, 0
    s_and_b32 s4, s4, 3
    s_add_u32 s4, s4, s84
    s_lshl_b32 s4, s4, 16
    v_mfma_f32_16x16x32_bf16 v[148:151], v[76:79], v[108:111], v[148:151]
    s_add_u32 s4, s4, s85
    v_mul_f32 v128, s82, v128
    v_mul_f32 v129, s82, v129
    v_mul_f32 v130, s82, v130
    v_mfma_f32_16x16x32_bf16 v[144:147], v[68:71], v[108:111], v[144:147]
    s_waitcnt vmcnt(0)
    v_mul_f32 v131, s82, v131
    v_mul_f32 v132, s82, v132
    v_mul_f32 v133, s82, v133
    v_mul_f32 v134, s82, v134
    v_mfma_f32_16x16x32_bf16 v[144:147], v[64:67], v[104:107], v[144:147]
    v_mfma_f32_16x16x32_bf16 v[28:31], v[16:19], v[104:107], v[28:31]
    v_mfma_f32_16x16x32_bf16 v[28:31], v[20:23], v[108:111], v[28:31]
    v_mul_f32 v135, s82, v135
    v_cvt_pk_bf16_f32 v40, v128, v129
    v_cvt_pk_bf16_f32 v41, v130, v131
    v_cvt_pk_bf16_f32 v42, v132, v133
    v_mfma_f32_16x16x32_bf16 v[160:163], v[64:67], v[112:115], v[160:163]
    ds_read_b128 v[104:107], v1 offset:43008
    v_cvt_pk_bf16_f32 v43, v134, v135
    buffer_store_dwordx4 v[40:43], v14, s[44:47], s4 offen offset:0 sc1
    v_mul_f32 v136, s82, v136
    v_mul_f32 v137, s82, v137
    v_mfma_f32_16x16x32_bf16 v[160:163], v[68:71], v[116:119], v[160:163]
    ds_read_b128 v[108:111], v2 offset:43008
    v_mul_f32 v138, s82, v138
    v_mul_f32 v139, s82, v139
    v_mul_f32 v140, s82, v140
    v_mul_f32 v141, s82, v141
    v_mfma_f32_16x16x32_bf16 v[164:167], v[76:79], v[116:119], v[164:167]
    s_add_u32 s5, s84, s58
    s_lshl_b32 s5, s5, 12
    s_and_b32 s6, s60, 1
    v_mul_f32 v142, s82, v142
    v_mul_f32 v143, s82, v143
    v_cvt_pk_bf16_f32 v44, v136, v137
    v_cvt_pk_bf16_f32 v45, v138, v139
    v_mfma_f32_16x16x32_bf16 v[164:167], v[72:75], v[112:115], v[164:167]
    s_lshl_b32 s6, s6, 3
    s_add_u32 s5, s5, s6
    s_add_u32 s5, s5, 0x1400000
    v_cvt_pk_bf16_f32 v46, v140, v141
    v_cvt_pk_bf16_f32 v47, v142, v143
    buffer_store_dwordx4 v[44:47], v15, s[44:47], s4 offen offset:0 sc1
    v_mul_f32 v144, s82, v144
    v_mul_f32 v145, s82, v145
    v_mul_f32 v146, s82, v146
    v_mul_f32 v147, s82, v147
    v_mfma_f32_16x16x32_bf16 v[168:171], v[80:83], v[112:115], v[168:171]
    v_cvt_pk_bf16_f32 v52, v24, v25
    v_cvt_pk_bf16_f32 v53, v26, v27
    v_cvt_pk_bf16_f32 v54, v28, v29
    v_mul_f32 v148, s82, v148
    v_mul_f32 v149, s82, v149
    v_mul_f32 v150, s82, v150
    v_mul_f32 v151, s82, v151
    v_mfma_f32_16x16x32_bf16 v[168:171], v[84:87], v[116:119], v[168:171]
    v_cvt_pk_bf16_f32 v55, v30, v31
    buffer_store_dwordx2 v[52:53], v14, s[44:47], s5 offen sc1
    buffer_store_dwordx2 v[54:55], v14, s[44:47], s5 offen offset:1024 sc1
    v_cvt_pk_bf16_f32 v40, v144, v145
    v_cvt_pk_bf16_f32 v41, v146, v147
    v_cvt_pk_bf16_f32 v42, v148, v149
    v_cvt_pk_bf16_f32 v43, v150, v151
    v_mfma_f32_16x16x32_bf16 v[172:175], v[92:95], v[116:119], v[172:175]
    buffer_store_dwordx4 v[40:43], v14, s[44:47], s4 offen offset:1024 sc1
    v_mul_f32 v152, s82, v152
    v_mul_f32 v153, s82, v153
    v_mul_f32 v154, s82, v154
    v_mfma_f32_16x16x32_bf16 v[172:175], v[88:91], v[112:115], v[172:175]
    v_mul_f32 v155, s82, v155
    v_mul_f32 v156, s82, v156
    v_mul_f32 v157, s82, v157
    v_mul_f32 v158, s82, v158
    s_waitcnt lgkmcnt(6)
    v_mfma_f32_16x16x32_bf16 v[188:191], v[88:91], v[120:123], v[188:191]
    ds_read_b128 v[112:115], v1 offset:45056
    v_mul_f32 v159, s82, v159
    v_cvt_pk_bf16_f32 v44, v152, v153
    v_cvt_pk_bf16_f32 v45, v154, v155
    v_cvt_pk_bf16_f32 v46, v156, v157
    s_waitcnt lgkmcnt(6)
    v_mfma_f32_16x16x32_bf16 v[188:191], v[92:95], v[124:127], v[188:191]
    ds_read_b128 v[116:119], v2 offset:45056
    v_cvt_pk_bf16_f32 v47, v158, v159
    buffer_store_dwordx4 v[44:47], v15, s[44:47], s4 offen offset:1024 sc1
    v_mfma_f32_16x16x32_bf16 v[184:187], v[84:87], v[124:127], v[184:187]
    v_mfma_f32_16x16x32_bf16 v[184:187], v[80:83], v[120:123], v[184:187]
    s_add_u32 s4, s58, 1
    s_and_b32 s4, s4, 3
    s_add_u32 s4, s4, s84
    s_lshl_b32 s4, s4, 16
    v_mfma_f32_16x16x32_bf16 v[180:183], v[72:75], v[120:123], v[180:183]
    s_add_u32 s4, s4, s85
    v_mul_f32 v160, s82, v160
    v_mul_f32 v161, s82, v161
    v_mul_f32 v162, s82, v162
    v_mfma_f32_16x16x32_bf16 v[180:183], v[76:79], v[124:127], v[180:183]
    v_mul_f32 v163, s82, v163
    v_mul_f32 v164, s82, v164
    v_mul_f32 v165, s82, v165
    v_mul_f32 v166, s82, v166
    v_mfma_f32_16x16x32_bf16 v[176:179], v[68:71], v[124:127], v[176:179]
    v_mul_f32 v167, s82, v167
    v_cvt_pk_bf16_f32 v40, v160, v161
    v_cvt_pk_bf16_f32 v41, v162, v163
    v_cvt_pk_bf16_f32 v42, v164, v165
    v_mfma_f32_16x16x32_bf16 v[176:179], v[64:67], v[120:123], v[176:179]
    v_cvt_pk_bf16_f32 v43, v166, v167
    buffer_store_dwordx4 v[40:43], v14, s[44:47], s4 offen offset:0 sc1
    v_mul_f32 v168, s82, v168
    v_mul_f32 v169, s82, v169
    s_waitcnt lgkmcnt(5)
    v_mfma_f32_16x16x32_bf16 v[192:195], v[64:67], v[96:99], v[192:195]
    ds_read_b128 v[120:123], v1 offset:47104
    v_mul_f32 v170, s82, v170
    v_mul_f32 v171, s82, v171
    v_mul_f32 v172, s82, v172
    v_mul_f32 v173, s82, v173
    s_waitcnt lgkmcnt(5)
    v_mfma_f32_16x16x32_bf16 v[192:195], v[68:71], v[100:103], v[192:195]
    ds_read_b128 v[124:127], v2 offset:47104
    v_mul_f32 v174, s82, v174
    v_mul_f32 v175, s82, v175
    v_cvt_pk_bf16_f32 v44, v168, v169
    v_cvt_pk_bf16_f32 v45, v170, v171
    v_mfma_f32_16x16x32_bf16 v[196:199], v[76:79], v[100:103], v[196:199]
    v_cvt_pk_bf16_f32 v46, v172, v173
    v_cvt_pk_bf16_f32 v47, v174, v175
    buffer_store_dwordx4 v[44:47], v15, s[44:47], s4 offen offset:0 sc1
    v_mfma_f32_16x16x32_bf16 v[196:199], v[72:75], v[96:99], v[196:199]
    v_mul_f32 v176, s82, v176
    v_mul_f32 v177, s82, v177
    v_mul_f32 v178, s82, v178
    v_mul_f32 v179, s82, v179
    v_mfma_f32_16x16x32_bf16 v[200:203], v[80:83], v[96:99], v[200:203]
    v_mul_f32 v180, s82, v180
    v_mul_f32 v181, s82, v181
    v_mul_f32 v182, s82, v182
    v_mul_f32 v183, s82, v183
    v_mfma_f32_16x16x32_bf16 v[200:203], v[84:87], v[100:103], v[200:203]
    v_cvt_pk_bf16_f32 v40, v176, v177
    v_cvt_pk_bf16_f32 v41, v178, v179
    v_cvt_pk_bf16_f32 v42, v180, v181
    v_cvt_pk_bf16_f32 v43, v182, v183
    v_mfma_f32_16x16x32_bf16 v[204:207], v[92:95], v[100:103], v[204:207]
    buffer_store_dwordx4 v[40:43], v14, s[44:47], s4 offen offset:1024 sc1
    v_mul_f32 v184, s82, v184
    v_mul_f32 v185, s82, v185
    v_mul_f32 v186, s82, v186
    v_mfma_f32_16x16x32_bf16 v[204:207], v[88:91], v[96:99], v[204:207]
    v_mul_f32 v187, s82, v187
    v_mul_f32 v188, s82, v188
    v_mul_f32 v189, s82, v189
    v_mul_f32 v190, s82, v190
    s_waitcnt lgkmcnt(5)
    v_mfma_f32_16x16x32_bf16 v[220:223], v[88:91], v[104:107], v[220:223]
    v_mul_f32 v191, s82, v191
    v_cvt_pk_bf16_f32 v44, v184, v185
    v_cvt_pk_bf16_f32 v45, v186, v187
    v_cvt_pk_bf16_f32 v46, v188, v189
    s_waitcnt lgkmcnt(4)
    v_mfma_f32_16x16x32_bf16 v[220:223], v[92:95], v[108:111], v[220:223]
    v_cvt_pk_bf16_f32 v47, v190, v191
    buffer_store_dwordx4 v[44:47], v15, s[44:47], s4 offen offset:1024 sc1
    v_mfma_f32_16x16x32_bf16 v[216:219], v[84:87], v[108:111], v[216:219]
    v_mfma_f32_16x16x32_bf16 v[216:219], v[80:83], v[104:107], v[216:219]
    s_add_u32 s4, s58, 2
    s_and_b32 s4, s4, 3
    s_add_u32 s4, s4, s84
    s_lshl_b32 s4, s4, 16
    v_mfma_f32_16x16x32_bf16 v[212:215], v[72:75], v[104:107], v[212:215]
    s_add_u32 s4, s4, s85
    v_mul_f32 v192, s82, v192
    v_mul_f32 v193, s82, v193
    v_mul_f32 v194, s82, v194
    v_mfma_f32_16x16x32_bf16 v[212:215], v[76:79], v[108:111], v[212:215]
    v_mul_f32 v195, s82, v195
    v_mul_f32 v196, s82, v196
    v_mul_f32 v197, s82, v197
    v_mul_f32 v198, s82, v198
    v_mfma_f32_16x16x32_bf16 v[208:211], v[68:71], v[108:111], v[208:211]
    v_mul_f32 v199, s82, v199
    v_cvt_pk_bf16_f32 v40, v192, v193
    v_cvt_pk_bf16_f32 v41, v194, v195
    v_cvt_pk_bf16_f32 v42, v196, v197
    v_mfma_f32_16x16x32_bf16 v[208:211], v[64:67], v[104:107], v[208:211]
    v_cvt_pk_bf16_f32 v43, v198, v199
    buffer_store_dwordx4 v[40:43], v14, s[44:47], s4 offen offset:0 sc1
    v_mul_f32 v200, s82, v200
    v_mul_f32 v201, s82, v201
    s_waitcnt lgkmcnt(3)
    v_mfma_f32_16x16x32_bf16 v[224:227], v[64:67], v[112:115], v[224:227]
    v_mul_f32 v202, s82, v202
    v_mul_f32 v203, s82, v203
    v_mul_f32 v204, s82, v204
    v_mul_f32 v205, s82, v205
    s_waitcnt lgkmcnt(2)
    v_mfma_f32_16x16x32_bf16 v[224:227], v[68:71], v[116:119], v[224:227]
    v_mul_f32 v206, s82, v206
    v_mul_f32 v207, s82, v207
    v_cvt_pk_bf16_f32 v44, v200, v201
    v_cvt_pk_bf16_f32 v45, v202, v203
    v_mfma_f32_16x16x32_bf16 v[228:231], v[76:79], v[116:119], v[228:231]
    v_cvt_pk_bf16_f32 v46, v204, v205
    v_cvt_pk_bf16_f32 v47, v206, v207
    buffer_store_dwordx4 v[44:47], v15, s[44:47], s4 offen offset:0 sc1
    v_mfma_f32_16x16x32_bf16 v[228:231], v[72:75], v[112:115], v[228:231]
    v_mul_f32 v208, s82, v208
    v_mul_f32 v209, s82, v209
    v_mul_f32 v210, s82, v210
    v_mul_f32 v211, s82, v211
    v_mfma_f32_16x16x32_bf16 v[232:235], v[80:83], v[112:115], v[232:235]
    v_mul_f32 v212, s82, v212
    v_mul_f32 v213, s82, v213
    v_mul_f32 v214, s82, v214
    v_mul_f32 v215, s82, v215
    v_mfma_f32_16x16x32_bf16 v[232:235], v[84:87], v[116:119], v[232:235]
    v_cvt_pk_bf16_f32 v40, v208, v209
    v_cvt_pk_bf16_f32 v41, v210, v211
    v_cvt_pk_bf16_f32 v42, v212, v213
    v_cvt_pk_bf16_f32 v43, v214, v215
    v_mfma_f32_16x16x32_bf16 v[236:239], v[92:95], v[116:119], v[236:239]
    buffer_store_dwordx4 v[40:43], v14, s[44:47], s4 offen offset:1024 sc1
    v_mul_f32 v216, s82, v216
    v_mul_f32 v217, s82, v217
    v_mul_f32 v218, s82, v218
    v_mfma_f32_16x16x32_bf16 v[236:239], v[88:91], v[112:115], v[236:239]
    v_mul_f32 v219, s82, v219
    v_mul_f32 v220, s82, v220
    v_mul_f32 v221, s82, v221
    v_mul_f32 v222, s82, v222
    s_waitcnt lgkmcnt(1)
    v_mfma_f32_16x16x32_bf16 v[252:255], v[88:91], v[120:123], v[252:255]
    v_mul_f32 v223, s82, v223
    v_cvt_pk_bf16_f32 v44, v216, v217
    v_cvt_pk_bf16_f32 v45, v218, v219
    v_cvt_pk_bf16_f32 v46, v220, v221
    s_waitcnt lgkmcnt(0)
    v_mfma_f32_16x16x32_bf16 v[252:255], v[92:95], v[124:127], v[252:255]
    v_cvt_pk_bf16_f32 v47, v222, v223
    buffer_store_dwordx4 v[44:47], v15, s[44:47], s4 offen offset:1024 sc1
    v_mfma_f32_16x16x32_bf16 v[248:251], v[84:87], v[124:127], v[248:251]
    v_mfma_f32_16x16x32_bf16 v[248:251], v[80:83], v[120:123], v[248:251]
    s_add_u32 s4, s58, 3
    s_and_b32 s4, s4, 3
    s_add_u32 s4, s4, s84
    s_lshl_b32 s4, s4, 16
    s_add_u32 s4, s4, s85
    v_mul_f32 v224, s82, v224
    v_mul_f32 v225, s82, v225
    v_mfma_f32_16x16x32_bf16 v[244:247], v[72:75], v[120:123], v[244:247]
    v_mul_f32 v226, s82, v226
    v_mul_f32 v227, s82, v227
    v_mul_f32 v228, s82, v228
    v_mul_f32 v229, s82, v229
    v_mul_f32 v230, s82, v230
    v_mul_f32 v231, s82, v231
    v_cvt_pk_bf16_f32 v40, v224, v225
    v_mfma_f32_16x16x32_bf16 v[244:247], v[76:79], v[124:127], v[244:247]
    v_cvt_pk_bf16_f32 v41, v226, v227
    v_cvt_pk_bf16_f32 v42, v228, v229
    v_cvt_pk_bf16_f32 v43, v230, v231
    buffer_store_dwordx4 v[40:43], v14, s[44:47], s4 offen offset:0 sc1
    v_mul_f32 v232, s82, v232
    v_mul_f32 v233, s82, v233
    v_mul_f32 v234, s82, v234
    v_mfma_f32_16x16x32_bf16 v[240:243], v[68:71], v[124:127], v[240:243]
    v_mul_f32 v235, s82, v235
    v_mul_f32 v236, s82, v236
    v_mul_f32 v237, s82, v237
    v_mul_f32 v238, s82, v238
    v_mul_f32 v239, s82, v239
    v_cvt_pk_bf16_f32 v44, v232, v233
    v_cvt_pk_bf16_f32 v45, v234, v235
    v_mfma_f32_16x16x32_bf16 v[240:243], v[64:67], v[120:123], v[240:243]
    v_cvt_pk_bf16_f32 v46, v236, v237
    v_cvt_pk_bf16_f32 v47, v238, v239
    buffer_store_dwordx4 v[44:47], v15, s[44:47], s4 offen offset:0 sc1
    s_nop 7
    v_pk_mul_f32 v[240:241], v[240:241], s[82:83]
    v_pk_mul_f32 v[242:243], v[242:243], s[82:83]
    v_pk_mul_f32 v[244:245], v[244:245], s[82:83]
    v_pk_mul_f32 v[246:247], v[246:247], s[82:83]
    v_cvt_pk_bf16_f32 v40, v240, v241
    v_cvt_pk_bf16_f32 v41, v242, v243
    v_cvt_pk_bf16_f32 v42, v244, v245
    v_cvt_pk_bf16_f32 v43, v246, v247
    buffer_store_dwordx4 v[40:43], v14, s[44:47], s4 offen offset:1024 sc1
    v_pk_mul_f32 v[248:249], v[248:249], s[82:83]
    v_pk_mul_f32 v[250:251], v[250:251], s[82:83]
    v_pk_mul_f32 v[252:253], v[252:253], s[82:83]
    v_pk_mul_f32 v[254:255], v[254:255], s[82:83]
    v_cvt_pk_bf16_f32 v44, v248, v249
    v_cvt_pk_bf16_f32 v45, v250, v251
    v_cvt_pk_bf16_f32 v46, v252, v253
    v_cvt_pk_bf16_f32 v47, v254, v255
    buffer_store_dwordx4 v[44:47], v15, s[44:47], s4 offen offset:1024 sc1
    s_cmp_ge_u32 s3, 4
    s_cbranch_scc1 p1_fin
    v_lshlrev_b32 v56, 16, v10
    v_and_b32 v57, s80, v10
    v_lshlrev_b32 v10, 16, v11
    v_and_b32 v11, s80, v11
    v_mul_f32 v56, v56, v10
    v_mul_f32 v57, v57, v11
    v_cvt_pk_bf16_f32 v57, v56, v57
    v_lshlrev_b32 v56, 16, v57
    v_and_b32 v57, s80, v57
    v_add_f32 v12, v12, v56
    v_add_f32 v13, v13, v57
    v_add_f32 v12, v12, v13
    s_nop 1
    v_add_f32_dpp v12, v12, v12 row_shr:1 row_mask:0xf bank_mask:0xf bound_ctrl:1
    s_nop 1
    v_add_f32_dpp v12, v12, v12 row_shr:2 row_mask:0xf bank_mask:0xf bound_ctrl:1
    s_nop 1
    v_add_f32_dpp v12, v12, v12 row_shr:4 row_mask:0xf bank_mask:0xf bound_ctrl:1
    s_nop 1
    v_add_f32_dpp v12, v12, v12 row_shr:8 row_mask:0xf bank_mask:0xf bound_ctrl:1
    s_nop 1
    v_add_f32_dpp v12, v12, v12 row_bcast:15 row_mask:0xa bank_mask:0xf
    v_cvt_pk_bf16_f32 v10, v12, v12
    v_lshlrev_b32 v10, 16, v10
    v_mul_f32 v10, 0xbfb8aa3b, v10
    v_exp_f32 v10, v10
    s_lshl_b32 s4, s56, 5
    v_add_f32 v10, 1.0, v10
    v_rcp_f32 v10, v10
    s_add_u32 s4, s4, s57
    v_cvt_pk_bf16_f32 v10, v10, v10
    v_lshlrev_b32 v10, 16, v10
    v_sub_f32 v11, 1.0, v10
    v_cvt_pk_bf16_f32 v11, v11, v11
    v_lshlrev_b32 v11, 16, v11
    v_lshrrev_b32 v12, 5, v0
    v_lshlrev_b32 v12, 3, v12
    s_lshl_b32 s4, s4, 2
    s_add_u32 s4, s4, s60
    s_lshl_b32 s4, s4, 4
    s_add_u32 s4, s4, 0x1480000
    s_mov_b32 exec_lo, 0x80000000
    s_mov_b32 exec_hi, 0x80000000
    buffer_store_dwordx2 v[10:11], v12, s[44:47], s4 offen sc1
    s_mov_b64 exec, -1
    s_branch p1_fin
p1_KL:
    s_mov_b32 m0, s72
    s_nop 0
    buffer_load_dwordx4 v12, s[20:23], s66 offen lds
    s_add_u32 m0, s72, 0x1000
    s_nop 0
    buffer_load_dwordx4 v12, s[24:27], s66 offen lds
    s_add_u32 s66, s66, 4096
    s_add_u32 m0, s71, 0x8000
    s_nop 0
    buffer_load_dwordx4 v8, s[12:15], s65 offen lds
    s_add_u32 m0, s71, 0xc000
    s_nop 0
    buffer_load_dwordx4 v8, s[16:19], s65 offen lds
    s_add_u32 m0, s71, 0x8400
    s_nop 0
    buffer_load_dwordx4 v9, s[12:15], s65 offen lds
    s_add_u32 m0, s71, 0xc400
    s_nop 0
    buffer_load_dwordx4 v9, s[16:19], s65 offen lds
    s_add_u32 m0, s71, 0x8800
    s_nop 0
    buffer_load_dwordx4 v10, s[12:15], s65 offen lds
    s_add_u32 m0, s71, 0xc800
    s_nop 0
    buffer_load_dwordx4 v10, s[16:19], s65 offen lds
    s_add_u32 m0, s71, 0x8c00
    s_nop 0
    buffer_load_dwordx4 v11, s[12:15], s65 offen lds
    s_add_u32 m0, s71, 0xcc00
    s_nop 0
    buffer_load_dwordx4 v11, s[16:19], s65 offen lds
    s_add_u32 s65, s65, s67
    s_waitcnt vmcnt(8)
    s_barrier
    s_add_u32 m0, s72, 0x2000
    s_nop 0
    buffer_load_dwordx4 v12, s[20:23], s66 offen lds
    s_add_u32 m0, s72, 0x3000
    s_nop 0
    buffer_load_dwordx4 v12, s[24:27], s66 offen lds
    s_add_u32 s66, s66, 4096
    s_add_u32 m0, s68, 0x8000
    s_nop 0
    buffer_load_dwordx4 v6, s[8:11], s61 offen lds
    s_add_u32 m0, s68, 0x8400
    s_nop 0
    buffer_load_dwordx4 v7, s[8:11], s61 offen lds
    s_add_u32 s61, s61, 128
    s_add_u32 m0, s68, 0x8800
    s_nop 0
    buffer_load_dwordx4 v6, s[8:11], s62 offen lds
    s_add_u32 m0, s68, 0x8c00
    s_nop 0
    buffer_load_dwordx4 v7, s[8:11], s62 offen lds
    s_add_u32 s62, s62, 128
    s_add_u32 m0, s68, 0x9000
    s_nop 0
    buffer_load_dwordx4 v6, s[8:11], s63 offen lds
    s_add_u32 m0, s68, 0x9400
    s_nop 0
    buffer_load_dwordx4 v7, s[8:11], s63 offen lds
    s_add_u32 s63, s63, 128
    s_add_u32 m0, s68, 0x9800
    s_nop 0
    buffer_load_dwordx4 v6, s[8:11], s64 offen lds
    s_add_u32 m0, s68, 0x9c00
    s_nop 0
    buffer_load_dwordx4 v7, s[8:11], s64 offen lds
    s_add_u32 s64, s64, 128
    ds_read_b128 v[96:99], v1 offset:0
    ds_read_b128 v[100:103], v2 offset:0
    ds_read_b64_tr_b16 v[32:33], v3 offset:0
    ds_read_b64_tr_b16 v[34:35], v3 offset:1024
    ds_read_b64_tr_b16 v[36:37], v3 offset:8192
    ds_read_b64_tr_b16 v[38:39], v3 offset:9216
    ds_read_b64_tr_b16 v[44:45], v4 offset:8192
    ds_read_b64_tr_b16 v[46:47], v4 offset:9216
    ds_read_b128 v[104:107], v1 offset:2048
    ds_read_b64_tr_b16 v[16:17], v5 offset:0
    ds_read_b128 v[108:111], v2 offset:2048
    ds_read_b64_tr_b16 v[18:19], v5 offset:256
    ds_read_b64_tr_b16 v[40:41], v4 offset:0
    ds_read_b64_tr_b16 v[42:43], v4 offset:1024
    ds_read_b64_tr_b16 v[48:49], v3 offset:16384
    ds_read_b64_tr_b16 v[50:51], v3 offset:17408
    ds_read_b64_tr_b16 v[52:53], v3 offset:24576
    ds_read_b64_tr_b16 v[54:55], v3 offset:25600
    ds_read_b128 v[112:115], v1 offset:4096
    ds_read_b64_tr_b16 v[20:21], v5 offset:2048
    ds_read_b128 v[116:119], v2 offset:4096
    ds_read_b64_tr_b16 v[22:23], v5 offset:2304
    ds_read_b64_tr_b16 v[60:61], v4 offset:24576
    ds_read_b64_tr_b16 v[62:63], v4 offset:25600
    ds_read_b64_tr_b16 v[56:57], v4 offset:16384
    ds_read_b64_tr_b16 v[58:59], v4 offset:17408
    s_mov_b32 s75, 6
    s_waitcnt lgkmcnt(15)
    v_mfma_f32_16x16x32_bf16 v[128:131], v[32:35], v[96:99], 0
    ds_read_b128 v[120:123], v1 offset:6144
    v_mfma_f32_16x16x32_bf16 v[128:131], v[36:39], v[100:103], v[128:131]
    ds_read_b128 v[124:127], v2 offset:6144
    v_mfma_f32_16x16x32_bf16 v[132:135], v[44:47], v[100:103], 0
    s_waitcnt lgkmcnt(14)
    v_mfma_f32_16x16x32_bf16 v[132:135], v[40:43], v[96:99], v[132:135]
    s_waitcnt lgkmcnt(12)
    v_mfma_f32_16x16x32_bf16 v[136:139], v[48:51], v[96:99], 0
    s_waitcnt lgkmcnt(10)
    v_mfma_f32_16x16x32_bf16 v[136:139], v[52:55], v[100:103], v[136:139]
    s_waitcnt lgkmcnt(4)
    v_mfma_f32_16x16x32_bf16 v[140:143], v[60:63], v[100:103], 0
    s_waitcnt lgkmcnt(2)
    v_mfma_f32_16x16x32_bf16 v[140:143], v[56:59], v[96:99], v[140:143]
    v_mfma_f32_16x16x32_bf16 v[24:27], v[16:19], v[96:99], 0
    v_mfma_f32_16x16x32_bf16 v[24:27], v[20:23], v[100:103], v[24:27]
    v_mfma_f32_16x16x32_bf16 v[156:159], v[56:59], v[104:107], 0
    ds_read_b128 v[96:99], v1 offset:8192
    v_mfma_f32_16x16x32_bf16 v[156:159], v[60:63], v[108:111], v[156:159]
    ds_read_b128 v[100:103], v2 offset:8192
    v_mfma_f32_16x16x32_bf16 v[152:155], v[52:55], v[108:111], 0
    v_mfma_f32_16x16x32_bf16 v[152:155], v[48:51], v[104:107], v[152:155]
    v_mfma_f32_16x16x32_bf16 v[148:151], v[40:43], v[104:107], 0
    v_mfma_f32_16x16x32_bf16 v[148:151], v[44:47], v[108:111], v[148:151]
    v_mfma_f32_16x16x32_bf16 v[144:147], v[36:39], v[108:111], 0
    v_mfma_f32_16x16x32_bf16 v[144:147], v[32:35], v[104:107], v[144:147]
    v_mfma_f32_16x16x32_bf16 v[28:31], v[16:19], v[104:107], 0
    v_mfma_f32_16x16x32_bf16 v[28:31], v[20:23], v[108:111], v[28:31]
    v_mfma_f32_16x16x32_bf16 v[160:163], v[32:35], v[112:115], 0
    ds_read_b128 v[104:107], v1 offset:10240
    v_mfma_f32_16x16x32_bf16 v[160:163], v[36:39], v[116:119], v[160:163]
    ds_read_b128 v[108:111], v2 offset:10240
    v_mfma_f32_16x16x32_bf16 v[164:167], v[44:47], v[116:119], 0
    v_mfma_f32_16x16x32_bf16 v[164:167], v[40:43], v[112:115], v[164:167]
    v_mfma_f32_16x16x32_bf16 v[168:171], v[48:51], v[112:115], 0
    v_mfma_f32_16x16x32_bf16 v[168:171], v[52:55], v[116:119], v[168:171]
    v_mfma_f32_16x16x32_bf16 v[172:175], v[60:63], v[116:119], 0
    v_mfma_f32_16x16x32_bf16 v[172:175], v[56:59], v[112:115], v[172:175]
    s_waitcnt lgkmcnt(5)
    v_mfma_f32_16x16x32_bf16 v[188:191], v[56:59], v[120:123], 0
    ds_read_b128 v[112:115], v1 offset:12288
    s_waitcnt lgkmcnt(5)
    v_mfma_f32_16x16x32_bf16 v[188:191], v[60:63], v[124:127], v[188:191]
    ds_read_b128 v[116:119], v2 offset:12288
    v_mfma_f32_16x16x32_bf16 v[184:187], v[52:55], v[124:127], 0
    v_mfma_f32_16x16x32_bf16 v[184:187], v[48:51], v[120:123], v[184:187]
    v_mfma_f32_16x16x32_bf16 v[180:183], v[40:43], v[120:123], 0
    v_mfma_f32_16x16x32_bf16 v[180:183], v[44:47], v[124:127], v[180:183]
    v_mfma_f32_16x16x32_bf16 v[176:179], v[36:39], v[124:127], 0
    v_mfma_f32_16x16x32_bf16 v[176:179], v[32:35], v[120:123], v[176:179]
    s_waitcnt lgkmcnt(5)
    v_mfma_f32_16x16x32_bf16 v[192:195], v[32:35], v[96:99], 0
    ds_read_b128 v[120:123], v1 offset:14336
    s_waitcnt lgkmcnt(5)
    v_mfma_f32_16x16x32_bf16 v[192:195], v[36:39], v[100:103], v[192:195]
    ds_read_b128 v[124:127], v2 offset:14336
    v_mfma_f32_16x16x32_bf16 v[196:199], v[44:47], v[100:103], 0
    v_mfma_f32_16x16x32_bf16 v[196:199], v[40:43], v[96:99], v[196:199]
    v_mfma_f32_16x16x32_bf16 v[200:203], v[48:51], v[96:99], 0
    v_mfma_f32_16x16x32_bf16 v[200:203], v[52:55], v[100:103], v[200:203]
    v_mfma_f32_16x16x32_bf16 v[204:207], v[60:63], v[100:103], 0
    v_mfma_f32_16x16x32_bf16 v[204:207], v[56:59], v[96:99], v[204:207]
    s_waitcnt vmcnt(0) lgkmcnt(0)
    s_barrier
    s_mov_b32 m0, s72
    s_nop 0
    buffer_load_dwordx4 v12, s[20:23], s66 offen lds
    s_add_u32 m0, s72, 0x1000
    s_nop 0
    buffer_load_dwordx4 v12, s[24:27], s66 offen lds
    s_add_u32 s66, s66, 4096
    s_mov_b32 m0, s71
    s_nop 0
    buffer_load_dwordx4 v8, s[12:15], s65 offen lds
    s_add_u32 m0, s71, 0x4000
    s_nop 0
    buffer_load_dwordx4 v8, s[16:19], s65 offen lds
    s_add_u32 m0, s71, 0x400
    s_nop 0
    buffer_load_dwordx4 v9, s[12:15], s65 offen lds
    s_add_u32 m0, s71, 0x4400
    s_nop 0
    buffer_load_dwordx4 v9, s[16:19], s65 offen lds
    s_add_u32 m0, s71, 0x800
    s_nop 0
    buffer_load_dwordx4 v10, s[12:15], s65 offen lds
    s_add_u32 m0, s71, 0x4800
    s_nop 0
    buffer_load_dwordx4 v10, s[16:19], s65 offen lds
    s_add_u32 m0, s71, 0xc00
    s_nop 0
    buffer_load_dwordx4 v11, s[12:15], s65 offen lds
    s_add_u32 m0, s71, 0x4c00
    s_nop 0
    buffer_load_dwordx4 v11, s[16:19], s65 offen lds
    s_add_u32 s65, s65, s67
    s_mov_b32 m0, s68
    s_nop 0
    buffer_load_dwordx4 v6, s[8:11], s61 offen lds
    s_add_u32 m0, s68, 0x400
    s_nop 0
    buffer_load_dwordx4 v7, s[8:11], s61 offen lds
    s_add_u32 s61, s61, 128
    s_add_u32 m0, s68, 0x800
    s_nop 0
    buffer_load_dwordx4 v6, s[8:11], s62 offen lds
    s_add_u32 m0, s68, 0xc00
    s_nop 0
    buffer_load_dwordx4 v7, s[8:11], s62 offen lds
    s_add_u32 s62, s62, 128
    v_mfma_f32_16x16x32_bf16 v[220:223], v[56:59], v[104:107], 0
    ds_read_b128 v[96:99], v1 offset:32768
    v_mfma_f32_16x16x32_bf16 v[220:223], v[60:63], v[108:111], v[220:223]
    ds_read_b128 v[100:103], v2 offset:32768
    v_mfma_f32_16x16x32_bf16 v[216:219], v[52:55], v[108:111], 0
    ds_read_b64_tr_b16 v[64:65], v3 offset:32768
    v_mfma_f32_16x16x32_bf16 v[216:219], v[48:51], v[104:107], v[216:219]
    ds_read_b64_tr_b16 v[66:67], v3 offset:33792
    v_mfma_f32_16x16x32_bf16 v[212:215], v[40:43], v[104:107], 0
    ds_read_b64_tr_b16 v[68:69], v3 offset:40960
    v_mfma_f32_16x16x32_bf16 v[212:215], v[44:47], v[108:111], v[212:215]
    ds_read_b64_tr_b16 v[70:71], v3 offset:41984
    v_mfma_f32_16x16x32_bf16 v[208:211], v[36:39], v[108:111], 0
    ds_read_b64_tr_b16 v[76:77], v4 offset:40960
    v_mfma_f32_16x16x32_bf16 v[208:211], v[32:35], v[104:107], v[208:211]
    ds_read_b64_tr_b16 v[78:79], v4 offset:41984
    v_mfma_f32_16x16x32_bf16 v[224:227], v[32:35], v[112:115], 0
    ds_read_b128 v[104:107], v1 offset:34816
    ds_read_b64_tr_b16 v[16:17], v5 offset:8192
    v_mfma_f32_16x16x32_bf16 v[224:227], v[36:39], v[116:119], v[224:227]
    ds_read_b128 v[108:111], v2 offset:34816
    ds_read_b64_tr_b16 v[18:19], v5 offset:8448
    v_mfma_f32_16x16x32_bf16 v[228:231], v[44:47], v[116:119], 0
    ds_read_b64_tr_b16 v[72:73], v4 offset:32768
    v_mfma_f32_16x16x32_bf16 v[228:231], v[40:43], v[112:115], v[228:231]
    ds_read_b64_tr_b16 v[74:75], v4 offset:33792
    v_mfma_f32_16x16x32_bf16 v[232:235], v[48:51], v[112:115], 0
    ds_read_b64_tr_b16 v[80:81], v3 offset:49152
    v_mfma_f32_16x16x32_bf16 v[232:235], v[52:55], v[116:119], v[232:235]
    ds_read_b64_tr_b16 v[82:83], v3 offset:50176
    v_mfma_f32_16x16x32_bf16 v[236:239], v[60:63], v[116:119], 0
    ds_read_b64_tr_b16 v[84:85], v3 offset:57344
    v_mfma_f32_16x16x32_bf16 v[236:239], v[56:59], v[112:115], v[236:239]
    ds_read_b64_tr_b16 v[86:87], v3 offset:58368
    v_mfma_f32_16x16x32_bf16 v[252:255], v[56:59], v[120:123], 0
    ds_read_b128 v[112:115], v1 offset:36864
    ds_read_b64_tr_b16 v[20:21], v5 offset:10240
    v_mfma_f32_16x16x32_bf16 v[252:255], v[60:63], v[124:127], v[252:255]
    ds_read_b128 v[116:119], v2 offset:36864
    ds_read_b64_tr_b16 v[22:23], v5 offset:10496
    v_mfma_f32_16x16x32_bf16 v[248:251], v[52:55], v[124:127], 0
    ds_read_b64_tr_b16 v[92:93], v4 offset:57344
    v_mfma_f32_16x16x32_bf16 v[248:251], v[48:51], v[120:123], v[248:251]
    ds_read_b64_tr_b16 v[94:95], v4 offset:58368
    v_mfma_f32_16x16x32_bf16 v[244:247], v[40:43], v[120:123], 0
    ds_read_b64_tr_b16 v[88:89], v4 offset:49152
    v_mfma_f32_16x16x32_bf16 v[244:247], v[44:47], v[124:127], v[244:247]
    ds_read_b64_tr_b16 v[90:91], v4 offset:50176
    v_mfma_f32_16x16x32_bf16 v[240:243], v[36:39], v[124:127], 0
    v_mfma_f32_16x16x32_bf16 v[240:243], v[32:35], v[120:123], v[240:243]
.p2align 6
p1_KL_loop:
    s_waitcnt lgkmcnt(15)
    v_mfma_f32_16x16x32_bf16 v[128:131], v[64:67], v[96:99], v[128:131]
    ds_read_b128 v[120:123], v1 offset:38912
    v_mfma_f32_16x16x32_bf16 v[128:131], v[68:71], v[100:103], v[128:131]
    ds_read_b128 v[124:127], v2 offset:38912
    v_mfma_f32_16x16x32_bf16 v[132:135], v[76:79], v[100:103], v[132:135]
    s_waitcnt lgkmcnt(14)
    v_mfma_f32_16x16x32_bf16 v[132:135], v[72:75], v[96:99], v[132:135]
    s_waitcnt lgkmcnt(12)
    v_mfma_f32_16x16x32_bf16 v[136:139], v[80:83], v[96:99], v[136:139]
    s_waitcnt lgkmcnt(10)
    v_mfma_f32_16x16x32_bf16 v[136:139], v[84:87], v[100:103], v[136:139]
    s_waitcnt lgkmcnt(4)
    v_mfma_f32_16x16x32_bf16 v[140:143], v[92:95], v[100:103], v[140:143]
    s_waitcnt lgkmcnt(2)
    v_mfma_f32_16x16x32_bf16 v[140:143], v[88:91], v[96:99], v[140:143]
    v_mfma_f32_16x16x32_bf16 v[24:27], v[16:19], v[96:99], v[24:27]
    v_mfma_f32_16x16x32_bf16 v[24:27], v[20:23], v[100:103], v[24:27]
    v_mfma_f32_16x16x32_bf16 v[156:159], v[88:91], v[104:107], v[156:159]
    ds_read_b128 v[96:99], v1 offset:40960
    v_mfma_f32_16x16x32_bf16 v[156:159], v[92:95], v[108:111], v[156:159]
    ds_read_b128 v[100:103], v2 offset:40960
    v_mfma_f32_16x16x32_bf16 v[152:155], v[84:87], v[108:111], v[152:155]
    v_mfma_f32_16x16x32_bf16 v[152:155], v[80:83], v[104:107], v[152:155]
    v_mfma_f32_16x16x32_bf16 v[148:151], v[72:75], v[104:107], v[148:151]
    v_mfma_f32_16x16x32_bf16 v[148:151], v[76:79], v[108:111], v[148:151]
    v_mfma_f32_16x16x32_bf16 v[144:147], v[68:71], v[108:111], v[144:147]
    v_mfma_f32_16x16x32_bf16 v[144:147], v[64:67], v[104:107], v[144:147]
    v_mfma_f32_16x16x32_bf16 v[28:31], v[16:19], v[104:107], v[28:31]
    v_mfma_f32_16x16x32_bf16 v[28:31], v[20:23], v[108:111], v[28:31]
    v_mfma_f32_16x16x32_bf16 v[160:163], v[64:67], v[112:115], v[160:163]
    ds_read_b128 v[104:107], v1 offset:43008
    v_mfma_f32_16x16x32_bf16 v[160:163], v[68:71], v[116:119], v[160:163]
    ds_read_b128 v[108:111], v2 offset:43008
    v_mfma_f32_16x16x32_bf16 v[164:167], v[76:79], v[116:119], v[164:167]
    v_mfma_f32_16x16x32_bf16 v[164:167], v[72:75], v[112:115], v[164:167]
    v_mfma_f32_16x16x32_bf16 v[168:171], v[80:83], v[112:115], v[168:171]
    v_mfma_f32_16x16x32_bf16 v[168:171], v[84:87], v[116:119], v[168:171]
    v_mfma_f32_16x16x32_bf16 v[172:175], v[92:95], v[116:119], v[172:175]
    v_mfma_f32_16x16x32_bf16 v[172:175], v[88:91], v[112:115], v[172:175]
    s_waitcnt lgkmcnt(5)
    v_mfma_f32_16x16x32_bf16 v[188:191], v[88:91], v[120:123], v[188:191]
    ds_read_b128 v[112:115], v1 offset:45056
    s_waitcnt lgkmcnt(5)
    v_mfma_f32_16x16x32_bf16 v[188:191], v[92:95], v[124:127], v[188:191]
    ds_read_b128 v[116:119], v2 offset:45056
    v_mfma_f32_16x16x32_bf16 v[184:187], v[84:87], v[124:127], v[184:187]
    v_mfma_f32_16x16x32_bf16 v[184:187], v[80:83], v[120:123], v[184:187]
    v_mfma_f32_16x16x32_bf16 v[180:183], v[72:75], v[120:123], v[180:183]
    v_mfma_f32_16x16x32_bf16 v[180:183], v[76:79], v[124:127], v[180:183]
    v_mfma_f32_16x16x32_bf16 v[176:179], v[68:71], v[124:127], v[176:179]
    v_mfma_f32_16x16x32_bf16 v[176:179], v[64:67], v[120:123], v[176:179]
    s_waitcnt lgkmcnt(5)
    v_mfma_f32_16x16x32_bf16 v[192:195], v[64:67], v[96:99], v[192:195]
    ds_read_b128 v[120:123], v1 offset:47104
    s_waitcnt lgkmcnt(5)
    v_mfma_f32_16x16x32_bf16 v[192:195], v[68:71], v[100:103], v[192:195]
    ds_read_b128 v[124:127], v2 offset:47104
    v_mfma_f32_16x16x32_bf16 v[196:199], v[76:79], v[100:103], v[196:199]
    v_mfma_f32_16x16x32_bf16 v[196:199], v[72:75], v[96:99], v[196:199]
    v_mfma_f32_16x16x32_bf16 v[200:203], v[80:83], v[96:99], v[200:203]
    v_mfma_f32_16x16x32_bf16 v[200:203], v[84:87], v[100:103], v[200:203]
    v_mfma_f32_16x16x32_bf16 v[204:207], v[92:95], v[100:103], v[204:207]
    v_mfma_f32_16x16x32_bf16 v[204:207], v[88:91], v[96:99], v[204:207]
    s_waitcnt vmcnt(0) lgkmcnt(0)
    s_barrier
    s_add_u32 m0, s72, 0x2000
    s_nop 0
    buffer_load_dwordx4 v12, s[20:23], s66 offen lds
    s_add_u32 m0, s72, 0x3000
    s_nop 0
    buffer_load_dwordx4 v12, s[24:27], s66 offen lds
    s_add_u32 s66, s66, 4096
    s_add_u32 m0, s71, 0x8000
    s_nop 0
    buffer_load_dwordx4 v8, s[12:15], s65 offen lds
    s_add_u32 m0, s71, 0xc000
    s_nop 0
    buffer_load_dwordx4 v8, s[16:19], s65 offen lds
    s_add_u32 m0, s71, 0x8400
    s_nop 0
    buffer_load_dwordx4 v9, s[12:15], s65 offen lds
    s_add_u32 m0, s71, 0xc400
    s_nop 0
    buffer_load_dwordx4 v9, s[16:19], s65 offen lds
    s_add_u32 m0, s71, 0x8800
    s_nop 0
    buffer_load_dwordx4 v10, s[12:15], s65 offen lds
    s_add_u32 m0, s71, 0xc800
    s_nop 0
    buffer_load_dwordx4 v10, s[16:19], s65 offen lds
    s_add_u32 m0, s71, 0x8c00
    s_nop 0
    buffer_load_dwordx4 v11, s[12:15], s65 offen lds
    s_add_u32 m0, s71, 0xcc00
    s_nop 0
    buffer_load_dwordx4 v11, s[16:19], s65 offen lds
    s_add_u32 s65, s65, s67
    s_add_u32 m0, s68, 0x8000
    s_nop 0
    buffer_load_dwordx4 v6, s[8:11], s61 offen lds
    s_add_u32 m0, s68, 0x8400
    s_nop 0
    buffer_load_dwordx4 v7, s[8:11], s61 offen lds
    s_add_u32 s61, s61, 128
    s_add_u32 m0, s68, 0x8800
    s_nop 0
    buffer_load_dwordx4 v6, s[8:11], s62 offen lds
    s_add_u32 m0, s68, 0x8c00
    s_nop 0
    buffer_load_dwordx4 v7, s[8:11], s62 offen lds
    s_add_u32 s62, s62, 128
    v_mfma_f32_16x16x32_bf16 v[220:223], v[88:91], v[104:107], v[220:223]
    ds_read_b128 v[96:99], v1 offset:0
    v_mfma_f32_16x16x32_bf16 v[220:223], v[92:95], v[108:111], v[220:223]
    ds_read_b128 v[100:103], v2 offset:0
    v_mfma_f32_16x16x32_bf16 v[216:219], v[84:87], v[108:111], v[216:219]
    ds_read_b64_tr_b16 v[32:33], v3 offset:0
    v_mfma_f32_16x16x32_bf16 v[216:219], v[80:83], v[104:107], v[216:219]
    ds_read_b64_tr_b16 v[34:35], v3 offset:1024
    v_mfma_f32_16x16x32_bf16 v[212:215], v[72:75], v[104:107], v[212:215]
    ds_read_b64_tr_b16 v[36:37], v3 offset:8192
    v_mfma_f32_16x16x32_bf16 v[212:215], v[76:79], v[108:111], v[212:215]
    ds_read_b64_tr_b16 v[38:39], v3 offset:9216
    v_mfma_f32_16x16x32_bf16 v[208:211], v[68:71], v[108:111], v[208:211]
    ds_read_b64_tr_b16 v[44:45], v4 offset:8192
    v_mfma_f32_16x16x32_bf16 v[208:211], v[64:67], v[104:107], v[208:211]
    ds_read_b64_tr_b16 v[46:47], v4 offset:9216
    v_mfma_f32_16x16x32_bf16 v[224:227], v[64:67], v[112:115], v[224:227]
    ds_read_b128 v[104:107], v1 offset:2048
    ds_read_b64_tr_b16 v[16:17], v5 offset:0
    v_mfma_f32_16x16x32_bf16 v[224:227], v[68:71], v[116:119], v[224:227]
    ds_read_b128 v[108:111], v2 offset:2048
    ds_read_b64_tr_b16 v[18:19], v5 offset:256
    v_mfma_f32_16x16x32_bf16 v[228:231], v[76:79], v[116:119], v[228:231]
    ds_read_b64_tr_b16 v[40:41], v4 offset:0
    v_mfma_f32_16x16x32_bf16 v[228:231], v[72:75], v[112:115], v[228:231]
    ds_read_b64_tr_b16 v[42:43], v4 offset:1024
    v_mfma_f32_16x16x32_bf16 v[232:235], v[80:83], v[112:115], v[232:235]
    ds_read_b64_tr_b16 v[48:49], v3 offset:16384
    v_mfma_f32_16x16x32_bf16 v[232:235], v[84:87], v[116:119], v[232:235]
    ds_read_b64_tr_b16 v[50:51], v3 offset:17408
    v_mfma_f32_16x16x32_bf16 v[236:239], v[92:95], v[116:119], v[236:239]
    ds_read_b64_tr_b16 v[52:53], v3 offset:24576
    v_mfma_f32_16x16x32_bf16 v[236:239], v[88:91], v[112:115], v[236:239]
    ds_read_b64_tr_b16 v[54:55], v3 offset:25600
    v_mfma_f32_16x16x32_bf16 v[252:255], v[88:91], v[120:123], v[252:255]
    ds_read_b128 v[112:115], v1 offset:4096
    ds_read_b64_tr_b16 v[20:21], v5 offset:2048
    v_mfma_f32_16x16x32_bf16 v[252:255], v[92:95], v[124:127], v[252:255]
    ds_read_b128 v[116:119], v2 offset:4096
    ds_read_b64_tr_b16 v[22:23], v5 offset:2304
    v_mfma_f32_16x16x32_bf16 v[248:251], v[84:87], v[124:127], v[248:251]
    ds_read_b64_tr_b16 v[60:61], v4 offset:24576
    v_mfma_f32_16x16x32_bf16 v[248:251], v[80:83], v[120:123], v[248:251]
    ds_read_b64_tr_b16 v[62:63], v4 offset:25600
    v_mfma_f32_16x16x32_bf16 v[244:247], v[72:75], v[120:123], v[244:247]
    ds_read_b64_tr_b16 v[56:57], v4 offset:16384
    v_mfma_f32_16x16x32_bf16 v[244:247], v[76:79], v[124:127], v[244:247]
    ds_read_b64_tr_b16 v[58:59], v4 offset:17408
    v_mfma_f32_16x16x32_bf16 v[240:243], v[68:71], v[124:127], v[240:243]
    v_mfma_f32_16x16x32_bf16 v[240:243], v[64:67], v[120:123], v[240:243]
    s_cmp_eq_u32 s75, 0
    s_cbranch_scc1 p1_KL_tail
    s_waitcnt lgkmcnt(15)
    v_mfma_f32_16x16x32_bf16 v[128:131], v[32:35], v[96:99], v[128:131]
    ds_read_b128 v[120:123], v1 offset:6144
    v_mfma_f32_16x16x32_bf16 v[128:131], v[36:39], v[100:103], v[128:131]
    ds_read_b128 v[124:127], v2 offset:6144
    v_mfma_f32_16x16x32_bf16 v[132:135], v[44:47], v[100:103], v[132:135]
    s_waitcnt lgkmcnt(14)
    v_mfma_f32_16x16x32_bf16 v[132:135], v[40:43], v[96:99], v[132:135]
    s_waitcnt lgkmcnt(12)
    v_mfma_f32_16x16x32_bf16 v[136:139], v[48:51], v[96:99], v[136:139]
    s_waitcnt lgkmcnt(10)
    v_mfma_f32_16x16x32_bf16 v[136:139], v[52:55], v[100:103], v[136:139]
    s_waitcnt lgkmcnt(4)
    v_mfma_f32_16x16x32_bf16 v[140:143], v[60:63], v[100:103], v[140:143]
    s_waitcnt lgkmcnt(2)
    v_mfma_f32_16x16x32_bf16 v[140:143], v[56:59], v[96:99], v[140:143]
    v_mfma_f32_16x16x32_bf16 v[24:27], v[16:19], v[96:99], v[24:27]
    v_mfma_f32_16x16x32_bf16 v[24:27], v[20:23], v[100:103], v[24:27]
    v_mfma_f32_16x16x32_bf16 v[156:159], v[56:59], v[104:107], v[156:159]
    ds_read_b128 v[96:99], v1 offset:8192
    v_mfma_f32_16x16x32_bf16 v[156:159], v[60:63], v[108:111], v[156:159]
    ds_read_b128 v[100:103], v2 offset:8192
    v_mfma_f32_16x16x32_bf16 v[152:155], v[52:55], v[108:111], v[152:155]
    v_mfma_f32_16x16x32_bf16 v[152:155], v[48:51], v[104:107], v[152:155]
    v_mfma_f32_16x16x32_bf16 v[148:151], v[40:43], v[104:107], v[148:151]
    v_mfma_f32_16x16x32_bf16 v[148:151], v[44:47], v[108:111], v[148:151]
    v_mfma_f32_16x16x32_bf16 v[144:147], v[36:39], v[108:111], v[144:147]
    v_mfma_f32_16x16x32_bf16 v[144:147], v[32:35], v[104:107], v[144:147]
    v_mfma_f32_16x16x32_bf16 v[28:31], v[16:19], v[104:107], v[28:31]
    v_mfma_f32_16x16x32_bf16 v[28:31], v[20:23], v[108:111], v[28:31]
    v_mfma_f32_16x16x32_bf16 v[160:163], v[32:35], v[112:115], v[160:163]
    ds_read_b128 v[104:107], v1 offset:10240
    v_mfma_f32_16x16x32_bf16 v[160:163], v[36:39], v[116:119], v[160:163]
    ds_read_b128 v[108:111], v2 offset:10240
    v_mfma_f32_16x16x32_bf16 v[164:167], v[44:47], v[116:119], v[164:167]
    v_mfma_f32_16x16x32_bf16 v[164:167], v[40:43], v[112:115], v[164:167]
    v_mfma_f32_16x16x32_bf16 v[168:171], v[48:51], v[112:115], v[168:171]
    v_mfma_f32_16x16x32_bf16 v[168:171], v[52:55], v[116:119], v[168:171]
    v_mfma_f32_16x16x32_bf16 v[172:175], v[60:63], v[116:119], v[172:175]
    v_mfma_f32_16x16x32_bf16 v[172:175], v[56:59], v[112:115], v[172:175]
    s_waitcnt lgkmcnt(5)
    v_mfma_f32_16x16x32_bf16 v[188:191], v[56:59], v[120:123], v[188:191]
    ds_read_b128 v[112:115], v1 offset:12288
    s_waitcnt lgkmcnt(5)
    v_mfma_f32_16x16x32_bf16 v[188:191], v[60:63], v[124:127], v[188:191]
    ds_read_b128 v[116:119], v2 offset:12288
    v_mfma_f32_16x16x32_bf16 v[184:187], v[52:55], v[124:127], v[184:187]
    v_mfma_f32_16x16x32_bf16 v[184:187], v[48:51], v[120:123], v[184:187]
    v_mfma_f32_16x16x32_bf16 v[180:183], v[40:43], v[120:123], v[180:183]
    v_mfma_f32_16x16x32_bf16 v[180:183], v[44:47], v[124:127], v[180:183]
    v_mfma_f32_16x16x32_bf16 v[176:179], v[36:39], v[124:127], v[176:179]
    v_mfma_f32_16x16x32_bf16 v[176:179], v[32:35], v[120:123], v[176:179]
    s_waitcnt lgkmcnt(5)
    v_mfma_f32_16x16x32_bf16 v[192:195], v[32:35], v[96:99], v[192:195]
    ds_read_b128 v[120:123], v1 offset:14336
    s_waitcnt lgkmcnt(5)
    v_mfma_f32_16x16x32_bf16 v[192:195], v[36:39], v[100:103], v[192:195]
    ds_read_b128 v[124:127], v2 offset:14336
    v_mfma_f32_16x16x32_bf16 v[196:199], v[44:47], v[100:103], v[196:199]
    v_mfma_f32_16x16x32_bf16 v[196:199], v[40:43], v[96:99], v[196:199]
    v_mfma_f32_16x16x32_bf16 v[200:203], v[48:51], v[96:99], v[200:203]
    v_mfma_f32_16x16x32_bf16 v[200:203], v[52:55], v[100:103], v[200:203]
    v_mfma_f32_16x16x32_bf16 v[204:207], v[60:63], v[100:103], v[204:207]
    v_mfma_f32_16x16x32_bf16 v[204:207], v[56:59], v[96:99], v[204:207]
    s_waitcnt vmcnt(0) lgkmcnt(0)
    s_barrier
    s_mov_b32 m0, s72
    s_nop 0
    buffer_load_dwordx4 v12, s[20:23], s66 offen lds
    s_add_u32 m0, s72, 0x1000
    s_nop 0
    buffer_load_dwordx4 v12, s[24:27], s66 offen lds
    s_add_u32 s66, s66, 4096
    s_mov_b32 m0, s71
    s_nop 0
    buffer_load_dwordx4 v8, s[12:15], s65 offen lds
    s_add_u32 m0, s71, 0x4000
    s_nop 0
    buffer_load_dwordx4 v8, s[16:19], s65 offen lds
    s_add_u32 m0, s71, 0x400
    s_nop 0
    buffer_load_dwordx4 v9, s[12:15], s65 offen lds
    s_add_u32 m0, s71, 0x4400
    s_nop 0
    buffer_load_dwordx4 v9, s[16:19], s65 offen lds
    s_add_u32 m0, s71, 0x800
    s_nop 0
    buffer_load_dwordx4 v10, s[12:15], s65 offen lds
    s_add_u32 m0, s71, 0x4800
    s_nop 0
    buffer_load_dwordx4 v10, s[16:19], s65 offen lds
    s_add_u32 m0, s71, 0xc00
    s_nop 0
    buffer_load_dwordx4 v11, s[12:15], s65 offen lds
    s_add_u32 m0, s71, 0x4c00
    s_nop 0
    buffer_load_dwordx4 v11, s[16:19], s65 offen lds
    s_add_u32 s65, s65, s67
    s_mov_b32 m0, s68
    s_nop 0
    buffer_load_dwordx4 v6, s[8:11], s61 offen lds
    s_add_u32 m0, s68, 0x400
    s_nop 0
    buffer_load_dwordx4 v7, s[8:11], s61 offen lds
    s_add_u32 s61, s61, 128
    s_add_u32 m0, s68, 0x800
    s_nop 0
    buffer_load_dwordx4 v6, s[8:11], s62 offen lds
    s_add_u32 m0, s68, 0xc00
    s_nop 0
    buffer_load_dwordx4 v7, s[8:11], s62 offen lds
    s_add_u32 s62, s62, 128
    v_mfma_f32_16x16x32_bf16 v[220:223], v[56:59], v[104:107], v[220:223]
    ds_read_b128 v[96:99], v1 offset:32768
    v_mfma_f32_16x16x32_bf16 v[220:223], v[60:63], v[108:111], v[220:223]
    ds_read_b128 v[100:103], v2 offset:32768
    v_mfma_f32_16x16x32_bf16 v[216:219], v[52:55], v[108:111], v[216:219]
    ds_read_b64_tr_b16 v[64:65], v3 offset:32768
    v_mfma_f32_16x16x32_bf16 v[216:219], v[48:51], v[104:107], v[216:219]
    ds_read_b64_tr_b16 v[66:67], v3 offset:33792
    v_mfma_f32_16x16x32_bf16 v[212:215], v[40:43], v[104:107], v[212:215]
    ds_read_b64_tr_b16 v[68:69], v3 offset:40960
    v_mfma_f32_16x16x32_bf16 v[212:215], v[44:47], v[108:111], v[212:215]
    ds_read_b64_tr_b16 v[70:71], v3 offset:41984
    v_mfma_f32_16x16x32_bf16 v[208:211], v[36:39], v[108:111], v[208:211]
    ds_read_b64_tr_b16 v[76:77], v4 offset:40960
    v_mfma_f32_16x16x32_bf16 v[208:211], v[32:35], v[104:107], v[208:211]
    ds_read_b64_tr_b16 v[78:79], v4 offset:41984
    v_mfma_f32_16x16x32_bf16 v[224:227], v[32:35], v[112:115], v[224:227]
    ds_read_b128 v[104:107], v1 offset:34816
    ds_read_b64_tr_b16 v[16:17], v5 offset:8192
    v_mfma_f32_16x16x32_bf16 v[224:227], v[36:39], v[116:119], v[224:227]
    ds_read_b128 v[108:111], v2 offset:34816
    ds_read_b64_tr_b16 v[18:19], v5 offset:8448
    v_mfma_f32_16x16x32_bf16 v[228:231], v[44:47], v[116:119], v[228:231]
    ds_read_b64_tr_b16 v[72:73], v4 offset:32768
    v_mfma_f32_16x16x32_bf16 v[228:231], v[40:43], v[112:115], v[228:231]
    ds_read_b64_tr_b16 v[74:75], v4 offset:33792
    v_mfma_f32_16x16x32_bf16 v[232:235], v[48:51], v[112:115], v[232:235]
    ds_read_b64_tr_b16 v[80:81], v3 offset:49152
    v_mfma_f32_16x16x32_bf16 v[232:235], v[52:55], v[116:119], v[232:235]
    ds_read_b64_tr_b16 v[82:83], v3 offset:50176
    v_mfma_f32_16x16x32_bf16 v[236:239], v[60:63], v[116:119], v[236:239]
    ds_read_b64_tr_b16 v[84:85], v3 offset:57344
    v_mfma_f32_16x16x32_bf16 v[236:239], v[56:59], v[112:115], v[236:239]
    ds_read_b64_tr_b16 v[86:87], v3 offset:58368
    v_mfma_f32_16x16x32_bf16 v[252:255], v[56:59], v[120:123], v[252:255]
    ds_read_b128 v[112:115], v1 offset:36864
    ds_read_b64_tr_b16 v[20:21], v5 offset:10240
    v_mfma_f32_16x16x32_bf16 v[252:255], v[60:63], v[124:127], v[252:255]
    ds_read_b128 v[116:119], v2 offset:36864
    ds_read_b64_tr_b16 v[22:23], v5 offset:10496
    v_mfma_f32_16x16x32_bf16 v[248:251], v[52:55], v[124:127], v[248:251]
    ds_read_b64_tr_b16 v[92:93], v4 offset:57344
    v_mfma_f32_16x16x32_bf16 v[248:251], v[48:51], v[120:123], v[248:251]
    ds_read_b64_tr_b16 v[94:95], v4 offset:58368
    v_mfma_f32_16x16x32_bf16 v[244:247], v[40:43], v[120:123], v[244:247]
    ds_read_b64_tr_b16 v[88:89], v4 offset:49152
    v_mfma_f32_16x16x32_bf16 v[244:247], v[44:47], v[124:127], v[244:247]
    ds_read_b64_tr_b16 v[90:91], v4 offset:50176
    v_mfma_f32_16x16x32_bf16 v[240:243], v[36:39], v[124:127], v[240:243]
    v_mfma_f32_16x16x32_bf16 v[240:243], v[32:35], v[120:123], v[240:243]
    s_sub_u32 s75, s75, 1
    s_branch p1_KL_loop
p1_KL_tail:
    s_waitcnt lgkmcnt(15)
    v_mfma_f32_16x16x32_bf16 v[128:131], v[32:35], v[96:99], v[128:131]
    ds_read_b128 v[120:123], v1 offset:6144
    v_mfma_f32_16x16x32_bf16 v[128:131], v[36:39], v[100:103], v[128:131]
    ds_read_b128 v[124:127], v2 offset:6144
    v_mfma_f32_16x16x32_bf16 v[132:135], v[44:47], v[100:103], v[132:135]
    s_waitcnt lgkmcnt(14)
    v_mfma_f32_16x16x32_bf16 v[132:135], v[40:43], v[96:99], v[132:135]
    s_waitcnt lgkmcnt(12)
    v_mfma_f32_16x16x32_bf16 v[136:139], v[48:51], v[96:99], v[136:139]
    s_waitcnt lgkmcnt(10)
    v_mfma_f32_16x16x32_bf16 v[136:139], v[52:55], v[100:103], v[136:139]
    s_waitcnt lgkmcnt(4)
    v_mfma_f32_16x16x32_bf16 v[140:143], v[60:63], v[100:103], v[140:143]
    s_waitcnt lgkmcnt(2)
    v_mfma_f32_16x16x32_bf16 v[140:143], v[56:59], v[96:99], v[140:143]
    v_mfma_f32_16x16x32_bf16 v[24:27], v[16:19], v[96:99], v[24:27]
    v_mfma_f32_16x16x32_bf16 v[24:27], v[20:23], v[100:103], v[24:27]
    v_mfma_f32_16x16x32_bf16 v[156:159], v[56:59], v[104:107], v[156:159]
    ds_read_b128 v[96:99], v1 offset:8192
    v_mfma_f32_16x16x32_bf16 v[156:159], v[60:63], v[108:111], v[156:159]
    ds_read_b128 v[100:103], v2 offset:8192
    v_mfma_f32_16x16x32_bf16 v[152:155], v[52:55], v[108:111], v[152:155]
    v_mfma_f32_16x16x32_bf16 v[152:155], v[48:51], v[104:107], v[152:155]
    v_mfma_f32_16x16x32_bf16 v[148:151], v[40:43], v[104:107], v[148:151]
    v_mfma_f32_16x16x32_bf16 v[148:151], v[44:47], v[108:111], v[148:151]
    v_mfma_f32_16x16x32_bf16 v[144:147], v[36:39], v[108:111], v[144:147]
    v_mfma_f32_16x16x32_bf16 v[144:147], v[32:35], v[104:107], v[144:147]
    v_mfma_f32_16x16x32_bf16 v[28:31], v[16:19], v[104:107], v[28:31]
    v_mfma_f32_16x16x32_bf16 v[28:31], v[20:23], v[108:111], v[28:31]
    v_mfma_f32_16x16x32_bf16 v[160:163], v[32:35], v[112:115], v[160:163]
    ds_read_b128 v[104:107], v1 offset:10240
    v_mfma_f32_16x16x32_bf16 v[160:163], v[36:39], v[116:119], v[160:163]
    ds_read_b128 v[108:111], v2 offset:10240
    v_mfma_f32_16x16x32_bf16 v[164:167], v[44:47], v[116:119], v[164:167]
    v_mfma_f32_16x16x32_bf16 v[164:167], v[40:43], v[112:115], v[164:167]
    v_mfma_f32_16x16x32_bf16 v[168:171], v[48:51], v[112:115], v[168:171]
    v_mfma_f32_16x16x32_bf16 v[168:171], v[52:55], v[116:119], v[168:171]
    v_mfma_f32_16x16x32_bf16 v[172:175], v[60:63], v[116:119], v[172:175]
    v_mfma_f32_16x16x32_bf16 v[172:175], v[56:59], v[112:115], v[172:175]
    s_waitcnt lgkmcnt(5)
    v_mfma_f32_16x16x32_bf16 v[188:191], v[56:59], v[120:123], v[188:191]
    ds_read_b128 v[112:115], v1 offset:12288
    s_waitcnt lgkmcnt(5)
    v_mfma_f32_16x16x32_bf16 v[188:191], v[60:63], v[124:127], v[188:191]
    ds_read_b128 v[116:119], v2 offset:12288
    v_mfma_f32_16x16x32_bf16 v[184:187], v[52:55], v[124:127], v[184:187]
    v_mfma_f32_16x16x32_bf16 v[184:187], v[48:51], v[120:123], v[184:187]
    v_mfma_f32_16x16x32_bf16 v[180:183], v[40:43], v[120:123], v[180:183]
    v_mfma_f32_16x16x32_bf16 v[180:183], v[44:47], v[124:127], v[180:183]
    v_mfma_f32_16x16x32_bf16 v[176:179], v[36:39], v[124:127], v[176:179]
    v_mfma_f32_16x16x32_bf16 v[176:179], v[32:35], v[120:123], v[176:179]
    s_waitcnt lgkmcnt(5)
    v_mfma_f32_16x16x32_bf16 v[192:195], v[32:35], v[96:99], v[192:195]
    ds_read_b128 v[120:123], v1 offset:14336
    s_waitcnt lgkmcnt(5)
    v_mfma_f32_16x16x32_bf16 v[192:195], v[36:39], v[100:103], v[192:195]
    ds_read_b128 v[124:127], v2 offset:14336
    v_mfma_f32_16x16x32_bf16 v[196:199], v[44:47], v[100:103], v[196:199]
    v_mfma_f32_16x16x32_bf16 v[196:199], v[40:43], v[96:99], v[196:199]
    v_mfma_f32_16x16x32_bf16 v[200:203], v[48:51], v[96:99], v[200:203]
    v_mfma_f32_16x16x32_bf16 v[200:203], v[52:55], v[100:103], v[200:203]
    v_mfma_f32_16x16x32_bf16 v[204:207], v[60:63], v[100:103], v[204:207]
    v_mfma_f32_16x16x32_bf16 v[204:207], v[56:59], v[96:99], v[204:207]
    s_waitcnt vmcnt(0) lgkmcnt(0)
    s_barrier
    s_load_dwordx2 s[20:21], s[0:1], 64
    s_load_dwordx2 s[24:25], s[0:1], 88
    s_mov_b32 s22, 0x700000
    s_mov_b32 s26, 256
    s_mov_b32 s27, 0x20000
    v_lshrrev_b32 v9, 3, v0
    v_bfe_u32 v10, v0, 1, 2
    v_lshrrev_b32 v11, 4, v0
    v_xor_b32 v10, v10, v11
    v_lshlrev_b32 v9, 11, v9
    v_lshl_add_u32 v9, v10, 5, v9
    v_and_b32 v10, 1, v0
    v_lshl_add_u32 v9, v10, 4, v9
    s_and_b32 s4, s2, 1
    s_lshl_b32 s4, s4, 3
    s_lshr_b32 s5, s2, 5
    s_add_u32 s4, s4, s5
    s_lshl_b32 s4, s4, 7
    s_lshl_b32 s5, s60, 14
    s_add_u32 s5, s5, s4
    v_add_u32 v6, s5, v9
    v_add_u32 v7, 0x10000, v6
    v_add_u32 v8, 0x20000, v6
    s_lshl_b32 s6, s60, 10
    s_add_u32 s6, s6, 0x14000
    v_lshlrev_b32 v9, 2, v0
    s_waitcnt lgkmcnt(0)
    buffer_load_dword v10, v9, s[24:27], 0 offen sc1
    s_mov_b32 m0, s6
    s_mov_b32 s7, 0x0
    buffer_load_dwordx4 v6, s[20:23], s7 offen lds
    s_add_u32 m0, s6, 4096
    s_mov_b32 s7, 0x0
    buffer_load_dwordx4 v7, s[20:23], s7 offen lds
    s_add_u32 m0, s6, 8192
    s_mov_b32 s7, 0x0
    buffer_load_dwordx4 v8, s[20:23], s7 offen lds
    s_add_u32 m0, s6, 12288
    s_mov_b32 s7, 0x30000
    buffer_load_dwordx4 v6, s[20:23], s7 offen lds
    s_add_u32 m0, s6, 16384
    s_mov_b32 s7, 0x30000
    buffer_load_dwordx4 v7, s[20:23], s7 offen lds
    s_add_u32 m0, s6, 20480
    s_mov_b32 s7, 0x30000
    buffer_load_dwordx4 v8, s[20:23], s7 offen lds
    s_add_u32 m0, s6, 24576
    s_mov_b32 s7, 0x60000
    buffer_load_dwordx4 v6, s[20:23], s7 offen lds
    s_add_u32 m0, s6, 28672
    s_mov_b32 s7, 0x60000
    buffer_load_dwordx4 v7, s[20:23], s7 offen lds
    s_add_u32 m0, s6, 32768
    s_mov_b32 s7, 0x60000
    buffer_load_dwordx4 v8, s[20:23], s7 offen lds
    s_add_u32 m0, s6, 36864
    s_mov_b32 s7, 0x90000
    buffer_load_dwordx4 v6, s[20:23], s7 offen lds
    v_mfma_f32_16x16x32_bf16 v[220:223], v[56:59], v[104:107], v[220:223]
    ds_read_b128 v[96:99], v1 offset:32768
    v_mfma_f32_16x16x32_bf16 v[220:223], v[60:63], v[108:111], v[220:223]
    ds_read_b128 v[100:103], v2 offset:32768
    v_mfma_f32_16x16x32_bf16 v[216:219], v[52:55], v[108:111], v[216:219]
    ds_read_b64_tr_b16 v[64:65], v3 offset:32768
    v_mfma_f32_16x16x32_bf16 v[216:219], v[48:51], v[104:107], v[216:219]
    ds_read_b64_tr_b16 v[66:67], v3 offset:33792
    v_mfma_f32_16x16x32_bf16 v[212:215], v[40:43], v[104:107], v[212:215]
    ds_read_b64_tr_b16 v[68:69], v3 offset:40960
    v_mfma_f32_16x16x32_bf16 v[212:215], v[44:47], v[108:111], v[212:215]
    ds_read_b64_tr_b16 v[70:71], v3 offset:41984
    v_mfma_f32_16x16x32_bf16 v[208:211], v[36:39], v[108:111], v[208:211]
    ds_read_b64_tr_b16 v[76:77], v4 offset:40960
    v_mfma_f32_16x16x32_bf16 v[208:211], v[32:35], v[104:107], v[208:211]
    ds_read_b64_tr_b16 v[78:79], v4 offset:41984
    v_mfma_f32_16x16x32_bf16 v[224:227], v[32:35], v[112:115], v[224:227]
    ds_read_b128 v[104:107], v1 offset:34816
    ds_read_b64_tr_b16 v[16:17], v5 offset:8192
    v_mfma_f32_16x16x32_bf16 v[224:227], v[36:39], v[116:119], v[224:227]
    ds_read_b128 v[108:111], v2 offset:34816
    ds_read_b64_tr_b16 v[18:19], v5 offset:8448
    v_mfma_f32_16x16x32_bf16 v[228:231], v[44:47], v[116:119], v[228:231]
    ds_read_b64_tr_b16 v[72:73], v4 offset:32768
    v_mfma_f32_16x16x32_bf16 v[228:231], v[40:43], v[112:115], v[228:231]
    ds_read_b64_tr_b16 v[74:75], v4 offset:33792
    v_mfma_f32_16x16x32_bf16 v[232:235], v[48:51], v[112:115], v[232:235]
    ds_read_b64_tr_b16 v[80:81], v3 offset:49152
    v_mfma_f32_16x16x32_bf16 v[232:235], v[52:55], v[116:119], v[232:235]
    ds_read_b64_tr_b16 v[82:83], v3 offset:50176
    v_mfma_f32_16x16x32_bf16 v[236:239], v[60:63], v[116:119], v[236:239]
    ds_read_b64_tr_b16 v[84:85], v3 offset:57344
    v_mfma_f32_16x16x32_bf16 v[236:239], v[56:59], v[112:115], v[236:239]
    ds_read_b64_tr_b16 v[86:87], v3 offset:58368
    v_mfma_f32_16x16x32_bf16 v[252:255], v[56:59], v[120:123], v[252:255]
    ds_read_b128 v[112:115], v1 offset:36864
    ds_read_b64_tr_b16 v[20:21], v5 offset:10240
    v_mfma_f32_16x16x32_bf16 v[252:255], v[60:63], v[124:127], v[252:255]
    ds_read_b128 v[116:119], v2 offset:36864
    ds_read_b64_tr_b16 v[22:23], v5 offset:10496
    v_mfma_f32_16x16x32_bf16 v[248:251], v[52:55], v[124:127], v[248:251]
    ds_read_b64_tr_b16 v[92:93], v4 offset:57344
    v_mfma_f32_16x16x32_bf16 v[248:251], v[48:51], v[120:123], v[248:251]
    ds_read_b64_tr_b16 v[94:95], v4 offset:58368
    v_mfma_f32_16x16x32_bf16 v[244:247], v[40:43], v[120:123], v[244:247]
    ds_read_b64_tr_b16 v[88:89], v4 offset:49152
    v_mfma_f32_16x16x32_bf16 v[244:247], v[44:47], v[124:127], v[244:247]
    ds_read_b64_tr_b16 v[90:91], v4 offset:50176
    v_mfma_f32_16x16x32_bf16 v[240:243], v[36:39], v[124:127], v[240:243]
    v_mfma_f32_16x16x32_bf16 v[240:243], v[32:35], v[120:123], v[240:243]
    s_waitcnt lgkmcnt(15)
    v_mfma_f32_16x16x32_bf16 v[128:131], v[64:67], v[96:99], v[128:131]
    ds_read_b128 v[120:123], v1 offset:38912
    v_lshlrev_b32 v14, 4, v0
    s_lshl_b32 s4, s56, 3
    s_lshl_b32 s5, s59, 2
    v_mfma_f32_16x16x32_bf16 v[128:131], v[68:71], v[100:103], v[128:131]
    ds_read_b128 v[124:127], v2 offset:38912
    s_add_u32 s84, s4, s5
    s_lshl_b32 s7, s58, 3
    s_add_u32 s7, s7, s60
    v_mfma_f32_16x16x32_bf16 v[132:135], v[76:79], v[100:103], v[132:135]
    s_lshl_b32 s7, s7, 11
    s_add_u32 s85, s7, 0x1000000
    s_mov_b32 s82, 0x3e8293ee
    s_waitcnt lgkmcnt(14)
    v_mfma_f32_16x16x32_bf16 v[132:135], v[72:75], v[96:99], v[132:135]
    s_mov_b32 s83, 0x3e8293ee
    v_add_u32 v15, 0x2000, v14
    s_waitcnt lgkmcnt(12)
    v_mfma_f32_16x16x32_bf16 v[136:139], v[80:83], v[96:99], v[136:139]
    s_waitcnt lgkmcnt(10)
    v_mfma_f32_16x16x32_bf16 v[136:139], v[84:87], v[100:103], v[136:139]
    s_waitcnt lgkmcnt(4)
    v_mfma_f32_16x16x32_bf16 v[140:143], v[92:95], v[100:103], v[140:143]
    s_waitcnt lgkmcnt(2)
    v_mfma_f32_16x16x32_bf16 v[140:143], v[88:91], v[96:99], v[140:143]
    v_mfma_f32_16x16x32_bf16 v[24:27], v[16:19], v[96:99], v[24:27]
    v_mfma_f32_16x16x32_bf16 v[24:27], v[20:23], v[100:103], v[24:27]
    v_mfma_f32_16x16x32_bf16 v[156:159], v[88:91], v[104:107], v[156:159]
    ds_read_b128 v[96:99], v1 offset:40960
    v_mfma_f32_16x16x32_bf16 v[156:159], v[92:95], v[108:111], v[156:159]
    ds_read_b128 v[100:103], v2 offset:40960
    v_mfma_f32_16x16x32_bf16 v[152:155], v[84:87], v[108:111], v[152:155]
    v_mfma_f32_16x16x32_bf16 v[152:155], v[80:83], v[104:107], v[152:155]
    v_mfma_f32_16x16x32_bf16 v[148:151], v[72:75], v[104:107], v[148:151]
    s_add_u32 s4, s58, 0
    s_and_b32 s4, s4, 3
    s_add_u32 s4, s4, s84
    s_lshl_b32 s4, s4, 16
    v_mfma_f32_16x16x32_bf16 v[148:151], v[76:79], v[108:111], v[148:151]
    s_add_u32 s4, s4, s85
    v_mul_f32 v128, s82, v128
    v_mul_f32 v129, s82, v129
    v_mul_f32 v130, s82, v130
    v_mfma_f32_16x16x32_bf16 v[144:147], v[68:71], v[108:111], v[144:147]
    v_mul_f32 v131, s82, v131
    v_mul_f32 v132, s82, v132
    v_mul_f32 v133, s82, v133
    v_mul_f32 v134, s82, v134
    v_mfma_f32_16x16x32_bf16 v[144:147], v[64:67], v[104:107], v[144:147]
    v_mfma_f32_16x16x32_bf16 v[28:31], v[16:19], v[104:107], v[28:31]
    v_mfma_f32_16x16x32_bf16 v[28:31], v[20:23], v[108:111], v[28:31]
    v_mul_f32 v135, s82, v135
    v_cvt_pk_bf16_f32 v40, v128, v129
    v_cvt_pk_bf16_f32 v41, v130, v131
    v_cvt_pk_bf16_f32 v42, v132, v133
    v_mfma_f32_16x16x32_bf16 v[160:163], v[64:67], v[112:115], v[160:163]
    ds_read_b128 v[104:107], v1 offset:43008
    v_cvt_pk_bf16_f32 v43, v134, v135
    buffer_store_dwordx4 v[40:43], v14, s[44:47], s4 offen offset:0 sc1
    v_mul_f32 v136, s82, v136
    v_mul_f32 v137, s82, v137
    v_mfma_f32_16x16x32_bf16 v[160:163], v[68:71], v[116:119], v[160:163]
    ds_read_b128 v[108:111], v2 offset:43008
    v_mul_f32 v138, s82, v138
    v_mul_f32 v139, s82, v139
    v_mul_f32 v140, s82, v140
    v_mul_f32 v141, s82, v141
    v_mfma_f32_16x16x32_bf16 v[164:167], v[76:79], v[116:119], v[164:167]
    s_add_u32 s5, s84, s58
    s_lshl_b32 s5, s5, 12
    s_and_b32 s6, s60, 1
    v_mul_f32 v142, s82, v142
    v_mul_f32 v143, s82, v143
    v_cvt_pk_bf16_f32 v44, v136, v137
    v_cvt_pk_bf16_f32 v45, v138, v139
    v_mfma_f32_16x16x32_bf16 v[164:167], v[72:75], v[112:115], v[164:167]
    s_lshl_b32 s6, s6, 3
    s_add_u32 s5, s5, s6
    s_add_u32 s5, s5, 0x1400000
    v_cvt_pk_bf16_f32 v46, v140, v141
    v_cvt_pk_bf16_f32 v47, v142, v143
    buffer_store_dwordx4 v[44:47], v15, s[44:47], s4 offen offset:0 sc1
    v_mul_f32 v144, s82, v144
    v_mul_f32 v145, s82, v145
    v_mul_f32 v146, s82, v146
    v_mul_f32 v147, s82, v147
    v_mfma_f32_16x16x32_bf16 v[168:171], v[80:83], v[112:115], v[168:171]
    v_cvt_pk_bf16_f32 v52, v24, v25
    v_cvt_pk_bf16_f32 v53, v26, v27
    v_cvt_pk_bf16_f32 v54, v28, v29
    v_mul_f32 v148, s82, v148
    v_mul_f32 v149, s82, v149
    v_mul_f32 v150, s82, v150
    v_mul_f32 v151, s82, v151
    v_mfma_f32_16x16x32_bf16 v[168:171], v[84:87], v[116:119], v[168:171]
    v_cvt_pk_bf16_f32 v55, v30, v31
    buffer_store_dwordx2 v[52:53], v14, s[44:47], s5 offen sc1
    buffer_store_dwordx2 v[54:55], v14, s[44:47], s5 offen offset:1024 sc1
    v_cvt_pk_bf16_f32 v40, v144, v145
    v_cvt_pk_bf16_f32 v41, v146, v147
    v_cvt_pk_bf16_f32 v42, v148, v149
    v_cvt_pk_bf16_f32 v43, v150, v151
    v_mfma_f32_16x16x32_bf16 v[172:175], v[92:95], v[116:119], v[172:175]
    buffer_store_dwordx4 v[40:43], v14, s[44:47], s4 offen offset:1024 sc1
    v_mul_f32 v152, s82, v152
    v_mul_f32 v153, s82, v153
    v_mul_f32 v154, s82, v154
    v_mfma_f32_16x16x32_bf16 v[172:175], v[88:91], v[112:115], v[172:175]
    v_mul_f32 v155, s82, v155
    v_mul_f32 v156, s82, v156
    v_mul_f32 v157, s82, v157
    v_mul_f32 v158, s82, v158
    s_waitcnt lgkmcnt(5)
    v_mfma_f32_16x16x32_bf16 v[188:191], v[88:91], v[120:123], v[188:191]
    ds_read_b128 v[112:115], v1 offset:45056
    v_mul_f32 v159, s82, v159
    v_cvt_pk_bf16_f32 v44, v152, v153
    v_cvt_pk_bf16_f32 v45, v154, v155
    v_cvt_pk_bf16_f32 v46, v156, v157
    s_waitcnt lgkmcnt(5)
    v_mfma_f32_16x16x32_bf16 v[188:191], v[92:95], v[124:127], v[188:191]
    ds_read_b128 v[116:119], v2 offset:45056
    v_cvt_pk_bf16_f32 v47, v158, v159
    buffer_store_dwordx4 v[44:47], v15, s[44:47], s4 offen offset:1024 sc1
    v_mfma_f32_16x16x32_bf16 v[184:187], v[84:87], v[124:127], v[184:187]
    v_mfma_f32_16x16x32_bf16 v[184:187], v[80:83], v[120:123], v[184:187]
    s_add_u32 s4, s58, 1
    s_and_b32 s4, s4, 3
    s_add_u32 s4, s4, s84
    s_lshl_b32 s4, s4, 16
    v_mfma_f32_16x16x32_bf16 v[180:183], v[72:75], v[120:123], v[180:183]
    s_add_u32 s4, s4, s85
    v_mul_f32 v160, s82, v160
    v_mul_f32 v161, s82, v161
    v_mul_f32 v162, s82, v162
    v_mfma_f32_16x16x32_bf16 v[180:183], v[76:79], v[124:127], v[180:183]
    v_mul_f32 v163, s82, v163
    v_mul_f32 v164, s82, v164
    v_mul_f32 v165, s82, v165
    v_mul_f32 v166, s82, v166
    v_mfma_f32_16x16x32_bf16 v[176:179], v[68:71], v[124:127], v[176:179]
    v_mul_f32 v167, s82, v167
    v_cvt_pk_bf16_f32 v40, v160, v161
    v_cvt_pk_bf16_f32 v41, v162, v163
    v_cvt_pk_bf16_f32 v42, v164, v165
    v_mfma_f32_16x16x32_bf16 v[176:179], v[64:67], v[120:123], v[176:179]
    v_cvt_pk_bf16_f32 v43, v166, v167
    buffer_store_dwordx4 v[40:43], v14, s[44:47], s4 offen offset:0 sc1
    v_mul_f32 v168, s82, v168
    v_mul_f32 v169, s82, v169
    s_waitcnt lgkmcnt(5)
    v_mfma_f32_16x16x32_bf16 v[192:195], v[64:67], v[96:99], v[192:195]
    ds_read_b128 v[120:123], v1 offset:47104
    v_mul_f32 v170, s82, v170
    v_mul_f32 v171, s82, v171
    v_mul_f32 v172, s82, v172
    v_mul_f32 v173, s82, v173
    s_waitcnt lgkmcnt(5)
    v_mfma_f32_16x16x32_bf16 v[192:195], v[68:71], v[100:103], v[192:195]
    ds_read_b128 v[124:127], v2 offset:47104
    v_mul_f32 v174, s82, v174
    v_mul_f32 v175, s82, v175
    v_cvt_pk_bf16_f32 v44, v168, v169
    v_cvt_pk_bf16_f32 v45, v170, v171
    v_mfma_f32_16x16x32_bf16 v[196:199], v[76:79], v[100:103], v[196:199]
    v_cvt_pk_bf16_f32 v46, v172, v173
    v_cvt_pk_bf16_f32 v47, v174, v175
    buffer_store_dwordx4 v[44:47], v15, s[44:47], s4 offen offset:0 sc1
    v_mfma_f32_16x16x32_bf16 v[196:199], v[72:75], v[96:99], v[196:199]
    v_mul_f32 v176, s82, v176
    v_mul_f32 v177, s82, v177
    v_mul_f32 v178, s82, v178
    v_mul_f32 v179, s82, v179
    v_mfma_f32_16x16x32_bf16 v[200:203], v[80:83], v[96:99], v[200:203]
    v_mul_f32 v180, s82, v180
    v_mul_f32 v181, s82, v181
    v_mul_f32 v182, s82, v182
    v_mul_f32 v183, s82, v183
    v_mfma_f32_16x16x32_bf16 v[200:203], v[84:87], v[100:103], v[200:203]
    v_cvt_pk_bf16_f32 v40, v176, v177
    v_cvt_pk_bf16_f32 v41, v178, v179
    v_cvt_pk_bf16_f32 v42, v180, v181
    v_cvt_pk_bf16_f32 v43, v182, v183
    v_mfma_f32_16x16x32_bf16 v[204:207], v[92:95], v[100:103], v[204:207]
    buffer_store_dwordx4 v[40:43], v14, s[44:47], s4 offen offset:1024 sc1
    v_mul_f32 v184, s82, v184
    v_mul_f32 v185, s82, v185
    v_mul_f32 v186, s82, v186
    v_mfma_f32_16x16x32_bf16 v[204:207], v[88:91], v[96:99], v[204:207]
    v_mul_f32 v187, s82, v187
    v_mul_f32 v188, s82, v188
    v_mul_f32 v189, s82, v189
    v_mul_f32 v190, s82, v190
    s_waitcnt lgkmcnt(5)
    v_mfma_f32_16x16x32_bf16 v[220:223], v[88:91], v[104:107], v[220:223]
    v_mul_f32 v191, s82, v191
    v_cvt_pk_bf16_f32 v44, v184, v185
    v_cvt_pk_bf16_f32 v45, v186, v187
    v_cvt_pk_bf16_f32 v46, v188, v189
    s_waitcnt lgkmcnt(4)
    v_mfma_f32_16x16x32_bf16 v[220:223], v[92:95], v[108:111], v[220:223]
    v_cvt_pk_bf16_f32 v47, v190, v191
    buffer_store_dwordx4 v[44:47], v15, s[44:47], s4 offen offset:1024 sc1
    v_mfma_f32_16x16x32_bf16 v[216:219], v[84:87], v[108:111], v[216:219]
    v_mfma_f32_16x16x32_bf16 v[216:219], v[80:83], v[104:107], v[216:219]
    s_add_u32 s4, s58, 2
    s_and_b32 s4, s4, 3
    s_add_u32 s4, s4, s84
    s_lshl_b32 s4, s4, 16
    v_mfma_f32_16x16x32_bf16 v[212:215], v[72:75], v[104:107], v[212:215]
    s_add_u32 s4, s4, s85
    v_mul_f32 v192, s82, v192
    v_mul_f32 v193, s82, v193
    v_mul_f32 v194, s82, v194
    v_mfma_f32_16x16x32_bf16 v[212:215], v[76:79], v[108:111], v[212:215]
    v_mul_f32 v195, s82, v195
    v_mul_f32 v196, s82, v196
    v_mul_f32 v197, s82, v197
    v_mul_f32 v198, s82, v198
    v_mfma_f32_16x16x32_bf16 v[208:211], v[68:71], v[108:111], v[208:211]
    v_mul_f32 v199, s82, v199
    v_cvt_pk_bf16_f32 v40, v192, v193
    v_cvt_pk_bf16_f32 v41, v194, v195
    v_cvt_pk_bf16_f32 v42, v196, v197
    v_mfma_f32_16x16x32_bf16 v[208:211], v[64:67], v[104:107], v[208:211]
    v_cvt_pk_bf16_f32 v43, v198, v199
    buffer_store_dwordx4 v[40:43], v14, s[44:47], s4 offen offset:0 sc1
    v_mul_f32 v200, s82, v200
    v_mul_f32 v201, s82, v201
    s_waitcnt lgkmcnt(3)
    v_mfma_f32_16x16x32_bf16 v[224:227], v[64:67], v[112:115], v[224:227]
    v_mul_f32 v202, s82, v202
    v_mul_f32 v203, s82, v203
    v_mul_f32 v204, s82, v204
    v_mul_f32 v205, s82, v205
    s_waitcnt lgkmcnt(2)
    v_mfma_f32_16x16x32_bf16 v[224:227], v[68:71], v[116:119], v[224:227]
    v_mul_f32 v206, s82, v206
    v_mul_f32 v207, s82, v207
    v_cvt_pk_bf16_f32 v44, v200, v201
    v_cvt_pk_bf16_f32 v45, v202, v203
    v_mfma_f32_16x16x32_bf16 v[228:231], v[76:79], v[116:119], v[228:231]
    v_cvt_pk_bf16_f32 v46, v204, v205
    v_cvt_pk_bf16_f32 v47, v206, v207
    buffer_store_dwordx4 v[44:47], v15, s[44:47], s4 offen offset:0 sc1
    v_mfma_f32_16x16x32_bf16 v[228:231], v[72:75], v[112:115], v[228:231]
    v_mul_f32 v208, s82, v208
    v_mul_f32 v209, s82, v209
    v_mul_f32 v210, s82, v210
    v_mul_f32 v211, s82, v211
    v_mfma_f32_16x16x32_bf16 v[232:235], v[80:83], v[112:115], v[232:235]
    v_mul_f32 v212, s82, v212
    v_mul_f32 v213, s82, v213
    v_mul_f32 v214, s82, v214
    v_mul_f32 v215, s82, v215
    v_mfma_f32_16x16x32_bf16 v[232:235], v[84:87], v[116:119], v[232:235]
    v_cvt_pk_bf16_f32 v40, v208, v209
    v_cvt_pk_bf16_f32 v41, v210, v211
    v_cvt_pk_bf16_f32 v42, v212, v213
    v_cvt_pk_bf16_f32 v43, v214, v215
    v_mfma_f32_16x16x32_bf16 v[236:239], v[92:95], v[116:119], v[236:239]
    buffer_store_dwordx4 v[40:43], v14, s[44:47], s4 offen offset:1024 sc1
    v_mul_f32 v216, s82, v216
    v_mul_f32 v217, s82, v217
    v_mul_f32 v218, s82, v218
    v_mfma_f32_16x16x32_bf16 v[236:239], v[88:91], v[112:115], v[236:239]
    v_mul_f32 v219, s82, v219
    v_mul_f32 v220, s82, v220
    v_mul_f32 v221, s82, v221
    v_mul_f32 v222, s82, v222
    s_waitcnt lgkmcnt(1)
    v_mfma_f32_16x16x32_bf16 v[252:255], v[88:91], v[120:123], v[252:255]
    v_mul_f32 v223, s82, v223
    v_cvt_pk_bf16_f32 v44, v216, v217
    v_cvt_pk_bf16_f32 v45, v218, v219
    v_cvt_pk_bf16_f32 v46, v220, v221
    s_waitcnt lgkmcnt(0)
    v_mfma_f32_16x16x32_bf16 v[252:255], v[92:95], v[124:127], v[252:255]
    v_cvt_pk_bf16_f32 v47, v222, v223
    buffer_store_dwordx4 v[44:47], v15, s[44:47], s4 offen offset:1024 sc1
    v_mfma_f32_16x16x32_bf16 v[248:251], v[84:87], v[124:127], v[248:251]
    v_mfma_f32_16x16x32_bf16 v[248:251], v[80:83], v[120:123], v[248:251]
    s_add_u32 s4, s58, 3
    s_and_b32 s4, s4, 3
    s_add_u32 s4, s4, s84
    s_lshl_b32 s4, s4, 16
    s_add_u32 s4, s4, s85
    v_mul_f32 v224, s82, v224
    v_mul_f32 v225, s82, v225
    v_mfma_f32_16x16x32_bf16 v[244:247], v[72:75], v[120:123], v[244:247]
    v_mul_f32 v226, s82, v226
    v_mul_f32 v227, s82, v227
    v_mul_f32 v228, s82, v228
    v_mul_f32 v229, s82, v229
    v_mul_f32 v230, s82, v230
    v_mul_f32 v231, s82, v231
    v_cvt_pk_bf16_f32 v40, v224, v225
    v_mfma_f32_16x16x32_bf16 v[244:247], v[76:79], v[124:127], v[244:247]
    v_cvt_pk_bf16_f32 v41, v226, v227
    v_cvt_pk_bf16_f32 v42, v228, v229
    v_cvt_pk_bf16_f32 v43, v230, v231
    buffer_store_dwordx4 v[40:43], v14, s[44:47], s4 offen offset:0 sc1
    v_mul_f32 v232, s82, v232
    v_mul_f32 v233, s82, v233
    v_mul_f32 v234, s82, v234
    v_mfma_f32_16x16x32_bf16 v[240:243], v[68:71], v[124:127], v[240:243]
    v_mul_f32 v235, s82, v235
    v_mul_f32 v236, s82, v236
    v_mul_f32 v237, s82, v237
    v_mul_f32 v238, s82, v238
    v_mul_f32 v239, s82, v239
    v_cvt_pk_bf16_f32 v44, v232, v233
    v_cvt_pk_bf16_f32 v45, v234, v235
    v_mfma_f32_16x16x32_bf16 v[240:243], v[64:67], v[120:123], v[240:243]
    v_cvt_pk_bf16_f32 v46, v236, v237
    v_cvt_pk_bf16_f32 v47, v238, v239
    buffer_store_dwordx4 v[44:47], v15, s[44:47], s4 offen offset:0 sc1
    s_nop 7
    v_pk_mul_f32 v[240:241], v[240:241], s[82:83]
    v_pk_mul_f32 v[242:243], v[242:243], s[82:83]
    v_pk_mul_f32 v[244:245], v[244:245], s[82:83]
    v_pk_mul_f32 v[246:247], v[246:247], s[82:83]
    v_cvt_pk_bf16_f32 v40, v240, v241
    v_cvt_pk_bf16_f32 v41, v242, v243
    v_cvt_pk_bf16_f32 v42, v244, v245
    v_cvt_pk_bf16_f32 v43, v246, v247
    buffer_store_dwordx4 v[40:43], v14, s[44:47], s4 offen offset:1024 sc1
    v_pk_mul_f32 v[248:249], v[248:249], s[82:83]
    v_pk_mul_f32 v[250:251], v[250:251], s[82:83]
    v_pk_mul_f32 v[252:253], v[252:253], s[82:83]
    v_pk_mul_f32 v[254:255], v[254:255], s[82:83]
    v_cvt_pk_bf16_f32 v44, v248, v249
    v_cvt_pk_bf16_f32 v45, v250, v251
    v_cvt_pk_bf16_f32 v46, v252, v253
    v_cvt_pk_bf16_f32 v47, v254, v255
    buffer_store_dwordx4 v[44:47], v15, s[44:47], s4 offen offset:1024 sc1
p1_K_last:
    s_branch p1_fin
p1_VC:
    s_barrier
    ds_read_b128 v[96:99], v1 offset:0
    ds_read_b128 v[100:103], v2 offset:0
    ds_read_b64_tr_b16 v[32:33], v3 offset:0
    ds_read_b64_tr_b16 v[34:35], v3 offset:1024
    ds_read_b64_tr_b16 v[36:37], v3 offset:8192
    ds_read_b64_tr_b16 v[38:39], v3 offset:9216
    ds_read_b64_tr_b16 v[44:45], v4 offset:8192
    ds_read_b64_tr_b16 v[46:47], v4 offset:9216
    ds_read_b128 v[104:107], v1 offset:2048
    ds_read_b64_tr_b16 v[16:17], v5 offset:0
    ds_read_b128 v[108:111], v2 offset:2048
    ds_read_b64_tr_b16 v[18:19], v5 offset:256
    ds_read_b64_tr_b16 v[40:41], v4 offset:0
    ds_read_b64_tr_b16 v[42:43], v4 offset:1024
    ds_read_b64_tr_b16 v[48:49], v3 offset:16384
    ds_read_b64_tr_b16 v[50:51], v3 offset:17408
    ds_read_b64_tr_b16 v[52:53], v3 offset:24576
    ds_read_b64_tr_b16 v[54:55], v3 offset:25600
    ds_read_b128 v[112:115], v1 offset:4096
    ds_read_b64_tr_b16 v[20:21], v5 offset:2048
    ds_read_b128 v[116:119], v2 offset:4096
    ds_read_b64_tr_b16 v[22:23], v5 offset:2304
    ds_read_b64_tr_b16 v[60:61], v4 offset:24576
    ds_read_b64_tr_b16 v[62:63], v4 offset:25600
    ds_read_b64_tr_b16 v[56:57], v4 offset:16384
    ds_read_b64_tr_b16 v[58:59], v4 offset:17408
    s_mov_b32 s75, 6
    s_waitcnt lgkmcnt(15)
    v_mfma_f32_16x16x32_bf16 v[128:131], v[32:35], v[96:99], 0
    ds_read_b128 v[120:123], v1 offset:6144
    v_mfma_f32_16x16x32_bf16 v[128:131], v[36:39], v[100:103], v[128:131]
    ds_read_b128 v[124:127], v2 offset:6144
    v_mfma_f32_16x16x32_bf16 v[132:135], v[44:47], v[100:103], 0
    s_waitcnt lgkmcnt(14)
    v_mfma_f32_16x16x32_bf16 v[132:135], v[40:43], v[96:99], v[132:135]
    s_waitcnt lgkmcnt(12)
    v_mfma_f32_16x16x32_bf16 v[136:139], v[48:51], v[96:99], 0
    s_waitcnt lgkmcnt(10)
    v_mfma_f32_16x16x32_bf16 v[136:139], v[52:55], v[100:103], v[136:139]
    s_waitcnt lgkmcnt(4)
    v_mfma_f32_16x16x32_bf16 v[140:143], v[60:63], v[100:103], 0
    s_waitcnt lgkmcnt(2)
    v_mfma_f32_16x16x32_bf16 v[140:143], v[56:59], v[96:99], v[140:143]
    v_mfma_f32_16x16x32_bf16 v[24:27], v[96:99], v[16:19], 0
    v_mfma_f32_16x16x32_bf16 v[24:27], v[100:103], v[20:23], v[24:27]
    v_mfma_f32_16x16x32_bf16 v[156:159], v[56:59], v[104:107], 0
    ds_read_b128 v[96:99], v1 offset:8192
    v_mfma_f32_16x16x32_bf16 v[156:159], v[60:63], v[108:111], v[156:159]
    ds_read_b128 v[100:103], v2 offset:8192
    v_mfma_f32_16x16x32_bf16 v[152:155], v[52:55], v[108:111], 0
    v_mfma_f32_16x16x32_bf16 v[152:155], v[48:51], v[104:107], v[152:155]
    v_mfma_f32_16x16x32_bf16 v[148:151], v[40:43], v[104:107], 0
    v_mfma_f32_16x16x32_bf16 v[148:151], v[44:47], v[108:111], v[148:151]
    v_mfma_f32_16x16x32_bf16 v[144:147], v[36:39], v[108:111], 0
    v_mfma_f32_16x16x32_bf16 v[144:147], v[32:35], v[104:107], v[144:147]
    v_mfma_f32_16x16x32_bf16 v[28:31], v[104:107], v[16:19], 0
    v_mfma_f32_16x16x32_bf16 v[28:31], v[108:111], v[20:23], v[28:31]
    v_mfma_f32_16x16x32_bf16 v[160:163], v[32:35], v[112:115], 0
    ds_read_b128 v[104:107], v1 offset:10240
    v_mfma_f32_16x16x32_bf16 v[160:163], v[36:39], v[116:119], v[160:163]
    ds_read_b128 v[108:111], v2 offset:10240
    v_mfma_f32_16x16x32_bf16 v[164:167], v[44:47], v[116:119], 0
    v_mfma_f32_16x16x32_bf16 v[164:167], v[40:43], v[112:115], v[164:167]
    v_mfma_f32_16x16x32_bf16 v[168:171], v[48:51], v[112:115], 0
    v_mfma_f32_16x16x32_bf16 v[168:171], v[52:55], v[116:119], v[168:171]
    v_mfma_f32_16x16x32_bf16 v[172:175], v[60:63], v[116:119], 0
    v_mfma_f32_16x16x32_bf16 v[172:175], v[56:59], v[112:115], v[172:175]
    s_waitcnt lgkmcnt(5)
    v_mfma_f32_16x16x32_bf16 v[188:191], v[56:59], v[120:123], 0
    ds_read_b128 v[112:115], v1 offset:12288
    s_waitcnt lgkmcnt(5)
    v_mfma_f32_16x16x32_bf16 v[188:191], v[60:63], v[124:127], v[188:191]
    ds_read_b128 v[116:119], v2 offset:12288
    v_mfma_f32_16x16x32_bf16 v[184:187], v[52:55], v[124:127], 0
    ds_read_b32 v10, v8 offset:0
    v_mfma_f32_16x16x32_bf16 v[184:187], v[48:51], v[120:123], v[184:187]
    v_mfma_f32_16x16x32_bf16 v[180:183], v[40:43], v[120:123], 0
    v_mfma_f32_16x16x32_bf16 v[180:183], v[44:47], v[124:127], v[180:183]
    v_mfma_f32_16x16x32_bf16 v[176:179], v[36:39], v[124:127], 0
    v_mfma_f32_16x16x32_bf16 v[176:179], v[32:35], v[120:123], v[176:179]
    s_waitcnt lgkmcnt(6)
    v_mfma_f32_16x16x32_bf16 v[192:195], v[32:35], v[96:99], 0
    ds_read_b128 v[120:123], v1 offset:14336
    s_waitcnt lgkmcnt(6)
    v_mfma_f32_16x16x32_bf16 v[192:195], v[36:39], v[100:103], v[192:195]
    ds_read_b128 v[124:127], v2 offset:14336
    v_mfma_f32_16x16x32_bf16 v[196:199], v[44:47], v[100:103], 0
    v_mfma_f32_16x16x32_bf16 v[196:199], v[40:43], v[96:99], v[196:199]
    v_mfma_f32_16x16x32_bf16 v[200:203], v[48:51], v[96:99], 0
    v_mfma_f32_16x16x32_bf16 v[200:203], v[52:55], v[100:103], v[200:203]
    v_mfma_f32_16x16x32_bf16 v[204:207], v[60:63], v[100:103], 0
    v_mfma_f32_16x16x32_bf16 v[204:207], v[56:59], v[96:99], v[204:207]
    s_waitcnt lgkmcnt(0)
    s_waitcnt vmcnt(0)
    v_lshlrev_b32 v14, 16, v10
    v_and_b32 v15, s80, v10
    v_lshlrev_b32 v10, 16, v11
    v_and_b32 v11, s80, v11
    v_mul_f32 v14, v14, v10
    v_mul_f32 v15, v15, v11
    v_cvt_pk_bf16_f32 v15, v14, v15
    v_lshlrev_b32 v14, 16, v15
    v_and_b32 v15, s80, v15
    v_add_f32 v12, v12, v14
    v_add_f32 v13, v13, v15
    buffer_load_dword v11, v9, s[48:51], s79 offen
    s_add_u32 s79, s79, 128
    s_lshl_b32 s4, s56, 3
    s_add_u32 s4, s4, s58
    s_lshl_b32 s4, s4, 12
    s_add_u32 s4, s4, 0x1400000
    v_and_b32 v14, 15, v0
    v_lshlrev_b32 v14, 7, v14
    v_bfe_u32 v15, v0, 4, 1
    v_lshl_add_u32 v14, v15, 14, v14
    v_add_u32 v14, s4, v14
    s_lshl_b32 s4, s56, 5
    s_add_u32 s4, s4, s57
    s_lshl_b32 s4, s4, 6
    s_add_u32 s4, s4, 0x1480000
    v_mov_b32 v15, s4
    v_cmp_gt_u32 vcc, 32, v0
    s_cmp_lg_u32 s3, 1
    s_cbranch_scc1 p1_V_nt
    v_cndmask_b32 v14, v15, v14, vcc
    buffer_load_dword v15, v14, s[44:47], 0 offen sc1
p1_V_nt:
    v_mov_b32 v7, 0
    buffer_store_dword v7, v6, s[44:47], 0 offen sc1
    v_lshrrev_b32 v14, 3, v0
    v_lshrrev_b32 v10, 4, v0
    v_and_b32 v7, 7, v0
    v_lshlrev_b32 v14, 11, v14
    v_xor_b32 v7, v10, v7
    v_lshl_add_u32 v6, v7, 4, v14
    v_xor_b32 v7, 64, v6
    v_add_u32 v7, 0x4000, v7
    s_lshl_b32 s6, s60, 1
    s_and_b32 s7, s6, 2
    s_add_u32 s7, s7, s58
    s_and_b32 s6, s6, 4
    s_lshl_b32 s4, s56, 3
    s_add_u32 s6, s6, s4
    s_and_b32 s4, s7, 3
    s_add_u32 s4, s4, s6
    s_lshl_b32 s4, s4, 16
    s_add_u32 s61, s4, 256
    s_add_u32 s62, s4, 0x8100
    s_add_u32 s7, s7, 1
    s_and_b32 s4, s7, 3
    s_add_u32 s4, s4, s6
    s_lshl_b32 s4, s4, 16
    s_add_u32 s63, s4, 256
    s_add_u32 s64, s4, 0x8100
    s_lshl_b32 s68, s60, 13
    s_mov_b32 s8, s28
    s_mov_b32 s9, s29
    s_barrier
    v_mfma_f32_16x16x32_bf16 v[220:223], v[56:59], v[104:107], 0
    ds_read_b128 v[96:99], v1 offset:32768
    v_mfma_f32_16x16x32_bf16 v[220:223], v[60:63], v[108:111], v[220:223]
    ds_read_b128 v[100:103], v2 offset:32768
    v_mfma_f32_16x16x32_bf16 v[216:219], v[52:55], v[108:111], 0
    ds_read_b64_tr_b16 v[64:65], v3 offset:32768
    v_mfma_f32_16x16x32_bf16 v[216:219], v[48:51], v[104:107], v[216:219]
    ds_read_b64_tr_b16 v[66:67], v3 offset:33792
    v_mfma_f32_16x16x32_bf16 v[212:215], v[40:43], v[104:107], 0
    ds_read_b64_tr_b16 v[68:69], v3 offset:40960
    v_mfma_f32_16x16x32_bf16 v[212:215], v[44:47], v[108:111], v[212:215]
    ds_read_b64_tr_b16 v[70:71], v3 offset:41984
    v_mfma_f32_16x16x32_bf16 v[208:211], v[36:39], v[108:111], 0
    ds_read_b64_tr_b16 v[76:77], v4 offset:40960
    v_mfma_f32_16x16x32_bf16 v[208:211], v[32:35], v[104:107], v[208:211]
    ds_read_b64_tr_b16 v[78:79], v4 offset:41984
    v_mfma_f32_16x16x32_bf16 v[224:227], v[32:35], v[112:115], 0
    ds_read_b128 v[104:107], v1 offset:34816
    ds_read_b64_tr_b16 v[16:17], v5 offset:8192
    v_mfma_f32_16x16x32_bf16 v[224:227], v[36:39], v[116:119], v[224:227]
    ds_read_b128 v[108:111], v2 offset:34816
    ds_read_b64_tr_b16 v[18:19], v5 offset:8448
    v_mfma_f32_16x16x32_bf16 v[228:231], v[44:47], v[116:119], 0
    ds_read_b64_tr_b16 v[72:73], v4 offset:32768
    v_mfma_f32_16x16x32_bf16 v[228:231], v[40:43], v[112:115], v[228:231]
    ds_read_b64_tr_b16 v[74:75], v4 offset:33792
    v_mfma_f32_16x16x32_bf16 v[232:235], v[48:51], v[112:115], 0
    ds_read_b64_tr_b16 v[80:81], v3 offset:49152
    v_mfma_f32_16x16x32_bf16 v[232:235], v[52:55], v[116:119], v[232:235]
    ds_read_b64_tr_b16 v[82:83], v3 offset:50176
    v_mfma_f32_16x16x32_bf16 v[236:239], v[60:63], v[116:119], 0
    ds_read_b64_tr_b16 v[84:85], v3 offset:57344
    v_mfma_f32_16x16x32_bf16 v[236:239], v[56:59], v[112:115], v[236:239]
    ds_read_b64_tr_b16 v[86:87], v3 offset:58368
    v_mfma_f32_16x16x32_bf16 v[252:255], v[56:59], v[120:123], 0
    ds_read_b128 v[112:115], v1 offset:36864
    ds_read_b64_tr_b16 v[20:21], v5 offset:10240
    v_mfma_f32_16x16x32_bf16 v[252:255], v[60:63], v[124:127], v[252:255]
    ds_read_b128 v[116:119], v2 offset:36864
    ds_read_b64_tr_b16 v[22:23], v5 offset:10496
    v_mfma_f32_16x16x32_bf16 v[248:251], v[52:55], v[124:127], 0
    ds_read_b64_tr_b16 v[92:93], v4 offset:57344
    v_mfma_f32_16x16x32_bf16 v[248:251], v[48:51], v[120:123], v[248:251]
    ds_read_b64_tr_b16 v[94:95], v4 offset:58368
    v_mfma_f32_16x16x32_bf16 v[244:247], v[40:43], v[120:123], 0
    ds_read_b64_tr_b16 v[88:89], v4 offset:49152
    v_mfma_f32_16x16x32_bf16 v[244:247], v[44:47], v[124:127], v[244:247]
    ds_read_b64_tr_b16 v[90:91], v4 offset:50176
    v_mfma_f32_16x16x32_bf16 v[240:243], v[36:39], v[124:127], 0
    v_mfma_f32_16x16x32_bf16 v[240:243], v[32:35], v[120:123], v[240:243]
.p2align 6
p1_VC_loop:
    s_waitcnt lgkmcnt(15)
    v_mfma_f32_16x16x32_bf16 v[128:131], v[64:67], v[96:99], v[128:131]
    ds_read_b128 v[120:123], v1 offset:38912
    v_mfma_f32_16x16x32_bf16 v[128:131], v[68:71], v[100:103], v[128:131]
    ds_read_b128 v[124:127], v2 offset:38912
    v_mfma_f32_16x16x32_bf16 v[132:135], v[76:79], v[100:103], v[132:135]
    s_waitcnt lgkmcnt(14)
    v_mfma_f32_16x16x32_bf16 v[132:135], v[72:75], v[96:99], v[132:135]
    s_waitcnt lgkmcnt(12)
    v_mfma_f32_16x16x32_bf16 v[136:139], v[80:83], v[96:99], v[136:139]
    s_waitcnt lgkmcnt(10)
    v_mfma_f32_16x16x32_bf16 v[136:139], v[84:87], v[100:103], v[136:139]
    s_waitcnt lgkmcnt(4)
    v_mfma_f32_16x16x32_bf16 v[140:143], v[92:95], v[100:103], v[140:143]
    s_waitcnt lgkmcnt(2)
    v_mfma_f32_16x16x32_bf16 v[140:143], v[88:91], v[96:99], v[140:143]
    v_mfma_f32_16x16x32_bf16 v[24:27], v[96:99], v[16:19], v[24:27]
    v_mfma_f32_16x16x32_bf16 v[24:27], v[100:103], v[20:23], v[24:27]
    v_mfma_f32_16x16x32_bf16 v[156:159], v[88:91], v[104:107], v[156:159]
    ds_read_b128 v[96:99], v1 offset:40960
    v_mfma_f32_16x16x32_bf16 v[156:159], v[92:95], v[108:111], v[156:159]
    ds_read_b128 v[100:103], v2 offset:40960
    v_mfma_f32_16x16x32_bf16 v[152:155], v[84:87], v[108:111], v[152:155]
    v_mfma_f32_16x16x32_bf16 v[152:155], v[80:83], v[104:107], v[152:155]
    v_mfma_f32_16x16x32_bf16 v[148:151], v[72:75], v[104:107], v[148:151]
    v_mfma_f32_16x16x32_bf16 v[148:151], v[76:79], v[108:111], v[148:151]
    v_mfma_f32_16x16x32_bf16 v[144:147], v[68:71], v[108:111], v[144:147]
    v_mfma_f32_16x16x32_bf16 v[144:147], v[64:67], v[104:107], v[144:147]
    v_mfma_f32_16x16x32_bf16 v[28:31], v[104:107], v[16:19], v[28:31]
    v_mfma_f32_16x16x32_bf16 v[28:31], v[108:111], v[20:23], v[28:31]
    v_mfma_f32_16x16x32_bf16 v[160:163], v[64:67], v[112:115], v[160:163]
    ds_read_b128 v[104:107], v1 offset:43008
    v_mfma_f32_16x16x32_bf16 v[160:163], v[68:71], v[116:119], v[160:163]
    ds_read_b128 v[108:111], v2 offset:43008
    v_mfma_f32_16x16x32_bf16 v[164:167], v[76:79], v[116:119], v[164:167]
    v_mfma_f32_16x16x32_bf16 v[164:167], v[72:75], v[112:115], v[164:167]
    v_mfma_f32_16x16x32_bf16 v[168:171], v[80:83], v[112:115], v[168:171]
    v_mfma_f32_16x16x32_bf16 v[168:171], v[84:87], v[116:119], v[168:171]
    v_mfma_f32_16x16x32_bf16 v[172:175], v[92:95], v[116:119], v[172:175]
    v_mfma_f32_16x16x32_bf16 v[172:175], v[88:91], v[112:115], v[172:175]
    s_waitcnt lgkmcnt(5)
    v_mfma_f32_16x16x32_bf16 v[188:191], v[88:91], v[120:123], v[188:191]
    ds_read_b128 v[112:115], v1 offset:45056
    s_waitcnt lgkmcnt(5)
    v_mfma_f32_16x16x32_bf16 v[188:191], v[92:95], v[124:127], v[188:191]
    ds_read_b128 v[116:119], v2 offset:45056
    v_mfma_f32_16x16x32_bf16 v[184:187], v[84:87], v[124:127], v[184:187]
    ds_read_b32 v10, v8 offset:32768
    v_mfma_f32_16x16x32_bf16 v[184:187], v[80:83], v[120:123], v[184:187]
    v_mfma_f32_16x16x32_bf16 v[180:183], v[72:75], v[120:123], v[180:183]
    v_mfma_f32_16x16x32_bf16 v[180:183], v[76:79], v[124:127], v[180:183]
    v_mfma_f32_16x16x32_bf16 v[176:179], v[68:71], v[124:127], v[176:179]
    v_mfma_f32_16x16x32_bf16 v[176:179], v[64:67], v[120:123], v[176:179]
    s_waitcnt lgkmcnt(6)
    v_mfma_f32_16x16x32_bf16 v[192:195], v[64:67], v[96:99], v[192:195]
    ds_read_b128 v[120:123], v1 offset:47104
    s_waitcnt lgkmcnt(6)
    v_mfma_f32_16x16x32_bf16 v[192:195], v[68:71], v[100:103], v[192:195]
    ds_read_b128 v[124:127], v2 offset:47104
    v_mfma_f32_16x16x32_bf16 v[196:199], v[76:79], v[100:103], v[196:199]
    v_mfma_f32_16x16x32_bf16 v[196:199], v[72:75], v[96:99], v[196:199]
    v_mfma_f32_16x16x32_bf16 v[200:203], v[80:83], v[96:99], v[200:203]
    v_mfma_f32_16x16x32_bf16 v[200:203], v[84:87], v[100:103], v[200:203]
    v_mfma_f32_16x16x32_bf16 v[204:207], v[92:95], v[100:103], v[204:207]
    v_mfma_f32_16x16x32_bf16 v[204:207], v[88:91], v[96:99], v[204:207]
    s_waitcnt lgkmcnt(0)
    s_waitcnt vmcnt(0)
    v_lshlrev_b32 v14, 16, v10
    v_and_b32 v15, s80, v10
    v_lshlrev_b32 v10, 16, v11
    v_and_b32 v11, s80, v11
    v_mul_f32 v14, v14, v10
    v_mul_f32 v15, v15, v11
    v_cvt_pk_bf16_f32 v15, v14, v15
    v_lshlrev_b32 v14, 16, v15
    v_and_b32 v15, s80, v15
    v_add_f32 v12, v12, v14
    v_add_f32 v13, v13, v15
    buffer_load_dword v11, v9, s[48:51], s79 offen
    s_add_u32 s79, s79, 128
    s_sub_u32 s73, s73, 1
    s_cmp_lg_u32 s73, 0
    s_cbranch_scc1 p1_V_nb
    v_mov_b32 v14, 1
    v_mov_b32 v15, 0
    s_mov_b64 exec, 1
    buffer_store_byte v14, v15, s[20:23], s2 offen sc1
    s_mov_b64 exec, -1
p1_V_nb:
    s_add_u32 m0, s68, 0x1000
    s_nop 0
    buffer_load_dwordx4 v6, s[8:11], s63 offen lds
    s_add_u32 m0, s68, 0x1400
    s_nop 0
    buffer_load_dwordx4 v7, s[8:11], s63 offen lds
    s_add_u32 s63, s63, 128
    s_add_u32 m0, s68, 0x1800
    s_nop 0
    buffer_load_dwordx4 v6, s[8:11], s64 offen lds
    s_add_u32 m0, s68, 0x1c00
    s_nop 0
    buffer_load_dwordx4 v7, s[8:11], s64 offen lds
    s_add_u32 s64, s64, 128
    s_waitcnt vmcnt(0)
    s_barrier
    v_mfma_f32_16x16x32_bf16 v[220:223], v[88:91], v[104:107], v[220:223]
    ds_read_b128 v[96:99], v1 offset:0
    v_mfma_f32_16x16x32_bf16 v[220:223], v[92:95], v[108:111], v[220:223]
    ds_read_b128 v[100:103], v2 offset:0
    v_mfma_f32_16x16x32_bf16 v[216:219], v[84:87], v[108:111], v[216:219]
    ds_read_b64_tr_b16 v[32:33], v3 offset:0
    v_mfma_f32_16x16x32_bf16 v[216:219], v[80:83], v[104:107], v[216:219]
    ds_read_b64_tr_b16 v[34:35], v3 offset:1024
    v_mfma_f32_16x16x32_bf16 v[212:215], v[72:75], v[104:107], v[212:215]
    ds_read_b64_tr_b16 v[36:37], v3 offset:8192
    v_mfma_f32_16x16x32_bf16 v[212:215], v[76:79], v[108:111], v[212:215]
    ds_read_b64_tr_b16 v[38:39], v3 offset:9216
    v_mfma_f32_16x16x32_bf16 v[208:211], v[68:71], v[108:111], v[208:211]
    ds_read_b64_tr_b16 v[44:45], v4 offset:8192
    v_mfma_f32_16x16x32_bf16 v[208:211], v[64:67], v[104:107], v[208:211]
    ds_read_b64_tr_b16 v[46:47], v4 offset:9216
    v_mfma_f32_16x16x32_bf16 v[224:227], v[64:67], v[112:115], v[224:227]
    ds_read_b128 v[104:107], v1 offset:2048
    ds_read_b64_tr_b16 v[16:17], v5 offset:0
    v_mfma_f32_16x16x32_bf16 v[224:227], v[68:71], v[116:119], v[224:227]
    ds_read_b128 v[108:111], v2 offset:2048
    ds_read_b64_tr_b16 v[18:19], v5 offset:256
    v_mfma_f32_16x16x32_bf16 v[228:231], v[76:79], v[116:119], v[228:231]
    ds_read_b64_tr_b16 v[40:41], v4 offset:0
    v_mfma_f32_16x16x32_bf16 v[228:231], v[72:75], v[112:115], v[228:231]
    ds_read_b64_tr_b16 v[42:43], v4 offset:1024
    v_mfma_f32_16x16x32_bf16 v[232:235], v[80:83], v[112:115], v[232:235]
    ds_read_b64_tr_b16 v[48:49], v3 offset:16384
    v_mfma_f32_16x16x32_bf16 v[232:235], v[84:87], v[116:119], v[232:235]
    ds_read_b64_tr_b16 v[50:51], v3 offset:17408
    v_mfma_f32_16x16x32_bf16 v[236:239], v[92:95], v[116:119], v[236:239]
    ds_read_b64_tr_b16 v[52:53], v3 offset:24576
    v_mfma_f32_16x16x32_bf16 v[236:239], v[88:91], v[112:115], v[236:239]
    ds_read_b64_tr_b16 v[54:55], v3 offset:25600
    v_mfma_f32_16x16x32_bf16 v[252:255], v[88:91], v[120:123], v[252:255]
    ds_read_b128 v[112:115], v1 offset:4096
    ds_read_b64_tr_b16 v[20:21], v5 offset:2048
    v_mfma_f32_16x16x32_bf16 v[252:255], v[92:95], v[124:127], v[252:255]
    ds_read_b128 v[116:119], v2 offset:4096
    ds_read_b64_tr_b16 v[22:23], v5 offset:2304
    v_mfma_f32_16x16x32_bf16 v[248:251], v[84:87], v[124:127], v[248:251]
    ds_read_b64_tr_b16 v[60:61], v4 offset:24576
    v_mfma_f32_16x16x32_bf16 v[248:251], v[80:83], v[120:123], v[248:251]
    ds_read_b64_tr_b16 v[62:63], v4 offset:25600
    v_mfma_f32_16x16x32_bf16 v[244:247], v[72:75], v[120:123], v[244:247]
    ds_read_b64_tr_b16 v[56:57], v4 offset:16384
    v_mfma_f32_16x16x32_bf16 v[244:247], v[76:79], v[124:127], v[244:247]
    ds_read_b64_tr_b16 v[58:59], v4 offset:17408
    v_mfma_f32_16x16x32_bf16 v[240:243], v[68:71], v[124:127], v[240:243]
    v_mfma_f32_16x16x32_bf16 v[240:243], v[64:67], v[120:123], v[240:243]
    s_cmp_eq_u32 s75, 0
    s_cbranch_scc1 p1_VC_tail
    s_waitcnt lgkmcnt(15)
    v_mfma_f32_16x16x32_bf16 v[128:131], v[32:35], v[96:99], v[128:131]
    ds_read_b128 v[120:123], v1 offset:6144
    v_mfma_f32_16x16x32_bf16 v[128:131], v[36:39], v[100:103], v[128:131]
    ds_read_b128 v[124:127], v2 offset:6144
    v_mfma_f32_16x16x32_bf16 v[132:135], v[44:47], v[100:103], v[132:135]
    s_waitcnt lgkmcnt(14)
    v_mfma_f32_16x16x32_bf16 v[132:135], v[40:43], v[96:99], v[132:135]
    s_waitcnt lgkmcnt(12)
    v_mfma_f32_16x16x32_bf16 v[136:139], v[48:51], v[96:99], v[136:139]
    s_waitcnt lgkmcnt(10)
    v_mfma_f32_16x16x32_bf16 v[136:139], v[52:55], v[100:103], v[136:139]
    s_waitcnt lgkmcnt(4)
    v_mfma_f32_16x16x32_bf16 v[140:143], v[60:63], v[100:103], v[140:143]
    s_waitcnt lgkmcnt(2)
    v_mfma_f32_16x16x32_bf16 v[140:143], v[56:59], v[96:99], v[140:143]
    v_mfma_f32_16x16x32_bf16 v[24:27], v[96:99], v[16:19], v[24:27]
    v_mfma_f32_16x16x32_bf16 v[24:27], v[100:103], v[20:23], v[24:27]
    v_mfma_f32_16x16x32_bf16 v[156:159], v[56:59], v[104:107], v[156:159]
    ds_read_b128 v[96:99], v1 offset:8192
    v_mfma_f32_16x16x32_bf16 v[156:159], v[60:63], v[108:111], v[156:159]
    ds_read_b128 v[100:103], v2 offset:8192
    v_mfma_f32_16x16x32_bf16 v[152:155], v[52:55], v[108:111], v[152:155]
    v_mfma_f32_16x16x32_bf16 v[152:155], v[48:51], v[104:107], v[152:155]
    v_mfma_f32_16x16x32_bf16 v[148:151], v[40:43], v[104:107], v[148:151]
    v_mfma_f32_16x16x32_bf16 v[148:151], v[44:47], v[108:111], v[148:151]
    v_mfma_f32_16x16x32_bf16 v[144:147], v[36:39], v[108:111], v[144:147]
    v_mfma_f32_16x16x32_bf16 v[144:147], v[32:35], v[104:107], v[144:147]
    v_mfma_f32_16x16x32_bf16 v[28:31], v[104:107], v[16:19], v[28:31]
    v_mfma_f32_16x16x32_bf16 v[28:31], v[108:111], v[20:23], v[28:31]
    v_mfma_f32_16x16x32_bf16 v[160:163], v[32:35], v[112:115], v[160:163]
    ds_read_b128 v[104:107], v1 offset:10240
    v_mfma_f32_16x16x32_bf16 v[160:163], v[36:39], v[116:119], v[160:163]
    ds_read_b128 v[108:111], v2 offset:10240
    v_mfma_f32_16x16x32_bf16 v[164:167], v[44:47], v[116:119], v[164:167]
    v_mfma_f32_16x16x32_bf16 v[164:167], v[40:43], v[112:115], v[164:167]
    v_mfma_f32_16x16x32_bf16 v[168:171], v[48:51], v[112:115], v[168:171]
    v_mfma_f32_16x16x32_bf16 v[168:171], v[52:55], v[116:119], v[168:171]
    v_mfma_f32_16x16x32_bf16 v[172:175], v[60:63], v[116:119], v[172:175]
    v_mfma_f32_16x16x32_bf16 v[172:175], v[56:59], v[112:115], v[172:175]
    s_waitcnt lgkmcnt(5)
    v_mfma_f32_16x16x32_bf16 v[188:191], v[56:59], v[120:123], v[188:191]
    ds_read_b128 v[112:115], v1 offset:12288
    s_waitcnt lgkmcnt(5)
    v_mfma_f32_16x16x32_bf16 v[188:191], v[60:63], v[124:127], v[188:191]
    ds_read_b128 v[116:119], v2 offset:12288
    v_mfma_f32_16x16x32_bf16 v[184:187], v[52:55], v[124:127], v[184:187]
    ds_read_b32 v10, v8 offset:0
    v_mfma_f32_16x16x32_bf16 v[184:187], v[48:51], v[120:123], v[184:187]
    v_mfma_f32_16x16x32_bf16 v[180:183], v[40:43], v[120:123], v[180:183]
    v_mfma_f32_16x16x32_bf16 v[180:183], v[44:47], v[124:127], v[180:183]
    v_mfma_f32_16x16x32_bf16 v[176:179], v[36:39], v[124:127], v[176:179]
    v_mfma_f32_16x16x32_bf16 v[176:179], v[32:35], v[120:123], v[176:179]
    s_waitcnt lgkmcnt(6)
    v_mfma_f32_16x16x32_bf16 v[192:195], v[32:35], v[96:99], v[192:195]
    ds_read_b128 v[120:123], v1 offset:14336
    s_waitcnt lgkmcnt(6)
    v_mfma_f32_16x16x32_bf16 v[192:195], v[36:39], v[100:103], v[192:195]
    ds_read_b128 v[124:127], v2 offset:14336
    v_mfma_f32_16x16x32_bf16 v[196:199], v[44:47], v[100:103], v[196:199]
    v_mfma_f32_16x16x32_bf16 v[196:199], v[40:43], v[96:99], v[196:199]
    v_mfma_f32_16x16x32_bf16 v[200:203], v[48:51], v[96:99], v[200:203]
    v_mfma_f32_16x16x32_bf16 v[200:203], v[52:55], v[100:103], v[200:203]
    v_mfma_f32_16x16x32_bf16 v[204:207], v[60:63], v[100:103], v[204:207]
    v_mfma_f32_16x16x32_bf16 v[204:207], v[56:59], v[96:99], v[204:207]
    s_waitcnt lgkmcnt(0)
    s_waitcnt vmcnt(0)
    v_lshlrev_b32 v14, 16, v10
    v_and_b32 v15, s80, v10
    v_lshlrev_b32 v10, 16, v11
    v_and_b32 v11, s80, v11
    v_mul_f32 v14, v14, v10
    v_mul_f32 v15, v15, v11
    v_cvt_pk_bf16_f32 v15, v14, v15
    v_lshlrev_b32 v14, 16, v15
    v_and_b32 v15, s80, v15
    v_add_f32 v12, v12, v14
    v_add_f32 v13, v13, v15
    buffer_load_dword v11, v9, s[48:51], s79 offen
    s_add_u32 s79, s79, 128
    s_add_u32 m0, s68, 0x9000
    s_nop 0
    buffer_load_dwordx4 v6, s[8:11], s63 offen lds
    s_add_u32 m0, s68, 0x9400
    s_nop 0
    buffer_load_dwordx4 v7, s[8:11], s63 offen lds
    s_add_u32 s63, s63, 128
    s_add_u32 m0, s68, 0x9800
    s_nop 0
    buffer_load_dwordx4 v6, s[8:11], s64 offen lds
    s_add_u32 m0, s68, 0x9c00
    s_nop 0
    buffer_load_dwordx4 v7, s[8:11], s64 offen lds
    s_add_u32 s64, s64, 128
    s_waitcnt vmcnt(0)
    s_barrier
    v_mfma_f32_16x16x32_bf16 v[220:223], v[56:59], v[104:107], v[220:223]
    ds_read_b128 v[96:99], v1 offset:32768
    v_mfma_f32_16x16x32_bf16 v[220:223], v[60:63], v[108:111], v[220:223]
    ds_read_b128 v[100:103], v2 offset:32768
    v_mfma_f32_16x16x32_bf16 v[216:219], v[52:55], v[108:111], v[216:219]
    ds_read_b64_tr_b16 v[64:65], v3 offset:32768
    v_mfma_f32_16x16x32_bf16 v[216:219], v[48:51], v[104:107], v[216:219]
    ds_read_b64_tr_b16 v[66:67], v3 offset:33792
    v_mfma_f32_16x16x32_bf16 v[212:215], v[40:43], v[104:107], v[212:215]
    ds_read_b64_tr_b16 v[68:69], v3 offset:40960
    v_mfma_f32_16x16x32_bf16 v[212:215], v[44:47], v[108:111], v[212:215]
    ds_read_b64_tr_b16 v[70:71], v3 offset:41984
    v_mfma_f32_16x16x32_bf16 v[208:211], v[36:39], v[108:111], v[208:211]
    ds_read_b64_tr_b16 v[76:77], v4 offset:40960
    v_mfma_f32_16x16x32_bf16 v[208:211], v[32:35], v[104:107], v[208:211]
    ds_read_b64_tr_b16 v[78:79], v4 offset:41984
    v_mfma_f32_16x16x32_bf16 v[224:227], v[32:35], v[112:115], v[224:227]
    ds_read_b128 v[104:107], v1 offset:34816
    ds_read_b64_tr_b16 v[16:17], v5 offset:8192
    v_mfma_f32_16x16x32_bf16 v[224:227], v[36:39], v[116:119], v[224:227]
    ds_read_b128 v[108:111], v2 offset:34816
    ds_read_b64_tr_b16 v[18:19], v5 offset:8448
    v_mfma_f32_16x16x32_bf16 v[228:231], v[44:47], v[116:119], v[228:231]
    ds_read_b64_tr_b16 v[72:73], v4 offset:32768
    v_mfma_f32_16x16x32_bf16 v[228:231], v[40:43], v[112:115], v[228:231]
    ds_read_b64_tr_b16 v[74:75], v4 offset:33792
    v_mfma_f32_16x16x32_bf16 v[232:235], v[48:51], v[112:115], v[232:235]
    ds_read_b64_tr_b16 v[80:81], v3 offset:49152
    v_mfma_f32_16x16x32_bf16 v[232:235], v[52:55], v[116:119], v[232:235]
    ds_read_b64_tr_b16 v[82:83], v3 offset:50176
    v_mfma_f32_16x16x32_bf16 v[236:239], v[60:63], v[116:119], v[236:239]
    ds_read_b64_tr_b16 v[84:85], v3 offset:57344
    v_mfma_f32_16x16x32_bf16 v[236:239], v[56:59], v[112:115], v[236:239]
    ds_read_b64_tr_b16 v[86:87], v3 offset:58368
    v_mfma_f32_16x16x32_bf16 v[252:255], v[56:59], v[120:123], v[252:255]
    ds_read_b128 v[112:115], v1 offset:36864
    ds_read_b64_tr_b16 v[20:21], v5 offset:10240
    v_mfma_f32_16x16x32_bf16 v[252:255], v[60:63], v[124:127], v[252:255]
    ds_read_b128 v[116:119], v2 offset:36864
    ds_read_b64_tr_b16 v[22:23], v5 offset:10496
    v_mfma_f32_16x16x32_bf16 v[248:251], v[52:55], v[124:127], v[248:251]
    ds_read_b64_tr_b16 v[92:93], v4 offset:57344
    v_mfma_f32_16x16x32_bf16 v[248:251], v[48:51], v[120:123], v[248:251]
    ds_read_b64_tr_b16 v[94:95], v4 offset:58368
    v_mfma_f32_16x16x32_bf16 v[244:247], v[40:43], v[120:123], v[244:247]
    ds_read_b64_tr_b16 v[88:89], v4 offset:49152
    v_mfma_f32_16x16x32_bf16 v[244:247], v[44:47], v[124:127], v[244:247]
    ds_read_b64_tr_b16 v[90:91], v4 offset:50176
    v_mfma_f32_16x16x32_bf16 v[240:243], v[36:39], v[124:127], v[240:243]
    v_mfma_f32_16x16x32_bf16 v[240:243], v[32:35], v[120:123], v[240:243]
    s_sub_u32 s75, s75, 1
    s_branch p1_VC_loop
p1_VC_tail:
    s_waitcnt lgkmcnt(15)
    v_mfma_f32_16x16x32_bf16 v[128:131], v[32:35], v[96:99], v[128:131]
    ds_read_b128 v[120:123], v1 offset:6144
    v_mfma_f32_16x16x32_bf16 v[128:131], v[36:39], v[100:103], v[128:131]
    ds_read_b128 v[124:127], v2 offset:6144
    v_mfma_f32_16x16x32_bf16 v[132:135], v[44:47], v[100:103], v[132:135]
    s_waitcnt lgkmcnt(14)
    v_mfma_f32_16x16x32_bf16 v[132:135], v[40:43], v[96:99], v[132:135]
    s_waitcnt lgkmcnt(12)
    v_mfma_f32_16x16x32_bf16 v[136:139], v[48:51], v[96:99], v[136:139]
    s_waitcnt lgkmcnt(10)
    v_mfma_f32_16x16x32_bf16 v[136:139], v[52:55], v[100:103], v[136:139]
    s_waitcnt lgkmcnt(4)
    v_mfma_f32_16x16x32_bf16 v[140:143], v[60:63], v[100:103], v[140:143]
    s_waitcnt lgkmcnt(2)
    v_mfma_f32_16x16x32_bf16 v[140:143], v[56:59], v[96:99], v[140:143]
    v_mfma_f32_16x16x32_bf16 v[24:27], v[96:99], v[16:19], v[24:27]
    v_mfma_f32_16x16x32_bf16 v[24:27], v[100:103], v[20:23], v[24:27]
    v_mfma_f32_16x16x32_bf16 v[156:159], v[56:59], v[104:107], v[156:159]
    ds_read_b128 v[96:99], v1 offset:8192
    v_mfma_f32_16x16x32_bf16 v[156:159], v[60:63], v[108:111], v[156:159]
    ds_read_b128 v[100:103], v2 offset:8192
    v_mfma_f32_16x16x32_bf16 v[152:155], v[52:55], v[108:111], v[152:155]
    v_mfma_f32_16x16x32_bf16 v[152:155], v[48:51], v[104:107], v[152:155]
    v_mfma_f32_16x16x32_bf16 v[148:151], v[40:43], v[104:107], v[148:151]
    v_mfma_f32_16x16x32_bf16 v[148:151], v[44:47], v[108:111], v[148:151]
    v_mfma_f32_16x16x32_bf16 v[144:147], v[36:39], v[108:111], v[144:147]
    v_mfma_f32_16x16x32_bf16 v[144:147], v[32:35], v[104:107], v[144:147]
    v_mfma_f32_16x16x32_bf16 v[28:31], v[104:107], v[16:19], v[28:31]
    v_mfma_f32_16x16x32_bf16 v[28:31], v[108:111], v[20:23], v[28:31]
    v_mfma_f32_16x16x32_bf16 v[160:163], v[32:35], v[112:115], v[160:163]
    ds_read_b128 v[104:107], v1 offset:10240
    v_mfma_f32_16x16x32_bf16 v[160:163], v[36:39], v[116:119], v[160:163]
    ds_read_b128 v[108:111], v2 offset:10240
    v_mfma_f32_16x16x32_bf16 v[164:167], v[44:47], v[116:119], v[164:167]
    v_mfma_f32_16x16x32_bf16 v[164:167], v[40:43], v[112:115], v[164:167]
    v_mfma_f32_16x16x32_bf16 v[168:171], v[48:51], v[112:115], v[168:171]
    v_mfma_f32_16x16x32_bf16 v[168:171], v[52:55], v[116:119], v[168:171]
    v_mfma_f32_16x16x32_bf16 v[172:175], v[60:63], v[116:119], v[172:175]
    v_mfma_f32_16x16x32_bf16 v[172:175], v[56:59], v[112:115], v[172:175]
    s_waitcnt lgkmcnt(5)
    v_mfma_f32_16x16x32_bf16 v[188:191], v[56:59], v[120:123], v[188:191]
    ds_read_b128 v[112:115], v1 offset:12288
    s_waitcnt lgkmcnt(5)
    v_mfma_f32_16x16x32_bf16 v[188:191], v[60:63], v[124:127], v[188:191]
    ds_read_b128 v[116:119], v2 offset:12288
    v_mfma_f32_16x16x32_bf16 v[184:187], v[52:55], v[124:127], v[184:187]
    ds_read_b32 v10, v8 offset:0
    v_mfma_f32_16x16x32_bf16 v[184:187], v[48:51], v[120:123], v[184:187]
    v_mfma_f32_16x16x32_bf16 v[180:183], v[40:43], v[120:123], v[180:183]
    v_mfma_f32_16x16x32_bf16 v[180:183], v[44:47], v[124:127], v[180:183]
    v_mfma_f32_16x16x32_bf16 v[176:179], v[36:39], v[124:127], v[176:179]
    v_mfma_f32_16x16x32_bf16 v[176:179], v[32:35], v[120:123], v[176:179]
    s_waitcnt lgkmcnt(6)
    v_mfma_f32_16x16x32_bf16 v[192:195], v[32:35], v[96:99], v[192:195]
    ds_read_b128 v[120:123], v1 offset:14336
    s_waitcnt lgkmcnt(6)
    v_mfma_f32_16x16x32_bf16 v[192:195], v[36:39], v[100:103], v[192:195]
    ds_read_b128 v[124:127], v2 offset:14336
    v_mfma_f32_16x16x32_bf16 v[196:199], v[44:47], v[100:103], v[196:199]
    v_mfma_f32_16x16x32_bf16 v[196:199], v[40:43], v[96:99], v[196:199]
    v_mfma_f32_16x16x32_bf16 v[200:203], v[48:51], v[96:99], v[200:203]
    v_mfma_f32_16x16x32_bf16 v[200:203], v[52:55], v[100:103], v[200:203]
    v_mfma_f32_16x16x32_bf16 v[204:207], v[60:63], v[100:103], v[204:207]
    v_mfma_f32_16x16x32_bf16 v[204:207], v[56:59], v[96:99], v[204:207]
    s_waitcnt lgkmcnt(0)
    s_waitcnt vmcnt(0)
    v_lshlrev_b32 v14, 16, v10
    v_and_b32 v15, s80, v10
    v_lshlrev_b32 v10, 16, v11
    v_and_b32 v11, s80, v11
    v_mul_f32 v14, v14, v10
    v_mul_f32 v15, v15, v11
    v_cvt_pk_bf16_f32 v15, v14, v15
    v_lshlrev_b32 v14, 16, v15
    v_and_b32 v15, s80, v15
    v_add_f32 v12, v12, v14
    v_add_f32 v13, v13, v15
    buffer_load_dword v11, v9, s[48:51], s79 offen
    s_add_u32 s79, s79, 128
    s_add_u32 m0, s68, 0x9000
    s_nop 0
    buffer_load_dwordx4 v6, s[8:11], s63 offen lds
    s_add_u32 m0, s68, 0x9400
    s_nop 0
    buffer_load_dwordx4 v7, s[8:11], s63 offen lds
    s_add_u32 s63, s63, 128
    s_add_u32 m0, s68, 0x9800
    s_nop 0
    buffer_load_dwordx4 v6, s[8:11], s64 offen lds
    s_add_u32 m0, s68, 0x9c00
    s_nop 0
    buffer_load_dwordx4 v7, s[8:11], s64 offen lds
    s_add_u32 s64, s64, 128
    s_waitcnt vmcnt(0)
    s_barrier
    v_mfma_f32_16x16x32_bf16 v[220:223], v[56:59], v[104:107], v[220:223]
    ds_read_b128 v[96:99], v1 offset:32768
    v_mfma_f32_16x16x32_bf16 v[220:223], v[60:63], v[108:111], v[220:223]
    ds_read_b128 v[100:103], v2 offset:32768
    v_mfma_f32_16x16x32_bf16 v[216:219], v[52:55], v[108:111], v[216:219]
    ds_read_b64_tr_b16 v[64:65], v3 offset:32768
    v_mfma_f32_16x16x32_bf16 v[216:219], v[48:51], v[104:107], v[216:219]
    ds_read_b64_tr_b16 v[66:67], v3 offset:33792
    v_mfma_f32_16x16x32_bf16 v[212:215], v[40:43], v[104:107], v[212:215]
    ds_read_b64_tr_b16 v[68:69], v3 offset:40960
    v_mfma_f32_16x16x32_bf16 v[212:215], v[44:47], v[108:111], v[212:215]
    ds_read_b64_tr_b16 v[70:71], v3 offset:41984
    v_mfma_f32_16x16x32_bf16 v[208:211], v[36:39], v[108:111], v[208:211]
    ds_read_b64_tr_b16 v[76:77], v4 offset:40960
    v_mfma_f32_16x16x32_bf16 v[208:211], v[32:35], v[104:107], v[208:211]
    ds_read_b64_tr_b16 v[78:79], v4 offset:41984
    v_mfma_f32_16x16x32_bf16 v[224:227], v[32:35], v[112:115], v[224:227]
    ds_read_b128 v[104:107], v1 offset:34816
    ds_read_b64_tr_b16 v[16:17], v5 offset:8192
    v_mfma_f32_16x16x32_bf16 v[224:227], v[36:39], v[116:119], v[224:227]
    ds_read_b128 v[108:111], v2 offset:34816
    ds_read_b64_tr_b16 v[18:19], v5 offset:8448
    v_mfma_f32_16x16x32_bf16 v[228:231], v[44:47], v[116:119], v[228:231]
    ds_read_b64_tr_b16 v[72:73], v4 offset:32768
    v_mfma_f32_16x16x32_bf16 v[228:231], v[40:43], v[112:115], v[228:231]
    ds_read_b64_tr_b16 v[74:75], v4 offset:33792
    v_mfma_f32_16x16x32_bf16 v[232:235], v[48:51], v[112:115], v[232:235]
    ds_read_b64_tr_b16 v[80:81], v3 offset:49152
    v_mfma_f32_16x16x32_bf16 v[232:235], v[52:55], v[116:119], v[232:235]
    ds_read_b64_tr_b16 v[82:83], v3 offset:50176
    v_mfma_f32_16x16x32_bf16 v[236:239], v[60:63], v[116:119], v[236:239]
    ds_read_b64_tr_b16 v[84:85], v3 offset:57344
    v_mfma_f32_16x16x32_bf16 v[236:239], v[56:59], v[112:115], v[236:239]
    ds_read_b64_tr_b16 v[86:87], v3 offset:58368
    v_mfma_f32_16x16x32_bf16 v[252:255], v[56:59], v[120:123], v[252:255]
    ds_read_b128 v[112:115], v1 offset:36864
    ds_read_b64_tr_b16 v[20:21], v5 offset:10240
    v_mfma_f32_16x16x32_bf16 v[252:255], v[60:63], v[124:127], v[252:255]
    ds_read_b128 v[116:119], v2 offset:36864
    ds_read_b64_tr_b16 v[22:23], v5 offset:10496
    v_mfma_f32_16x16x32_bf16 v[248:251], v[52:55], v[124:127], v[248:251]
    ds_read_b64_tr_b16 v[92:93], v4 offset:57344
    v_mfma_f32_16x16x32_bf16 v[248:251], v[48:51], v[120:123], v[248:251]
    ds_read_b64_tr_b16 v[94:95], v4 offset:58368
    v_mfma_f32_16x16x32_bf16 v[244:247], v[40:43], v[120:123], v[244:247]
    ds_read_b64_tr_b16 v[88:89], v4 offset:49152
    v_mfma_f32_16x16x32_bf16 v[244:247], v[44:47], v[124:127], v[244:247]
    ds_read_b64_tr_b16 v[90:91], v4 offset:50176
    v_mfma_f32_16x16x32_bf16 v[240:243], v[36:39], v[124:127], v[240:243]
    v_mfma_f32_16x16x32_bf16 v[240:243], v[32:35], v[120:123], v[240:243]
    s_waitcnt lgkmcnt(15)
    v_mfma_f32_16x16x32_bf16 v[128:131], v[64:67], v[96:99], v[128:131]
    ds_read_b128 v[120:123], v1 offset:38912
    v_lshlrev_b32 v14, 4, v0
    s_lshl_b32 s4, s56, 3
    s_lshl_b32 s5, s59, 2
    v_mfma_f32_16x16x32_bf16 v[128:131], v[68:71], v[100:103], v[128:131]
    ds_read_b128 v[124:127], v2 offset:38912
    s_add_u32 s84, s4, s5
    s_lshl_b32 s7, s58, 3
    s_add_u32 s7, s7, s60
    v_mfma_f32_16x16x32_bf16 v[132:135], v[76:79], v[100:103], v[132:135]
    ds_read_b32 v10, v8 offset:32768
    s_lshl_b32 s7, s7, 11
    s_add_u32 s85, s7, 0x1000000
    s_mov_b32 s82, 0x3e8293ee
    s_waitcnt lgkmcnt(15)
    v_mfma_f32_16x16x32_bf16 v[132:135], v[72:75], v[96:99], v[132:135]
    s_mov_b32 s83, 0x3e8293ee
    v_add_u32 v15, 0x2000, v14
    s_waitcnt lgkmcnt(13)
    v_mfma_f32_16x16x32_bf16 v[136:139], v[80:83], v[96:99], v[136:139]
    s_waitcnt lgkmcnt(11)
    v_mfma_f32_16x16x32_bf16 v[136:139], v[84:87], v[100:103], v[136:139]
    s_waitcnt lgkmcnt(5)
    v_mfma_f32_16x16x32_bf16 v[140:143], v[92:95], v[100:103], v[140:143]
    s_waitcnt lgkmcnt(3)
    v_mfma_f32_16x16x32_bf16 v[140:143], v[88:91], v[96:99], v[140:143]
    v_mfma_f32_16x16x32_bf16 v[24:27], v[96:99], v[16:19], v[24:27]
    v_mfma_f32_16x16x32_bf16 v[24:27], v[100:103], v[20:23], v[24:27]
    v_mfma_f32_16x16x32_bf16 v[156:159], v[88:91], v[104:107], v[156:159]
    ds_read_b128 v[96:99], v1 offset:40960
    v_mfma_f32_16x16x32_bf16 v[156:159], v[92:95], v[108:111], v[156:159]
    ds_read_b128 v[100:103], v2 offset:40960
    v_mfma_f32_16x16x32_bf16 v[152:155], v[84:87], v[108:111], v[152:155]
    v_mfma_f32_16x16x32_bf16 v[152:155], v[80:83], v[104:107], v[152:155]
    v_mfma_f32_16x16x32_bf16 v[148:151], v[72:75], v[104:107], v[148:151]
    s_add_u32 s4, s58, 0
    s_and_b32 s4, s4, 3
    s_add_u32 s4, s4, s84
    s_lshl_b32 s4, s4, 16
    v_mfma_f32_16x16x32_bf16 v[148:151], v[76:79], v[108:111], v[148:151]
    s_add_u32 s4, s4, s85
    v_mul_f32 v128, s82, v128
    v_mul_f32 v129, s82, v129
    v_mul_f32 v130, s82, v130
    v_mfma_f32_16x16x32_bf16 v[144:147], v[68:71], v[108:111], v[144:147]
    s_waitcnt vmcnt(0)
    v_mul_f32 v131, s82, v131
    v_mul_f32 v132, s82, v132
    v_mul_f32 v133, s82, v133
    v_mul_f32 v134, s82, v134
    v_mfma_f32_16x16x32_bf16 v[144:147], v[64:67], v[104:107], v[144:147]
    v_mfma_f32_16x16x32_bf16 v[28:31], v[104:107], v[16:19], v[28:31]
    v_mfma_f32_16x16x32_bf16 v[28:31], v[108:111], v[20:23], v[28:31]
    v_mul_f32 v135, s82, v135
    v_cvt_pk_bf16_f32 v40, v128, v129
    v_cvt_pk_bf16_f32 v41, v130, v131
    v_cvt_pk_bf16_f32 v42, v132, v133
    v_mfma_f32_16x16x32_bf16 v[160:163], v[64:67], v[112:115], v[160:163]
    ds_read_b128 v[104:107], v1 offset:43008
    v_cvt_pk_bf16_f32 v43, v134, v135
    buffer_store_dwordx4 v[40:43], v14, s[44:47], s4 offen offset:0 sc1
    v_mul_f32 v136, s82, v136
    v_mul_f32 v137, s82, v137
    v_mfma_f32_16x16x32_bf16 v[160:163], v[68:71], v[116:119], v[160:163]
    ds_read_b128 v[108:111], v2 offset:43008
    v_mul_f32 v138, s82, v138
    v_mul_f32 v139, s82, v139
    v_mul_f32 v140, s82, v140
    v_mul_f32 v141, s82, v141
    v_mfma_f32_16x16x32_bf16 v[164:167], v[76:79], v[116:119], v[164:167]
    s_add_u32 s5, s84, s58
    s_lshl_b32 s5, s5, 12
    s_and_b32 s6, s60, 1
    v_mul_f32 v142, s82, v142
    v_mul_f32 v143, s82, v143
    v_cvt_pk_bf16_f32 v44, v136, v137
    v_cvt_pk_bf16_f32 v45, v138, v139
    v_mfma_f32_16x16x32_bf16 v[164:167], v[72:75], v[112:115], v[164:167]
    s_lshl_b32 s6, s6, 10
    s_add_u32 s5, s5, s6
    s_add_u32 s5, s5, 0x1400800
    v_cvt_pk_bf16_f32 v46, v140, v141
    v_cvt_pk_bf16_f32 v47, v142, v143
    buffer_store_dwordx4 v[44:47], v15, s[44:47], s4 offen offset:0 sc1
    v_mul_f32 v144, s82, v144
    v_mul_f32 v145, s82, v145
    v_mul_f32 v146, s82, v146
    v_mul_f32 v147, s82, v147
    v_mfma_f32_16x16x32_bf16 v[168:171], v[80:83], v[112:115], v[168:171]
    v_cvt_pk_bf16_f32 v52, v24, v25
    v_cvt_pk_bf16_f32 v53, v26, v27
    v_cvt_pk_bf16_f32 v54, v28, v29
    v_mul_f32 v148, s82, v148
    v_mul_f32 v149, s82, v149
    v_mul_f32 v150, s82, v150
    v_mul_f32 v151, s82, v151
    v_mfma_f32_16x16x32_bf16 v[168:171], v[84:87], v[116:119], v[168:171]
    v_cvt_pk_bf16_f32 v55, v30, v31
    buffer_store_dwordx4 v[52:55], v14, s[44:47], s5 offen sc1
    v_cvt_pk_bf16_f32 v40, v144, v145
    v_cvt_pk_bf16_f32 v41, v146, v147
    v_cvt_pk_bf16_f32 v42, v148, v149
    v_cvt_pk_bf16_f32 v43, v150, v151
    v_mfma_f32_16x16x32_bf16 v[172:175], v[92:95], v[116:119], v[172:175]
    buffer_store_dwordx4 v[40:43], v14, s[44:47], s4 offen offset:1024 sc1
    v_mul_f32 v152, s82, v152
    v_mul_f32 v153, s82, v153
    v_mul_f32 v154, s82, v154
    v_mfma_f32_16x16x32_bf16 v[172:175], v[88:91], v[112:115], v[172:175]
    v_mul_f32 v155, s82, v155
    v_mul_f32 v156, s82, v156
    v_mul_f32 v157, s82, v157
    v_mul_f32 v158, s82, v158
    s_waitcnt lgkmcnt(6)
    v_mfma_f32_16x16x32_bf16 v[188:191], v[88:91], v[120:123], v[188:191]
    ds_read_b128 v[112:115], v1 offset:45056
    v_mul_f32 v159, s82, v159
    v_cvt_pk_bf16_f32 v44, v152, v153
    v_cvt_pk_bf16_f32 v45, v154, v155
    v_cvt_pk_bf16_f32 v46, v156, v157
    s_waitcnt lgkmcnt(6)
    v_mfma_f32_16x16x32_bf16 v[188:191], v[92:95], v[124:127], v[188:191]
    ds_read_b128 v[116:119], v2 offset:45056
    v_cvt_pk_bf16_f32 v47, v158, v159
    buffer_store_dwordx4 v[44:47], v15, s[44:47], s4 offen offset:1024 sc1
    v_mfma_f32_16x16x32_bf16 v[184:187], v[84:87], v[124:127], v[184:187]
    v_mfma_f32_16x16x32_bf16 v[184:187], v[80:83], v[120:123], v[184:187]
    s_add_u32 s4, s58, 1
    s_and_b32 s4, s4, 3
    s_add_u32 s4, s4, s84
    s_lshl_b32 s4, s4, 16
    v_mfma_f32_16x16x32_bf16 v[180:183], v[72:75], v[120:123], v[180:183]
    s_add_u32 s4, s4, s85
    v_mul_f32 v160, s82, v160
    v_mul_f32 v161, s82, v161
    v_mul_f32 v162, s82, v162
    v_mfma_f32_16x16x32_bf16 v[180:183], v[76:79], v[124:127], v[180:183]
    v_mul_f32 v163, s82, v163
    v_mul_f32 v164, s82, v164
    v_mul_f32 v165, s82, v165
    v_mul_f32 v166, s82, v166
    v_mfma_f32_16x16x32_bf16 v[176:179], v[68:71], v[124:127], v[176:179]
    v_mul_f32 v167, s82, v167
    v_cvt_pk_bf16_f32 v40, v160, v161
    v_cvt_pk_bf16_f32 v41, v162, v163
    v_cvt_pk_bf16_f32 v42, v164, v165
    v_mfma_f32_16x16x32_bf16 v[176:179], v[64:67], v[120:123], v[176:179]
    v_cvt_pk_bf16_f32 v43, v166, v167
    buffer_store_dwordx4 v[40:43], v14, s[44:47], s4 offen offset:0 sc1
    v_mul_f32 v168, s82, v168
    v_mul_f32 v169, s82, v169
    s_waitcnt lgkmcnt(5)
    v_mfma_f32_16x16x32_bf16 v[192:195], v[64:67], v[96:99], v[192:195]
    ds_read_b128 v[120:123], v1 offset:47104
    v_mul_f32 v170, s82, v170
    v_mul_f32 v171, s82, v171
    v_mul_f32 v172, s82, v172
    v_mul_f32 v173, s82, v173
    s_waitcnt lgkmcnt(5)
    v_mfma_f32_16x16x32_bf16 v[192:195], v[68:71], v[100:103], v[192:195]
    ds_read_b128 v[124:127], v2 offset:47104
    v_mul_f32 v174, s82, v174
    v_mul_f32 v175, s82, v175
    v_cvt_pk_bf16_f32 v44, v168, v169
    v_cvt_pk_bf16_f32 v45, v170, v171
    v_mfma_f32_16x16x32_bf16 v[196:199], v[76:79], v[100:103], v[196:199]
    v_cvt_pk_bf16_f32 v46, v172, v173
    v_cvt_pk_bf16_f32 v47, v174, v175
    buffer_store_dwordx4 v[44:47], v15, s[44:47], s4 offen offset:0 sc1
    v_mfma_f32_16x16x32_bf16 v[196:199], v[72:75], v[96:99], v[196:199]
    v_mul_f32 v176, s82, v176
    v_mul_f32 v177, s82, v177
    v_mul_f32 v178, s82, v178
    v_mul_f32 v179, s82, v179
    v_mfma_f32_16x16x32_bf16 v[200:203], v[80:83], v[96:99], v[200:203]
    v_mul_f32 v180, s82, v180
    v_mul_f32 v181, s82, v181
    v_mul_f32 v182, s82, v182
    v_mul_f32 v183, s82, v183
    v_mfma_f32_16x16x32_bf16 v[200:203], v[84:87], v[100:103], v[200:203]
    v_cvt_pk_bf16_f32 v40, v176, v177
    v_cvt_pk_bf16_f32 v41, v178, v179
    v_cvt_pk_bf16_f32 v42, v180, v181
    v_cvt_pk_bf16_f32 v43, v182, v183
    v_mfma_f32_16x16x32_bf16 v[204:207], v[92:95], v[100:103], v[204:207]
    buffer_store_dwordx4 v[40:43], v14, s[44:47], s4 offen offset:1024 sc1
    v_mul_f32 v184, s82, v184
    v_mul_f32 v185, s82, v185
    v_mul_f32 v186, s82, v186
    v_mfma_f32_16x16x32_bf16 v[204:207], v[88:91], v[96:99], v[204:207]
    v_mul_f32 v187, s82, v187
    v_mul_f32 v188, s82, v188
    v_mul_f32 v189, s82, v189
    v_mul_f32 v190, s82, v190
    s_waitcnt lgkmcnt(5)
    v_mfma_f32_16x16x32_bf16 v[220:223], v[88:91], v[104:107], v[220:223]
    v_mul_f32 v191, s82, v191
    v_cvt_pk_bf16_f32 v44, v184, v185
    v_cvt_pk_bf16_f32 v45, v186, v187
    v_cvt_pk_bf16_f32 v46, v188, v189
    s_waitcnt lgkmcnt(4)
    v_mfma_f32_16x16x32_bf16 v[220:223], v[92:95], v[108:111], v[220:223]
    v_cvt_pk_bf16_f32 v47, v190, v191
    buffer_store_dwordx4 v[44:47], v15, s[44:47], s4 offen offset:1024 sc1
    v_mfma_f32_16x16x32_bf16 v[216:219], v[84:87], v[108:111], v[216:219]
    v_mfma_f32_16x16x32_bf16 v[216:219], v[80:83], v[104:107], v[216:219]
    s_add_u32 s4, s58, 2
    s_and_b32 s4, s4, 3
    s_add_u32 s4, s4, s84
    s_lshl_b32 s4, s4, 16
    v_mfma_f32_16x16x32_bf16 v[212:215], v[72:75], v[104:107], v[212:215]
    s_add_u32 s4, s4, s85
    v_mul_f32 v192, s82, v192
    v_mul_f32 v193, s82, v193
    v_mul_f32 v194, s82, v194
    v_mfma_f32_16x16x32_bf16 v[212:215], v[76:79], v[108:111], v[212:215]
    v_mul_f32 v195, s82, v195
    v_mul_f32 v196, s82, v196
    v_mul_f32 v197, s82, v197
    v_mul_f32 v198, s82, v198
    v_mfma_f32_16x16x32_bf16 v[208:211], v[68:71], v[108:111], v[208:211]
    v_mul_f32 v199, s82, v199
    v_cvt_pk_bf16_f32 v40, v192, v193
    v_cvt_pk_bf16_f32 v41, v194, v195
    v_cvt_pk_bf16_f32 v42, v196, v197
    v_mfma_f32_16x16x32_bf16 v[208:211], v[64:67], v[104:107], v[208:211]
    v_cvt_pk_bf16_f32 v43, v198, v199
    buffer_store_dwordx4 v[40:43], v14, s[44:47], s4 offen offset:0 sc1
    v_mul_f32 v200, s82, v200
    v_mul_f32 v201, s82, v201
    s_waitcnt lgkmcnt(3)
    v_mfma_f32_16x16x32_bf16 v[224:227], v[64:67], v[112:115], v[224:227]
    v_mul_f32 v202, s82, v202
    v_mul_f32 v203, s82, v203
    v_mul_f32 v204, s82, v204
    v_mul_f32 v205, s82, v205
    s_waitcnt lgkmcnt(2)
    v_mfma_f32_16x16x32_bf16 v[224:227], v[68:71], v[116:119], v[224:227]
    v_mul_f32 v206, s82, v206
    v_mul_f32 v207, s82, v207
    v_cvt_pk_bf16_f32 v44, v200, v201
    v_cvt_pk_bf16_f32 v45, v202, v203
    v_mfma_f32_16x16x32_bf16 v[228:231], v[76:79], v[116:119], v[228:231]
    v_cvt_pk_bf16_f32 v46, v204, v205
    v_cvt_pk_bf16_f32 v47, v206, v207
    buffer_store_dwordx4 v[44:47], v15, s[44:47], s4 offen offset:0 sc1
    v_mfma_f32_16x16x32_bf16 v[228:231], v[72:75], v[112:115], v[228:231]
    v_mul_f32 v208, s82, v208
    v_mul_f32 v209, s82, v209
    v_mul_f32 v210, s82, v210
    v_mul_f32 v211, s82, v211
    v_mfma_f32_16x16x32_bf16 v[232:235], v[80:83], v[112:115], v[232:235]
    v_mul_f32 v212, s82, v212
    v_mul_f32 v213, s82, v213
    v_mul_f32 v214, s82, v214
    v_mul_f32 v215, s82, v215
    v_mfma_f32_16x16x32_bf16 v[232:235], v[84:87], v[116:119], v[232:235]
    v_cvt_pk_bf16_f32 v40, v208, v209
    v_cvt_pk_bf16_f32 v41, v210, v211
    v_cvt_pk_bf16_f32 v42, v212, v213
    v_cvt_pk_bf16_f32 v43, v214, v215
    v_mfma_f32_16x16x32_bf16 v[236:239], v[92:95], v[116:119], v[236:239]
    buffer_store_dwordx4 v[40:43], v14, s[44:47], s4 offen offset:1024 sc1
    v_mul_f32 v216, s82, v216
    v_mul_f32 v217, s82, v217
    v_mul_f32 v218, s82, v218
    v_mfma_f32_16x16x32_bf16 v[236:239], v[88:91], v[112:115], v[236:239]
    v_mul_f32 v219, s82, v219
    v_mul_f32 v220, s82, v220
    v_mul_f32 v221, s82, v221
    v_mul_f32 v222, s82, v222
    s_waitcnt lgkmcnt(1)
    v_mfma_f32_16x16x32_bf16 v[252:255], v[88:91], v[120:123], v[252:255]
    v_mul_f32 v223, s82, v223
    v_cvt_pk_bf16_f32 v44, v216, v217
    v_cvt_pk_bf16_f32 v45, v218, v219
    v_cvt_pk_bf16_f32 v46, v220, v221
    s_waitcnt lgkmcnt(0)
    v_mfma_f32_16x16x32_bf16 v[252:255], v[92:95], v[124:127], v[252:255]
    v_cvt_pk_bf16_f32 v47, v222, v223
    buffer_store_dwordx4 v[44:47], v15, s[44:47], s4 offen offset:1024 sc1
    v_mfma_f32_16x16x32_bf16 v[248:251], v[84:87], v[124:127], v[248:251]
    v_mfma_f32_16x16x32_bf16 v[248:251], v[80:83], v[120:123], v[248:251]
    s_add_u32 s4, s58, 3
    s_and_b32 s4, s4, 3
    s_add_u32 s4, s4, s84
    s_lshl_b32 s4, s4, 16
    s_add_u32 s4, s4, s85
    v_mul_f32 v224, s82, v224
    v_mul_f32 v225, s82, v225
    v_mfma_f32_16x16x32_bf16 v[244:247], v[72:75], v[120:123], v[244:247]
    v_mul_f32 v226, s82, v226
    v_mul_f32 v227, s82, v227
    v_mul_f32 v228, s82, v228
    v_mul_f32 v229, s82, v229
    v_mul_f32 v230, s82, v230
    v_mul_f32 v231, s82, v231
    v_cvt_pk_bf16_f32 v40, v224, v225
    v_mfma_f32_16x16x32_bf16 v[244:247], v[76:79], v[124:127], v[244:247]
    v_cvt_pk_bf16_f32 v41, v226, v227
    v_cvt_pk_bf16_f32 v42, v228, v229
    v_cvt_pk_bf16_f32 v43, v230, v231
    buffer_store_dwordx4 v[40:43], v14, s[44:47], s4 offen offset:0 sc1
    v_mul_f32 v232, s82, v232
    v_mul_f32 v233, s82, v233
    v_mul_f32 v234, s82, v234
    v_mfma_f32_16x16x32_bf16 v[240:243], v[68:71], v[124:127], v[240:243]
    v_mul_f32 v235, s82, v235
    v_mul_f32 v236, s82, v236
    v_mul_f32 v237, s82, v237
    v_mul_f32 v238, s82, v238
    v_mul_f32 v239, s82, v239
    v_cvt_pk_bf16_f32 v44, v232, v233
    v_cvt_pk_bf16_f32 v45, v234, v235
    v_mfma_f32_16x16x32_bf16 v[240:243], v[64:67], v[120:123], v[240:243]
    v_cvt_pk_bf16_f32 v46, v236, v237
    v_cvt_pk_bf16_f32 v47, v238, v239
    buffer_store_dwordx4 v[44:47], v15, s[44:47], s4 offen offset:0 sc1
    s_nop 7
    v_pk_mul_f32 v[240:241], v[240:241], s[82:83]
    v_pk_mul_f32 v[242:243], v[242:243], s[82:83]
    v_pk_mul_f32 v[244:245], v[244:245], s[82:83]
    v_pk_mul_f32 v[246:247], v[246:247], s[82:83]
    v_cvt_pk_bf16_f32 v40, v240, v241
    v_cvt_pk_bf16_f32 v41, v242, v243
    v_cvt_pk_bf16_f32 v42, v244, v245
    v_cvt_pk_bf16_f32 v43, v246, v247
    buffer_store_dwordx4 v[40:43], v14, s[44:47], s4 offen offset:1024 sc1
    v_pk_mul_f32 v[248:249], v[248:249], s[82:83]
    v_pk_mul_f32 v[250:251], v[250:251], s[82:83]
    v_pk_mul_f32 v[252:253], v[252:253], s[82:83]
    v_pk_mul_f32 v[254:255], v[254:255], s[82:83]
    v_cvt_pk_bf16_f32 v44, v248, v249
    v_cvt_pk_bf16_f32 v45, v250, v251
    v_cvt_pk_bf16_f32 v46, v252, v253
    v_cvt_pk_bf16_f32 v47, v254, v255
    buffer_store_dwordx4 v[44:47], v15, s[44:47], s4 offen offset:1024 sc1
    s_cmp_ge_u32 s3, 4
    s_cbranch_scc1 p1_fin
    v_lshlrev_b32 v56, 16, v10
    v_and_b32 v57, s80, v10
    v_lshlrev_b32 v10, 16, v11
    v_and_b32 v11, s80, v11
    v_mul_f32 v56, v56, v10
    v_mul_f32 v57, v57, v11
    v_cvt_pk_bf16_f32 v57, v56, v57
    v_lshlrev_b32 v56, 16, v57
    v_and_b32 v57, s80, v57
    v_add_f32 v12, v12, v56
    v_add_f32 v13, v13, v57
    v_add_f32 v12, v12, v13
    s_nop 1
    v_add_f32_dpp v12, v12, v12 row_shr:1 row_mask:0xf bank_mask:0xf bound_ctrl:1
    s_nop 1
    v_add_f32_dpp v12, v12, v12 row_shr:2 row_mask:0xf bank_mask:0xf bound_ctrl:1
    s_nop 1
    v_add_f32_dpp v12, v12, v12 row_shr:4 row_mask:0xf bank_mask:0xf bound_ctrl:1
    s_nop 1
    v_add_f32_dpp v12, v12, v12 row_shr:8 row_mask:0xf bank_mask:0xf bound_ctrl:1
    s_nop 1
    v_add_f32_dpp v12, v12, v12 row_bcast:15 row_mask:0xa bank_mask:0xf
    v_cvt_pk_bf16_f32 v10, v12, v12
    v_lshlrev_b32 v10, 16, v10
    v_mul_f32 v10, 0xbfb8aa3b, v10
    v_exp_f32 v10, v10
    s_lshl_b32 s4, s56, 5
    v_add_f32 v10, 1.0, v10
    v_rcp_f32 v10, v10
    s_add_u32 s4, s4, s57
    v_cvt_pk_bf16_f32 v10, v10, v10
    v_lshlrev_b32 v10, 16, v10
    v_sub_f32 v11, 1.0, v10
    v_cvt_pk_bf16_f32 v11, v11, v11
    v_lshlrev_b32 v11, 16, v11
    v_lshrrev_b32 v12, 5, v0
    v_lshlrev_b32 v12, 3, v12
    s_lshl_b32 s4, s4, 2
    s_add_u32 s4, s4, s60
    s_lshl_b32 s4, s4, 4
    s_add_u32 s4, s4, 0x1480000
    s_mov_b32 exec_lo, 0x80000000
    s_mov_b32 exec_hi, 0x80000000
    buffer_store_dwordx2 v[10:11], v12, s[44:47], s4 offen sc1
    s_mov_b64 exec, -1
    s_branch p1_fin
p1_VL:
    s_mov_b32 m0, s72
    s_nop 0
    buffer_load_dwordx4 v12, s[20:23], s66 offen lds
    s_add_u32 m0, s72, 0x1000
    s_nop 0
    buffer_load_dwordx4 v12, s[24:27], s66 offen lds
    s_add_u32 s66, s66, 4096
    s_add_u32 m0, s71, 0x8000
    s_nop 0
    buffer_load_dwordx4 v8, s[12:15], s65 offen lds
    s_add_u32 m0, s71, 0xc000
    s_nop 0
    buffer_load_dwordx4 v8, s[16:19], s65 offen lds
    s_add_u32 m0, s71, 0x8400
    s_nop 0
    buffer_load_dwordx4 v9, s[12:15], s65 offen lds
    s_add_u32 m0, s71, 0xc400
    s_nop 0
    buffer_load_dwordx4 v9, s[16:19], s65 offen lds
    s_add_u32 m0, s71, 0x8800
    s_nop 0
    buffer_load_dwordx4 v10, s[12:15], s65 offen lds
    s_add_u32 m0, s71, 0xc800
    s_nop 0
    buffer_load_dwordx4 v10, s[16:19], s65 offen lds
    s_add_u32 m0, s71, 0x8c00
    s_nop 0
    buffer_load_dwordx4 v11, s[12:15], s65 offen lds
    s_add_u32 m0, s71, 0xcc00
    s_nop 0
    buffer_load_dwordx4 v11, s[16:19], s65 offen lds
    s_add_u32 s65, s65, s67
    s_waitcnt vmcnt(8)
    s_barrier
    s_add_u32 m0, s72, 0x2000
    s_nop 0
    buffer_load_dwordx4 v12, s[20:23], s66 offen lds
    s_add_u32 m0, s72, 0x3000
    s_nop 0
    buffer_load_dwordx4 v12, s[24:27], s66 offen lds
    s_add_u32 s66, s66, 4096
    s_add_u32 m0, s68, 0x8000
    s_nop 0
    buffer_load_dwordx4 v6, s[8:11], s61 offen lds
    s_add_u32 m0, s68, 0x8400
    s_nop 0
    buffer_load_dwordx4 v7, s[8:11], s61 offen lds
    s_add_u32 s61, s61, 128
    s_add_u32 m0, s68, 0x8800
    s_nop 0
    buffer_load_dwordx4 v6, s[8:11], s62 offen lds
    s_add_u32 m0, s68, 0x8c00
    s_nop 0
    buffer_load_dwordx4 v7, s[8:11], s62 offen lds
    s_add_u32 s62, s62, 128
    s_add_u32 m0, s68, 0x9000
    s_nop 0
    buffer_load_dwordx4 v6, s[8:11], s63 offen lds
    s_add_u32 m0, s68, 0x9400
    s_nop 0
    buffer_load_dwordx4 v7, s[8:11], s63 offen lds
    s_add_u32 s63, s63, 128
    s_add_u32 m0, s68, 0x9800
    s_nop 0
    buffer_load_dwordx4 v6, s[8:11], s64 offen lds
    s_add_u32 m0, s68, 0x9c00
    s_nop 0
    buffer_load_dwordx4 v7, s[8:11], s64 offen lds
    s_add_u32 s64, s64, 128
    ds_read_b128 v[96:99], v1 offset:0
    ds_read_b128 v[100:103], v2 offset:0
    ds_read_b64_tr_b16 v[32:33], v3 offset:0
    ds_read_b64_tr_b16 v[34:35], v3 offset:1024
    ds_read_b64_tr_b16 v[36:37], v3 offset:8192
    ds_read_b64_tr_b16 v[38:39], v3 offset:9216
    ds_read_b64_tr_b16 v[44:45], v4 offset:8192
    ds_read_b64_tr_b16 v[46:47], v4 offset:9216
    ds_read_b128 v[104:107], v1 offset:2048
    ds_read_b64_tr_b16 v[16:17], v5 offset:0
    ds_read_b128 v[108:111], v2 offset:2048
    ds_read_b64_tr_b16 v[18:19], v5 offset:256
    ds_read_b64_tr_b16 v[40:41], v4 offset:0
    ds_read_b64_tr_b16 v[42:43], v4 offset:1024
    ds_read_b64_tr_b16 v[48:49], v3 offset:16384
    ds_read_b64_tr_b16 v[50:51], v3 offset:17408
    ds_read_b64_tr_b16 v[52:53], v3 offset:24576
    ds_read_b64_tr_b16 v[54:55], v3 offset:25600
    ds_read_b128 v[112:115], v1 offset:4096
    ds_read_b64_tr_b16 v[20:21], v5 offset:2048
    ds_read_b128 v[116:119], v2 offset:4096
    ds_read_b64_tr_b16 v[22:23], v5 offset:2304
    ds_read_b64_tr_b16 v[60:61], v4 offset:24576
    ds_read_b64_tr_b16 v[62:63], v4 offset:25600
    ds_read_b64_tr_b16 v[56:57], v4 offset:16384
    ds_read_b64_tr_b16 v[58:59], v4 offset:17408
    s_mov_b32 s75, 6
    s_waitcnt lgkmcnt(15)
    v_mfma_f32_16x16x32_bf16 v[128:131], v[32:35], v[96:99], 0
    ds_read_b128 v[120:123], v1 offset:6144
    v_mfma_f32_16x16x32_bf16 v[128:131], v[36:39], v[100:103], v[128:131]
    ds_read_b128 v[124:127], v2 offset:6144
    v_mfma_f32_16x16x32_bf16 v[132:135], v[44:47], v[100:103], 0
    s_waitcnt lgkmcnt(14)
    v_mfma_f32_16x16x32_bf16 v[132:135], v[40:43], v[96:99], v[132:135]
    s_waitcnt lgkmcnt(12)
    v_mfma_f32_16x16x32_bf16 v[136:139], v[48:51], v[96:99], 0
    s_waitcnt lgkmcnt(10)
    v_mfma_f32_16x16x32_bf16 v[136:139], v[52:55], v[100:103], v[136:139]
    s_waitcnt lgkmcnt(4)
    v_mfma_f32_16x16x32_bf16 v[140:143], v[60:63], v[100:103], 0
    s_waitcnt lgkmcnt(2)
    v_mfma_f32_16x16x32_bf16 v[140:143], v[56:59], v[96:99], v[140:143]
    v_mfma_f32_16x16x32_bf16 v[24:27], v[96:99], v[16:19], 0
    v_mfma_f32_16x16x32_bf16 v[24:27], v[100:103], v[20:23], v[24:27]
    v_mfma_f32_16x16x32_bf16 v[156:159], v[56:59], v[104:107], 0
    ds_read_b128 v[96:99], v1 offset:8192
    v_mfma_f32_16x16x32_bf16 v[156:159], v[60:63], v[108:111], v[156:159]
    ds_read_b128 v[100:103], v2 offset:8192
    v_mfma_f32_16x16x32_bf16 v[152:155], v[52:55], v[108:111], 0
    v_mfma_f32_16x16x32_bf16 v[152:155], v[48:51], v[104:107], v[152:155]
    v_mfma_f32_16x16x32_bf16 v[148:151], v[40:43], v[104:107], 0
    v_mfma_f32_16x16x32_bf16 v[148:151], v[44:47], v[108:111], v[148:151]
    v_mfma_f32_16x16x32_bf16 v[144:147], v[36:39], v[108:111], 0
    v_mfma_f32_16x16x32_bf16 v[144:147], v[32:35], v[104:107], v[144:147]
    v_mfma_f32_16x16x32_bf16 v[28:31], v[104:107], v[16:19], 0
    v_mfma_f32_16x16x32_bf16 v[28:31], v[108:111], v[20:23], v[28:31]
    v_mfma_f32_16x16x32_bf16 v[160:163], v[32:35], v[112:115], 0
    ds_read_b128 v[104:107], v1 offset:10240
    v_mfma_f32_16x16x32_bf16 v[160:163], v[36:39], v[116:119], v[160:163]
    ds_read_b128 v[108:111], v2 offset:10240
    v_mfma_f32_16x16x32_bf16 v[164:167], v[44:47], v[116:119], 0
    v_mfma_f32_16x16x32_bf16 v[164:167], v[40:43], v[112:115], v[164:167]
    v_mfma_f32_16x16x32_bf16 v[168:171], v[48:51], v[112:115], 0
    v_mfma_f32_16x16x32_bf16 v[168:171], v[52:55], v[116:119], v[168:171]
    v_mfma_f32_16x16x32_bf16 v[172:175], v[60:63], v[116:119], 0
    v_mfma_f32_16x16x32_bf16 v[172:175], v[56:59], v[112:115], v[172:175]
    s_waitcnt lgkmcnt(5)
    v_mfma_f32_16x16x32_bf16 v[188:191], v[56:59], v[120:123], 0
    ds_read_b128 v[112:115], v1 offset:12288
    s_waitcnt lgkmcnt(5)
    v_mfma_f32_16x16x32_bf16 v[188:191], v[60:63], v[124:127], v[188:191]
    ds_read_b128 v[116:119], v2 offset:12288
    v_mfma_f32_16x16x32_bf16 v[184:187], v[52:55], v[124:127], 0
    v_mfma_f32_16x16x32_bf16 v[184:187], v[48:51], v[120:123], v[184:187]
    v_mfma_f32_16x16x32_bf16 v[180:183], v[40:43], v[120:123], 0
    v_mfma_f32_16x16x32_bf16 v[180:183], v[44:47], v[124:127], v[180:183]
    v_mfma_f32_16x16x32_bf16 v[176:179], v[36:39], v[124:127], 0
    v_mfma_f32_16x16x32_bf16 v[176:179], v[32:35], v[120:123], v[176:179]
    s_waitcnt lgkmcnt(5)
    v_mfma_f32_16x16x32_bf16 v[192:195], v[32:35], v[96:99], 0
    ds_read_b128 v[120:123], v1 offset:14336
    s_waitcnt lgkmcnt(5)
    v_mfma_f32_16x16x32_bf16 v[192:195], v[36:39], v[100:103], v[192:195]
    ds_read_b128 v[124:127], v2 offset:14336
    v_mfma_f32_16x16x32_bf16 v[196:199], v[44:47], v[100:103], 0
    v_mfma_f32_16x16x32_bf16 v[196:199], v[40:43], v[96:99], v[196:199]
    v_mfma_f32_16x16x32_bf16 v[200:203], v[48:51], v[96:99], 0
    v_mfma_f32_16x16x32_bf16 v[200:203], v[52:55], v[100:103], v[200:203]
    v_mfma_f32_16x16x32_bf16 v[204:207], v[60:63], v[100:103], 0
    v_mfma_f32_16x16x32_bf16 v[204:207], v[56:59], v[96:99], v[204:207]
    s_waitcnt vmcnt(0) lgkmcnt(0)
    s_barrier
    s_mov_b32 m0, s72
    s_nop 0
    buffer_load_dwordx4 v12, s[20:23], s66 offen lds
    s_add_u32 m0, s72, 0x1000
    s_nop 0
    buffer_load_dwordx4 v12, s[24:27], s66 offen lds
    s_add_u32 s66, s66, 4096
    s_mov_b32 m0, s71
    s_nop 0
    buffer_load_dwordx4 v8, s[12:15], s65 offen lds
    s_add_u32 m0, s71, 0x4000
    s_nop 0
    buffer_load_dwordx4 v8, s[16:19], s65 offen lds
    s_add_u32 m0, s71, 0x400
    s_nop 0
    buffer_load_dwordx4 v9, s[12:15], s65 offen lds
    s_add_u32 m0, s71, 0x4400
    s_nop 0
    buffer_load_dwordx4 v9, s[16:19], s65 offen lds
    s_add_u32 m0, s71, 0x800
    s_nop 0
    buffer_load_dwordx4 v10, s[12:15], s65 offen lds
    s_add_u32 m0, s71, 0x4800
    s_nop 0
    buffer_load_dwordx4 v10, s[16:19], s65 offen lds
    s_add_u32 m0, s71, 0xc00
    s_nop 0
    buffer_load_dwordx4 v11, s[12:15], s65 offen lds
    s_add_u32 m0, s71, 0x4c00
    s_nop 0
    buffer_load_dwordx4 v11, s[16:19], s65 offen lds
    s_add_u32 s65, s65, s67
    s_mov_b32 m0, s68
    s_nop 0
    buffer_load_dwordx4 v6, s[8:11], s61 offen lds
    s_add_u32 m0, s68, 0x400
    s_nop 0
    buffer_load_dwordx4 v7, s[8:11], s61 offen lds
    s_add_u32 s61, s61, 128
    s_add_u32 m0, s68, 0x800
    s_nop 0
    buffer_load_dwordx4 v6, s[8:11], s62 offen lds
    s_add_u32 m0, s68, 0xc00
    s_nop 0
    buffer_load_dwordx4 v7, s[8:11], s62 offen lds
    s_add_u32 s62, s62, 128
    v_mfma_f32_16x16x32_bf16 v[220:223], v[56:59], v[104:107], 0
    ds_read_b128 v[96:99], v1 offset:32768
    v_mfma_f32_16x16x32_bf16 v[220:223], v[60:63], v[108:111], v[220:223]
    ds_read_b128 v[100:103], v2 offset:32768
    v_mfma_f32_16x16x32_bf16 v[216:219], v[52:55], v[108:111], 0
    ds_read_b64_tr_b16 v[64:65], v3 offset:32768
    v_mfma_f32_16x16x32_bf16 v[216:219], v[48:51], v[104:107], v[216:219]
    ds_read_b64_tr_b16 v[66:67], v3 offset:33792
    v_mfma_f32_16x16x32_bf16 v[212:215], v[40:43], v[104:107], 0
    ds_read_b64_tr_b16 v[68:69], v3 offset:40960
    v_mfma_f32_16x16x32_bf16 v[212:215], v[44:47], v[108:111], v[212:215]
    ds_read_b64_tr_b16 v[70:71], v3 offset:41984
    v_mfma_f32_16x16x32_bf16 v[208:211], v[36:39], v[108:111], 0
    ds_read_b64_tr_b16 v[76:77], v4 offset:40960
    v_mfma_f32_16x16x32_bf16 v[208:211], v[32:35], v[104:107], v[208:211]
    ds_read_b64_tr_b16 v[78:79], v4 offset:41984
    v_mfma_f32_16x16x32_bf16 v[224:227], v[32:35], v[112:115], 0
    ds_read_b128 v[104:107], v1 offset:34816
    ds_read_b64_tr_b16 v[16:17], v5 offset:8192
    v_mfma_f32_16x16x32_bf16 v[224:227], v[36:39], v[116:119], v[224:227]
    ds_read_b128 v[108:111], v2 offset:34816
    ds_read_b64_tr_b16 v[18:19], v5 offset:8448
    v_mfma_f32_16x16x32_bf16 v[228:231], v[44:47], v[116:119], 0
    ds_read_b64_tr_b16 v[72:73], v4 offset:32768
    v_mfma_f32_16x16x32_bf16 v[228:231], v[40:43], v[112:115], v[228:231]
    ds_read_b64_tr_b16 v[74:75], v4 offset:33792
    v_mfma_f32_16x16x32_bf16 v[232:235], v[48:51], v[112:115], 0
    ds_read_b64_tr_b16 v[80:81], v3 offset:49152
    v_mfma_f32_16x16x32_bf16 v[232:235], v[52:55], v[116:119], v[232:235]
    ds_read_b64_tr_b16 v[82:83], v3 offset:50176
    v_mfma_f32_16x16x32_bf16 v[236:239], v[60:63], v[116:119], 0
    ds_read_b64_tr_b16 v[84:85], v3 offset:57344
    v_mfma_f32_16x16x32_bf16 v[236:239], v[56:59], v[112:115], v[236:239]
    ds_read_b64_tr_b16 v[86:87], v3 offset:58368
    v_mfma_f32_16x16x32_bf16 v[252:255], v[56:59], v[120:123], 0
    ds_read_b128 v[112:115], v1 offset:36864
    ds_read_b64_tr_b16 v[20:21], v5 offset:10240
    v_mfma_f32_16x16x32_bf16 v[252:255], v[60:63], v[124:127], v[252:255]
    ds_read_b128 v[116:119], v2 offset:36864
    ds_read_b64_tr_b16 v[22:23], v5 offset:10496
    v_mfma_f32_16x16x32_bf16 v[248:251], v[52:55], v[124:127], 0
    ds_read_b64_tr_b16 v[92:93], v4 offset:57344
    v_mfma_f32_16x16x32_bf16 v[248:251], v[48:51], v[120:123], v[248:251]
    ds_read_b64_tr_b16 v[94:95], v4 offset:58368
    v_mfma_f32_16x16x32_bf16 v[244:247], v[40:43], v[120:123], 0
    ds_read_b64_tr_b16 v[88:89], v4 offset:49152
    v_mfma_f32_16x16x32_bf16 v[244:247], v[44:47], v[124:127], v[244:247]
    ds_read_b64_tr_b16 v[90:91], v4 offset:50176
    v_mfma_f32_16x16x32_bf16 v[240:243], v[36:39], v[124:127], 0
    v_mfma_f32_16x16x32_bf16 v[240:243], v[32:35], v[120:123], v[240:243]
.p2align 6
p1_VL_loop:
    s_waitcnt lgkmcnt(15)
    v_mfma_f32_16x16x32_bf16 v[128:131], v[64:67], v[96:99], v[128:131]
    ds_read_b128 v[120:123], v1 offset:38912
    v_mfma_f32_16x16x32_bf16 v[128:131], v[68:71], v[100:103], v[128:131]
    ds_read_b128 v[124:127], v2 offset:38912
    v_mfma_f32_16x16x32_bf16 v[132:135], v[76:79], v[100:103], v[132:135]
    s_waitcnt lgkmcnt(14)
    v_mfma_f32_16x16x32_bf16 v[132:135], v[72:75], v[96:99], v[132:135]
    s_waitcnt lgkmcnt(12)
    v_mfma_f32_16x16x32_bf16 v[136:139], v[80:83], v[96:99], v[136:139]
    s_waitcnt lgkmcnt(10)
    v_mfma_f32_16x16x32_bf16 v[136:139], v[84:87], v[100:103], v[136:139]
    s_waitcnt lgkmcnt(4)
    v_mfma_f32_16x16x32_bf16 v[140:143], v[92:95], v[100:103], v[140:143]
    s_waitcnt lgkmcnt(2)
    v_mfma_f32_16x16x32_bf16 v[140:143], v[88:91], v[96:99], v[140:143]
    v_mfma_f32_16x16x32_bf16 v[24:27], v[96:99], v[16:19], v[24:27]
    v_mfma_f32_16x16x32_bf16 v[24:27], v[100:103], v[20:23], v[24:27]
    v_mfma_f32_16x16x32_bf16 v[156:159], v[88:91], v[104:107], v[156:159]
    ds_read_b128 v[96:99], v1 offset:40960
    v_mfma_f32_16x16x32_bf16 v[156:159], v[92:95], v[108:111], v[156:159]
    ds_read_b128 v[100:103], v2 offset:40960
    v_mfma_f32_16x16x32_bf16 v[152:155], v[84:87], v[108:111], v[152:155]
    v_mfma_f32_16x16x32_bf16 v[152:155], v[80:83], v[104:107], v[152:155]
    v_mfma_f32_16x16x32_bf16 v[148:151], v[72:75], v[104:107], v[148:151]
    v_mfma_f32_16x16x32_bf16 v[148:151], v[76:79], v[108:111], v[148:151]
    v_mfma_f32_16x16x32_bf16 v[144:147], v[68:71], v[108:111], v[144:147]
    v_mfma_f32_16x16x32_bf16 v[144:147], v[64:67], v[104:107], v[144:147]
    v_mfma_f32_16x16x32_bf16 v[28:31], v[104:107], v[16:19], v[28:31]
    v_mfma_f32_16x16x32_bf16 v[28:31], v[108:111], v[20:23], v[28:31]
    v_mfma_f32_16x16x32_bf16 v[160:163], v[64:67], v[112:115], v[160:163]
    ds_read_b128 v[104:107], v1 offset:43008
    v_mfma_f32_16x16x32_bf16 v[160:163], v[68:71], v[116:119], v[160:163]
    ds_read_b128 v[108:111], v2 offset:43008
    v_mfma_f32_16x16x32_bf16 v[164:167], v[76:79], v[116:119], v[164:167]
    v_mfma_f32_16x16x32_bf16 v[164:167], v[72:75], v[112:115], v[164:167]
    v_mfma_f32_16x16x32_bf16 v[168:171], v[80:83], v[112:115], v[168:171]
    v_mfma_f32_16x16x32_bf16 v[168:171], v[84:87], v[116:119], v[168:171]
    v_mfma_f32_16x16x32_bf16 v[172:175], v[92:95], v[116:119], v[172:175]
    v_mfma_f32_16x16x32_bf16 v[172:175], v[88:91], v[112:115], v[172:175]
    s_waitcnt lgkmcnt(5)
    v_mfma_f32_16x16x32_bf16 v[188:191], v[88:91], v[120:123], v[188:191]
    ds_read_b128 v[112:115], v1 offset:45056
    s_waitcnt lgkmcnt(5)
    v_mfma_f32_16x16x32_bf16 v[188:191], v[92:95], v[124:127], v[188:191]
    ds_read_b128 v[116:119], v2 offset:45056
    v_mfma_f32_16x16x32_bf16 v[184:187], v[84:87], v[124:127], v[184:187]
    v_mfma_f32_16x16x32_bf16 v[184:187], v[80:83], v[120:123], v[184:187]
    v_mfma_f32_16x16x32_bf16 v[180:183], v[72:75], v[120:123], v[180:183]
    v_mfma_f32_16x16x32_bf16 v[180:183], v[76:79], v[124:127], v[180:183]
    v_mfma_f32_16x16x32_bf16 v[176:179], v[68:71], v[124:127], v[176:179]
    v_mfma_f32_16x16x32_bf16 v[176:179], v[64:67], v[120:123], v[176:179]
    s_waitcnt lgkmcnt(5)
    v_mfma_f32_16x16x32_bf16 v[192:195], v[64:67], v[96:99], v[192:195]
    ds_read_b128 v[120:123], v1 offset:47104
    s_waitcnt lgkmcnt(5)
    v_mfma_f32_16x16x32_bf16 v[192:195], v[68:71], v[100:103], v[192:195]
    ds_read_b128 v[124:127], v2 offset:47104
    v_mfma_f32_16x16x32_bf16 v[196:199], v[76:79], v[100:103], v[196:199]
    v_mfma_f32_16x16x32_bf16 v[196:199], v[72:75], v[96:99], v[196:199]
    v_mfma_f32_16x16x32_bf16 v[200:203], v[80:83], v[96:99], v[200:203]
    v_mfma_f32_16x16x32_bf16 v[200:203], v[84:87], v[100:103], v[200:203]
    v_mfma_f32_16x16x32_bf16 v[204:207], v[92:95], v[100:103], v[204:207]
    v_mfma_f32_16x16x32_bf16 v[204:207], v[88:91], v[96:99], v[204:207]
    s_waitcnt vmcnt(0) lgkmcnt(0)
    s_barrier
    s_add_u32 m0, s72, 0x2000
    s_nop 0
    buffer_load_dwordx4 v12, s[20:23], s66 offen lds
    s_add_u32 m0, s72, 0x3000
    s_nop 0
    buffer_load_dwordx4 v12, s[24:27], s66 offen lds
    s_add_u32 s66, s66, 4096
    s_add_u32 m0, s71, 0x8000
    s_nop 0
    buffer_load_dwordx4 v8, s[12:15], s65 offen lds
    s_add_u32 m0, s71, 0xc000
    s_nop 0
    buffer_load_dwordx4 v8, s[16:19], s65 offen lds
    s_add_u32 m0, s71, 0x8400
    s_nop 0
    buffer_load_dwordx4 v9, s[12:15], s65 offen lds
    s_add_u32 m0, s71, 0xc400
    s_nop 0
    buffer_load_dwordx4 v9, s[16:19], s65 offen lds
    s_add_u32 m0, s71, 0x8800
    s_nop 0
    buffer_load_dwordx4 v10, s[12:15], s65 offen lds
    s_add_u32 m0, s71, 0xc800
    s_nop 0
    buffer_load_dwordx4 v10, s[16:19], s65 offen lds
    s_add_u32 m0, s71, 0x8c00
    s_nop 0
    buffer_load_dwordx4 v11, s[12:15], s65 offen lds
    s_add_u32 m0, s71, 0xcc00
    s_nop 0
    buffer_load_dwordx4 v11, s[16:19], s65 offen lds
    s_add_u32 s65, s65, s67
    s_add_u32 m0, s68, 0x8000
    s_nop 0
    buffer_load_dwordx4 v6, s[8:11], s61 offen lds
    s_add_u32 m0, s68, 0x8400
    s_nop 0
    buffer_load_dwordx4 v7, s[8:11], s61 offen lds
    s_add_u32 s61, s61, 128
    s_add_u32 m0, s68, 0x8800
    s_nop 0
    buffer_load_dwordx4 v6, s[8:11], s62 offen lds
    s_add_u32 m0, s68, 0x8c00
    s_nop 0
    buffer_load_dwordx4 v7, s[8:11], s62 offen lds
    s_add_u32 s62, s62, 128
    v_mfma_f32_16x16x32_bf16 v[220:223], v[88:91], v[104:107], v[220:223]
    ds_read_b128 v[96:99], v1 offset:0
    v_mfma_f32_16x16x32_bf16 v[220:223], v[92:95], v[108:111], v[220:223]
    ds_read_b128 v[100:103], v2 offset:0
    v_mfma_f32_16x16x32_bf16 v[216:219], v[84:87], v[108:111], v[216:219]
    ds_read_b64_tr_b16 v[32:33], v3 offset:0
    v_mfma_f32_16x16x32_bf16 v[216:219], v[80:83], v[104:107], v[216:219]
    ds_read_b64_tr_b16 v[34:35], v3 offset:1024
    v_mfma_f32_16x16x32_bf16 v[212:215], v[72:75], v[104:107], v[212:215]
    ds_read_b64_tr_b16 v[36:37], v3 offset:8192
    v_mfma_f32_16x16x32_bf16 v[212:215], v[76:79], v[108:111], v[212:215]
    ds_read_b64_tr_b16 v[38:39], v3 offset:9216
    v_mfma_f32_16x16x32_bf16 v[208:211], v[68:71], v[108:111], v[208:211]
    ds_read_b64_tr_b16 v[44:45], v4 offset:8192
    v_mfma_f32_16x16x32_bf16 v[208:211], v[64:67], v[104:107], v[208:211]
    ds_read_b64_tr_b16 v[46:47], v4 offset:9216
    v_mfma_f32_16x16x32_bf16 v[224:227], v[64:67], v[112:115], v[224:227]
    ds_read_b128 v[104:107], v1 offset:2048
    ds_read_b64_tr_b16 v[16:17], v5 offset:0
    v_mfma_f32_16x16x32_bf16 v[224:227], v[68:71], v[116:119], v[224:227]
    ds_read_b128 v[108:111], v2 offset:2048
    ds_read_b64_tr_b16 v[18:19], v5 offset:256
    v_mfma_f32_16x16x32_bf16 v[228:231], v[76:79], v[116:119], v[228:231]
    ds_read_b64_tr_b16 v[40:41], v4 offset:0
    v_mfma_f32_16x16x32_bf16 v[228:231], v[72:75], v[112:115], v[228:231]
    ds_read_b64_tr_b16 v[42:43], v4 offset:1024
    v_mfma_f32_16x16x32_bf16 v[232:235], v[80:83], v[112:115], v[232:235]
    ds_read_b64_tr_b16 v[48:49], v3 offset:16384
    v_mfma_f32_16x16x32_bf16 v[232:235], v[84:87], v[116:119], v[232:235]
    ds_read_b64_tr_b16 v[50:51], v3 offset:17408
    v_mfma_f32_16x16x32_bf16 v[236:239], v[92:95], v[116:119], v[236:239]
    ds_read_b64_tr_b16 v[52:53], v3 offset:24576
    v_mfma_f32_16x16x32_bf16 v[236:239], v[88:91], v[112:115], v[236:239]
    ds_read_b64_tr_b16 v[54:55], v3 offset:25600
    v_mfma_f32_16x16x32_bf16 v[252:255], v[88:91], v[120:123], v[252:255]
    ds_read_b128 v[112:115], v1 offset:4096
    ds_read_b64_tr_b16 v[20:21], v5 offset:2048
    v_mfma_f32_16x16x32_bf16 v[252:255], v[92:95], v[124:127], v[252:255]
    ds_read_b128 v[116:119], v2 offset:4096
    ds_read_b64_tr_b16 v[22:23], v5 offset:2304
    v_mfma_f32_16x16x32_bf16 v[248:251], v[84:87], v[124:127], v[248:251]
    ds_read_b64_tr_b16 v[60:61], v4 offset:24576
    v_mfma_f32_16x16x32_bf16 v[248:251], v[80:83], v[120:123], v[248:251]
    ds_read_b64_tr_b16 v[62:63], v4 offset:25600
    v_mfma_f32_16x16x32_bf16 v[244:247], v[72:75], v[120:123], v[244:247]
    ds_read_b64_tr_b16 v[56:57], v4 offset:16384
    v_mfma_f32_16x16x32_bf16 v[244:247], v[76:79], v[124:127], v[244:247]
    ds_read_b64_tr_b16 v[58:59], v4 offset:17408
    v_mfma_f32_16x16x32_bf16 v[240:243], v[68:71], v[124:127], v[240:243]
    v_mfma_f32_16x16x32_bf16 v[240:243], v[64:67], v[120:123], v[240:243]
    s_cmp_eq_u32 s75, 0
    s_cbranch_scc1 p1_VL_tail
    s_waitcnt lgkmcnt(15)
    v_mfma_f32_16x16x32_bf16 v[128:131], v[32:35], v[96:99], v[128:131]
    ds_read_b128 v[120:123], v1 offset:6144
    v_mfma_f32_16x16x32_bf16 v[128:131], v[36:39], v[100:103], v[128:131]
    ds_read_b128 v[124:127], v2 offset:6144
    v_mfma_f32_16x16x32_bf16 v[132:135], v[44:47], v[100:103], v[132:135]
    s_waitcnt lgkmcnt(14)
    v_mfma_f32_16x16x32_bf16 v[132:135], v[40:43], v[96:99], v[132:135]
    s_waitcnt lgkmcnt(12)
    v_mfma_f32_16x16x32_bf16 v[136:139], v[48:51], v[96:99], v[136:139]
    s_waitcnt lgkmcnt(10)
    v_mfma_f32_16x16x32_bf16 v[136:139], v[52:55], v[100:103], v[136:139]
    s_waitcnt lgkmcnt(4)
    v_mfma_f32_16x16x32_bf16 v[140:143], v[60:63], v[100:103], v[140:143]
    s_waitcnt lgkmcnt(2)
    v_mfma_f32_16x16x32_bf16 v[140:143], v[56:59], v[96:99], v[140:143]
    v_mfma_f32_16x16x32_bf16 v[24:27], v[96:99], v[16:19], v[24:27]
    v_mfma_f32_16x16x32_bf16 v[24:27], v[100:103], v[20:23], v[24:27]
    v_mfma_f32_16x16x32_bf16 v[156:159], v[56:59], v[104:107], v[156:159]
    ds_read_b128 v[96:99], v1 offset:8192
    v_mfma_f32_16x16x32_bf16 v[156:159], v[60:63], v[108:111], v[156:159]
    ds_read_b128 v[100:103], v2 offset:8192
    v_mfma_f32_16x16x32_bf16 v[152:155], v[52:55], v[108:111], v[152:155]
    v_mfma_f32_16x16x32_bf16 v[152:155], v[48:51], v[104:107], v[152:155]
    v_mfma_f32_16x16x32_bf16 v[148:151], v[40:43], v[104:107], v[148:151]
    v_mfma_f32_16x16x32_bf16 v[148:151], v[44:47], v[108:111], v[148:151]
    v_mfma_f32_16x16x32_bf16 v[144:147], v[36:39], v[108:111], v[144:147]
    v_mfma_f32_16x16x32_bf16 v[144:147], v[32:35], v[104:107], v[144:147]
    v_mfma_f32_16x16x32_bf16 v[28:31], v[104:107], v[16:19], v[28:31]
    v_mfma_f32_16x16x32_bf16 v[28:31], v[108:111], v[20:23], v[28:31]
    v_mfma_f32_16x16x32_bf16 v[160:163], v[32:35], v[112:115], v[160:163]
    ds_read_b128 v[104:107], v1 offset:10240
    v_mfma_f32_16x16x32_bf16 v[160:163], v[36:39], v[116:119], v[160:163]
    ds_read_b128 v[108:111], v2 offset:10240
    v_mfma_f32_16x16x32_bf16 v[164:167], v[44:47], v[116:119], v[164:167]
    v_mfma_f32_16x16x32_bf16 v[164:167], v[40:43], v[112:115], v[164:167]
    v_mfma_f32_16x16x32_bf16 v[168:171], v[48:51], v[112:115], v[168:171]
    v_mfma_f32_16x16x32_bf16 v[168:171], v[52:55], v[116:119], v[168:171]
    v_mfma_f32_16x16x32_bf16 v[172:175], v[60:63], v[116:119], v[172:175]
    v_mfma_f32_16x16x32_bf16 v[172:175], v[56:59], v[112:115], v[172:175]
    s_waitcnt lgkmcnt(5)
    v_mfma_f32_16x16x32_bf16 v[188:191], v[56:59], v[120:123], v[188:191]
    ds_read_b128 v[112:115], v1 offset:12288
    s_waitcnt lgkmcnt(5)
    v_mfma_f32_16x16x32_bf16 v[188:191], v[60:63], v[124:127], v[188:191]
    ds_read_b128 v[116:119], v2 offset:12288
    v_mfma_f32_16x16x32_bf16 v[184:187], v[52:55], v[124:127], v[184:187]
    v_mfma_f32_16x16x32_bf16 v[184:187], v[48:51], v[120:123], v[184:187]
    v_mfma_f32_16x16x32_bf16 v[180:183], v[40:43], v[120:123], v[180:183]
    v_mfma_f32_16x16x32_bf16 v[180:183], v[44:47], v[124:127], v[180:183]
    v_mfma_f32_16x16x32_bf16 v[176:179], v[36:39], v[124:127], v[176:179]
    v_mfma_f32_16x16x32_bf16 v[176:179], v[32:35], v[120:123], v[176:179]
    s_waitcnt lgkmcnt(5)
    v_mfma_f32_16x16x32_bf16 v[192:195], v[32:35], v[96:99], v[192:195]
    ds_read_b128 v[120:123], v1 offset:14336
    s_waitcnt lgkmcnt(5)
    v_mfma_f32_16x16x32_bf16 v[192:195], v[36:39], v[100:103], v[192:195]
    ds_read_b128 v[124:127], v2 offset:14336
    v_mfma_f32_16x16x32_bf16 v[196:199], v[44:47], v[100:103], v[196:199]
    v_mfma_f32_16x16x32_bf16 v[196:199], v[40:43], v[96:99], v[196:199]
    v_mfma_f32_16x16x32_bf16 v[200:203], v[48:51], v[96:99], v[200:203]
    v_mfma_f32_16x16x32_bf16 v[200:203], v[52:55], v[100:103], v[200:203]
    v_mfma_f32_16x16x32_bf16 v[204:207], v[60:63], v[100:103], v[204:207]
    v_mfma_f32_16x16x32_bf16 v[204:207], v[56:59], v[96:99], v[204:207]
    s_waitcnt vmcnt(0) lgkmcnt(0)
    s_barrier
    s_mov_b32 m0, s72
    s_nop 0
    buffer_load_dwordx4 v12, s[20:23], s66 offen lds
    s_add_u32 m0, s72, 0x1000
    s_nop 0
    buffer_load_dwordx4 v12, s[24:27], s66 offen lds
    s_add_u32 s66, s66, 4096
    s_mov_b32 m0, s71
    s_nop 0
    buffer_load_dwordx4 v8, s[12:15], s65 offen lds
    s_add_u32 m0, s71, 0x4000
    s_nop 0
    buffer_load_dwordx4 v8, s[16:19], s65 offen lds
    s_add_u32 m0, s71, 0x400
    s_nop 0
    buffer_load_dwordx4 v9, s[12:15], s65 offen lds
    s_add_u32 m0, s71, 0x4400
    s_nop 0
    buffer_load_dwordx4 v9, s[16:19], s65 offen lds
    s_add_u32 m0, s71, 0x800
    s_nop 0
    buffer_load_dwordx4 v10, s[12:15], s65 offen lds
    s_add_u32 m0, s71, 0x4800
    s_nop 0
    buffer_load_dwordx4 v10, s[16:19], s65 offen lds
    s_add_u32 m0, s71, 0xc00
    s_nop 0
    buffer_load_dwordx4 v11, s[12:15], s65 offen lds
    s_add_u32 m0, s71, 0x4c00
    s_nop 0
    buffer_load_dwordx4 v11, s[16:19], s65 offen lds
    s_add_u32 s65, s65, s67
    s_mov_b32 m0, s68
    s_nop 0
    buffer_load_dwordx4 v6, s[8:11], s61 offen lds
    s_add_u32 m0, s68, 0x400
    s_nop 0
    buffer_load_dwordx4 v7, s[8:11], s61 offen lds
    s_add_u32 s61, s61, 128
    s_add_u32 m0, s68, 0x800
    s_nop 0
    buffer_load_dwordx4 v6, s[8:11], s62 offen lds
    s_add_u32 m0, s68, 0xc00
    s_nop 0
    buffer_load_dwordx4 v7, s[8:11], s62 offen lds
    s_add_u32 s62, s62, 128
    v_mfma_f32_16x16x32_bf16 v[220:223], v[56:59], v[104:107], v[220:223]
    ds_read_b128 v[96:99], v1 offset:32768
    v_mfma_f32_16x16x32_bf16 v[220:223], v[60:63], v[108:111], v[220:223]
    ds_read_b128 v[100:103], v2 offset:32768
    v_mfma_f32_16x16x32_bf16 v[216:219], v[52:55], v[108:111], v[216:219]
    ds_read_b64_tr_b16 v[64:65], v3 offset:32768
    v_mfma_f32_16x16x32_bf16 v[216:219], v[48:51], v[104:107], v[216:219]
    ds_read_b64_tr_b16 v[66:67], v3 offset:33792
    v_mfma_f32_16x16x32_bf16 v[212:215], v[40:43], v[104:107], v[212:215]
    ds_read_b64_tr_b16 v[68:69], v3 offset:40960
    v_mfma_f32_16x16x32_bf16 v[212:215], v[44:47], v[108:111], v[212:215]
    ds_read_b64_tr_b16 v[70:71], v3 offset:41984
    v_mfma_f32_16x16x32_bf16 v[208:211], v[36:39], v[108:111], v[208:211]
    ds_read_b64_tr_b16 v[76:77], v4 offset:40960
    v_mfma_f32_16x16x32_bf16 v[208:211], v[32:35], v[104:107], v[208:211]
    ds_read_b64_tr_b16 v[78:79], v4 offset:41984
    v_mfma_f32_16x16x32_bf16 v[224:227], v[32:35], v[112:115], v[224:227]
    ds_read_b128 v[104:107], v1 offset:34816
    ds_read_b64_tr_b16 v[16:17], v5 offset:8192
    v_mfma_f32_16x16x32_bf16 v[224:227], v[36:39], v[116:119], v[224:227]
    ds_read_b128 v[108:111], v2 offset:34816
    ds_read_b64_tr_b16 v[18:19], v5 offset:8448
    v_mfma_f32_16x16x32_bf16 v[228:231], v[44:47], v[116:119], v[228:231]
    ds_read_b64_tr_b16 v[72:73], v4 offset:32768
    v_mfma_f32_16x16x32_bf16 v[228:231], v[40:43], v[112:115], v[228:231]
    ds_read_b64_tr_b16 v[74:75], v4 offset:33792
    v_mfma_f32_16x16x32_bf16 v[232:235], v[48:51], v[112:115], v[232:235]
    ds_read_b64_tr_b16 v[80:81], v3 offset:49152
    v_mfma_f32_16x16x32_bf16 v[232:235], v[52:55], v[116:119], v[232:235]
    ds_read_b64_tr_b16 v[82:83], v3 offset:50176
    v_mfma_f32_16x16x32_bf16 v[236:239], v[60:63], v[116:119], v[236:239]
    ds_read_b64_tr_b16 v[84:85], v3 offset:57344
    v_mfma_f32_16x16x32_bf16 v[236:239], v[56:59], v[112:115], v[236:239]
    ds_read_b64_tr_b16 v[86:87], v3 offset:58368
    v_mfma_f32_16x16x32_bf16 v[252:255], v[56:59], v[120:123], v[252:255]
    ds_read_b128 v[112:115], v1 offset:36864
    ds_read_b64_tr_b16 v[20:21], v5 offset:10240
    v_mfma_f32_16x16x32_bf16 v[252:255], v[60:63], v[124:127], v[252:255]
    ds_read_b128 v[116:119], v2 offset:36864
    ds_read_b64_tr_b16 v[22:23], v5 offset:10496
    v_mfma_f32_16x16x32_bf16 v[248:251], v[52:55], v[124:127], v[248:251]
    ds_read_b64_tr_b16 v[92:93], v4 offset:57344
    v_mfma_f32_16x16x32_bf16 v[248:251], v[48:51], v[120:123], v[248:251]
    ds_read_b64_tr_b16 v[94:95], v4 offset:58368
    v_mfma_f32_16x16x32_bf16 v[244:247], v[40:43], v[120:123], v[244:247]
    ds_read_b64_tr_b16 v[88:89], v4 offset:49152
    v_mfma_f32_16x16x32_bf16 v[244:247], v[44:47], v[124:127], v[244:247]
    ds_read_b64_tr_b16 v[90:91], v4 offset:50176
    v_mfma_f32_16x16x32_bf16 v[240:243], v[36:39], v[124:127], v[240:243]
    v_mfma_f32_16x16x32_bf16 v[240:243], v[32:35], v[120:123], v[240:243]
    s_sub_u32 s75, s75, 1
    s_branch p1_VL_loop
p1_VL_tail:
    s_waitcnt lgkmcnt(15)
    v_mfma_f32_16x16x32_bf16 v[128:131], v[32:35], v[96:99], v[128:131]
    ds_read_b128 v[120:123], v1 offset:6144
    v_mfma_f32_16x16x32_bf16 v[128:131], v[36:39], v[100:103], v[128:131]
    ds_read_b128 v[124:127], v2 offset:6144
    v_mfma_f32_16x16x32_bf16 v[132:135], v[44:47], v[100:103], v[132:135]
    s_waitcnt lgkmcnt(14)
    v_mfma_f32_16x16x32_bf16 v[132:135], v[40:43], v[96:99], v[132:135]
    s_waitcnt lgkmcnt(12)
    v_mfma_f32_16x16x32_bf16 v[136:139], v[48:51], v[96:99], v[136:139]
    s_waitcnt lgkmcnt(10)
    v_mfma_f32_16x16x32_bf16 v[136:139], v[52:55], v[100:103], v[136:139]
    s_waitcnt lgkmcnt(4)
    v_mfma_f32_16x16x32_bf16 v[140:143], v[60:63], v[100:103], v[140:143]
    s_waitcnt lgkmcnt(2)
    v_mfma_f32_16x16x32_bf16 v[140:143], v[56:59], v[96:99], v[140:143]
    v_mfma_f32_16x16x32_bf16 v[24:27], v[96:99], v[16:19], v[24:27]
    v_mfma_f32_16x16x32_bf16 v[24:27], v[100:103], v[20:23], v[24:27]
    v_mfma_f32_16x16x32_bf16 v[156:159], v[56:59], v[104:107], v[156:159]
    ds_read_b128 v[96:99], v1 offset:8192
    v_mfma_f32_16x16x32_bf16 v[156:159], v[60:63], v[108:111], v[156:159]
    ds_read_b128 v[100:103], v2 offset:8192
    v_mfma_f32_16x16x32_bf16 v[152:155], v[52:55], v[108:111], v[152:155]
    v_mfma_f32_16x16x32_bf16 v[152:155], v[48:51], v[104:107], v[152:155]
    v_mfma_f32_16x16x32_bf16 v[148:151], v[40:43], v[104:107], v[148:151]
    v_mfma_f32_16x16x32_bf16 v[148:151], v[44:47], v[108:111], v[148:151]
    v_mfma_f32_16x16x32_bf16 v[144:147], v[36:39], v[108:111], v[144:147]
    v_mfma_f32_16x16x32_bf16 v[144:147], v[32:35], v[104:107], v[144:147]
    v_mfma_f32_16x16x32_bf16 v[28:31], v[104:107], v[16:19], v[28:31]
    v_mfma_f32_16x16x32_bf16 v[28:31], v[108:111], v[20:23], v[28:31]
    v_mfma_f32_16x16x32_bf16 v[160:163], v[32:35], v[112:115], v[160:163]
    ds_read_b128 v[104:107], v1 offset:10240
    v_mfma_f32_16x16x32_bf16 v[160:163], v[36:39], v[116:119], v[160:163]
    ds_read_b128 v[108:111], v2 offset:10240
    v_mfma_f32_16x16x32_bf16 v[164:167], v[44:47], v[116:119], v[164:167]
    v_mfma_f32_16x16x32_bf16 v[164:167], v[40:43], v[112:115], v[164:167]
    v_mfma_f32_16x16x32_bf16 v[168:171], v[48:51], v[112:115], v[168:171]
    v_mfma_f32_16x16x32_bf16 v[168:171], v[52:55], v[116:119], v[168:171]
    v_mfma_f32_16x16x32_bf16 v[172:175], v[60:63], v[116:119], v[172:175]
    v_mfma_f32_16x16x32_bf16 v[172:175], v[56:59], v[112:115], v[172:175]
    s_waitcnt lgkmcnt(5)
    v_mfma_f32_16x16x32_bf16 v[188:191], v[56:59], v[120:123], v[188:191]
    ds_read_b128 v[112:115], v1 offset:12288
    s_waitcnt lgkmcnt(5)
    v_mfma_f32_16x16x32_bf16 v[188:191], v[60:63], v[124:127], v[188:191]
    ds_read_b128 v[116:119], v2 offset:12288
    v_mfma_f32_16x16x32_bf16 v[184:187], v[52:55], v[124:127], v[184:187]
    v_mfma_f32_16x16x32_bf16 v[184:187], v[48:51], v[120:123], v[184:187]
    v_mfma_f32_16x16x32_bf16 v[180:183], v[40:43], v[120:123], v[180:183]
    v_mfma_f32_16x16x32_bf16 v[180:183], v[44:47], v[124:127], v[180:183]
    v_mfma_f32_16x16x32_bf16 v[176:179], v[36:39], v[124:127], v[176:179]
    v_mfma_f32_16x16x32_bf16 v[176:179], v[32:35], v[120:123], v[176:179]
    s_waitcnt lgkmcnt(5)
    v_mfma_f32_16x16x32_bf16 v[192:195], v[32:35], v[96:99], v[192:195]
    ds_read_b128 v[120:123], v1 offset:14336
    s_waitcnt lgkmcnt(5)
    v_mfma_f32_16x16x32_bf16 v[192:195], v[36:39], v[100:103], v[192:195]
    ds_read_b128 v[124:127], v2 offset:14336
    v_mfma_f32_16x16x32_bf16 v[196:199], v[44:47], v[100:103], v[196:199]
    v_mfma_f32_16x16x32_bf16 v[196:199], v[40:43], v[96:99], v[196:199]
    v_mfma_f32_16x16x32_bf16 v[200:203], v[48:51], v[96:99], v[200:203]
    v_mfma_f32_16x16x32_bf16 v[200:203], v[52:55], v[100:103], v[200:203]
    v_mfma_f32_16x16x32_bf16 v[204:207], v[60:63], v[100:103], v[204:207]
    v_mfma_f32_16x16x32_bf16 v[204:207], v[56:59], v[96:99], v[204:207]
    s_waitcnt vmcnt(0) lgkmcnt(0)
    s_barrier
    s_load_dwordx2 s[20:21], s[0:1], 64
    s_load_dwordx2 s[24:25], s[0:1], 88
    s_mov_b32 s22, 0x700000
    s_mov_b32 s26, 256
    s_mov_b32 s27, 0x20000
    v_lshrrev_b32 v9, 3, v0
    v_bfe_u32 v10, v0, 1, 2
    v_lshrrev_b32 v11, 4, v0
    v_xor_b32 v10, v10, v11
    v_lshlrev_b32 v9, 11, v9
    v_lshl_add_u32 v9, v10, 5, v9
    v_and_b32 v10, 1, v0
    v_lshl_add_u32 v9, v10, 4, v9
    s_and_b32 s4, s2, 1
    s_lshl_b32 s4, s4, 3
    s_lshr_b32 s5, s2, 5
    s_add_u32 s4, s4, s5
    s_lshl_b32 s4, s4, 7
    s_lshl_b32 s5, s60, 14
    s_add_u32 s5, s5, s4
    v_add_u32 v6, s5, v9
    v_add_u32 v7, 0x10000, v6
    v_add_u32 v8, 0x20000, v6
    s_lshl_b32 s6, s60, 10
    s_add_u32 s6, s6, 0x14000
    v_lshlrev_b32 v9, 2, v0
    s_waitcnt lgkmcnt(0)
    buffer_load_dword v10, v9, s[24:27], 0 offen sc1
    s_mov_b32 m0, s6
    s_mov_b32 s7, 0x0
    buffer_load_dwordx4 v6, s[20:23], s7 offen lds
    s_add_u32 m0, s6, 4096
    s_mov_b32 s7, 0x0
    buffer_load_dwordx4 v7, s[20:23], s7 offen lds
    s_add_u32 m0, s6, 8192
    s_mov_b32 s7, 0x0
    buffer_load_dwordx4 v8, s[20:23], s7 offen lds
    s_add_u32 m0, s6, 12288
    s_mov_b32 s7, 0x30000
    buffer_load_dwordx4 v6, s[20:23], s7 offen lds
    s_add_u32 m0, s6, 16384
    s_mov_b32 s7, 0x30000
    buffer_load_dwordx4 v7, s[20:23], s7 offen lds
    s_add_u32 m0, s6, 20480
    s_mov_b32 s7, 0x30000
    buffer_load_dwordx4 v8, s[20:23], s7 offen lds
    s_add_u32 m0, s6, 24576
    s_mov_b32 s7, 0x60000
    buffer_load_dwordx4 v6, s[20:23], s7 offen lds
    s_add_u32 m0, s6, 28672
    s_mov_b32 s7, 0x60000
    buffer_load_dwordx4 v7, s[20:23], s7 offen lds
    s_add_u32 m0, s6, 32768
    s_mov_b32 s7, 0x60000
    buffer_load_dwordx4 v8, s[20:23], s7 offen lds
    s_add_u32 m0, s6, 36864
    s_mov_b32 s7, 0x90000
    buffer_load_dwordx4 v6, s[20:23], s7 offen lds
    v_mfma_f32_16x16x32_bf16 v[220:223], v[56:59], v[104:107], v[220:223]
    ds_read_b128 v[96:99], v1 offset:32768
    v_mfma_f32_16x16x32_bf16 v[220:223], v[60:63], v[108:111], v[220:223]
    ds_read_b128 v[100:103], v2 offset:32768
    v_mfma_f32_16x16x32_bf16 v[216:219], v[52:55], v[108:111], v[216:219]
    ds_read_b64_tr_b16 v[64:65], v3 offset:32768
    v_mfma_f32_16x16x32_bf16 v[216:219], v[48:51], v[104:107], v[216:219]
    ds_read_b64_tr_b16 v[66:67], v3 offset:33792
    v_mfma_f32_16x16x32_bf16 v[212:215], v[40:43], v[104:107], v[212:215]
    ds_read_b64_tr_b16 v[68:69], v3 offset:40960
    v_mfma_f32_16x16x32_bf16 v[212:215], v[44:47], v[108:111], v[212:215]
    ds_read_b64_tr_b16 v[70:71], v3 offset:41984
    v_mfma_f32_16x16x32_bf16 v[208:211], v[36:39], v[108:111], v[208:211]
    ds_read_b64_tr_b16 v[76:77], v4 offset:40960
    v_mfma_f32_16x16x32_bf16 v[208:211], v[32:35], v[104:107], v[208:211]
    ds_read_b64_tr_b16 v[78:79], v4 offset:41984
    v_mfma_f32_16x16x32_bf16 v[224:227], v[32:35], v[112:115], v[224:227]
    ds_read_b128 v[104:107], v1 offset:34816
    ds_read_b64_tr_b16 v[16:17], v5 offset:8192
    v_mfma_f32_16x16x32_bf16 v[224:227], v[36:39], v[116:119], v[224:227]
    ds_read_b128 v[108:111], v2 offset:34816
    ds_read_b64_tr_b16 v[18:19], v5 offset:8448
    v_mfma_f32_16x16x32_bf16 v[228:231], v[44:47], v[116:119], v[228:231]
    ds_read_b64_tr_b16 v[72:73], v4 offset:32768
    v_mfma_f32_16x16x32_bf16 v[228:231], v[40:43], v[112:115], v[228:231]
    ds_read_b64_tr_b16 v[74:75], v4 offset:33792
    v_mfma_f32_16x16x32_bf16 v[232:235], v[48:51], v[112:115], v[232:235]
    ds_read_b64_tr_b16 v[80:81], v3 offset:49152
    v_mfma_f32_16x16x32_bf16 v[232:235], v[52:55], v[116:119], v[232:235]
    ds_read_b64_tr_b16 v[82:83], v3 offset:50176
    v_mfma_f32_16x16x32_bf16 v[236:239], v[60:63], v[116:119], v[236:239]
    ds_read_b64_tr_b16 v[84:85], v3 offset:57344
    v_mfma_f32_16x16x32_bf16 v[236:239], v[56:59], v[112:115], v[236:239]
    ds_read_b64_tr_b16 v[86:87], v3 offset:58368
    v_mfma_f32_16x16x32_bf16 v[252:255], v[56:59], v[120:123], v[252:255]
    ds_read_b128 v[112:115], v1 offset:36864
    ds_read_b64_tr_b16 v[20:21], v5 offset:10240
    v_mfma_f32_16x16x32_bf16 v[252:255], v[60:63], v[124:127], v[252:255]
    ds_read_b128 v[116:119], v2 offset:36864
    ds_read_b64_tr_b16 v[22:23], v5 offset:10496
    v_mfma_f32_16x16x32_bf16 v[248:251], v[52:55], v[124:127], v[248:251]
    ds_read_b64_tr_b16 v[92:93], v4 offset:57344
    v_mfma_f32_16x16x32_bf16 v[248:251], v[48:51], v[120:123], v[248:251]
    ds_read_b64_tr_b16 v[94:95], v4 offset:58368
    v_mfma_f32_16x16x32_bf16 v[244:247], v[40:43], v[120:123], v[244:247]
    ds_read_b64_tr_b16 v[88:89], v4 offset:49152
    v_mfma_f32_16x16x32_bf16 v[244:247], v[44:47], v[124:127], v[244:247]
    ds_read_b64_tr_b16 v[90:91], v4 offset:50176
    v_mfma_f32_16x16x32_bf16 v[240:243], v[36:39], v[124:127], v[240:243]
    v_mfma_f32_16x16x32_bf16 v[240:243], v[32:35], v[120:123], v[240:243]
    s_waitcnt lgkmcnt(15)
    v_mfma_f32_16x16x32_bf16 v[128:131], v[64:67], v[96:99], v[128:131]
    ds_read_b128 v[120:123], v1 offset:38912
    v_lshlrev_b32 v14, 4, v0
    s_lshl_b32 s4, s56, 3
    s_lshl_b32 s5, s59, 2
    v_mfma_f32_16x16x32_bf16 v[128:131], v[68:71], v[100:103], v[128:131]
    ds_read_b128 v[124:127], v2 offset:38912
    s_add_u32 s84, s4, s5
    s_lshl_b32 s7, s58, 3
    s_add_u32 s7, s7, s60
    v_mfma_f32_16x16x32_bf16 v[132:135], v[76:79], v[100:103], v[132:135]
    s_lshl_b32 s7, s7, 11
    s_add_u32 s85, s7, 0x1000000
    s_mov_b32 s82, 0x3e8293ee
    s_waitcnt lgkmcnt(14)
    v_mfma_f32_16x16x32_bf16 v[132:135], v[72:75], v[96:99], v[132:135]
    s_mov_b32 s83, 0x3e8293ee
    v_add_u32 v15, 0x2000, v14
    s_waitcnt lgkmcnt(12)
    v_mfma_f32_16x16x32_bf16 v[136:139], v[80:83], v[96:99], v[136:139]
    s_waitcnt lgkmcnt(10)
    v_mfma_f32_16x16x32_bf16 v[136:139], v[84:87], v[100:103], v[136:139]
    s_waitcnt lgkmcnt(4)
    v_mfma_f32_16x16x32_bf16 v[140:143], v[92:95], v[100:103], v[140:143]
    s_waitcnt lgkmcnt(2)
    v_mfma_f32_16x16x32_bf16 v[140:143], v[88:91], v[96:99], v[140:143]
    v_mfma_f32_16x16x32_bf16 v[24:27], v[96:99], v[16:19], v[24:27]
    v_mfma_f32_16x16x32_bf16 v[24:27], v[100:103], v[20:23], v[24:27]
    v_mfma_f32_16x16x32_bf16 v[156:159], v[88:91], v[104:107], v[156:159]
    ds_read_b128 v[96:99], v1 offset:40960
    v_mfma_f32_16x16x32_bf16 v[156:159], v[92:95], v[108:111], v[156:159]
    ds_read_b128 v[100:103], v2 offset:40960
    v_mfma_f32_16x16x32_bf16 v[152:155], v[84:87], v[108:111], v[152:155]
    v_mfma_f32_16x16x32_bf16 v[152:155], v[80:83], v[104:107], v[152:155]
    v_mfma_f32_16x16x32_bf16 v[148:151], v[72:75], v[104:107], v[148:151]
    s_add_u32 s4, s58, 0
    s_and_b32 s4, s4, 3
    s_add_u32 s4, s4, s84
    s_lshl_b32 s4, s4, 16
    v_mfma_f32_16x16x32_bf16 v[148:151], v[76:79], v[108:111], v[148:151]
    s_add_u32 s4, s4, s85
    v_mul_f32 v128, s82, v128
    v_mul_f32 v129, s82, v129
    v_mul_f32 v130, s82, v130
    v_mfma_f32_16x16x32_bf16 v[144:147], v[68:71], v[108:111], v[144:147]
    v_mul_f32 v131, s82, v131
    v_mul_f32 v132, s82, v132
    v_mul_f32 v133, s82, v133
    v_mul_f32 v134, s82, v134
    v_mfma_f32_16x16x32_bf16 v[144:147], v[64:67], v[104:107], v[144:147]
    v_mfma_f32_16x16x32_bf16 v[28:31], v[104:107], v[16:19], v[28:31]
    v_mfma_f32_16x16x32_bf16 v[28:31], v[108:111], v[20:23], v[28:31]
    v_mul_f32 v135, s82, v135
    v_cvt_pk_bf16_f32 v40, v128, v129
    v_cvt_pk_bf16_f32 v41, v130, v131
    v_cvt_pk_bf16_f32 v42, v132, v133
    v_mfma_f32_16x16x32_bf16 v[160:163], v[64:67], v[112:115], v[160:163]
    ds_read_b128 v[104:107], v1 offset:43008
    v_cvt_pk_bf16_f32 v43, v134, v135
    buffer_store_dwordx4 v[40:43], v14, s[44:47], s4 offen offset:0 sc1
    v_mul_f32 v136, s82, v136
    v_mul_f32 v137, s82, v137
    v_mfma_f32_16x16x32_bf16 v[160:163], v[68:71], v[116:119], v[160:163]
    ds_read_b128 v[108:111], v2 offset:43008
    v_mul_f32 v138, s82, v138
    v_mul_f32 v139, s82, v139
    v_mul_f32 v140, s82, v140
    v_mul_f32 v141, s82, v141
    v_mfma_f32_16x16x32_bf16 v[164:167], v[76:79], v[116:119], v[164:167]
    s_add_u32 s5, s84, s58
    s_lshl_b32 s5, s5, 12
    s_and_b32 s6, s60, 1
    v_mul_f32 v142, s82, v142
    v_mul_f32 v143, s82, v143
    v_cvt_pk_bf16_f32 v44, v136, v137
    v_cvt_pk_bf16_f32 v45, v138, v139
    v_mfma_f32_16x16x32_bf16 v[164:167], v[72:75], v[112:115], v[164:167]
    s_lshl_b32 s6, s6, 10
    s_add_u32 s5, s5, s6
    s_add_u32 s5, s5, 0x1400800
    v_cvt_pk_bf16_f32 v46, v140, v141
    v_cvt_pk_bf16_f32 v47, v142, v143
    buffer_store_dwordx4 v[44:47], v15, s[44:47], s4 offen offset:0 sc1
    v_mul_f32 v144, s82, v144
    v_mul_f32 v145, s82, v145
    v_mul_f32 v146, s82, v146
    v_mul_f32 v147, s82, v147
    v_mfma_f32_16x16x32_bf16 v[168:171], v[80:83], v[112:115], v[168:171]
    v_cvt_pk_bf16_f32 v52, v24, v25
    v_cvt_pk_bf16_f32 v53, v26, v27
    v_cvt_pk_bf16_f32 v54, v28, v29
    v_mul_f32 v148, s82, v148
    v_mul_f32 v149, s82, v149
    v_mul_f32 v150, s82, v150
    v_mul_f32 v151, s82, v151
    v_mfma_f32_16x16x32_bf16 v[168:171], v[84:87], v[116:119], v[168:171]
    v_cvt_pk_bf16_f32 v55, v30, v31
    buffer_store_dwordx4 v[52:55], v14, s[44:47], s5 offen sc1
    v_cvt_pk_bf16_f32 v40, v144, v145
    v_cvt_pk_bf16_f32 v41, v146, v147
    v_cvt_pk_bf16_f32 v42, v148, v149
    v_cvt_pk_bf16_f32 v43, v150, v151
    v_mfma_f32_16x16x32_bf16 v[172:175], v[92:95], v[116:119], v[172:175]
    buffer_store_dwordx4 v[40:43], v14, s[44:47], s4 offen offset:1024 sc1
    v_mul_f32 v152, s82, v152
    v_mul_f32 v153, s82, v153
    v_mul_f32 v154, s82, v154
    v_mfma_f32_16x16x32_bf16 v[172:175], v[88:91], v[112:115], v[172:175]
    v_mul_f32 v155, s82, v155
    v_mul_f32 v156, s82, v156
    v_mul_f32 v157, s82, v157
    v_mul_f32 v158, s82, v158
    s_waitcnt lgkmcnt(5)
    v_mfma_f32_16x16x32_bf16 v[188:191], v[88:91], v[120:123], v[188:191]
    ds_read_b128 v[112:115], v1 offset:45056
    v_mul_f32 v159, s82, v159
    v_cvt_pk_bf16_f32 v44, v152, v153
    v_cvt_pk_bf16_f32 v45, v154, v155
    v_cvt_pk_bf16_f32 v46, v156, v157
    s_waitcnt lgkmcnt(5)
    v_mfma_f32_16x16x32_bf16 v[188:191], v[92:95], v[124:127], v[188:191]
    ds_read_b128 v[116:119], v2 offset:45056
    v_cvt_pk_bf16_f32 v47, v158, v159
    buffer_store_dwordx4 v[44:47], v15, s[44:47], s4 offen offset:1024 sc1
    v_mfma_f32_16x16x32_bf16 v[184:187], v[84:87], v[124:127], v[184:187]
    v_mfma_f32_16x16x32_bf16 v[184:187], v[80:83], v[120:123], v[184:187]
    s_add_u32 s4, s58, 1
    s_and_b32 s4, s4, 3
    s_add_u32 s4, s4, s84
    s_lshl_b32 s4, s4, 16
    v_mfma_f32_16x16x32_bf16 v[180:183], v[72:75], v[120:123], v[180:183]
    s_add_u32 s4, s4, s85
    v_mul_f32 v160, s82, v160
    v_mul_f32 v161, s82, v161
    v_mul_f32 v162, s82, v162
    v_mfma_f32_16x16x32_bf16 v[180:183], v[76:79], v[124:127], v[180:183]
    v_mul_f32 v163, s82, v163
    v_mul_f32 v164, s82, v164
    v_mul_f32 v165, s82, v165
    v_mul_f32 v166, s82, v166
    v_mfma_f32_16x16x32_bf16 v[176:179], v[68:71], v[124:127], v[176:179]
    v_mul_f32 v167, s82, v167
    v_cvt_pk_bf16_f32 v40, v160, v161
    v_cvt_pk_bf16_f32 v41, v162, v163
    v_cvt_pk_bf16_f32 v42, v164, v165
    v_mfma_f32_16x16x32_bf16 v[176:179], v[64:67], v[120:123], v[176:179]
    v_cvt_pk_bf16_f32 v43, v166, v167
    buffer_store_dwordx4 v[40:43], v14, s[44:47], s4 offen offset:0 sc1
    v_mul_f32 v168, s82, v168
    v_mul_f32 v169, s82, v169
    s_waitcnt lgkmcnt(5)
    v_mfma_f32_16x16x32_bf16 v[192:195], v[64:67], v[96:99], v[192:195]
    ds_read_b128 v[120:123], v1 offset:47104
    v_mul_f32 v170, s82, v170
    v_mul_f32 v171, s82, v171
    v_mul_f32 v172, s82, v172
    v_mul_f32 v173, s82, v173
    s_waitcnt lgkmcnt(5)
    v_mfma_f32_16x16x32_bf16 v[192:195], v[68:71], v[100:103], v[192:195]
    ds_read_b128 v[124:127], v2 offset:47104
    v_mul_f32 v174, s82, v174
    v_mul_f32 v175, s82, v175
    v_cvt_pk_bf16_f32 v44, v168, v169
    v_cvt_pk_bf16_f32 v45, v170, v171
    v_mfma_f32_16x16x32_bf16 v[196:199], v[76:79], v[100:103], v[196:199]
    v_cvt_pk_bf16_f32 v46, v172, v173
    v_cvt_pk_bf16_f32 v47, v174, v175
    buffer_store_dwordx4 v[44:47], v15, s[44:47], s4 offen offset:0 sc1
    v_mfma_f32_16x16x32_bf16 v[196:199], v[72:75], v[96:99], v[196:199]
    v_mul_f32 v176, s82, v176
    v_mul_f32 v177, s82, v177
    v_mul_f32 v178, s82, v178
    v_mul_f32 v179, s82, v179
    v_mfma_f32_16x16x32_bf16 v[200:203], v[80:83], v[96:99], v[200:203]
    v_mul_f32 v180, s82, v180
    v_mul_f32 v181, s82, v181
    v_mul_f32 v182, s82, v182
    v_mul_f32 v183, s82, v183
    v_mfma_f32_16x16x32_bf16 v[200:203], v[84:87], v[100:103], v[200:203]
    v_cvt_pk_bf16_f32 v40, v176, v177
    v_cvt_pk_bf16_f32 v41, v178, v179
    v_cvt_pk_bf16_f32 v42, v180, v181
    v_cvt_pk_bf16_f32 v43, v182, v183
    v_mfma_f32_16x16x32_bf16 v[204:207], v[92:95], v[100:103], v[204:207]
    buffer_store_dwordx4 v[40:43], v14, s[44:47], s4 offen offset:1024 sc1
    v_mul_f32 v184, s82, v184
    v_mul_f32 v185, s82, v185
    v_mul_f32 v186, s82, v186
    v_mfma_f32_16x16x32_bf16 v[204:207], v[88:91], v[96:99], v[204:207]
    v_mul_f32 v187, s82, v187
    v_mul_f32 v188, s82, v188
    v_mul_f32 v189, s82, v189
    v_mul_f32 v190, s82, v190
    s_waitcnt lgkmcnt(5)
    v_mfma_f32_16x16x32_bf16 v[220:223], v[88:91], v[104:107], v[220:223]
    v_mul_f32 v191, s82, v191
    v_cvt_pk_bf16_f32 v44, v184, v185
    v_cvt_pk_bf16_f32 v45, v186, v187
    v_cvt_pk_bf16_f32 v46, v188, v189
    s_waitcnt lgkmcnt(4)
    v_mfma_f32_16x16x32_bf16 v[220:223], v[92:95], v[108:111], v[220:223]
    v_cvt_pk_bf16_f32 v47, v190, v191
    buffer_store_dwordx4 v[44:47], v15, s[44:47], s4 offen offset:1024 sc1
    v_mfma_f32_16x16x32_bf16 v[216:219], v[84:87], v[108:111], v[216:219]
    v_mfma_f32_16x16x32_bf16 v[216:219], v[80:83], v[104:107], v[216:219]
    s_add_u32 s4, s58, 2
    s_and_b32 s4, s4, 3
    s_add_u32 s4, s4, s84
    s_lshl_b32 s4, s4, 16
    v_mfma_f32_16x16x32_bf16 v[212:215], v[72:75], v[104:107], v[212:215]
    s_add_u32 s4, s4, s85
    v_mul_f32 v192, s82, v192
    v_mul_f32 v193, s82, v193
    v_mul_f32 v194, s82, v194
    v_mfma_f32_16x16x32_bf16 v[212:215], v[76:79], v[108:111], v[212:215]
    v_mul_f32 v195, s82, v195
    v_mul_f32 v196, s82, v196
    v_mul_f32 v197, s82, v197
    v_mul_f32 v198, s82, v198
    v_mfma_f32_16x16x32_bf16 v[208:211], v[68:71], v[108:111], v[208:211]
    v_mul_f32 v199, s82, v199
    v_cvt_pk_bf16_f32 v40, v192, v193
    v_cvt_pk_bf16_f32 v41, v194, v195
    v_cvt_pk_bf16_f32 v42, v196, v197
    v_mfma_f32_16x16x32_bf16 v[208:211], v[64:67], v[104:107], v[208:211]
    v_cvt_pk_bf16_f32 v43, v198, v199
    buffer_store_dwordx4 v[40:43], v14, s[44:47], s4 offen offset:0 sc1
    v_mul_f32 v200, s82, v200
    v_mul_f32 v201, s82, v201
    s_waitcnt lgkmcnt(3)
    v_mfma_f32_16x16x32_bf16 v[224:227], v[64:67], v[112:115], v[224:227]
    v_mul_f32 v202, s82, v202
    v_mul_f32 v203, s82, v203
    v_mul_f32 v204, s82, v204
    v_mul_f32 v205, s82, v205
    s_waitcnt lgkmcnt(2)
    v_mfma_f32_16x16x32_bf16 v[224:227], v[68:71], v[116:119], v[224:227]
    v_mul_f32 v206, s82, v206
    v_mul_f32 v207, s82, v207
    v_cvt_pk_bf16_f32 v44, v200, v201
    v_cvt_pk_bf16_f32 v45, v202, v203
    v_mfma_f32_16x16x32_bf16 v[228:231], v[76:79], v[116:119], v[228:231]
    v_cvt_pk_bf16_f32 v46, v204, v205
    v_cvt_pk_bf16_f32 v47, v206, v207
    buffer_store_dwordx4 v[44:47], v15, s[44:47], s4 offen offset:0 sc1
    v_mfma_f32_16x16x32_bf16 v[228:231], v[72:75], v[112:115], v[228:231]
    v_mul_f32 v208, s82, v208
    v_mul_f32 v209, s82, v209
    v_mul_f32 v210, s82, v210
    v_mul_f32 v211, s82, v211
    v_mfma_f32_16x16x32_bf16 v[232:235], v[80:83], v[112:115], v[232:235]
    v_mul_f32 v212, s82, v212
    v_mul_f32 v213, s82, v213
    v_mul_f32 v214, s82, v214
    v_mul_f32 v215, s82, v215
    v_mfma_f32_16x16x32_bf16 v[232:235], v[84:87], v[116:119], v[232:235]
    v_cvt_pk_bf16_f32 v40, v208, v209
    v_cvt_pk_bf16_f32 v41, v210, v211
    v_cvt_pk_bf16_f32 v42, v212, v213
    v_cvt_pk_bf16_f32 v43, v214, v215
    v_mfma_f32_16x16x32_bf16 v[236:239], v[92:95], v[116:119], v[236:239]
    buffer_store_dwordx4 v[40:43], v14, s[44:47], s4 offen offset:1024 sc1
    v_mul_f32 v216, s82, v216
    v_mul_f32 v217, s82, v217
    v_mul_f32 v218, s82, v218
    v_mfma_f32_16x16x32_bf16 v[236:239], v[88:91], v[112:115], v[236:239]
    v_mul_f32 v219, s82, v219
    v_mul_f32 v220, s82, v220
    v_mul_f32 v221, s82, v221
    v_mul_f32 v222, s82, v222
    s_waitcnt lgkmcnt(1)
    v_mfma_f32_16x16x32_bf16 v[252:255], v[88:91], v[120:123], v[252:255]
    v_mul_f32 v223, s82, v223
    v_cvt_pk_bf16_f32 v44, v216, v217
    v_cvt_pk_bf16_f32 v45, v218, v219
    v_cvt_pk_bf16_f32 v46, v220, v221
    s_waitcnt lgkmcnt(0)
    v_mfma_f32_16x16x32_bf16 v[252:255], v[92:95], v[124:127], v[252:255]
    v_cvt_pk_bf16_f32 v47, v222, v223
    buffer_store_dwordx4 v[44:47], v15, s[44:47], s4 offen offset:1024 sc1
    v_mfma_f32_16x16x32_bf16 v[248:251], v[84:87], v[124:127], v[248:251]
    v_mfma_f32_16x16x32_bf16 v[248:251], v[80:83], v[120:123], v[248:251]
    s_add_u32 s4, s58, 3
    s_and_b32 s4, s4, 3
    s_add_u32 s4, s4, s84
    s_lshl_b32 s4, s4, 16
    s_add_u32 s4, s4, s85
    v_mul_f32 v224, s82, v224
    v_mul_f32 v225, s82, v225
    v_mfma_f32_16x16x32_bf16 v[244:247], v[72:75], v[120:123], v[244:247]
    v_mul_f32 v226, s82, v226
    v_mul_f32 v227, s82, v227
    v_mul_f32 v228, s82, v228
    v_mul_f32 v229, s82, v229
    v_mul_f32 v230, s82, v230
    v_mul_f32 v231, s82, v231
    v_cvt_pk_bf16_f32 v40, v224, v225
    v_mfma_f32_16x16x32_bf16 v[244:247], v[76:79], v[124:127], v[244:247]
    v_cvt_pk_bf16_f32 v41, v226, v227
    v_cvt_pk_bf16_f32 v42, v228, v229
    v_cvt_pk_bf16_f32 v43, v230, v231
    buffer_store_dwordx4 v[40:43], v14, s[44:47], s4 offen offset:0 sc1
    v_mul_f32 v232, s82, v232
    v_mul_f32 v233, s82, v233
    v_mul_f32 v234, s82, v234
    v_mfma_f32_16x16x32_bf16 v[240:243], v[68:71], v[124:127], v[240:243]
    v_mul_f32 v235, s82, v235
    v_mul_f32 v236, s82, v236
    v_mul_f32 v237, s82, v237
    v_mul_f32 v238, s82, v238
    v_mul_f32 v239, s82, v239
    v_cvt_pk_bf16_f32 v44, v232, v233
    v_cvt_pk_bf16_f32 v45, v234, v235
    v_mfma_f32_16x16x32_bf16 v[240:243], v[64:67], v[120:123], v[240:243]
    v_cvt_pk_bf16_f32 v46, v236, v237
    v_cvt_pk_bf16_f32 v47, v238, v239
    buffer_store_dwordx4 v[44:47], v15, s[44:47], s4 offen offset:0 sc1
    s_nop 7
    v_pk_mul_f32 v[240:241], v[240:241], s[82:83]
    v_pk_mul_f32 v[242:243], v[242:243], s[82:83]
    v_pk_mul_f32 v[244:245], v[244:245], s[82:83]
    v_pk_mul_f32 v[246:247], v[246:247], s[82:83]
    v_cvt_pk_bf16_f32 v40, v240, v241
    v_cvt_pk_bf16_f32 v41, v242, v243
    v_cvt_pk_bf16_f32 v42, v244, v245
    v_cvt_pk_bf16_f32 v43, v246, v247
    buffer_store_dwordx4 v[40:43], v14, s[44:47], s4 offen offset:1024 sc1
    v_pk_mul_f32 v[248:249], v[248:249], s[82:83]
    v_pk_mul_f32 v[250:251], v[250:251], s[82:83]
    v_pk_mul_f32 v[252:253], v[252:253], s[82:83]
    v_pk_mul_f32 v[254:255], v[254:255], s[82:83]
    v_cvt_pk_bf16_f32 v44, v248, v249
    v_cvt_pk_bf16_f32 v45, v250, v251
    v_cvt_pk_bf16_f32 v46, v252, v253
    v_cvt_pk_bf16_f32 v47, v254, v255
    buffer_store_dwordx4 v[44:47], v15, s[44:47], s4 offen offset:1024 sc1
p1_V_last:
    s_branch p1_fin
p1_fin:
    s_lshl_b32 s4, s56, 2
    s_add_u32 s4, s4, s58
    s_lshl_b32 s4, s4, 2
    s_add_u32 s4, s4, 0x1c01f00
    v_lshl_add_u32 v97, v0, 7, s4
    s_cmp_ge_u32 s57, 28
    s_cselect_b32 s5, 34, 2
    v_mov_b32 v96, 0x7fffff00
    v_cmp_gt_u32 vcc, s5, v0
    s_lshl_b32 s4, s56, 5
    s_add_u32 s4, s4, s57
    v_cndmask_b32 v96, v96, v97, vcc
    s_lshl_b32 s4, s4, 2
    s_add_u32 s4, s4, 0x1c01000
    v_writelane_b32 v96, s4, 1
    s_mov_b32 s4, 0x7fffff00
    v_writelane_b32 v96, s4, 0
    s_cmp_lg_u32 s3, 4
    s_cbranch_scc1 p1_dbg_ok
    s_mov_b32 s5, 0x20000
    s_waitcnt vmcnt(18)
p1_dbg:
    v_cmp_ne_u32 vcc, 0x01010101, v10
    s_sub_u32 s5, s5, 1
    s_cbranch_scc1 p1_dbg_ok
    s_cbranch_vccz p1_dbg_ok
    buffer_load_dword v10, v9, s[24:27], 0 offen sc1
    s_waitcnt vmcnt(0)
    s_branch p1_dbg
p1_dbg_ok:
    s_mov_b32 s60, s57
p2:
    s_load_dwordx2 s[24:25], s[0:1], 96
    s_load_dwordx2 s[26:27], s[0:1], 64
    s_load_dwordx2 s[28:29], s[0:1], 32
    s_load_dwordx2 s[30:31], s[0:1], 80
    s_and_b32 s4, s2, 7
    s_lshr_b32 s5, s2, 3
    s_lshr_b32 s6, s4, 1
    s_lshl_b32 s6, s6, 2
    s_and_b32 s7, s5, 3
    s_add_u32 s34, s6, s7
    s_and_b32 s4, s4, 1
    s_lshl_b32 s4, s4, 3
    s_lshr_b32 s5, s5, 2
    s_add_u32 s35, s4, s5
    s_and_b32 s33, s3, 3
    s_lshl_b32 s4, s34, 2
    s_add_u32 s36, s4, s33
    s_mov_b32 s10, 0x2000000
    s_mov_b32 s11, 0x20000
    v_lshlrev_b32 v1, 4, v0
    s_cmp_ge_u32 s3, 4
    s_cbranch_scc1 p2_G
    s_setprio 1
    s_lshl_b32 s4, s36, 5
    s_lshl_b32 s5, s35, 1
    s_add_u32 s4, s4, s5
    s_lshl_b32 s4, s4, 11
    s_add_u32 s46, s4, 0x1000000
    s_lshl_b32 s5, s35, 7
    s_add_u32 s5, s5, s36
    s_lshl_b32 s5, s5, 11
    s_add_u32 s47, s5, 0x1800000
    s_add_u32 s56, s47, 0x20000
    s_lshl_b32 s48, s36, 8
    s_add_u32 s48, s48, 0x1480000
    v_and_b32 v6, 15, v0
    v_lshlrev_b32 v6, 3, v6
    v_add_u32 v2, 0x20000, v1
    s_waitcnt lgkmcnt(0)
    s_mov_b32 s8, s24
    s_mov_b32 s9, s25
    v_mov_b32 v3, v6
    s_waitcnt vmcnt(0)
    s_barrier
    v_and_b32 v7, 3, v0
    v_cmp_eq_u32 vcc, 0, v7
    v_mov_b32 v8, 0x3f803f80
    s_mov_b32 s37, 7
    v_cndmask_b32 v12, 0, v8, vcc
    v_cndmask_b32 v13, 0, v8, vcc
    v_cndmask_b32 v14, 0, v8, vcc
    v_cndmask_b32 v15, 0, v8, vcc
    s_lshl_b32 s4, s33, 8
    s_add_u32 s4, s4, 0x1e400
    v_lshl_add_u32 v186, v0, 2, s4
    v_lshlrev_b32 v187, 8, v7
    v_add_u32 v187, 0x1e000, v187
    v_mov_b32 v188, 1
    s_mov_b32 s58, 0
    s_mov_b32 s59, 2
    v_mov_b32 v8, 0
    ds_write_b32 v186, v188
    v_mov_b32 v72, 0
    v_mov_b32 v73, 0
    v_mov_b32 v74, 0
    v_mov_b32 v75, 0
    v_mov_b32 v76, 0
    v_mov_b32 v77, 0
    v_mov_b32 v78, 0
    v_mov_b32 v79, 0
    v_mov_b32 v80, 0
    v_mov_b32 v81, 0
    v_mov_b32 v82, 0
    v_mov_b32 v83, 0
    v_mov_b32 v84, 0
    v_mov_b32 v85, 0
    v_mov_b32 v86, 0
    v_mov_b32 v87, 0
    v_mov_b32 v88, 0
    v_mov_b32 v89, 0
    v_mov_b32 v90, 0
    v_mov_b32 v91, 0
    v_mov_b32 v92, 0
    v_mov_b32 v93, 0
    v_mov_b32 v94, 0
    v_mov_b32 v95, 0
    v_mov_b32 v96, 0
    v_mov_b32 v97, 0
    v_mov_b32 v98, 0
    v_mov_b32 v99, 0
    v_mov_b32 v100, 0
    v_mov_b32 v101, 0
    v_mov_b32 v102, 0
    v_mov_b32 v103, 0
    v_mov_b32 v104, 0
    v_mov_b32 v105, 0
    v_mov_b32 v106, 0
    v_mov_b32 v107, 0
    v_mov_b32 v108, 0
    v_mov_b32 v109, 0
    v_mov_b32 v110, 0
    v_mov_b32 v111, 0
    v_mov_b32 v112, 0
    v_mov_b32 v113, 0
    v_mov_b32 v114, 0
    v_mov_b32 v115, 0
    v_mov_b32 v116, 0
    v_mov_b32 v117, 0
    v_mov_b32 v118, 0
    v_mov_b32 v119, 0
    v_mov_b32 v120, 0
    v_mov_b32 v121, 0
    v_mov_b32 v122, 0
    v_mov_b32 v123, 0
    v_mov_b32 v124, 0
    v_mov_b32 v125, 0
    v_mov_b32 v126, 0
    v_mov_b32 v127, 0
    v_mov_b32 v152, 0
    v_mov_b32 v153, 0
    v_mov_b32 v154, 0
    v_mov_b32 v155, 0
    v_mov_b32 v156, 0
    v_mov_b32 v157, 0
    v_mov_b32 v158, 0
    v_mov_b32 v159, 0
    s_barrier
    buffer_load_dwordx4 v[16:19], v1, s[8:11], s46 offen offset:0 sc1
    buffer_load_dwordx4 v[20:23], v1, s[8:11], s46 offen offset:1024 sc1
    buffer_load_dwordx4 v[24:27], v1, s[8:11], s46 offen offset:2048 sc1
    buffer_load_dwordx4 v[28:31], v1, s[8:11], s46 offen offset:3072 sc1
    s_waitcnt lgkmcnt(0)
    s_barrier
    ds_read_b128 v[128:131], v2 offset:0
    ds_read_b128 v[132:135], v2 offset:1024
    ds_read_b128 v[136:139], v2 offset:4096
    ds_read_b128 v[140:143], v2 offset:5120
    s_waitcnt vmcnt(0)
    s_waitcnt lgkmcnt(2)
    v_mfma_f32_16x16x32_bf16 v[32:35], v[128:131], v[16:19], 0
    v_mfma_f32_16x16x32_bf16 v[40:43], v[128:131], v[20:23], 0
    v_mfma_f32_16x16x32_bf16 v[44:47], v[132:135], v[20:23], 0
    v_mfma_f32_16x16x32_bf16 v[36:39], v[132:135], v[16:19], 0
    s_nop 7
.p2align 6
p2_A_loop:
    v_mfma_f32_16x16x32_bf16 v[48:51], v[128:131], v[24:27], 0
    ds_read_b128 v[144:147], v2 offset:2048
    v_exp_f32 v32, v32
    v_mfma_f32_16x16x32_bf16 v[56:59], v[128:131], v[28:31], 0
    v_exp_f32 v33, v33
    v_mfma_f32_16x16x32_bf16 v[60:63], v[132:135], v[28:31], 0
    ds_read_b32 v189, v187
    v_exp_f32 v34, v34
    v_mfma_f32_16x16x32_bf16 v[52:55], v[132:135], v[24:27], 0
    v_exp_f32 v35, v35
    v_exp_f32 v36, v36
    v_exp_f32 v37, v37
    v_cvt_pk_bf16_f32 v64, v32, v33
    v_cvt_pk_bf16_f32 v65, v34, v35
    v_cvt_pk_bf16_f32 v66, v36, v37
    v_mfma_f32_16x16x32_bf16 v[96:99], v[152:155], v[72:75], v[96:99]
    ds_read_b128 v[148:151], v2 offset:3072
    v_exp_f32 v38, v38
    v_mfma_f32_16x16x32_bf16 v[120:123], v[12:15], v[72:75], v[120:123]
    v_exp_f32 v39, v39
    v_mfma_f32_16x16x32_bf16 v[100:103], v[156:159], v[72:75], v[100:103]
    v_exp_f32 v40, v40
    v_exp_f32 v41, v41
    v_exp_f32 v42, v42
    v_cvt_pk_bf16_f32 v67, v38, v39
    v_cvt_pk_bf16_f32 v68, v40, v41
    v_mfma_f32_16x16x32_bf16 v[108:111], v[156:159], v[76:79], v[108:111]
    s_waitcnt lgkmcnt(1)
    v_exp_f32 v43, v43
    v_cmp_gt_u32 vcc, s58, v189
    v_mfma_f32_16x16x32_bf16 v[124:127], v[12:15], v[76:79], v[124:127]
    v_exp_f32 v44, v44
    v_mfma_f32_16x16x32_bf16 v[104:107], v[152:155], v[76:79], v[104:107]
    s_cbranch_vccnz p2_A_w0
p2_A_w0r:
    v_exp_f32 v45, v45
    v_exp_f32 v46, v46
    v_cvt_pk_bf16_f32 v69, v42, v43
    v_exp_f32 v47, v47
    v_cvt_pk_bf16_f32 v70, v44, v45
    v_cvt_pk_bf16_f32 v71, v46, v47
    v_mfma_f32_16x16x32_bf16 v[32:35], v[136:139], v[16:19], 0
    ds_read_b128 v[128:131], v2 offset:8192
    v_exp_f32 v48, v48
    v_mfma_f32_16x16x32_bf16 v[40:43], v[136:139], v[20:23], 0
    v_exp_f32 v49, v49
    v_mfma_f32_16x16x32_bf16 v[44:47], v[140:143], v[20:23], 0
    v_exp_f32 v50, v50
    v_mfma_f32_16x16x32_bf16 v[36:39], v[140:143], v[16:19], 0
    s_waitcnt lgkmcnt(1)
    v_exp_f32 v51, v51
    v_exp_f32 v52, v52
    v_exp_f32 v53, v53
    v_cvt_pk_bf16_f32 v72, v48, v49
    v_cvt_pk_bf16_f32 v73, v50, v51
    v_cvt_pk_bf16_f32 v74, v52, v53
    v_mfma_f32_16x16x32_bf16 v[80:83], v[144:147], v[64:67], v[80:83]
    ds_read_b128 v[132:135], v2 offset:9216
    v_exp_f32 v54, v54
    v_mfma_f32_16x16x32_bf16 v[112:115], v[12:15], v[64:67], v[112:115]
    v_exp_f32 v55, v55
    v_mfma_f32_16x16x32_bf16 v[84:87], v[148:151], v[64:67], v[84:87]
    v_exp_f32 v56, v56
    v_exp_f32 v57, v57
    v_exp_f32 v58, v58
    v_cvt_pk_bf16_f32 v75, v54, v55
    v_cvt_pk_bf16_f32 v76, v56, v57
    v_mfma_f32_16x16x32_bf16 v[92:95], v[148:151], v[68:71], v[92:95]
    v_exp_f32 v59, v59
    v_mfma_f32_16x16x32_bf16 v[116:119], v[12:15], v[68:71], v[116:119]
    v_exp_f32 v60, v60
    v_mfma_f32_16x16x32_bf16 v[88:91], v[144:147], v[68:71], v[88:91]
    v_exp_f32 v61, v61
    v_exp_f32 v62, v62
    v_cvt_pk_bf16_f32 v77, v58, v59
    v_exp_f32 v63, v63
    v_cvt_pk_bf16_f32 v78, v60, v61
    v_cvt_pk_bf16_f32 v79, v62, v63
    v_mfma_f32_16x16x32_bf16 v[48:51], v[136:139], v[24:27], 0
    ds_read_b128 v[152:155], v2 offset:6144
    v_exp_f32 v32, v32
    v_mfma_f32_16x16x32_bf16 v[56:59], v[136:139], v[28:31], 0
    v_exp_f32 v33, v33
    v_mfma_f32_16x16x32_bf16 v[60:63], v[140:143], v[28:31], 0
    v_exp_f32 v34, v34
    v_mfma_f32_16x16x32_bf16 v[52:55], v[140:143], v[24:27], 0
    v_exp_f32 v35, v35
    v_exp_f32 v36, v36
    v_exp_f32 v37, v37
    v_cvt_pk_bf16_f32 v64, v32, v33
    v_cvt_pk_bf16_f32 v65, v34, v35
    v_cvt_pk_bf16_f32 v66, v36, v37
    v_mfma_f32_16x16x32_bf16 v[96:99], v[144:147], v[72:75], v[96:99]
    ds_read_b128 v[156:159], v2 offset:7168
    v_exp_f32 v38, v38
    v_mfma_f32_16x16x32_bf16 v[120:123], v[12:15], v[72:75], v[120:123]
    v_exp_f32 v39, v39
    v_mfma_f32_16x16x32_bf16 v[100:103], v[148:151], v[72:75], v[100:103]
    v_exp_f32 v40, v40
    v_exp_f32 v41, v41
    v_exp_f32 v42, v42
    v_cvt_pk_bf16_f32 v67, v38, v39
    v_cvt_pk_bf16_f32 v68, v40, v41
    v_mfma_f32_16x16x32_bf16 v[108:111], v[148:151], v[76:79], v[108:111]
    v_exp_f32 v43, v43
    v_mfma_f32_16x16x32_bf16 v[124:127], v[12:15], v[76:79], v[124:127]
    v_exp_f32 v44, v44
    v_mfma_f32_16x16x32_bf16 v[104:107], v[144:147], v[76:79], v[104:107]
    s_waitcnt lgkmcnt(2)
    v_exp_f32 v45, v45
    v_exp_f32 v46, v46
    v_cvt_pk_bf16_f32 v69, v42, v43
    v_exp_f32 v47, v47
    v_cvt_pk_bf16_f32 v70, v44, v45
    v_cvt_pk_bf16_f32 v71, v46, v47
    v_mfma_f32_16x16x32_bf16 v[32:35], v[128:131], v[16:19], 0
    ds_read_b128 v[136:139], v2 offset:12288
    v_exp_f32 v48, v48
    v_mfma_f32_16x16x32_bf16 v[40:43], v[128:131], v[20:23], 0
    v_exp_f32 v49, v49
    v_mfma_f32_16x16x32_bf16 v[44:47], v[132:135], v[20:23], 0
    v_exp_f32 v50, v50
    v_mfma_f32_16x16x32_bf16 v[36:39], v[132:135], v[16:19], 0
    s_waitcnt lgkmcnt(1)
    v_exp_f32 v51, v51
    v_exp_f32 v52, v52
    v_exp_f32 v53, v53
    v_cvt_pk_bf16_f32 v72, v48, v49
    v_cvt_pk_bf16_f32 v73, v50, v51
    v_cvt_pk_bf16_f32 v74, v52, v53
    v_mfma_f32_16x16x32_bf16 v[80:83], v[152:155], v[64:67], v[80:83]
    ds_read_b128 v[140:143], v2 offset:13312
    v_exp_f32 v54, v54
    v_mfma_f32_16x16x32_bf16 v[112:115], v[12:15], v[64:67], v[112:115]
    v_exp_f32 v55, v55
    v_mfma_f32_16x16x32_bf16 v[84:87], v[156:159], v[64:67], v[84:87]
    ds_add_u32 v186, v188
    v_exp_f32 v56, v56
    v_exp_f32 v57, v57
    v_exp_f32 v58, v58
    v_cvt_pk_bf16_f32 v75, v54, v55
    v_cvt_pk_bf16_f32 v76, v56, v57
    v_mfma_f32_16x16x32_bf16 v[92:95], v[156:159], v[68:71], v[92:95]
    v_exp_f32 v59, v59
    v_mfma_f32_16x16x32_bf16 v[116:119], v[12:15], v[68:71], v[116:119]
    s_add_u32 s58, s58, 1
    v_exp_f32 v60, v60
    v_mfma_f32_16x16x32_bf16 v[88:91], v[152:155], v[68:71], v[88:91]
    s_max_u32 s58, s58, 3
    v_exp_f32 v61, v61
    v_exp_f32 v62, v62
    v_cvt_pk_bf16_f32 v77, v58, v59
    v_exp_f32 v63, v63
    v_cvt_pk_bf16_f32 v78, v60, v61
    v_cvt_pk_bf16_f32 v79, v62, v63
    v_mfma_f32_16x16x32_bf16 v[48:51], v[128:131], v[24:27], 0
    ds_read_b128 v[144:147], v2 offset:10240
    v_exp_f32 v32, v32
    v_mfma_f32_16x16x32_bf16 v[56:59], v[128:131], v[28:31], 0
    v_exp_f32 v33, v33
    v_mfma_f32_16x16x32_bf16 v[60:63], v[132:135], v[28:31], 0
    ds_read_b32 v189, v187
    v_exp_f32 v34, v34
    v_mfma_f32_16x16x32_bf16 v[52:55], v[132:135], v[24:27], 0
    v_exp_f32 v35, v35
    v_exp_f32 v36, v36
    v_exp_f32 v37, v37
    v_cvt_pk_bf16_f32 v64, v32, v33
    v_cvt_pk_bf16_f32 v65, v34, v35
    v_cvt_pk_bf16_f32 v66, v36, v37
    v_mfma_f32_16x16x32_bf16 v[96:99], v[152:155], v[72:75], v[96:99]
    ds_read_b128 v[148:151], v2 offset:11264
    v_exp_f32 v38, v38
    v_mfma_f32_16x16x32_bf16 v[120:123], v[12:15], v[72:75], v[120:123]
    v_exp_f32 v39, v39
    v_mfma_f32_16x16x32_bf16 v[100:103], v[156:159], v[72:75], v[100:103]
    v_exp_f32 v40, v40
    v_exp_f32 v41, v41
    v_exp_f32 v42, v42
    v_cvt_pk_bf16_f32 v67, v38, v39
    v_cvt_pk_bf16_f32 v68, v40, v41
    v_mfma_f32_16x16x32_bf16 v[108:111], v[156:159], v[76:79], v[108:111]
    s_waitcnt lgkmcnt(1)
    v_exp_f32 v43, v43
    v_cmp_gt_u32 vcc, s58, v189
    v_mfma_f32_16x16x32_bf16 v[124:127], v[12:15], v[76:79], v[124:127]
    v_exp_f32 v44, v44
    v_mfma_f32_16x16x32_bf16 v[104:107], v[152:155], v[76:79], v[104:107]
    s_cbranch_vccnz p2_A_w2
p2_A_w2r:
    v_exp_f32 v45, v45
    v_exp_f32 v46, v46
    v_cvt_pk_bf16_f32 v69, v42, v43
    v_exp_f32 v47, v47
    v_cvt_pk_bf16_f32 v70, v44, v45
    v_cvt_pk_bf16_f32 v71, v46, v47
    v_mfma_f32_16x16x32_bf16 v[32:35], v[136:139], v[16:19], 0
    ds_read_b128 v[128:131], v2 offset:16384
    v_exp_f32 v48, v48
    v_mfma_f32_16x16x32_bf16 v[40:43], v[136:139], v[20:23], 0
    v_exp_f32 v49, v49
    v_mfma_f32_16x16x32_bf16 v[44:47], v[140:143], v[20:23], 0
    v_exp_f32 v50, v50
    v_mfma_f32_16x16x32_bf16 v[36:39], v[140:143], v[16:19], 0
    s_waitcnt lgkmcnt(1)
    v_exp_f32 v51, v51
    v_exp_f32 v52, v52
    v_exp_f32 v53, v53
    v_cvt_pk_bf16_f32 v72, v48, v49
    v_cvt_pk_bf16_f32 v73, v50, v51
    v_cvt_pk_bf16_f32 v74, v52, v53
    v_mfma_f32_16x16x32_bf16 v[80:83], v[144:147], v[64:67], v[80:83]
    ds_read_b128 v[132:135], v2 offset:17408
    v_exp_f32 v54, v54
    v_mfma_f32_16x16x32_bf16 v[112:115], v[12:15], v[64:67], v[112:115]
    v_exp_f32 v55, v55
    v_mfma_f32_16x16x32_bf16 v[84:87], v[148:151], v[64:67], v[84:87]
    v_exp_f32 v56, v56
    v_exp_f32 v57, v57
    v_exp_f32 v58, v58
    v_cvt_pk_bf16_f32 v75, v54, v55
    v_cvt_pk_bf16_f32 v76, v56, v57
    v_mfma_f32_16x16x32_bf16 v[92:95], v[148:151], v[68:71], v[92:95]
    v_exp_f32 v59, v59
    v_mfma_f32_16x16x32_bf16 v[116:119], v[12:15], v[68:71], v[116:119]
    v_exp_f32 v60, v60
    v_mfma_f32_16x16x32_bf16 v[88:91], v[144:147], v[68:71], v[88:91]
    v_exp_f32 v61, v61
    v_exp_f32 v62, v62
    v_cvt_pk_bf16_f32 v77, v58, v59
    v_exp_f32 v63, v63
    v_cvt_pk_bf16_f32 v78, v60, v61
    v_cvt_pk_bf16_f32 v79, v62, v63
    v_mfma_f32_16x16x32_bf16 v[48:51], v[136:139], v[24:27], 0
    ds_read_b128 v[152:155], v2 offset:14336
    v_exp_f32 v32, v32
    v_mfma_f32_16x16x32_bf16 v[56:59], v[136:139], v[28:31], 0
    v_exp_f32 v33, v33
    v_mfma_f32_16x16x32_bf16 v[60:63], v[140:143], v[28:31], 0
    v_exp_f32 v34, v34
    v_mfma_f32_16x16x32_bf16 v[52:55], v[140:143], v[24:27], 0
    v_exp_f32 v35, v35
    v_exp_f32 v36, v36
    v_exp_f32 v37, v37
    v_cvt_pk_bf16_f32 v64, v32, v33
    v_cvt_pk_bf16_f32 v65, v34, v35
    v_cvt_pk_bf16_f32 v66, v36, v37
    v_mfma_f32_16x16x32_bf16 v[96:99], v[144:147], v[72:75], v[96:99]
    ds_read_b128 v[156:159], v2 offset:15360
    v_exp_f32 v38, v38
    v_mfma_f32_16x16x32_bf16 v[120:123], v[12:15], v[72:75], v[120:123]
    v_exp_f32 v39, v39
    v_mfma_f32_16x16x32_bf16 v[100:103], v[148:151], v[72:75], v[100:103]
    v_exp_f32 v40, v40
    v_exp_f32 v41, v41
    v_exp_f32 v42, v42
    v_cvt_pk_bf16_f32 v67, v38, v39
    v_cvt_pk_bf16_f32 v68, v40, v41
    v_mfma_f32_16x16x32_bf16 v[108:111], v[148:151], v[76:79], v[108:111]
    v_exp_f32 v43, v43
    v_mfma_f32_16x16x32_bf16 v[124:127], v[12:15], v[76:79], v[124:127]
    v_exp_f32 v44, v44
    v_mfma_f32_16x16x32_bf16 v[104:107], v[144:147], v[76:79], v[104:107]
    s_waitcnt lgkmcnt(2)
    v_exp_f32 v45, v45
    v_exp_f32 v46, v46
    v_cvt_pk_bf16_f32 v69, v42, v43
    v_exp_f32 v47, v47
    v_cvt_pk_bf16_f32 v70, v44, v45
    v_cvt_pk_bf16_f32 v71, v46, v47
    v_mfma_f32_16x16x32_bf16 v[32:35], v[128:131], v[16:19], 0
    ds_read_b128 v[136:139], v2 offset:20480
    v_exp_f32 v48, v48
    v_mfma_f32_16x16x32_bf16 v[40:43], v[128:131], v[20:23], 0
    v_exp_f32 v49, v49
    v_mfma_f32_16x16x32_bf16 v[44:47], v[132:135], v[20:23], 0
    v_exp_f32 v50, v50
    v_mfma_f32_16x16x32_bf16 v[36:39], v[132:135], v[16:19], 0
    s_waitcnt lgkmcnt(1)
    v_exp_f32 v51, v51
    v_exp_f32 v52, v52
    v_exp_f32 v53, v53
    v_cvt_pk_bf16_f32 v72, v48, v49
    v_cvt_pk_bf16_f32 v73, v50, v51
    v_cvt_pk_bf16_f32 v74, v52, v53
    v_mfma_f32_16x16x32_bf16 v[80:83], v[152:155], v[64:67], v[80:83]
    ds_read_b128 v[140:143], v2 offset:21504
    v_exp_f32 v54, v54
    v_mfma_f32_16x16x32_bf16 v[112:115], v[12:15], v[64:67], v[112:115]
    v_exp_f32 v55, v55
    v_mfma_f32_16x16x32_bf16 v[84:87], v[156:159], v[64:67], v[84:87]
    ds_add_u32 v186, v188
    v_exp_f32 v56, v56
    v_exp_f32 v57, v57
    v_exp_f32 v58, v58
    v_cvt_pk_bf16_f32 v75, v54, v55
    v_cvt_pk_bf16_f32 v76, v56, v57
    v_mfma_f32_16x16x32_bf16 v[92:95], v[156:159], v[68:71], v[92:95]
    v_exp_f32 v59, v59
    v_mfma_f32_16x16x32_bf16 v[116:119], v[12:15], v[68:71], v[116:119]
    s_add_u32 s58, s58, 1
    v_exp_f32 v60, v60
    v_mfma_f32_16x16x32_bf16 v[88:91], v[152:155], v[68:71], v[88:91]
    v_exp_f32 v61, v61
    v_exp_f32 v62, v62
    v_cvt_pk_bf16_f32 v77, v58, v59
    v_exp_f32 v63, v63
    v_cvt_pk_bf16_f32 v78, v60, v61
    v_cvt_pk_bf16_f32 v79, v62, v63
    v_mfma_f32_16x16x32_bf16 v[48:51], v[128:131], v[24:27], 0
    ds_read_b128 v[144:147], v2 offset:18432
    v_exp_f32 v32, v32
    v_mfma_f32_16x16x32_bf16 v[56:59], v[128:131], v[28:31], 0
    v_exp_f32 v33, v33
    v_mfma_f32_16x16x32_bf16 v[60:63], v[132:135], v[28:31], 0
    ds_read_b32 v189, v187
    v_exp_f32 v34, v34
    v_mfma_f32_16x16x32_bf16 v[52:55], v[132:135], v[24:27], 0
    v_exp_f32 v35, v35
    v_exp_f32 v36, v36
    v_exp_f32 v37, v37
    v_cvt_pk_bf16_f32 v64, v32, v33
    v_cvt_pk_bf16_f32 v65, v34, v35
    v_cvt_pk_bf16_f32 v66, v36, v37
    v_mfma_f32_16x16x32_bf16 v[96:99], v[152:155], v[72:75], v[96:99]
    ds_read_b128 v[148:151], v2 offset:19456
    v_exp_f32 v38, v38
    v_mfma_f32_16x16x32_bf16 v[120:123], v[12:15], v[72:75], v[120:123]
    v_exp_f32 v39, v39
    v_mfma_f32_16x16x32_bf16 v[100:103], v[156:159], v[72:75], v[100:103]
    v_exp_f32 v40, v40
    v_exp_f32 v41, v41
    v_exp_f32 v42, v42
    v_cvt_pk_bf16_f32 v67, v38, v39
    v_cvt_pk_bf16_f32 v68, v40, v41
    v_mfma_f32_16x16x32_bf16 v[108:111], v[156:159], v[76:79], v[108:111]
    s_waitcnt lgkmcnt(1)
    v_exp_f32 v43, v43
    v_cmp_gt_u32 vcc, s58, v189
    v_mfma_f32_16x16x32_bf16 v[124:127], v[12:15], v[76:79], v[124:127]
    v_exp_f32 v44, v44
    v_mfma_f32_16x16x32_bf16 v[104:107], v[152:155], v[76:79], v[104:107]
    s_cbranch_vccnz p2_A_w4
p2_A_w4r:
    v_exp_f32 v45, v45
    v_exp_f32 v46, v46
    v_cvt_pk_bf16_f32 v69, v42, v43
    v_exp_f32 v47, v47
    v_cvt_pk_bf16_f32 v70, v44, v45
    v_cvt_pk_bf16_f32 v71, v46, v47
    v_mfma_f32_16x16x32_bf16 v[32:35], v[136:139], v[16:19], 0
    ds_read_b128 v[128:131], v2 offset:24576
    v_exp_f32 v48, v48
    v_mfma_f32_16x16x32_bf16 v[40:43], v[136:139], v[20:23], 0
    v_exp_f32 v49, v49
    v_mfma_f32_16x16x32_bf16 v[44:47], v[140:143], v[20:23], 0
    v_exp_f32 v50, v50
    v_mfma_f32_16x16x32_bf16 v[36:39], v[140:143], v[16:19], 0
    s_waitcnt lgkmcnt(1)
    v_exp_f32 v51, v51
    v_exp_f32 v52, v52
    v_exp_f32 v53, v53
    v_cvt_pk_bf16_f32 v72, v48, v49
    v_cvt_pk_bf16_f32 v73, v50, v51
    v_cvt_pk_bf16_f32 v74, v52, v53
    v_mfma_f32_16x16x32_bf16 v[80:83], v[144:147], v[64:67], v[80:83]
    ds_read_b128 v[132:135], v2 offset:25600
    v_exp_f32 v54, v54
    v_mfma_f32_16x16x32_bf16 v[112:115], v[12:15], v[64:67], v[112:115]
    v_exp_f32 v55, v55
    v_mfma_f32_16x16x32_bf16 v[84:87], v[148:151], v[64:67], v[84:87]
    v_exp_f32 v56, v56
    v_exp_f32 v57, v57
    v_exp_f32 v58, v58
    v_cvt_pk_bf16_f32 v75, v54, v55
    v_cvt_pk_bf16_f32 v76, v56, v57
    v_mfma_f32_16x16x32_bf16 v[92:95], v[148:151], v[68:71], v[92:95]
    v_exp_f32 v59, v59
    v_mfma_f32_16x16x32_bf16 v[116:119], v[12:15], v[68:71], v[116:119]
    v_exp_f32 v60, v60
    v_mfma_f32_16x16x32_bf16 v[88:91], v[144:147], v[68:71], v[88:91]
    v_exp_f32 v61, v61
    v_exp_f32 v62, v62
    v_cvt_pk_bf16_f32 v77, v58, v59
    v_exp_f32 v63, v63
    v_cvt_pk_bf16_f32 v78, v60, v61
    v_cvt_pk_bf16_f32 v79, v62, v63
    v_mfma_f32_16x16x32_bf16 v[48:51], v[136:139], v[24:27], 0
    ds_read_b128 v[152:155], v2 offset:22528
    v_exp_f32 v32, v32
    v_mfma_f32_16x16x32_bf16 v[56:59], v[136:139], v[28:31], 0
    v_exp_f32 v33, v33
    v_mfma_f32_16x16x32_bf16 v[60:63], v[140:143], v[28:31], 0
    v_exp_f32 v34, v34
    v_mfma_f32_16x16x32_bf16 v[52:55], v[140:143], v[24:27], 0
    v_exp_f32 v35, v35
    v_exp_f32 v36, v36
    v_exp_f32 v37, v37
    v_cvt_pk_bf16_f32 v64, v32, v33
    v_cvt_pk_bf16_f32 v65, v34, v35
    v_cvt_pk_bf16_f32 v66, v36, v37
    v_mfma_f32_16x16x32_bf16 v[96:99], v[144:147], v[72:75], v[96:99]
    ds_read_b128 v[156:159], v2 offset:23552
    v_exp_f32 v38, v38
    v_mfma_f32_16x16x32_bf16 v[120:123], v[12:15], v[72:75], v[120:123]
    v_exp_f32 v39, v39
    v_mfma_f32_16x16x32_bf16 v[100:103], v[148:151], v[72:75], v[100:103]
    v_exp_f32 v40, v40
    v_exp_f32 v41, v41
    v_exp_f32 v42, v42
    v_cvt_pk_bf16_f32 v67, v38, v39
    v_cvt_pk_bf16_f32 v68, v40, v41
    v_mfma_f32_16x16x32_bf16 v[108:111], v[148:151], v[76:79], v[108:111]
    v_exp_f32 v43, v43
    v_mfma_f32_16x16x32_bf16 v[124:127], v[12:15], v[76:79], v[124:127]
    v_exp_f32 v44, v44
    v_mfma_f32_16x16x32_bf16 v[104:107], v[144:147], v[76:79], v[104:107]
    s_waitcnt lgkmcnt(2)
    v_exp_f32 v45, v45
    v_exp_f32 v46, v46
    v_cvt_pk_bf16_f32 v69, v42, v43
    v_exp_f32 v47, v47
    v_cvt_pk_bf16_f32 v70, v44, v45
    v_cvt_pk_bf16_f32 v71, v46, v47
    v_mfma_f32_16x16x32_bf16 v[32:35], v[128:131], v[16:19], 0
    ds_read_b128 v[136:139], v2 offset:28672
    v_exp_f32 v48, v48
    v_mfma_f32_16x16x32_bf16 v[40:43], v[128:131], v[20:23], 0
    v_exp_f32 v49, v49
    v_mfma_f32_16x16x32_bf16 v[44:47], v[132:135], v[20:23], 0
    v_exp_f32 v50, v50
    v_mfma_f32_16x16x32_bf16 v[36:39], v[132:135], v[16:19], 0
    s_waitcnt lgkmcnt(1)
    v_exp_f32 v51, v51
    v_exp_f32 v52, v52
    v_exp_f32 v53, v53
    v_cvt_pk_bf16_f32 v72, v48, v49
    v_cvt_pk_bf16_f32 v73, v50, v51
    v_cvt_pk_bf16_f32 v74, v52, v53
    v_mfma_f32_16x16x32_bf16 v[80:83], v[152:155], v[64:67], v[80:83]
    ds_read_b128 v[140:143], v2 offset:29696
    v_exp_f32 v54, v54
    v_mfma_f32_16x16x32_bf16 v[112:115], v[12:15], v[64:67], v[112:115]
    v_exp_f32 v55, v55
    v_mfma_f32_16x16x32_bf16 v[84:87], v[156:159], v[64:67], v[84:87]
    ds_add_u32 v186, v188
    v_exp_f32 v56, v56
    v_exp_f32 v57, v57
    v_exp_f32 v58, v58
    v_cvt_pk_bf16_f32 v75, v54, v55
    v_cvt_pk_bf16_f32 v76, v56, v57
    v_mfma_f32_16x16x32_bf16 v[92:95], v[156:159], v[68:71], v[92:95]
    v_exp_f32 v59, v59
    v_mfma_f32_16x16x32_bf16 v[116:119], v[12:15], v[68:71], v[116:119]
    s_add_u32 s58, s58, 1
    v_exp_f32 v60, v60
    v_mfma_f32_16x16x32_bf16 v[88:91], v[152:155], v[68:71], v[88:91]
    v_exp_f32 v61, v61
    v_exp_f32 v62, v62
    v_cvt_pk_bf16_f32 v77, v58, v59
    v_exp_f32 v63, v63
    v_cvt_pk_bf16_f32 v78, v60, v61
    v_cvt_pk_bf16_f32 v79, v62, v63
    v_mfma_f32_16x16x32_bf16 v[48:51], v[128:131], v[24:27], 0
    ds_read_b128 v[144:147], v2 offset:26624
    v_exp_f32 v32, v32
    v_mfma_f32_16x16x32_bf16 v[56:59], v[128:131], v[28:31], 0
    v_exp_f32 v33, v33
    v_mfma_f32_16x16x32_bf16 v[60:63], v[132:135], v[28:31], 0
    ds_read_b32 v189, v187
    v_exp_f32 v34, v34
    v_mfma_f32_16x16x32_bf16 v[52:55], v[132:135], v[24:27], 0
    v_exp_f32 v35, v35
    v_exp_f32 v36, v36
    v_exp_f32 v37, v37
    v_cvt_pk_bf16_f32 v64, v32, v33
    v_cvt_pk_bf16_f32 v65, v34, v35
    v_cvt_pk_bf16_f32 v66, v36, v37
    v_mfma_f32_16x16x32_bf16 v[96:99], v[152:155], v[72:75], v[96:99]
    ds_read_b128 v[148:151], v2 offset:27648
    v_exp_f32 v38, v38
    v_mfma_f32_16x16x32_bf16 v[120:123], v[12:15], v[72:75], v[120:123]
    v_exp_f32 v39, v39
    v_mfma_f32_16x16x32_bf16 v[100:103], v[156:159], v[72:75], v[100:103]
    v_exp_f32 v40, v40
    v_exp_f32 v41, v41
    v_exp_f32 v42, v42
    v_cvt_pk_bf16_f32 v67, v38, v39
    v_cvt_pk_bf16_f32 v68, v40, v41
    v_mfma_f32_16x16x32_bf16 v[108:111], v[156:159], v[76:79], v[108:111]
    s_waitcnt lgkmcnt(1)
    v_exp_f32 v43, v43
    v_cmp_gt_u32 vcc, s58, v189
    v_mfma_f32_16x16x32_bf16 v[124:127], v[12:15], v[76:79], v[124:127]
    v_exp_f32 v44, v44
    v_mfma_f32_16x16x32_bf16 v[104:107], v[152:155], v[76:79], v[104:107]
    s_cbranch_vccnz p2_A_w6
p2_A_w6r:
    v_exp_f32 v45, v45
    v_exp_f32 v46, v46
    v_cvt_pk_bf16_f32 v69, v42, v43
    v_exp_f32 v47, v47
    v_cvt_pk_bf16_f32 v70, v44, v45
    v_cvt_pk_bf16_f32 v71, v46, v47
    v_mfma_f32_16x16x32_bf16 v[32:35], v[136:139], v[16:19], 0
    ds_read_b128 v[128:131], v2 offset:0
    v_exp_f32 v48, v48
    v_mfma_f32_16x16x32_bf16 v[40:43], v[136:139], v[20:23], 0
    v_exp_f32 v49, v49
    v_mfma_f32_16x16x32_bf16 v[44:47], v[140:143], v[20:23], 0
    v_exp_f32 v50, v50
    v_mfma_f32_16x16x32_bf16 v[36:39], v[140:143], v[16:19], 0
    s_waitcnt lgkmcnt(1)
    v_exp_f32 v51, v51
    v_exp_f32 v52, v52
    v_exp_f32 v53, v53
    v_cvt_pk_bf16_f32 v72, v48, v49
    v_cvt_pk_bf16_f32 v73, v50, v51
    v_cvt_pk_bf16_f32 v74, v52, v53
    v_mfma_f32_16x16x32_bf16 v[80:83], v[144:147], v[64:67], v[80:83]
    ds_read_b128 v[132:135], v2 offset:1024
    v_exp_f32 v54, v54
    v_mfma_f32_16x16x32_bf16 v[112:115], v[12:15], v[64:67], v[112:115]
    v_exp_f32 v55, v55
    v_mfma_f32_16x16x32_bf16 v[84:87], v[148:151], v[64:67], v[84:87]
    v_exp_f32 v56, v56
    v_exp_f32 v57, v57
    v_exp_f32 v58, v58
    v_cvt_pk_bf16_f32 v75, v54, v55
    v_cvt_pk_bf16_f32 v76, v56, v57
    v_mfma_f32_16x16x32_bf16 v[92:95], v[148:151], v[68:71], v[92:95]
    v_exp_f32 v59, v59
    v_mfma_f32_16x16x32_bf16 v[116:119], v[12:15], v[68:71], v[116:119]
    v_exp_f32 v60, v60
    v_mfma_f32_16x16x32_bf16 v[88:91], v[144:147], v[68:71], v[88:91]
    v_exp_f32 v61, v61
    v_exp_f32 v62, v62
    v_cvt_pk_bf16_f32 v77, v58, v59
    v_exp_f32 v63, v63
    v_cvt_pk_bf16_f32 v78, v60, v61
    v_cvt_pk_bf16_f32 v79, v62, v63
    v_mfma_f32_16x16x32_bf16 v[48:51], v[136:139], v[24:27], 0
    ds_read_b128 v[152:155], v2 offset:30720
    v_exp_f32 v32, v32
    v_mfma_f32_16x16x32_bf16 v[56:59], v[136:139], v[28:31], 0
    v_exp_f32 v33, v33
    v_mfma_f32_16x16x32_bf16 v[60:63], v[140:143], v[28:31], 0
    v_exp_f32 v34, v34
    v_mfma_f32_16x16x32_bf16 v[52:55], v[140:143], v[24:27], 0
    v_exp_f32 v35, v35
    v_exp_f32 v36, v36
    v_exp_f32 v37, v37
    v_cvt_pk_bf16_f32 v64, v32, v33
    v_cvt_pk_bf16_f32 v65, v34, v35
    v_cvt_pk_bf16_f32 v66, v36, v37
    v_mfma_f32_16x16x32_bf16 v[96:99], v[144:147], v[72:75], v[96:99]
    ds_read_b128 v[156:159], v2 offset:31744
    v_exp_f32 v38, v38
    v_mfma_f32_16x16x32_bf16 v[120:123], v[12:15], v[72:75], v[120:123]
    v_exp_f32 v39, v39
    v_mfma_f32_16x16x32_bf16 v[100:103], v[148:151], v[72:75], v[100:103]
    v_exp_f32 v40, v40
    v_exp_f32 v41, v41
    v_exp_f32 v42, v42
    v_cvt_pk_bf16_f32 v67, v38, v39
    v_cvt_pk_bf16_f32 v68, v40, v41
    v_mfma_f32_16x16x32_bf16 v[108:111], v[148:151], v[76:79], v[108:111]
    v_exp_f32 v43, v43
    v_mfma_f32_16x16x32_bf16 v[124:127], v[12:15], v[76:79], v[124:127]
    v_exp_f32 v44, v44
    v_mfma_f32_16x16x32_bf16 v[104:107], v[144:147], v[76:79], v[104:107]
    s_waitcnt lgkmcnt(2)
    v_exp_f32 v45, v45
    v_exp_f32 v46, v46
    v_cvt_pk_bf16_f32 v69, v42, v43
    v_exp_f32 v47, v47
    v_cvt_pk_bf16_f32 v70, v44, v45
    v_cvt_pk_bf16_f32 v71, v46, v47
    v_mfma_f32_16x16x32_bf16 v[32:35], v[128:131], v[16:19], 0
    ds_read_b128 v[136:139], v2 offset:4096
    v_exp_f32 v48, v48
    v_mfma_f32_16x16x32_bf16 v[40:43], v[128:131], v[20:23], 0
    v_exp_f32 v49, v49
    v_mfma_f32_16x16x32_bf16 v[44:47], v[132:135], v[20:23], 0
    v_exp_f32 v50, v50
    v_mfma_f32_16x16x32_bf16 v[36:39], v[132:135], v[16:19], 0
    s_waitcnt lgkmcnt(1)
    v_exp_f32 v51, v51
    v_exp_f32 v52, v52
    v_exp_f32 v53, v53
    v_cvt_pk_bf16_f32 v72, v48, v49
    v_cvt_pk_bf16_f32 v73, v50, v51
    v_cvt_pk_bf16_f32 v74, v52, v53
    v_mfma_f32_16x16x32_bf16 v[80:83], v[152:155], v[64:67], v[80:83]
    ds_read_b128 v[140:143], v2 offset:5120
    v_exp_f32 v54, v54
    v_mfma_f32_16x16x32_bf16 v[112:115], v[12:15], v[64:67], v[112:115]
    v_exp_f32 v55, v55
    v_mfma_f32_16x16x32_bf16 v[84:87], v[156:159], v[64:67], v[84:87]
    ds_add_u32 v186, v188
    v_exp_f32 v56, v56
    v_exp_f32 v57, v57
    v_exp_f32 v58, v58
    v_cvt_pk_bf16_f32 v75, v54, v55
    v_cvt_pk_bf16_f32 v76, v56, v57
    v_mfma_f32_16x16x32_bf16 v[92:95], v[156:159], v[68:71], v[92:95]
    v_exp_f32 v59, v59
    v_mfma_f32_16x16x32_bf16 v[116:119], v[12:15], v[68:71], v[116:119]
    s_add_u32 s58, s58, 1
    v_exp_f32 v60, v60
    v_mfma_f32_16x16x32_bf16 v[88:91], v[152:155], v[68:71], v[88:91]
    v_exp_f32 v61, v61
    v_exp_f32 v62, v62
    v_cvt_pk_bf16_f32 v77, v58, v59
    v_exp_f32 v63, v63
    v_cvt_pk_bf16_f32 v78, v60, v61
    v_cvt_pk_bf16_f32 v79, v62, v63
    s_cmp_eq_u32 s37, 5
    s_cbranch_scc1 p2_A_g
p2_A_nog:
    s_sub_u32 s37, s37, 1
    s_cbranch_scc0 p2_A_loop
    s_waitcnt vmcnt(0)
    v_mfma_f32_16x16x32_bf16 v[96:99], v[152:155], v[72:75], v[96:99]
    v_mfma_f32_16x16x32_bf16 v[120:123], v[12:15], v[72:75], v[120:123]
    v_mfma_f32_16x16x32_bf16 v[100:103], v[156:159], v[72:75], v[100:103]
    v_mfma_f32_16x16x32_bf16 v[108:111], v[156:159], v[76:79], v[108:111]
    v_mfma_f32_16x16x32_bf16 v[124:127], v[12:15], v[76:79], v[124:127]
    v_mfma_f32_16x16x32_bf16 v[104:107], v[152:155], v[76:79], v[104:107]
p2_A_fin:
    s_waitcnt lgkmcnt(0)
    v_rcp_f32 v32, v112
    s_nop 0
    v_mul_f32 v32, v32, v4
    v_mul_f32 v40, v80, v32
    v_mul_f32 v41, v81, v32
    v_mul_f32 v42, v82, v32
    v_mul_f32 v43, v83, v32
    v_mul_f32 v44, v84, v32
    v_mul_f32 v45, v85, v32
    v_mul_f32 v46, v86, v32
    v_mul_f32 v47, v87, v32
    v_cvt_pk_bf16_f32 v128, v40, v41
    v_cvt_pk_bf16_f32 v129, v42, v43
    v_cvt_pk_bf16_f32 v130, v44, v45
    v_cvt_pk_bf16_f32 v131, v46, v47
    buffer_store_dwordx4 v[128:131], v1, s[8:11], s47 offen offset:0 sc1
    v_rcp_f32 v34, v116
    s_nop 0
    v_mul_f32 v34, v34, v5
    v_mul_f32 v40, v88, v34
    v_mul_f32 v41, v89, v34
    v_mul_f32 v42, v90, v34
    v_mul_f32 v43, v91, v34
    v_mul_f32 v44, v92, v34
    v_mul_f32 v45, v93, v34
    v_mul_f32 v46, v94, v34
    v_mul_f32 v47, v95, v34
    v_cvt_pk_bf16_f32 v132, v40, v41
    v_cvt_pk_bf16_f32 v133, v42, v43
    v_cvt_pk_bf16_f32 v134, v44, v45
    v_cvt_pk_bf16_f32 v135, v46, v47
    buffer_store_dwordx4 v[132:135], v1, s[8:11], s47 offen offset:1024 sc1
    v_rcp_f32 v36, v120
    s_nop 0
    v_mul_f32 v36, v36, v4
    v_mul_f32 v40, v96, v36
    v_mul_f32 v41, v97, v36
    v_mul_f32 v42, v98, v36
    v_mul_f32 v43, v99, v36
    v_mul_f32 v44, v100, v36
    v_mul_f32 v45, v101, v36
    v_mul_f32 v46, v102, v36
    v_mul_f32 v47, v103, v36
    v_cvt_pk_bf16_f32 v136, v40, v41
    v_cvt_pk_bf16_f32 v137, v42, v43
    v_cvt_pk_bf16_f32 v138, v44, v45
    v_cvt_pk_bf16_f32 v139, v46, v47
    buffer_store_dwordx4 v[136:139], v1, s[8:11], s56 offen offset:0 sc1
    v_rcp_f32 v38, v124
    s_nop 0
    v_mul_f32 v38, v38, v5
    v_mul_f32 v40, v104, v38
    v_mul_f32 v41, v105, v38
    v_mul_f32 v42, v106, v38
    v_mul_f32 v43, v107, v38
    v_mul_f32 v44, v108, v38
    v_mul_f32 v45, v109, v38
    v_mul_f32 v46, v110, v38
    v_mul_f32 v47, v111, v38
    v_cvt_pk_bf16_f32 v140, v40, v41
    v_cvt_pk_bf16_f32 v141, v42, v43
    v_cvt_pk_bf16_f32 v142, v44, v45
    v_cvt_pk_bf16_f32 v143, v46, v47
    buffer_store_dwordx4 v[140:143], v1, s[8:11], s56 offen offset:1024 sc1
    s_cmp_eq_u32 s58, 0
    s_cbranch_scc1 p2_A_sig
    v_max3_f32 v6, abs(v80), abs(v81), abs(v82)
    v_max3_f32 v6, v6, abs(v83), abs(v84)
    v_max3_f32 v6, v6, abs(v85), abs(v86)
    v_max3_f32 v6, v6, abs(v87), abs(v88)
    v_max3_f32 v6, v6, abs(v89), abs(v90)
    v_max3_f32 v6, v6, abs(v91), abs(v92)
    v_max3_f32 v6, v6, abs(v93), abs(v94)
    v_max3_f32 v6, v6, abs(v95), abs(v96)
    v_max3_f32 v6, v6, abs(v97), abs(v98)
    v_max3_f32 v6, v6, abs(v99), abs(v100)
    v_max3_f32 v6, v6, abs(v101), abs(v102)
    v_max3_f32 v6, v6, abs(v103), abs(v104)
    v_max3_f32 v6, v6, abs(v105), abs(v106)
    v_max3_f32 v6, v6, abs(v107), abs(v108)
    v_max3_f32 v6, v6, abs(v109), abs(v110)
    v_max_f32 v6, v6, abs(v111)
    s_mov_b32 s4, 0x1f800000
    s_mov_b32 s5, 0x5f800000
    s_mov_b32 s6, 0x7b800000
    v_cmp_gt_f32 s[50:51], s6, v6
    v_cmp_lt_f32 s[52:53], s4, v112
    v_cmp_gt_f32 vcc, s5, v112
    s_nop 0
    s_and_b64 s[50:51], s[50:51], s[52:53]
    s_and_b64 s[50:51], s[50:51], vcc
    v_cmp_lt_f32 s[52:53], s4, v116
    v_cmp_gt_f32 vcc, s5, v116
    s_nop 0
    s_and_b64 s[50:51], s[50:51], s[52:53]
    s_and_b64 s[50:51], s[50:51], vcc
    v_cmp_lt_f32 s[52:53], s4, v120
    v_cmp_gt_f32 vcc, s5, v120
    s_nop 0
    s_and_b64 s[50:51], s[50:51], s[52:53]
    s_and_b64 s[50:51], s[50:51], vcc
    v_cmp_lt_f32 s[52:53], s4, v124
    v_cmp_gt_f32 vcc, s5, v124
    s_nop 0
    s_and_b64 s[50:51], s[50:51], s[52:53]
    s_and_b64 s[50:51], s[50:51], vcc
    s_cmp_eq_u64 s[50:51], -1
    s_cbranch_scc0 p2_A_fb
p2_A_sig:
    v_mov_b32 v6, 0x1e800
    s_lshl_b32 s4, s34, 7
    s_lshl_b32 s5, s35, 2
    s_add_u32 s4, s4, s5
    s_add_u32 s4, s4, 0x1c00000
    v_mov_b32 v9, 0
    s_mov_b64 exec, 1
    s_waitcnt vmcnt(0)
    ds_add_rtn_u32 v8, v6, v188
    s_waitcnt lgkmcnt(0)
    v_readfirstlane_b32 s5, v8
    s_nop 1
    s_cmp_lg_u32 s5, 3
    s_cbranch_scc1 p2_fin
    buffer_store_dword v188, v9, s[8:11], s4 offen sc1
    s_branch p2_fin
p2_A_w0:
    s_sleep 1
    ds_read_b32 v189, v187
    s_waitcnt lgkmcnt(0)
    v_cmp_gt_u32 vcc, s58, v189
    s_nop 4
    s_cbranch_vccnz p2_A_w0
    s_branch p2_A_w0r
p2_A_w2:
    s_sleep 1
    ds_read_b32 v189, v187
    s_waitcnt lgkmcnt(0)
    v_cmp_gt_u32 vcc, s58, v189
    s_nop 4
    s_cbranch_vccnz p2_A_w2
    s_branch p2_A_w2r
p2_A_w4:
    s_sleep 1
    ds_read_b32 v189, v187
    s_waitcnt lgkmcnt(0)
    v_cmp_gt_u32 vcc, s58, v189
    s_nop 4
    s_cbranch_vccnz p2_A_w4
    s_branch p2_A_w4r
p2_A_w6:
    s_sleep 1
    ds_read_b32 v189, v187
    s_waitcnt lgkmcnt(0)
    v_cmp_gt_u32 vcc, s58, v189
    s_nop 4
    s_cbranch_vccnz p2_A_w6
    s_branch p2_A_w6r
p2_A_g:
    buffer_load_dword v4, v3, s[8:11], s48 offen offset:0 sc1
    buffer_load_dword v5, v3, s[8:11], s48 offen offset:128 sc1
    s_branch p2_A_nog
p2_A_fb:
    s_waitcnt vmcnt(0)
    s_mov_b32 s58, 0
    v_mov_b32 v176, 0xff800000
    v_mov_b32 v177, 0xff800000
    v_mov_b32 v178, 0xff800000
    v_mov_b32 v179, 0xff800000
    s_mov_b32 s49, 0x1400000
    s_mov_b32 s37, 63
p2_A_fb1:
    buffer_load_dwordx4 v[128:131], v1, s[8:11], s49 offen sc1
    buffer_load_dwordx4 v[132:135], v1, s[8:11], s49 offen offset:1024 sc1
    s_add_u32 s49, s49, 4096
    s_waitcnt vmcnt(0)
    v_mfma_f32_16x16x32_bf16 v[32:35], v[128:131], v[16:19], 0
    v_mfma_f32_16x16x32_bf16 v[40:43], v[128:131], v[20:23], 0
    v_mfma_f32_16x16x32_bf16 v[44:47], v[132:135], v[20:23], 0
    v_mfma_f32_16x16x32_bf16 v[36:39], v[132:135], v[16:19], 0
    v_mfma_f32_16x16x32_bf16 v[48:51], v[128:131], v[24:27], 0
    v_mfma_f32_16x16x32_bf16 v[56:59], v[128:131], v[28:31], 0
    v_mfma_f32_16x16x32_bf16 v[60:63], v[132:135], v[28:31], 0
    v_mfma_f32_16x16x32_bf16 v[52:55], v[132:135], v[24:27], 0
    s_nop 7
    v_max3_f32 v176, v176, v32, v33
    v_max3_f32 v176, v176, v34, v35
    v_max3_f32 v176, v176, v36, v37
    v_max3_f32 v176, v176, v38, v39
    v_max3_f32 v177, v177, v40, v41
    v_max3_f32 v177, v177, v42, v43
    v_max3_f32 v177, v177, v44, v45
    v_max3_f32 v177, v177, v46, v47
    v_max3_f32 v178, v178, v48, v49
    v_max3_f32 v178, v178, v50, v51
    v_max3_f32 v178, v178, v52, v53
    v_max3_f32 v178, v178, v54, v55
    v_max3_f32 v179, v179, v56, v57
    v_max3_f32 v179, v179, v58, v59
    v_max3_f32 v179, v179, v60, v61
    v_max3_f32 v179, v179, v62, v63
    s_sub_u32 s37, s37, 1
    s_cbranch_scc0 p2_A_fb1
    v_mov_b32 v6, v176
    v_mov_b32 v7, v177
    v_mov_b32 v8, v178
    v_mov_b32 v9, v179
    s_nop 1
    v_permlane32_swap_b32 v6, v176
    v_permlane32_swap_b32 v7, v177
    v_permlane32_swap_b32 v8, v178
    v_permlane32_swap_b32 v9, v179
    s_nop 1
    v_max_f32 v176, v176, v6
    v_max_f32 v177, v177, v7
    v_max_f32 v178, v178, v8
    v_max_f32 v179, v179, v9
    v_mov_b32 v6, v176
    v_mov_b32 v7, v177
    v_mov_b32 v8, v178
    v_mov_b32 v9, v179
    s_nop 1
    v_permlane16_swap_b32 v6, v176
    v_permlane16_swap_b32 v7, v177
    v_permlane16_swap_b32 v8, v178
    v_permlane16_swap_b32 v9, v179
    s_nop 1
    v_max_f32 v176, v176, v6
    v_max_f32 v177, v177, v7
    v_max_f32 v178, v178, v8
    v_max_f32 v179, v179, v9
    v_sub_f32 v160, 0, v176
    v_sub_f32 v161, 0, v176
    v_sub_f32 v162, 0, v176
    v_sub_f32 v163, 0, v176
    v_sub_f32 v164, 0, v177
    v_sub_f32 v165, 0, v177
    v_sub_f32 v166, 0, v177
    v_sub_f32 v167, 0, v177
    v_sub_f32 v168, 0, v178
    v_sub_f32 v169, 0, v178
    v_sub_f32 v170, 0, v178
    v_sub_f32 v171, 0, v178
    v_sub_f32 v172, 0, v179
    v_sub_f32 v173, 0, v179
    v_sub_f32 v174, 0, v179
    v_sub_f32 v175, 0, v179
    v_mov_b32 v80, 0
    v_mov_b32 v81, 0
    v_mov_b32 v82, 0
    v_mov_b32 v83, 0
    v_mov_b32 v84, 0
    v_mov_b32 v85, 0
    v_mov_b32 v86, 0
    v_mov_b32 v87, 0
    v_mov_b32 v88, 0
    v_mov_b32 v89, 0
    v_mov_b32 v90, 0
    v_mov_b32 v91, 0
    v_mov_b32 v92, 0
    v_mov_b32 v93, 0
    v_mov_b32 v94, 0
    v_mov_b32 v95, 0
    v_mov_b32 v96, 0
    v_mov_b32 v97, 0
    v_mov_b32 v98, 0
    v_mov_b32 v99, 0
    v_mov_b32 v100, 0
    v_mov_b32 v101, 0
    v_mov_b32 v102, 0
    v_mov_b32 v103, 0
    v_mov_b32 v104, 0
    v_mov_b32 v105, 0
    v_mov_b32 v106, 0
    v_mov_b32 v107, 0
    v_mov_b32 v108, 0
    v_mov_b32 v109, 0
    v_mov_b32 v110, 0
    v_mov_b32 v111, 0
    v_mov_b32 v112, 0
    v_mov_b32 v113, 0
    v_mov_b32 v114, 0
    v_mov_b32 v115, 0
    v_mov_b32 v116, 0
    v_mov_b32 v117, 0
    v_mov_b32 v118, 0
    v_mov_b32 v119, 0
    v_mov_b32 v120, 0
    v_mov_b32 v121, 0
    v_mov_b32 v122, 0
    v_mov_b32 v123, 0
    v_mov_b32 v124, 0
    v_mov_b32 v125, 0
    v_mov_b32 v126, 0
    v_mov_b32 v127, 0
    s_mov_b32 s49, 0x1400000
    s_mov_b32 s37, 63
p2_A_fb2:
    buffer_load_dwordx4 v[128:131], v1, s[8:11], s49 offen offset:0 sc1
    buffer_load_dwordx4 v[132:135], v1, s[8:11], s49 offen offset:1024 sc1
    buffer_load_dwordx4 v[144:147], v1, s[8:11], s49 offen offset:2048 sc1
    buffer_load_dwordx4 v[148:151], v1, s[8:11], s49 offen offset:3072 sc1
    s_add_u32 s49, s49, 4096
    s_waitcnt vmcnt(0)
    v_mfma_f32_16x16x32_bf16 v[32:35], v[128:131], v[16:19], v[160:163]
    v_mfma_f32_16x16x32_bf16 v[40:43], v[128:131], v[20:23], v[164:167]
    v_mfma_f32_16x16x32_bf16 v[44:47], v[132:135], v[20:23], v[164:167]
    v_mfma_f32_16x16x32_bf16 v[36:39], v[132:135], v[16:19], v[160:163]
    v_mfma_f32_16x16x32_bf16 v[48:51], v[128:131], v[24:27], v[168:171]
    v_mfma_f32_16x16x32_bf16 v[56:59], v[128:131], v[28:31], v[172:175]
    v_mfma_f32_16x16x32_bf16 v[60:63], v[132:135], v[28:31], v[172:175]
    v_mfma_f32_16x16x32_bf16 v[52:55], v[132:135], v[24:27], v[168:171]
    s_nop 7
    v_exp_f32 v32, v32
    v_exp_f32 v33, v33
    v_exp_f32 v34, v34
    v_exp_f32 v35, v35
    v_exp_f32 v36, v36
    v_exp_f32 v37, v37
    v_exp_f32 v38, v38
    v_exp_f32 v39, v39
    v_exp_f32 v40, v40
    v_exp_f32 v41, v41
    v_exp_f32 v42, v42
    v_exp_f32 v43, v43
    v_exp_f32 v44, v44
    v_exp_f32 v45, v45
    v_exp_f32 v46, v46
    v_exp_f32 v47, v47
    v_exp_f32 v48, v48
    v_exp_f32 v49, v49
    v_exp_f32 v50, v50
    v_exp_f32 v51, v51
    v_exp_f32 v52, v52
    v_exp_f32 v53, v53
    v_exp_f32 v54, v54
    v_exp_f32 v55, v55
    v_exp_f32 v56, v56
    v_exp_f32 v57, v57
    v_exp_f32 v58, v58
    v_exp_f32 v59, v59
    v_exp_f32 v60, v60
    v_exp_f32 v61, v61
    v_exp_f32 v62, v62
    v_exp_f32 v63, v63
    s_nop 0
    v_cvt_pk_bf16_f32 v64, v32, v33
    v_cvt_pk_bf16_f32 v65, v34, v35
    v_cvt_pk_bf16_f32 v66, v36, v37
    v_cvt_pk_bf16_f32 v67, v38, v39
    v_cvt_pk_bf16_f32 v68, v40, v41
    v_cvt_pk_bf16_f32 v69, v42, v43
    v_cvt_pk_bf16_f32 v70, v44, v45
    v_cvt_pk_bf16_f32 v71, v46, v47
    v_cvt_pk_bf16_f32 v72, v48, v49
    v_cvt_pk_bf16_f32 v73, v50, v51
    v_cvt_pk_bf16_f32 v74, v52, v53
    v_cvt_pk_bf16_f32 v75, v54, v55
    v_cvt_pk_bf16_f32 v76, v56, v57
    v_cvt_pk_bf16_f32 v77, v58, v59
    v_cvt_pk_bf16_f32 v78, v60, v61
    v_cvt_pk_bf16_f32 v79, v62, v63
    s_nop 1
    v_mfma_f32_16x16x32_bf16 v[80:83], v[144:147], v[64:67], v[80:83]
    v_mfma_f32_16x16x32_bf16 v[112:115], v[12:15], v[64:67], v[112:115]
    v_mfma_f32_16x16x32_bf16 v[84:87], v[148:151], v[64:67], v[84:87]
    v_mfma_f32_16x16x32_bf16 v[92:95], v[148:151], v[68:71], v[92:95]
    v_mfma_f32_16x16x32_bf16 v[116:119], v[12:15], v[68:71], v[116:119]
    v_mfma_f32_16x16x32_bf16 v[88:91], v[144:147], v[68:71], v[88:91]
    v_mfma_f32_16x16x32_bf16 v[96:99], v[144:147], v[72:75], v[96:99]
    v_mfma_f32_16x16x32_bf16 v[120:123], v[12:15], v[72:75], v[120:123]
    v_mfma_f32_16x16x32_bf16 v[100:103], v[148:151], v[72:75], v[100:103]
    v_mfma_f32_16x16x32_bf16 v[108:111], v[148:151], v[76:79], v[108:111]
    v_mfma_f32_16x16x32_bf16 v[124:127], v[12:15], v[76:79], v[124:127]
    v_mfma_f32_16x16x32_bf16 v[104:107], v[144:147], v[76:79], v[104:107]
    s_sub_u32 s37, s37, 1
    s_cbranch_scc0 p2_A_fb2
    s_nop 7
    s_branch p2_A_fin
p2_G:
    s_setprio 0
    v_lshrrev_b32 v14, 3, v0
    v_bfe_u32 v15, v0, 1, 2
    v_lshrrev_b32 v16, 4, v0
    v_xor_b32 v15, v15, v16
    v_lshlrev_b32 v14, 11, v14
    v_lshl_add_u32 v14, v15, 5, v14
    v_and_b32 v15, 1, v0
    v_lshl_add_u32 v14, v15, 4, v14
    s_lshl_b32 s4, s35, 7
    s_lshl_b32 s5, s33, 14
    s_add_u32 s5, s5, s4
    v_add_u32 v6, s5, v14
    v_add_u32 v7, 0x10000, v6
    v_add_u32 v8, 0x20000, v6
    s_lshl_b32 s38, s36, 11
    v_add_u32 v25, 0x20000, v1
    s_mov_b32 s39, 0
    s_lshl_b32 s42, s33, 10
    s_mov_b32 s40, s42
    s_add_u32 s41, s42, 0x1e000
    s_lshl_b32 s4, s33, 11
    s_add_u32 s43, s4, 0x1400000
    s_add_u32 s44, s4, 0x20000
    s_mov_b32 s14, 0x700000
    s_mov_b32 s15, 0x20000
    s_mov_b32 s18, 0x200000
    s_mov_b32 s19, 0x20000
    s_mov_b32 s22, 0x400000
    s_mov_b32 s23, 0x20000
    s_lshl_b32 s48, s36, 8
    s_add_u32 s48, s48, 0x1480004
    s_waitcnt lgkmcnt(0)
    s_mov_b32 s8, s24
    s_mov_b32 s9, s25
    s_mov_b32 s12, s26
    s_mov_b32 s13, s27
    s_waitcnt vmcnt(0)
    s_barrier
    s_cmp_lg_u32 s33, 0
    s_cbranch_scc1 p2_G_nosig
    s_waitcnt vmcnt(0)
p2_G_nowb:
    v_mov_b32 v97, 1
    buffer_store_dword v97, v96, s[8:11], 0 offen sc1
p2_G_nosig:
    s_mov_b32 s39, 0xa0000
    s_mov_b32 s16, s28
    s_mov_b32 s17, s29
    s_mov_b32 s20, s30
    s_mov_b32 s21, s31
    v_lshrrev_b32 v14, 2, v0
    v_bfe_u32 v15, v0, 3, 2
    v_lshlrev_b32 v14, 7, v14
    v_lshl_add_u32 v14, v15, 5, v14
    v_and_b32 v15, 3, v0
    v_lshl_add_u32 v2, v15, 3, v14
    v_add_u32 v2, 0x14000, v2
    v_xor_b32 v3, 32, v2
    v_xor_b32 v4, 64, v2
    v_xor_b32 v5, 0x60, v2
    v_mov_b32 v14, 0x1e800
    v_mov_b32 v15, 0
    ds_write_b32 v14, v15
    s_lshl_b32 s4, s33, 8
    s_add_u32 s4, s4, 0x1e000
    v_lshl_add_u32 v20, v0, 2, s4
    v_mov_b32 v22, 1
    ds_write_b32 v20, v22
    v_and_b32 v21, 7, v0
    v_lshlrev_b32 v21, 8, v21
    v_add_u32 v21, 0x1e000, v21
    v_mov_b32 v22, 1
    v_bfe_u32 v24, v0, 2, 1
    v_sub_u32 v24, 1, v24
    v_and_b32 v17, 15, v0
    v_lshlrev_b32 v17, 3, v17
    s_mov_b32 s45, 0x14000
    v_mov_b32 v26, 3
    s_lshl_b32 s4, s2, 2
    s_add_u32 s4, s4, s33
    s_lshl_b32 s62, s4, 8
    s_mul_i32 s61, s4, 768
    s_add_u32 s61, s61, 0x280000
    v_min_u32 v29, 5, v0
    v_lshlrev_b32 v29, 7, v29
    v_and_b32 v31, 1, v0
    v_lshlrev_b32 v31, 7, v31
    s_lshl_b32 s4, s34, 7
    s_add_u32 s4, s4, 0x1c00000
    v_and_b32 v27, 15, v0
    v_lshl_add_u32 v27, v27, 2, s4
    s_mov_b32 s57, 0xa000
    v_and_b32 v14, 31, v0
    v_lshlrev_b32 v14, 2, v14
    s_lshr_b32 s6, s34, 1
    s_lshl_b32 s6, s6, 7
    s_add_u32 s6, s6, 0x1c01000
    s_cmp_lg_u32 s33, 0
    s_cbranch_scc1 p2_G_p1ok
    s_and_b32 s4, s2, 31
    s_lshl_b32 s4, s4, 7
    s_add_u32 s4, s4, 0x1c02000
    s_mov_b32 s5, 0x20000
p2_G_p1:
    buffer_load_dword v15, v14, s[8:11], s4 offen sc1
    s_waitcnt vmcnt(0)
    v_cmp_eq_u32 vcc, 0, v15
    s_sub_u32 s5, s5, 1
    s_cbranch_scc1 p2_G_p1ok
    s_cbranch_vccz p2_G_p1ok
    s_branch p2_G_p1
p2_G_p1ok:
    s_waitcnt lgkmcnt(0)
    s_barrier
    s_mov_b32 m0, s44
    s_add_u32 s44, s44, 8192
    buffer_load_dwordx4 v1, s[8:11], s43 offen sc1 lds
    buffer_load_dwordx4 v1, s[8:11], s43 offen offset:1024 sc1 lds
    s_add_u32 s43, s43, 8192
    s_and_b32 s44, s44, 0x27fff
    s_mov_b32 m0, s44
    s_add_u32 s44, s44, 8192
    buffer_load_dwordx4 v1, s[8:11], s43 offen sc1 lds
    buffer_load_dwordx4 v1, s[8:11], s43 offen offset:1024 sc1 lds
    s_add_u32 s43, s43, 8192
    s_and_b32 s44, s44, 0x27fff
    s_cmp_lg_u32 s33, 0
    s_cbranch_scc1 p2_G_nh
    buffer_load_dword v15, v14, s[8:11], s6 offen sc1
    v_mov_b32 v16, 0x1e804
    s_waitcnt vmcnt(0)
    v_cmp_eq_u32 vcc, 0, v15
    s_nop 1
    v_mov_b32 v15, vcc_lo
    ds_write_b32 v16, v15
p2_G_nh:
    v_mov_b32 v32, 0
    v_mov_b32 v33, 0
    v_mov_b32 v34, 0
    v_mov_b32 v35, 0
    v_mov_b32 v36, 0
    v_mov_b32 v37, 0
    v_mov_b32 v38, 0
    v_mov_b32 v39, 0
    v_mov_b32 v40, 0
    v_mov_b32 v41, 0
    v_mov_b32 v42, 0
    v_mov_b32 v43, 0
    v_mov_b32 v44, 0
    v_mov_b32 v45, 0
    v_mov_b32 v46, 0
    v_mov_b32 v47, 0
    v_mov_b32 v48, 0
    v_mov_b32 v49, 0
    v_mov_b32 v50, 0
    v_mov_b32 v51, 0
    v_mov_b32 v52, 0
    v_mov_b32 v53, 0
    v_mov_b32 v54, 0
    v_mov_b32 v55, 0
    v_mov_b32 v56, 0
    v_mov_b32 v57, 0
    v_mov_b32 v58, 0
    v_mov_b32 v59, 0
    v_mov_b32 v60, 0
    v_mov_b32 v61, 0
    v_mov_b32 v62, 0
    v_mov_b32 v63, 0
    s_waitcnt vmcnt(0) lgkmcnt(0)
    s_barrier
    v_mov_b32 v16, 0x1e804
    ds_read_b32 v15, v16
    s_mov_b32 s5, 0x20000
    s_waitcnt lgkmcnt(0)
    v_cmp_ne_u32 vcc, 0, v15
    s_nop 4
    s_cbranch_vccz p2_G_p2ok
p2_G_p2:
    buffer_load_dword v15, v14, s[8:11], s6 offen sc1
    s_waitcnt vmcnt(0)
    v_cmp_eq_u32 vcc, 0, v15
    s_sub_u32 s5, s5, 1
    s_cbranch_scc1 p2_G_p2ok
    s_cbranch_vccz p2_G_p2ok
    s_sleep 8
    s_branch p2_G_p2
p2_G_p2ok:
    buffer_load_dwordx4 v[128:131], v1, s[8:11], s38 offen offset:0 sc1
    buffer_load_dwordx4 v[132:135], v1, s[8:11], s38 offen offset:1024 sc1
    buffer_load_dwordx4 v[136:139], v25, s[8:11], s38 offen offset:0 sc1
    buffer_load_dwordx4 v[140:143], v25, s[8:11], s38 offen offset:1024 sc1
    s_add_u32 s38, s38, 0x40000
    ds_read_b64_tr_b16 v[64:65], v2 offset:0
    ds_read_b64_tr_b16 v[66:67], v2 offset:2048
    ds_read_b64_tr_b16 v[80:81], v2 offset:4096
    ds_read_b64_tr_b16 v[82:83], v2 offset:6144
    ds_read_b64_tr_b16 v[68:69], v3 offset:0
    ds_read_b64_tr_b16 v[70:71], v3 offset:2048
    ds_read_b64_tr_b16 v[84:85], v3 offset:4096
    ds_read_b64_tr_b16 v[86:87], v3 offset:6144
    ds_read_b64_tr_b16 v[72:73], v4 offset:0
    ds_read_b64_tr_b16 v[74:75], v4 offset:2048
    ds_read_b64_tr_b16 v[88:89], v4 offset:4096
    ds_read_b64_tr_b16 v[90:91], v4 offset:6144
    ds_read_b64_tr_b16 v[76:77], v5 offset:0
    ds_read_b64_tr_b16 v[78:79], v5 offset:2048
    ds_read_b64_tr_b16 v[92:93], v5 offset:4096
    ds_read_b64_tr_b16 v[94:95], v5 offset:6144
    buffer_load_dwordx4 v[144:147], v1, s[8:11], s38 offen offset:0 sc1
    buffer_load_dwordx4 v[148:151], v1, s[8:11], s38 offen offset:1024 sc1
    buffer_load_dwordx4 v[152:155], v25, s[8:11], s38 offen offset:0 sc1
    buffer_load_dwordx4 v[156:159], v25, s[8:11], s38 offen offset:1024 sc1
    s_add_u32 s38, s38, 0x40000
    s_mov_b32 m0, s44
    s_add_u32 s44, s44, 8192
    buffer_load_dwordx4 v1, s[8:11], s43 offen sc1 lds
    buffer_load_dwordx4 v1, s[8:11], s43 offen offset:1024 sc1 lds
    s_add_u32 s43, s43, 8192
    s_and_b32 s44, s44, 0x27fff
    buffer_load_dword v10, v17, s[8:11], s48 offen offset:0 sc1
    buffer_load_dword v12, v17, s[8:11], s48 offen offset:128 sc1
    s_waitcnt vmcnt(8)
    ds_add_u32 v20, v22
    v_add_u32 v24, 1, v24
    s_waitcnt lgkmcnt(13)
    v_mfma_f32_16x16x32_bf16 v[32:35], v[64:67], v[128:131], v[32:35]
    ds_read_b64_tr_b16 v[96:97], v2 offset:8192
    v_mfma_f32_16x16x32_bf16 v[32:35], v[80:83], v[136:139], v[32:35]
    ds_read_b64_tr_b16 v[98:99], v2 offset:10240
    buffer_load_dwordx4 v[160:163], v1, s[8:11], s38 offen offset:0 sc1
    s_waitcnt lgkmcnt(11)
    v_mfma_f32_16x16x32_bf16 v[36:39], v[84:87], v[136:139], v[36:39]
    ds_read_b64_tr_b16 v[112:113], v2 offset:12288
    buffer_load_dwordx4 v[168:171], v25, s[8:11], s38 offen offset:0 sc1
    v_mfma_f32_16x16x32_bf16 v[36:39], v[68:71], v[128:131], v[36:39]
    ds_read_b64_tr_b16 v[114:115], v2 offset:14336
    buffer_load_dwordx4 v[164:167], v1, s[8:11], s38 offen offset:1024 sc1
    s_waitcnt lgkmcnt(9)
    v_mfma_f32_16x16x32_bf16 v[40:43], v[72:75], v[128:131], v[40:43]
    ds_read_b64_tr_b16 v[100:101], v3 offset:8192
    buffer_load_dwordx4 v[172:175], v25, s[8:11], s38 offen offset:1024 sc1
    s_add_u32 s38, s38, 0x40000
    ds_read_b32 v23, v21
    v_mfma_f32_16x16x32_bf16 v[40:43], v[88:91], v[136:139], v[40:43]
    ds_read_b64_tr_b16 v[102:103], v3 offset:10240
    s_waitcnt lgkmcnt(8)
    v_mfma_f32_16x16x32_bf16 v[44:47], v[92:95], v[136:139], v[44:47]
    ds_read_b64_tr_b16 v[116:117], v3 offset:12288
    v_mfma_f32_16x16x32_bf16 v[44:47], v[76:79], v[128:131], v[44:47]
    ds_read_b64_tr_b16 v[118:119], v3 offset:14336
    s_waitcnt lgkmcnt(3)
    v_cmp_gt_i32 vcc, v24, v23
    s_nop 0
    s_cbranch_vccnz p2_G_w0
p2_G_w0r:
    v_mfma_f32_16x16x32_bf16 v[60:63], v[76:79], v[132:135], v[60:63]
    ds_read_b64_tr_b16 v[104:105], v4 offset:8192
    buffer_load_dwordx4 v[176:179], v1, s[8:11], s38 offen offset:0 sc1
    s_mov_b32 m0, s44
    s_add_u32 s44, s44, 8192
    buffer_load_dwordx4 v1, s[8:11], s43 offen sc1 lds
    v_mfma_f32_16x16x32_bf16 v[60:63], v[92:95], v[140:143], v[60:63]
    ds_read_b64_tr_b16 v[106:107], v4 offset:10240
    buffer_load_dwordx4 v[184:187], v25, s[8:11], s38 offen offset:0 sc1
    buffer_load_dwordx4 v1, s[8:11], s43 offen offset:1024 sc1 lds
    v_mfma_f32_16x16x32_bf16 v[56:59], v[88:91], v[140:143], v[56:59]
    ds_read_b64_tr_b16 v[120:121], v4 offset:12288
    s_add_u32 s43, s43, 8192
    s_and_b32 s44, s44, 0x27fff
    s_mov_b32 m0, s40
    v_mfma_f32_16x16x32_bf16 v[56:59], v[72:75], v[132:135], v[56:59]
    ds_read_b64_tr_b16 v[122:123], v4 offset:14336
    buffer_load_dwordx4 v6, s[12:15], s39 offen lds
    v_mfma_f32_16x16x32_bf16 v[52:55], v[68:71], v[132:135], v[52:55]
    ds_read_b64_tr_b16 v[108:109], v5 offset:8192
    s_add_u32 m0, s40, 4096
    v_mfma_f32_16x16x32_bf16 v[52:55], v[84:87], v[140:143], v[52:55]
    ds_read_b64_tr_b16 v[110:111], v5 offset:10240
    buffer_load_dwordx4 v7, s[12:15], s39 offen lds
    v_mfma_f32_16x16x32_bf16 v[48:51], v[80:83], v[140:143], v[48:51]
    ds_read_b64_tr_b16 v[124:125], v5 offset:12288
    s_add_u32 m0, s40, 8192
    s_add_u32 s40, s40, 12288
    buffer_load_dwordx4 v8, s[12:15], s39 offen lds
    v_mfma_f32_16x16x32_bf16 v[48:51], v[64:67], v[132:135], v[48:51]
    ds_read_b64_tr_b16 v[126:127], v5 offset:14336
    buffer_load_dwordx4 v[180:183], v1, s[8:11], s38 offen offset:1024 sc1
    buffer_load_dwordx4 v[188:191], v25, s[8:11], s38 offen offset:1024 sc1
    s_add_u32 s38, s38, 0x40000
    s_add_u32 s39, s39, 0x30000
    s_cmp_eq_u32 s40, s41
    s_cselect_b32 s40, s42, s40
    buffer_load_dword v9, v29, s[12:15], s61 offen
    s_waitcnt vmcnt(21)
    v_mfma_f32_16x16x32_bf16 v[32:35], v[96:99], v[144:147], v[32:35]
    ds_read_b64_tr_b16 v[64:65], v2 offset:16384
    s_add_u32 s61, s61, 0xc0000
    buffer_load_dword v9, v31, s[16:19], s62 offen
    s_waitcnt vmcnt(20)
    v_mfma_f32_16x16x32_bf16 v[32:35], v[112:115], v[152:155], v[32:35]
    ds_read_b64_tr_b16 v[66:67], v2 offset:18432
    buffer_load_dwordx4 v[192:195], v1, s[8:11], s38 offen offset:0 sc1
    s_add_u32 s62, s62, 0x40000
    s_waitcnt lgkmcnt(10)
    v_mfma_f32_16x16x32_bf16 v[36:39], v[116:119], v[152:155], v[36:39]
    ds_read_b64_tr_b16 v[80:81], v2 offset:20480
    buffer_load_dwordx4 v[200:203], v25, s[8:11], s38 offen offset:0 sc1
    v_mfma_f32_16x16x32_bf16 v[36:39], v[100:103], v[144:147], v[36:39]
    ds_read_b64_tr_b16 v[82:83], v2 offset:22528
    buffer_load_dwordx4 v[196:199], v1, s[8:11], s38 offen offset:1024 sc1
    s_waitcnt vmcnt(18)
    ds_add_u32 v20, v22
    v_add_u32 v24, 1, v24
    s_waitcnt lgkmcnt(9)
    v_mfma_f32_16x16x32_bf16 v[40:43], v[104:107], v[144:147], v[40:43]
    ds_read_b64_tr_b16 v[68:69], v3 offset:16384
    buffer_load_dwordx4 v[204:207], v25, s[8:11], s38 offen offset:1024 sc1
    s_add_u32 s38, s38, 0x40000
    v_mfma_f32_16x16x32_bf16 v[40:43], v[120:123], v[152:155], v[40:43]
    ds_read_b64_tr_b16 v[70:71], v3 offset:18432
    s_waitcnt lgkmcnt(7)
    v_mfma_f32_16x16x32_bf16 v[44:47], v[124:127], v[152:155], v[44:47]
    ds_read_b64_tr_b16 v[84:85], v3 offset:20480
    v_mfma_f32_16x16x32_bf16 v[44:47], v[108:111], v[144:147], v[44:47]
    ds_read_b64_tr_b16 v[86:87], v3 offset:22528
    v_mfma_f32_16x16x32_bf16 v[60:63], v[108:111], v[148:151], v[60:63]
    ds_read_b64_tr_b16 v[72:73], v4 offset:16384
    buffer_load_dwordx4 v[128:131], v1, s[8:11], s38 offen offset:0 sc1
    ds_read_b32 v23, v21
    v_mfma_f32_16x16x32_bf16 v[60:63], v[124:127], v[156:159], v[60:63]
    ds_read_b64_tr_b16 v[74:75], v4 offset:18432
    buffer_load_dwordx4 v[136:139], v25, s[8:11], s38 offen offset:0 sc1
    v_mfma_f32_16x16x32_bf16 v[56:59], v[120:123], v[156:159], v[56:59]
    ds_read_b64_tr_b16 v[88:89], v4 offset:20480
    v_mfma_f32_16x16x32_bf16 v[56:59], v[104:107], v[148:151], v[56:59]
    ds_read_b64_tr_b16 v[90:91], v4 offset:22528
    s_waitcnt lgkmcnt(3)
    v_cmp_gt_i32 vcc, v24, v23
    s_nop 0
    s_cbranch_vccnz p2_G_w1
p2_G_w1r:
    v_mfma_f32_16x16x32_bf16 v[52:55], v[100:103], v[148:151], v[52:55]
    ds_read_b64_tr_b16 v[76:77], v5 offset:16384
    s_mov_b32 m0, s44
    s_add_u32 s44, s44, 8192
    buffer_load_dwordx4 v1, s[8:11], s43 offen sc1 lds
    v_mfma_f32_16x16x32_bf16 v[52:55], v[116:119], v[156:159], v[52:55]
    ds_read_b64_tr_b16 v[78:79], v5 offset:18432
    buffer_load_dwordx4 v1, s[8:11], s43 offen offset:1024 sc1 lds
    v_mfma_f32_16x16x32_bf16 v[48:51], v[112:115], v[156:159], v[48:51]
    ds_read_b64_tr_b16 v[92:93], v5 offset:20480
    s_add_u32 s43, s43, 8192
    s_and_b32 s44, s44, 0x27fff
    s_mov_b32 m0, s40
    v_mfma_f32_16x16x32_bf16 v[48:51], v[96:99], v[148:151], v[48:51]
    ds_read_b64_tr_b16 v[94:95], v5 offset:22528
    buffer_load_dwordx4 v[132:135], v1, s[8:11], s38 offen offset:1024 sc1
    buffer_load_dwordx4 v[140:143], v25, s[8:11], s38 offen offset:1024 sc1
    s_add_u32 s38, s38, 0x40000
    buffer_load_dwordx4 v6, s[12:15], s39 offen lds
    s_waitcnt vmcnt(25)
    v_mfma_f32_16x16x32_bf16 v[32:35], v[64:67], v[160:163], v[32:35]
    ds_read_b64_tr_b16 v[96:97], v2 offset:24576
    s_add_u32 m0, s40, 4096
    s_waitcnt vmcnt(24)
    v_mfma_f32_16x16x32_bf16 v[32:35], v[80:83], v[168:171], v[32:35]
    ds_read_b64_tr_b16 v[98:99], v2 offset:26624
    buffer_load_dwordx4 v[144:147], v1, s[8:11], s38 offen offset:0 sc1
    buffer_load_dwordx4 v7, s[12:15], s39 offen lds
    v_mfma_f32_16x16x32_bf16 v[36:39], v[84:87], v[168:171], v[36:39]
    ds_read_b64_tr_b16 v[112:113], v2 offset:28672
    buffer_load_dwordx4 v[152:155], v25, s[8:11], s38 offen offset:0 sc1
    s_add_u32 m0, s40, 8192
    s_add_u32 s40, s40, 12288
    buffer_load_dwordx4 v8, s[12:15], s39 offen lds
    v_mfma_f32_16x16x32_bf16 v[36:39], v[68:71], v[160:163], v[36:39]
    ds_read_b64_tr_b16 v[114:115], v2 offset:30720
    buffer_load_dwordx4 v[148:151], v1, s[8:11], s38 offen offset:1024 sc1
    s_add_u32 s39, s39, 0x30000
    s_cmp_eq_u32 s40, s41
    s_cselect_b32 s40, s42, s40
    s_waitcnt lgkmcnt(8)
    v_mfma_f32_16x16x32_bf16 v[40:43], v[72:75], v[160:163], v[40:43]
    ds_read_b64_tr_b16 v[100:101], v3 offset:24576
    buffer_load_dwordx4 v[156:159], v25, s[8:11], s38 offen offset:1024 sc1
    s_add_u32 s38, s38, 0x40000
    v_mfma_f32_16x16x32_bf16 v[40:43], v[88:91], v[168:171], v[40:43]
    ds_read_b64_tr_b16 v[102:103], v3 offset:26624
    s_waitcnt lgkmcnt(6)
    v_mfma_f32_16x16x32_bf16 v[44:47], v[92:95], v[168:171], v[44:47]
    ds_read_b64_tr_b16 v[116:117], v3 offset:28672
    v_mfma_f32_16x16x32_bf16 v[44:47], v[76:79], v[160:163], v[44:47]
    ds_read_b64_tr_b16 v[118:119], v3 offset:30720
    s_waitcnt vmcnt(14)
    ds_add_u32 v20, v22
    v_add_u32 v24, 1, v24
    v_mfma_f32_16x16x32_bf16 v[60:63], v[76:79], v[164:167], v[60:63]
    ds_read_b64_tr_b16 v[104:105], v4 offset:24576
    buffer_load_dwordx4 v[160:163], v1, s[8:11], s38 offen offset:0 sc1
    v_mfma_f32_16x16x32_bf16 v[60:63], v[92:95], v[172:175], v[60:63]
    ds_read_b64_tr_b16 v[106:107], v4 offset:26624
    buffer_load_dwordx4 v[168:171], v25, s[8:11], s38 offen offset:0 sc1
    v_mfma_f32_16x16x32_bf16 v[56:59], v[88:91], v[172:175], v[56:59]
    ds_read_b64_tr_b16 v[120:121], v4 offset:28672
    v_mfma_f32_16x16x32_bf16 v[56:59], v[72:75], v[164:167], v[56:59]
    ds_read_b64_tr_b16 v[122:123], v4 offset:30720
    v_mfma_f32_16x16x32_bf16 v[52:55], v[68:71], v[164:167], v[52:55]
    ds_read_b64_tr_b16 v[108:109], v5 offset:24576
    ds_read_b32 v23, v21
    v_mfma_f32_16x16x32_bf16 v[52:55], v[84:87], v[172:175], v[52:55]
    ds_read_b64_tr_b16 v[110:111], v5 offset:26624
    v_mfma_f32_16x16x32_bf16 v[48:51], v[80:83], v[172:175], v[48:51]
    ds_read_b64_tr_b16 v[124:125], v5 offset:28672
    v_mfma_f32_16x16x32_bf16 v[48:51], v[64:67], v[164:167], v[48:51]
    ds_read_b64_tr_b16 v[126:127], v5 offset:30720
    buffer_load_dwordx4 v[164:167], v1, s[8:11], s38 offen offset:1024 sc1
    buffer_load_dwordx4 v[172:175], v25, s[8:11], s38 offen offset:1024 sc1
    s_add_u32 s38, s38, 0x40000
    s_waitcnt lgkmcnt(3)
    v_cmp_gt_i32 vcc, v24, v23
    s_nop 0
    s_cbranch_vccnz p2_G_w2
p2_G_w2r:
    v_mfma_f32_16x16x32_bf16 v[32:35], v[96:99], v[176:179], v[32:35]
    ds_read_b64_tr_b16 v[64:65], v2 offset:32768
    s_mov_b32 m0, s44
    s_add_u32 s44, s44, 8192
    buffer_load_dwordx4 v1, s[8:11], s43 offen sc1 lds
    v_mfma_f32_16x16x32_bf16 v[32:35], v[112:115], v[184:187], v[32:35]
    ds_read_b64_tr_b16 v[66:67], v2 offset:34816
    buffer_load_dwordx4 v1, s[8:11], s43 offen offset:1024 sc1 lds
    v_mfma_f32_16x16x32_bf16 v[36:39], v[116:119], v[184:187], v[36:39]
    ds_read_b64_tr_b16 v[80:81], v2 offset:36864
    s_add_u32 s43, s43, 8192
    s_and_b32 s44, s44, 0x27fff
    s_mov_b32 m0, s40
    v_mfma_f32_16x16x32_bf16 v[36:39], v[100:103], v[176:179], v[36:39]
    ds_read_b64_tr_b16 v[82:83], v2 offset:38912
    buffer_load_dwordx4 v6, s[12:15], s39 offen lds
    v_mfma_f32_16x16x32_bf16 v[40:43], v[104:107], v[176:179], v[40:43]
    ds_read_b64_tr_b16 v[68:69], v3 offset:32768
    s_add_u32 m0, s40, 4096
    v_mfma_f32_16x16x32_bf16 v[40:43], v[120:123], v[184:187], v[40:43]
    ds_read_b64_tr_b16 v[70:71], v3 offset:34816
    buffer_load_dwordx4 v7, s[12:15], s39 offen lds
    s_waitcnt lgkmcnt(6)
    v_mfma_f32_16x16x32_bf16 v[44:47], v[124:127], v[184:187], v[44:47]
    ds_read_b64_tr_b16 v[84:85], v3 offset:36864
    s_add_u32 m0, s40, 8192
    s_add_u32 s40, s40, 12288
    buffer_load_dwordx4 v8, s[12:15], s39 offen lds
    v_mfma_f32_16x16x32_bf16 v[44:47], v[108:111], v[176:179], v[44:47]
    ds_read_b64_tr_b16 v[86:87], v3 offset:38912
    s_add_u32 s39, s39, 0x30000
    s_cmp_eq_u32 s40, s41
    s_cselect_b32 s40, s42, s40
    v_mfma_f32_16x16x32_bf16 v[60:63], v[108:111], v[180:183], v[60:63]
    ds_read_b64_tr_b16 v[72:73], v4 offset:32768
    buffer_load_dwordx4 v[176:179], v1, s[8:11], s38 offen offset:0 sc1
    v_mfma_f32_16x16x32_bf16 v[60:63], v[124:127], v[188:191], v[60:63]
    ds_read_b64_tr_b16 v[74:75], v4 offset:34816
    buffer_load_dwordx4 v[184:187], v25, s[8:11], s38 offen offset:0 sc1
    v_mfma_f32_16x16x32_bf16 v[56:59], v[120:123], v[188:191], v[56:59]
    ds_read_b64_tr_b16 v[88:89], v4 offset:36864
    v_mfma_f32_16x16x32_bf16 v[56:59], v[104:107], v[180:183], v[56:59]
    ds_read_b64_tr_b16 v[90:91], v4 offset:38912
    s_waitcnt vmcnt(11)
    ds_add_u32 v20, v22
    v_add_u32 v24, 1, v24
    v_mfma_f32_16x16x32_bf16 v[52:55], v[100:103], v[180:183], v[52:55]
    ds_read_b64_tr_b16 v[76:77], v5 offset:32768
    v_mfma_f32_16x16x32_bf16 v[52:55], v[116:119], v[188:191], v[52:55]
    ds_read_b64_tr_b16 v[78:79], v5 offset:34816
    v_mfma_f32_16x16x32_bf16 v[48:51], v[112:115], v[188:191], v[48:51]
    ds_read_b64_tr_b16 v[92:93], v5 offset:36864
    s_cmp_eq_u32 s45, 0x14000
    s_cselect_b32 s47, 0xfffec000, s57
    v_mfma_f32_16x16x32_bf16 v[48:51], v[96:99], v[180:183], v[48:51]
    ds_read_b64_tr_b16 v[94:95], v5 offset:38912
    buffer_load_dwordx4 v[180:183], v1, s[8:11], s38 offen offset:1024 sc1
    buffer_load_dwordx4 v[188:191], v25, s[8:11], s38 offen offset:1024 sc1
    s_add_u32 s38, s38, 0x40000
    v_add_u32 v2, s47, v2
    v_add_u32 v3, s47, v3
    v_add_u32 v4, s47, v4
    v_add_u32 v5, s47, v5
    s_waitcnt lgkmcnt(13)
    v_mfma_f32_16x16x32_bf16 v[32:35], v[64:67], v[192:195], v[32:35]
    s_add_u32 s45, s45, s47
    ds_read_b64_tr_b16 v[96:97], v2 offset:0
    ds_read_b32 v23, v21
    v_mfma_f32_16x16x32_bf16 v[32:35], v[80:83], v[200:203], v[32:35]
    ds_read_b64_tr_b16 v[98:99], v2 offset:2048
    s_waitcnt lgkmcnt(12)
    v_mfma_f32_16x16x32_bf16 v[36:39], v[84:87], v[200:203], v[36:39]
    ds_read_b64_tr_b16 v[112:113], v2 offset:4096
    v_mfma_f32_16x16x32_bf16 v[36:39], v[68:71], v[192:195], v[36:39]
    ds_read_b64_tr_b16 v[114:115], v2 offset:6144
    s_waitcnt lgkmcnt(3)
    v_cmp_gt_i32 vcc, v24, v23
    s_nop 0
    s_cbranch_vccnz p2_G_w3
p2_G_w3r:
    v_mfma_f32_16x16x32_bf16 v[40:43], v[72:75], v[192:195], v[40:43]
    ds_read_b64_tr_b16 v[100:101], v3 offset:0
    s_mov_b32 m0, s44
    s_add_u32 s44, s44, 8192
    buffer_load_dwordx4 v1, s[8:11], s43 offen sc1 lds
    v_mfma_f32_16x16x32_bf16 v[40:43], v[88:91], v[200:203], v[40:43]
    ds_read_b64_tr_b16 v[102:103], v3 offset:2048
    buffer_load_dwordx4 v1, s[8:11], s43 offen offset:1024 sc1 lds
    v_mfma_f32_16x16x32_bf16 v[44:47], v[92:95], v[200:203], v[44:47]
    ds_read_b64_tr_b16 v[116:117], v3 offset:4096
    s_add_u32 s43, s43, 8192
    s_and_b32 s44, s44, 0x27fff
    s_mov_b32 m0, s40
    v_mfma_f32_16x16x32_bf16 v[44:47], v[76:79], v[192:195], v[44:47]
    ds_read_b64_tr_b16 v[118:119], v3 offset:6144
    buffer_load_dwordx4 v6, s[12:15], s39 offen lds
    v_mfma_f32_16x16x32_bf16 v[60:63], v[76:79], v[196:199], v[60:63]
    ds_read_b64_tr_b16 v[104:105], v4 offset:0
    buffer_load_dwordx4 v[192:195], v1, s[8:11], s38 offen offset:0 sc1
    s_add_u32 m0, s40, 4096
    v_mfma_f32_16x16x32_bf16 v[60:63], v[92:95], v[204:207], v[60:63]
    ds_read_b64_tr_b16 v[106:107], v4 offset:2048
    buffer_load_dwordx4 v[200:203], v25, s[8:11], s38 offen offset:0 sc1
    buffer_load_dwordx4 v7, s[12:15], s39 offen lds
    v_mfma_f32_16x16x32_bf16 v[56:59], v[88:91], v[204:207], v[56:59]
    ds_read_b64_tr_b16 v[120:121], v4 offset:4096
    s_add_u32 m0, s40, 8192
    s_add_u32 s40, s40, 12288
    buffer_load_dwordx4 v8, s[12:15], s39 offen lds
    v_mfma_f32_16x16x32_bf16 v[56:59], v[72:75], v[196:199], v[56:59]
    ds_read_b64_tr_b16 v[122:123], v4 offset:6144
    s_add_u32 s39, s39, 0x30000
    s_cmp_eq_u32 s40, s41
    s_cselect_b32 s40, s42, s40
    v_mfma_f32_16x16x32_bf16 v[52:55], v[68:71], v[196:199], v[52:55]
    ds_read_b64_tr_b16 v[108:109], v5 offset:0
    v_mfma_f32_16x16x32_bf16 v[52:55], v[84:87], v[204:207], v[52:55]
    ds_read_b64_tr_b16 v[110:111], v5 offset:2048
    v_mfma_f32_16x16x32_bf16 v[48:51], v[80:83], v[204:207], v[48:51]
    ds_read_b64_tr_b16 v[124:125], v5 offset:4096
    v_mfma_f32_16x16x32_bf16 v[48:51], v[64:67], v[196:199], v[48:51]
    ds_read_b64_tr_b16 v[126:127], v5 offset:6144
    buffer_load_dwordx4 v[196:199], v1, s[8:11], s38 offen offset:1024 sc1
    buffer_load_dwordx4 v[204:207], v25, s[8:11], s38 offen offset:1024 sc1
    s_add_u32 s38, s38, 0x40000
    s_mov_b32 s37, 2
.p2align 6
p2_G_loop:
    s_waitcnt vmcnt(11)
    ds_add_u32 v20, v22
    v_add_u32 v24, 1, v24
    s_waitcnt lgkmcnt(13)
    v_mfma_f32_16x16x32_bf16 v[32:35], v[96:99], v[128:131], v[32:35]
    ds_read_b64_tr_b16 v[64:65], v2 offset:8192
    v_mfma_f32_16x16x32_bf16 v[32:35], v[112:115], v[136:139], v[32:35]
    ds_read_b64_tr_b16 v[66:67], v2 offset:10240
    s_waitcnt lgkmcnt(11)
    v_mfma_f32_16x16x32_bf16 v[36:39], v[116:119], v[136:139], v[36:39]
    ds_read_b64_tr_b16 v[80:81], v2 offset:12288
    v_mfma_f32_16x16x32_bf16 v[36:39], v[100:103], v[128:131], v[36:39]
    ds_read_b64_tr_b16 v[82:83], v2 offset:14336
    s_waitcnt lgkmcnt(9)
    v_mfma_f32_16x16x32_bf16 v[40:43], v[104:107], v[128:131], v[40:43]
    ds_read_b64_tr_b16 v[68:69], v3 offset:8192
    ds_read_b32 v23, v21
    v_mfma_f32_16x16x32_bf16 v[40:43], v[120:123], v[136:139], v[40:43]
    ds_read_b64_tr_b16 v[70:71], v3 offset:10240
    s_waitcnt lgkmcnt(8)
    v_mfma_f32_16x16x32_bf16 v[44:47], v[124:127], v[136:139], v[44:47]
    ds_read_b64_tr_b16 v[84:85], v3 offset:12288
    v_mfma_f32_16x16x32_bf16 v[44:47], v[108:111], v[128:131], v[44:47]
    ds_read_b64_tr_b16 v[86:87], v3 offset:14336
    s_waitcnt lgkmcnt(3)
    v_cmp_gt_i32 vcc, v24, v23
    s_nop 0
    s_cbranch_vccnz p2_G_w20
p2_G_w20r:
    v_mfma_f32_16x16x32_bf16 v[60:63], v[108:111], v[132:135], v[60:63]
    ds_read_b64_tr_b16 v[72:73], v4 offset:8192
    buffer_load_dwordx4 v[128:131], v1, s[8:11], s38 offen offset:0 sc1
    s_mov_b32 m0, s44
    s_add_u32 s44, s44, 8192
    buffer_load_dwordx4 v1, s[8:11], s43 offen sc1 lds
    v_mfma_f32_16x16x32_bf16 v[60:63], v[124:127], v[140:143], v[60:63]
    ds_read_b64_tr_b16 v[74:75], v4 offset:10240
    buffer_load_dwordx4 v[136:139], v25, s[8:11], s38 offen offset:0 sc1
    buffer_load_dwordx4 v1, s[8:11], s43 offen offset:1024 sc1 lds
    v_mfma_f32_16x16x32_bf16 v[56:59], v[120:123], v[140:143], v[56:59]
    ds_read_b64_tr_b16 v[88:89], v4 offset:12288
    s_add_u32 s43, s43, 8192
    s_and_b32 s44, s44, 0x27fff
    s_mov_b32 m0, s40
    v_mfma_f32_16x16x32_bf16 v[56:59], v[104:107], v[132:135], v[56:59]
    ds_read_b64_tr_b16 v[90:91], v4 offset:14336
    buffer_load_dwordx4 v6, s[12:15], s39 offen lds
    v_mfma_f32_16x16x32_bf16 v[52:55], v[100:103], v[132:135], v[52:55]
    ds_read_b64_tr_b16 v[76:77], v5 offset:8192
    s_add_u32 m0, s40, 4096
    v_mfma_f32_16x16x32_bf16 v[52:55], v[116:119], v[140:143], v[52:55]
    ds_read_b64_tr_b16 v[78:79], v5 offset:10240
    buffer_load_dwordx4 v7, s[12:15], s39 offen lds
    v_mfma_f32_16x16x32_bf16 v[48:51], v[112:115], v[140:143], v[48:51]
    ds_read_b64_tr_b16 v[92:93], v5 offset:12288
    s_add_u32 m0, s40, 8192
    s_add_u32 s40, s40, 12288
    buffer_load_dwordx4 v8, s[12:15], s39 offen lds
    v_mfma_f32_16x16x32_bf16 v[48:51], v[96:99], v[132:135], v[48:51]
    ds_read_b64_tr_b16 v[94:95], v5 offset:14336
    buffer_load_dwordx4 v[132:135], v1, s[8:11], s38 offen offset:1024 sc1
    buffer_load_dwordx4 v[140:143], v25, s[8:11], s38 offen offset:1024 sc1
    s_add_u32 s38, s38, 0x40000
    s_add_u32 s39, s39, 0x30000
    s_cmp_eq_u32 s40, s41
    s_cselect_b32 s40, s42, s40
    buffer_load_dword v9, v29, s[12:15], s61 offen
    v_mfma_f32_16x16x32_bf16 v[32:35], v[64:67], v[144:147], v[32:35]
    ds_read_b64_tr_b16 v[96:97], v2 offset:16384
    s_add_u32 s61, s61, 0xc0000
    buffer_load_dword v9, v31, s[16:19], s62 offen
    v_mfma_f32_16x16x32_bf16 v[32:35], v[80:83], v[152:155], v[32:35]
    ds_read_b64_tr_b16 v[98:99], v2 offset:18432
    s_add_u32 s62, s62, 0x40000
    s_waitcnt lgkmcnt(10)
    v_mfma_f32_16x16x32_bf16 v[36:39], v[84:87], v[152:155], v[36:39]
    ds_read_b64_tr_b16 v[112:113], v2 offset:20480
    v_mfma_f32_16x16x32_bf16 v[36:39], v[68:71], v[144:147], v[36:39]
    ds_read_b64_tr_b16 v[114:115], v2 offset:22528
    s_waitcnt vmcnt(11)
    ds_add_u32 v20, v22
    v_add_u32 v24, 1, v24
    s_waitcnt lgkmcnt(9)
    v_mfma_f32_16x16x32_bf16 v[40:43], v[72:75], v[144:147], v[40:43]
    ds_read_b64_tr_b16 v[100:101], v3 offset:16384
    v_mfma_f32_16x16x32_bf16 v[40:43], v[88:91], v[152:155], v[40:43]
    ds_read_b64_tr_b16 v[102:103], v3 offset:18432
    s_waitcnt lgkmcnt(7)
    v_mfma_f32_16x16x32_bf16 v[44:47], v[92:95], v[152:155], v[44:47]
    ds_read_b64_tr_b16 v[116:117], v3 offset:20480
    v_mfma_f32_16x16x32_bf16 v[44:47], v[76:79], v[144:147], v[44:47]
    ds_read_b64_tr_b16 v[118:119], v3 offset:22528
    v_mfma_f32_16x16x32_bf16 v[60:63], v[76:79], v[148:151], v[60:63]
    ds_read_b64_tr_b16 v[104:105], v4 offset:16384
    buffer_load_dwordx4 v[144:147], v1, s[8:11], s38 offen offset:0 sc1
    ds_read_b32 v23, v21
    v_mfma_f32_16x16x32_bf16 v[60:63], v[92:95], v[156:159], v[60:63]
    ds_read_b64_tr_b16 v[106:107], v4 offset:18432
    buffer_load_dwordx4 v[152:155], v25, s[8:11], s38 offen offset:0 sc1
    v_mfma_f32_16x16x32_bf16 v[56:59], v[88:91], v[156:159], v[56:59]
    ds_read_b64_tr_b16 v[120:121], v4 offset:20480
    v_mfma_f32_16x16x32_bf16 v[56:59], v[72:75], v[148:151], v[56:59]
    ds_read_b64_tr_b16 v[122:123], v4 offset:22528
    s_waitcnt lgkmcnt(3)
    v_cmp_gt_i32 vcc, v24, v23
    s_nop 0
    s_cbranch_vccnz p2_G_w21
p2_G_w21r:
    v_mfma_f32_16x16x32_bf16 v[52:55], v[68:71], v[148:151], v[52:55]
    ds_read_b64_tr_b16 v[108:109], v5 offset:16384
    s_mov_b32 m0, s44
    s_add_u32 s44, s44, 8192
    buffer_load_dwordx4 v1, s[8:11], s43 offen sc1 lds
    v_mfma_f32_16x16x32_bf16 v[52:55], v[84:87], v[156:159], v[52:55]
    ds_read_b64_tr_b16 v[110:111], v5 offset:18432
    buffer_load_dwordx4 v1, s[8:11], s43 offen offset:1024 sc1 lds
    v_mfma_f32_16x16x32_bf16 v[48:51], v[80:83], v[156:159], v[48:51]
    ds_read_b64_tr_b16 v[124:125], v5 offset:20480
    s_add_u32 s43, s43, 8192
    s_and_b32 s44, s44, 0x27fff
    s_mov_b32 m0, s40
    v_mfma_f32_16x16x32_bf16 v[48:51], v[64:67], v[148:151], v[48:51]
    ds_read_b64_tr_b16 v[126:127], v5 offset:22528
    buffer_load_dwordx4 v[148:151], v1, s[8:11], s38 offen offset:1024 sc1
    buffer_load_dwordx4 v[156:159], v25, s[8:11], s38 offen offset:1024 sc1
    s_add_u32 s38, s38, 0x40000
    buffer_load_dwordx4 v6, s[12:15], s39 offen lds
    v_mfma_f32_16x16x32_bf16 v[32:35], v[96:99], v[160:163], v[32:35]
    ds_read_b64_tr_b16 v[64:65], v2 offset:24576
    s_add_u32 m0, s40, 4096
    v_mfma_f32_16x16x32_bf16 v[32:35], v[112:115], v[168:171], v[32:35]
    ds_read_b64_tr_b16 v[66:67], v2 offset:26624
    buffer_load_dwordx4 v7, s[12:15], s39 offen lds
    v_mfma_f32_16x16x32_bf16 v[36:39], v[116:119], v[168:171], v[36:39]
    ds_read_b64_tr_b16 v[80:81], v2 offset:28672
    s_add_u32 m0, s40, 8192
    s_add_u32 s40, s40, 12288
    buffer_load_dwordx4 v8, s[12:15], s39 offen lds
    v_mfma_f32_16x16x32_bf16 v[36:39], v[100:103], v[160:163], v[36:39]
    ds_read_b64_tr_b16 v[82:83], v2 offset:30720
    s_add_u32 s39, s39, 0x30000
    s_cmp_eq_u32 s40, s41
    s_cselect_b32 s40, s42, s40
    s_waitcnt lgkmcnt(8)
    v_mfma_f32_16x16x32_bf16 v[40:43], v[104:107], v[160:163], v[40:43]
    ds_read_b64_tr_b16 v[68:69], v3 offset:24576
    v_mfma_f32_16x16x32_bf16 v[40:43], v[120:123], v[168:171], v[40:43]
    ds_read_b64_tr_b16 v[70:71], v3 offset:26624
    s_waitcnt lgkmcnt(6)
    v_mfma_f32_16x16x32_bf16 v[44:47], v[124:127], v[168:171], v[44:47]
    ds_read_b64_tr_b16 v[84:85], v3 offset:28672
    v_mfma_f32_16x16x32_bf16 v[44:47], v[108:111], v[160:163], v[44:47]
    ds_read_b64_tr_b16 v[86:87], v3 offset:30720
    s_waitcnt vmcnt(9)
    ds_add_u32 v20, v22
    v_add_u32 v24, 1, v24
    v_mfma_f32_16x16x32_bf16 v[60:63], v[108:111], v[164:167], v[60:63]
    ds_read_b64_tr_b16 v[72:73], v4 offset:24576
    buffer_load_dwordx4 v[160:163], v1, s[8:11], s38 offen offset:0 sc1
    v_mfma_f32_16x16x32_bf16 v[60:63], v[124:127], v[172:175], v[60:63]
    ds_read_b64_tr_b16 v[74:75], v4 offset:26624
    buffer_load_dwordx4 v[168:171], v25, s[8:11], s38 offen offset:0 sc1
    v_mfma_f32_16x16x32_bf16 v[56:59], v[120:123], v[172:175], v[56:59]
    ds_read_b64_tr_b16 v[88:89], v4 offset:28672
    v_mfma_f32_16x16x32_bf16 v[56:59], v[104:107], v[164:167], v[56:59]
    ds_read_b64_tr_b16 v[90:91], v4 offset:30720
    v_mfma_f32_16x16x32_bf16 v[52:55], v[100:103], v[164:167], v[52:55]
    ds_read_b64_tr_b16 v[76:77], v5 offset:24576
    ds_read_b32 v23, v21
    v_mfma_f32_16x16x32_bf16 v[52:55], v[116:119], v[172:175], v[52:55]
    ds_read_b64_tr_b16 v[78:79], v5 offset:26624
    v_mfma_f32_16x16x32_bf16 v[48:51], v[112:115], v[172:175], v[48:51]
    ds_read_b64_tr_b16 v[92:93], v5 offset:28672
    v_mfma_f32_16x16x32_bf16 v[48:51], v[96:99], v[164:167], v[48:51]
    ds_read_b64_tr_b16 v[94:95], v5 offset:30720
    buffer_load_dwordx4 v[164:167], v1, s[8:11], s38 offen offset:1024 sc1
    buffer_load_dwordx4 v[172:175], v25, s[8:11], s38 offen offset:1024 sc1
    s_add_u32 s38, s38, 0x40000
    s_waitcnt lgkmcnt(3)
    v_cmp_gt_i32 vcc, v24, v23
    s_nop 0
    s_cbranch_vccnz p2_G_w22
p2_G_w22r:
    v_mfma_f32_16x16x32_bf16 v[32:35], v[64:67], v[176:179], v[32:35]
    ds_read_b64_tr_b16 v[96:97], v2 offset:32768
    s_mov_b32 m0, s44
    s_add_u32 s44, s44, 8192
    buffer_load_dwordx4 v1, s[8:11], s43 offen sc1 lds
    v_mfma_f32_16x16x32_bf16 v[32:35], v[80:83], v[184:187], v[32:35]
    ds_read_b64_tr_b16 v[98:99], v2 offset:34816
    buffer_load_dwordx4 v1, s[8:11], s43 offen offset:1024 sc1 lds
    v_mfma_f32_16x16x32_bf16 v[36:39], v[84:87], v[184:187], v[36:39]
    ds_read_b64_tr_b16 v[112:113], v2 offset:36864
    s_add_u32 s43, s43, 8192
    s_and_b32 s44, s44, 0x27fff
    s_mov_b32 m0, s40
    v_mfma_f32_16x16x32_bf16 v[36:39], v[68:71], v[176:179], v[36:39]
    ds_read_b64_tr_b16 v[114:115], v2 offset:38912
    buffer_load_dwordx4 v6, s[12:15], s39 offen lds
    v_mfma_f32_16x16x32_bf16 v[40:43], v[72:75], v[176:179], v[40:43]
    ds_read_b64_tr_b16 v[100:101], v3 offset:32768
    s_add_u32 m0, s40, 4096
    v_mfma_f32_16x16x32_bf16 v[40:43], v[88:91], v[184:187], v[40:43]
    ds_read_b64_tr_b16 v[102:103], v3 offset:34816
    buffer_load_dwordx4 v7, s[12:15], s39 offen lds
    s_waitcnt lgkmcnt(6)
    v_mfma_f32_16x16x32_bf16 v[44:47], v[92:95], v[184:187], v[44:47]
    ds_read_b64_tr_b16 v[116:117], v3 offset:36864
    s_add_u32 m0, s40, 8192
    s_add_u32 s40, s40, 12288
    buffer_load_dwordx4 v8, s[12:15], s39 offen lds
    v_mfma_f32_16x16x32_bf16 v[44:47], v[76:79], v[176:179], v[44:47]
    ds_read_b64_tr_b16 v[118:119], v3 offset:38912
    s_add_u32 s39, s39, 0x30000
    s_cmp_eq_u32 s40, s41
    s_cselect_b32 s40, s42, s40
    v_mfma_f32_16x16x32_bf16 v[60:63], v[76:79], v[180:183], v[60:63]
    ds_read_b64_tr_b16 v[104:105], v4 offset:32768
    buffer_load_dwordx4 v[176:179], v1, s[8:11], s38 offen offset:0 sc1
    v_mfma_f32_16x16x32_bf16 v[60:63], v[92:95], v[188:191], v[60:63]
    ds_read_b64_tr_b16 v[106:107], v4 offset:34816
    buffer_load_dwordx4 v[184:187], v25, s[8:11], s38 offen offset:0 sc1
    v_mfma_f32_16x16x32_bf16 v[56:59], v[88:91], v[188:191], v[56:59]
    ds_read_b64_tr_b16 v[120:121], v4 offset:36864
    v_mfma_f32_16x16x32_bf16 v[56:59], v[72:75], v[180:183], v[56:59]
    ds_read_b64_tr_b16 v[122:123], v4 offset:38912
    s_waitcnt vmcnt(11)
    ds_add_u32 v20, v22
    v_add_u32 v24, 1, v24
    v_mfma_f32_16x16x32_bf16 v[52:55], v[68:71], v[180:183], v[52:55]
    ds_read_b64_tr_b16 v[108:109], v5 offset:32768
    v_mfma_f32_16x16x32_bf16 v[52:55], v[84:87], v[188:191], v[52:55]
    ds_read_b64_tr_b16 v[110:111], v5 offset:34816
    v_mfma_f32_16x16x32_bf16 v[48:51], v[80:83], v[188:191], v[48:51]
    ds_read_b64_tr_b16 v[124:125], v5 offset:36864
    s_cmp_eq_u32 s45, 0x14000
    s_cselect_b32 s47, 0xfffec000, s57
    v_mfma_f32_16x16x32_bf16 v[48:51], v[64:67], v[180:183], v[48:51]
    ds_read_b64_tr_b16 v[126:127], v5 offset:38912
    buffer_load_dwordx4 v[180:183], v1, s[8:11], s38 offen offset:1024 sc1
    buffer_load_dwordx4 v[188:191], v25, s[8:11], s38 offen offset:1024 sc1
    s_add_u32 s38, s38, 0x40000
    v_add_u32 v2, s47, v2
    v_add_u32 v3, s47, v3
    v_add_u32 v4, s47, v4
    v_add_u32 v5, s47, v5
    s_waitcnt lgkmcnt(13)
    v_mfma_f32_16x16x32_bf16 v[32:35], v[96:99], v[192:195], v[32:35]
    s_add_u32 s45, s45, s47
    ds_read_b64_tr_b16 v[64:65], v2 offset:0
    ds_read_b32 v23, v21
    v_mfma_f32_16x16x32_bf16 v[32:35], v[112:115], v[200:203], v[32:35]
    ds_read_b64_tr_b16 v[66:67], v2 offset:2048
    s_waitcnt lgkmcnt(12)
    v_mfma_f32_16x16x32_bf16 v[36:39], v[116:119], v[200:203], v[36:39]
    ds_read_b64_tr_b16 v[80:81], v2 offset:4096
    v_mfma_f32_16x16x32_bf16 v[36:39], v[100:103], v[192:195], v[36:39]
    ds_read_b64_tr_b16 v[82:83], v2 offset:6144
    s_waitcnt lgkmcnt(3)
    v_cmp_gt_i32 vcc, v24, v23
    s_nop 0
    s_cbranch_vccnz p2_G_w23
p2_G_w23r:
    v_mfma_f32_16x16x32_bf16 v[40:43], v[104:107], v[192:195], v[40:43]
    ds_read_b64_tr_b16 v[68:69], v3 offset:0
    s_mov_b32 m0, s44
    s_add_u32 s44, s44, 8192
    buffer_load_dwordx4 v1, s[8:11], s43 offen sc1 lds
    v_mfma_f32_16x16x32_bf16 v[40:43], v[120:123], v[200:203], v[40:43]
    ds_read_b64_tr_b16 v[70:71], v3 offset:2048
    buffer_load_dwordx4 v1, s[8:11], s43 offen offset:1024 sc1 lds
    v_mfma_f32_16x16x32_bf16 v[44:47], v[124:127], v[200:203], v[44:47]
    ds_read_b64_tr_b16 v[84:85], v3 offset:4096
    s_add_u32 s43, s43, 8192
    s_and_b32 s44, s44, 0x27fff
    s_mov_b32 m0, s40
    v_mfma_f32_16x16x32_bf16 v[44:47], v[108:111], v[192:195], v[44:47]
    ds_read_b64_tr_b16 v[86:87], v3 offset:6144
    buffer_load_dwordx4 v6, s[12:15], s39 offen lds
    v_mfma_f32_16x16x32_bf16 v[60:63], v[108:111], v[196:199], v[60:63]
    ds_read_b64_tr_b16 v[72:73], v4 offset:0
    buffer_load_dwordx4 v[192:195], v1, s[8:11], s38 offen offset:0 sc1
    s_add_u32 m0, s40, 4096
    v_mfma_f32_16x16x32_bf16 v[60:63], v[124:127], v[204:207], v[60:63]
    ds_read_b64_tr_b16 v[74:75], v4 offset:2048
    buffer_load_dwordx4 v[200:203], v25, s[8:11], s38 offen offset:0 sc1
    buffer_load_dwordx4 v7, s[12:15], s39 offen lds
    v_mfma_f32_16x16x32_bf16 v[56:59], v[120:123], v[204:207], v[56:59]
    ds_read_b64_tr_b16 v[88:89], v4 offset:4096
    s_add_u32 m0, s40, 8192
    s_add_u32 s40, s40, 12288
    buffer_load_dwordx4 v8, s[12:15], s39 offen lds
    v_mfma_f32_16x16x32_bf16 v[56:59], v[104:107], v[196:199], v[56:59]
    ds_read_b64_tr_b16 v[90:91], v4 offset:6144
    s_add_u32 s39, s39, 0x30000
    s_cmp_eq_u32 s40, s41
    s_cselect_b32 s40, s42, s40
    v_mfma_f32_16x16x32_bf16 v[52:55], v[100:103], v[196:199], v[52:55]
    ds_read_b64_tr_b16 v[76:77], v5 offset:0
    v_mfma_f32_16x16x32_bf16 v[52:55], v[116:119], v[204:207], v[52:55]
    ds_read_b64_tr_b16 v[78:79], v5 offset:2048
    v_mfma_f32_16x16x32_bf16 v[48:51], v[112:115], v[204:207], v[48:51]
    ds_read_b64_tr_b16 v[92:93], v5 offset:4096
    v_mfma_f32_16x16x32_bf16 v[48:51], v[96:99], v[196:199], v[48:51]
    ds_read_b64_tr_b16 v[94:95], v5 offset:6144
    buffer_load_dwordx4 v[196:199], v1, s[8:11], s38 offen offset:1024 sc1
    buffer_load_dwordx4 v[204:207], v25, s[8:11], s38 offen offset:1024 sc1
    s_add_u32 s38, s38, 0x40000
    s_waitcnt vmcnt(11)
    ds_add_u32 v20, v22
    v_add_u32 v24, 1, v24
    s_waitcnt lgkmcnt(13)
    v_mfma_f32_16x16x32_bf16 v[32:35], v[64:67], v[128:131], v[32:35]
    ds_read_b64_tr_b16 v[96:97], v2 offset:8192
    v_mfma_f32_16x16x32_bf16 v[32:35], v[80:83], v[136:139], v[32:35]
    ds_read_b64_tr_b16 v[98:99], v2 offset:10240
    s_waitcnt lgkmcnt(11)
    v_mfma_f32_16x16x32_bf16 v[36:39], v[84:87], v[136:139], v[36:39]
    ds_read_b64_tr_b16 v[112:113], v2 offset:12288
    v_mfma_f32_16x16x32_bf16 v[36:39], v[68:71], v[128:131], v[36:39]
    ds_read_b64_tr_b16 v[114:115], v2 offset:14336
    s_waitcnt lgkmcnt(9)
    v_mfma_f32_16x16x32_bf16 v[40:43], v[72:75], v[128:131], v[40:43]
    ds_read_b64_tr_b16 v[100:101], v3 offset:8192
    ds_read_b32 v23, v21
    v_mfma_f32_16x16x32_bf16 v[40:43], v[88:91], v[136:139], v[40:43]
    ds_read_b64_tr_b16 v[102:103], v3 offset:10240
    s_waitcnt lgkmcnt(8)
    v_mfma_f32_16x16x32_bf16 v[44:47], v[92:95], v[136:139], v[44:47]
    ds_read_b64_tr_b16 v[116:117], v3 offset:12288
    v_mfma_f32_16x16x32_bf16 v[44:47], v[76:79], v[128:131], v[44:47]
    ds_read_b64_tr_b16 v[118:119], v3 offset:14336
    s_waitcnt lgkmcnt(3)
    v_cmp_gt_i32 vcc, v24, v23
    s_nop 0
    s_cbranch_vccnz p2_G_w24
p2_G_w24r:
    v_mfma_f32_16x16x32_bf16 v[60:63], v[76:79], v[132:135], v[60:63]
    ds_read_b64_tr_b16 v[104:105], v4 offset:8192
    buffer_load_dwordx4 v[128:131], v1, s[8:11], s38 offen offset:0 sc1
    s_mov_b32 m0, s44
    s_add_u32 s44, s44, 8192
    buffer_load_dwordx4 v1, s[8:11], s43 offen sc1 lds
    v_mfma_f32_16x16x32_bf16 v[60:63], v[92:95], v[140:143], v[60:63]
    ds_read_b64_tr_b16 v[106:107], v4 offset:10240
    buffer_load_dwordx4 v[136:139], v25, s[8:11], s38 offen offset:0 sc1
    buffer_load_dwordx4 v1, s[8:11], s43 offen offset:1024 sc1 lds
    v_mfma_f32_16x16x32_bf16 v[56:59], v[88:91], v[140:143], v[56:59]
    ds_read_b64_tr_b16 v[120:121], v4 offset:12288
    s_add_u32 s43, s43, 8192
    s_and_b32 s44, s44, 0x27fff
    s_mov_b32 m0, s40
    v_mfma_f32_16x16x32_bf16 v[56:59], v[72:75], v[132:135], v[56:59]
    ds_read_b64_tr_b16 v[122:123], v4 offset:14336
    buffer_load_dwordx4 v6, s[12:15], s39 offen lds
    v_mfma_f32_16x16x32_bf16 v[52:55], v[68:71], v[132:135], v[52:55]
    ds_read_b64_tr_b16 v[108:109], v5 offset:8192
    s_add_u32 m0, s40, 4096
    v_mfma_f32_16x16x32_bf16 v[52:55], v[84:87], v[140:143], v[52:55]
    ds_read_b64_tr_b16 v[110:111], v5 offset:10240
    buffer_load_dwordx4 v7, s[12:15], s39 offen lds
    v_mfma_f32_16x16x32_bf16 v[48:51], v[80:83], v[140:143], v[48:51]
    ds_read_b64_tr_b16 v[124:125], v5 offset:12288
    s_add_u32 m0, s40, 8192
    s_add_u32 s40, s40, 12288
    buffer_load_dwordx4 v8, s[12:15], s39 offen lds
    v_mfma_f32_16x16x32_bf16 v[48:51], v[64:67], v[132:135], v[48:51]
    ds_read_b64_tr_b16 v[126:127], v5 offset:14336
    buffer_load_dwordx4 v[132:135], v1, s[8:11], s38 offen offset:1024 sc1
    buffer_load_dwordx4 v[140:143], v25, s[8:11], s38 offen offset:1024 sc1
    s_add_u32 s38, s38, 0x40000
    s_add_u32 s39, s39, 0x30000
    s_cmp_eq_u32 s40, s41
    s_cselect_b32 s40, s42, s40
    buffer_load_dword v9, v29, s[12:15], s61 offen
    v_mfma_f32_16x16x32_bf16 v[32:35], v[96:99], v[144:147], v[32:35]
    ds_read_b64_tr_b16 v[64:65], v2 offset:16384
    s_add_u32 s61, s61, 0xc0000
    buffer_load_dword v9, v31, s[16:19], s62 offen
    v_mfma_f32_16x16x32_bf16 v[32:35], v[112:115], v[152:155], v[32:35]
    ds_read_b64_tr_b16 v[66:67], v2 offset:18432
    s_add_u32 s62, s62, 0x40000
    s_waitcnt lgkmcnt(10)
    v_mfma_f32_16x16x32_bf16 v[36:39], v[116:119], v[152:155], v[36:39]
    ds_read_b64_tr_b16 v[80:81], v2 offset:20480
    v_mfma_f32_16x16x32_bf16 v[36:39], v[100:103], v[144:147], v[36:39]
    ds_read_b64_tr_b16 v[82:83], v2 offset:22528
    s_waitcnt vmcnt(11)
    ds_add_u32 v20, v22
    v_add_u32 v24, 1, v24
    s_waitcnt lgkmcnt(9)
    v_mfma_f32_16x16x32_bf16 v[40:43], v[104:107], v[144:147], v[40:43]
    ds_read_b64_tr_b16 v[68:69], v3 offset:16384
    v_mfma_f32_16x16x32_bf16 v[40:43], v[120:123], v[152:155], v[40:43]
    ds_read_b64_tr_b16 v[70:71], v3 offset:18432
    s_waitcnt lgkmcnt(7)
    v_mfma_f32_16x16x32_bf16 v[44:47], v[124:127], v[152:155], v[44:47]
    ds_read_b64_tr_b16 v[84:85], v3 offset:20480
    v_mfma_f32_16x16x32_bf16 v[44:47], v[108:111], v[144:147], v[44:47]
    ds_read_b64_tr_b16 v[86:87], v3 offset:22528
    v_mfma_f32_16x16x32_bf16 v[60:63], v[108:111], v[148:151], v[60:63]
    ds_read_b64_tr_b16 v[72:73], v4 offset:16384
    buffer_load_dwordx4 v[144:147], v1, s[8:11], s38 offen offset:0 sc1
    ds_read_b32 v23, v21
    v_mfma_f32_16x16x32_bf16 v[60:63], v[124:127], v[156:159], v[60:63]
    ds_read_b64_tr_b16 v[74:75], v4 offset:18432
    buffer_load_dwordx4 v[152:155], v25, s[8:11], s38 offen offset:0 sc1
    v_mfma_f32_16x16x32_bf16 v[56:59], v[120:123], v[156:159], v[56:59]
    ds_read_b64_tr_b16 v[88:89], v4 offset:20480
    v_mfma_f32_16x16x32_bf16 v[56:59], v[104:107], v[148:151], v[56:59]
    ds_read_b64_tr_b16 v[90:91], v4 offset:22528
    s_waitcnt lgkmcnt(3)
    v_cmp_gt_i32 vcc, v24, v23
    s_nop 0
    s_cbranch_vccnz p2_G_w25
p2_G_w25r:
    v_mfma_f32_16x16x32_bf16 v[52:55], v[100:103], v[148:151], v[52:55]
    ds_read_b64_tr_b16 v[76:77], v5 offset:16384
    s_mov_b32 m0, s44
    s_add_u32 s44, s44, 8192
    buffer_load_dwordx4 v1, s[8:11], s43 offen sc1 lds
    v_mfma_f32_16x16x32_bf16 v[52:55], v[116:119], v[156:159], v[52:55]
    ds_read_b64_tr_b16 v[78:79], v5 offset:18432
    buffer_load_dwordx4 v1, s[8:11], s43 offen offset:1024 sc1 lds
    v_mfma_f32_16x16x32_bf16 v[48:51], v[112:115], v[156:159], v[48:51]
    ds_read_b64_tr_b16 v[92:93], v5 offset:20480
    s_add_u32 s43, s43, 8192
    s_and_b32 s44, s44, 0x27fff
    s_mov_b32 m0, s40
    v_mfma_f32_16x16x32_bf16 v[48:51], v[96:99], v[148:151], v[48:51]
    ds_read_b64_tr_b16 v[94:95], v5 offset:22528
    buffer_load_dwordx4 v[148:151], v1, s[8:11], s38 offen offset:1024 sc1
    buffer_load_dwordx4 v[156:159], v25, s[8:11], s38 offen offset:1024 sc1
    s_add_u32 s38, s38, 0x40000
    buffer_load_dwordx4 v6, s[12:15], s39 offen lds
    v_mfma_f32_16x16x32_bf16 v[32:35], v[64:67], v[160:163], v[32:35]
    ds_read_b64_tr_b16 v[96:97], v2 offset:24576
    s_add_u32 m0, s40, 4096
    v_mfma_f32_16x16x32_bf16 v[32:35], v[80:83], v[168:171], v[32:35]
    ds_read_b64_tr_b16 v[98:99], v2 offset:26624
    buffer_load_dwordx4 v7, s[12:15], s39 offen lds
    v_mfma_f32_16x16x32_bf16 v[36:39], v[84:87], v[168:171], v[36:39]
    ds_read_b64_tr_b16 v[112:113], v2 offset:28672
    s_add_u32 m0, s40, 8192
    s_add_u32 s40, s40, 12288
    buffer_load_dwordx4 v8, s[12:15], s39 offen lds
    v_mfma_f32_16x16x32_bf16 v[36:39], v[68:71], v[160:163], v[36:39]
    ds_read_b64_tr_b16 v[114:115], v2 offset:30720
    s_add_u32 s39, s39, 0x30000
    s_cmp_eq_u32 s40, s41
    s_cselect_b32 s40, s42, s40
    s_waitcnt lgkmcnt(8)
    v_mfma_f32_16x16x32_bf16 v[40:43], v[72:75], v[160:163], v[40:43]
    ds_read_b64_tr_b16 v[100:101], v3 offset:24576
    v_mfma_f32_16x16x32_bf16 v[40:43], v[88:91], v[168:171], v[40:43]
    ds_read_b64_tr_b16 v[102:103], v3 offset:26624
    s_waitcnt lgkmcnt(6)
    v_mfma_f32_16x16x32_bf16 v[44:47], v[92:95], v[168:171], v[44:47]
    ds_read_b64_tr_b16 v[116:117], v3 offset:28672
    v_mfma_f32_16x16x32_bf16 v[44:47], v[76:79], v[160:163], v[44:47]
    ds_read_b64_tr_b16 v[118:119], v3 offset:30720
    s_waitcnt vmcnt(9)
    ds_add_u32 v20, v22
    v_add_u32 v24, 1, v24
    v_mfma_f32_16x16x32_bf16 v[60:63], v[76:79], v[164:167], v[60:63]
    ds_read_b64_tr_b16 v[104:105], v4 offset:24576
    buffer_load_dwordx4 v[160:163], v1, s[8:11], s38 offen offset:0 sc1
    v_mfma_f32_16x16x32_bf16 v[60:63], v[92:95], v[172:175], v[60:63]
    ds_read_b64_tr_b16 v[106:107], v4 offset:26624
    buffer_load_dwordx4 v[168:171], v25, s[8:11], s38 offen offset:0 sc1
    v_mfma_f32_16x16x32_bf16 v[56:59], v[88:91], v[172:175], v[56:59]
    ds_read_b64_tr_b16 v[120:121], v4 offset:28672
    v_mfma_f32_16x16x32_bf16 v[56:59], v[72:75], v[164:167], v[56:59]
    ds_read_b64_tr_b16 v[122:123], v4 offset:30720
    v_mfma_f32_16x16x32_bf16 v[52:55], v[68:71], v[164:167], v[52:55]
    ds_read_b64_tr_b16 v[108:109], v5 offset:24576
    ds_read_b32 v23, v21
    v_mfma_f32_16x16x32_bf16 v[52:55], v[84:87], v[172:175], v[52:55]
    ds_read_b64_tr_b16 v[110:111], v5 offset:26624
    v_mfma_f32_16x16x32_bf16 v[48:51], v[80:83], v[172:175], v[48:51]
    ds_read_b64_tr_b16 v[124:125], v5 offset:28672
    v_mfma_f32_16x16x32_bf16 v[48:51], v[64:67], v[164:167], v[48:51]
    ds_read_b64_tr_b16 v[126:127], v5 offset:30720
    buffer_load_dwordx4 v[164:167], v1, s[8:11], s38 offen offset:1024 sc1
    buffer_load_dwordx4 v[172:175], v25, s[8:11], s38 offen offset:1024 sc1
    s_add_u32 s38, s38, 0x40000
    s_waitcnt lgkmcnt(3)
    v_cmp_gt_i32 vcc, v24, v23
    s_nop 0
    s_cbranch_vccnz p2_G_w26
p2_G_w26r:
    v_mfma_f32_16x16x32_bf16 v[32:35], v[96:99], v[176:179], v[32:35]
    ds_read_b64_tr_b16 v[64:65], v2 offset:32768
    s_mov_b32 m0, s44
    s_add_u32 s44, s44, 8192
    buffer_load_dwordx4 v1, s[8:11], s43 offen sc1 lds
    v_mfma_f32_16x16x32_bf16 v[32:35], v[112:115], v[184:187], v[32:35]
    ds_read_b64_tr_b16 v[66:67], v2 offset:34816
    buffer_load_dwordx4 v1, s[8:11], s43 offen offset:1024 sc1 lds
    v_mfma_f32_16x16x32_bf16 v[36:39], v[116:119], v[184:187], v[36:39]
    ds_read_b64_tr_b16 v[80:81], v2 offset:36864
    s_add_u32 s43, s43, 8192
    s_and_b32 s44, s44, 0x27fff
    s_mov_b32 m0, s40
    v_mfma_f32_16x16x32_bf16 v[36:39], v[100:103], v[176:179], v[36:39]
    ds_read_b64_tr_b16 v[82:83], v2 offset:38912
    buffer_load_dwordx4 v6, s[12:15], s39 offen lds
    v_mfma_f32_16x16x32_bf16 v[40:43], v[104:107], v[176:179], v[40:43]
    ds_read_b64_tr_b16 v[68:69], v3 offset:32768
    s_add_u32 m0, s40, 4096
    v_mfma_f32_16x16x32_bf16 v[40:43], v[120:123], v[184:187], v[40:43]
    ds_read_b64_tr_b16 v[70:71], v3 offset:34816
    buffer_load_dwordx4 v7, s[12:15], s39 offen lds
    s_waitcnt lgkmcnt(6)
    v_mfma_f32_16x16x32_bf16 v[44:47], v[124:127], v[184:187], v[44:47]
    ds_read_b64_tr_b16 v[84:85], v3 offset:36864
    s_add_u32 m0, s40, 8192
    s_add_u32 s40, s40, 12288
    buffer_load_dwordx4 v8, s[12:15], s39 offen lds
    v_mfma_f32_16x16x32_bf16 v[44:47], v[108:111], v[176:179], v[44:47]
    ds_read_b64_tr_b16 v[86:87], v3 offset:38912
    s_add_u32 s39, s39, 0x30000
    s_cmp_eq_u32 s40, s41
    s_cselect_b32 s40, s42, s40
    v_mfma_f32_16x16x32_bf16 v[60:63], v[108:111], v[180:183], v[60:63]
    ds_read_b64_tr_b16 v[72:73], v4 offset:32768
    buffer_load_dwordx4 v[176:179], v1, s[8:11], s38 offen offset:0 sc1
    v_mfma_f32_16x16x32_bf16 v[60:63], v[124:127], v[188:191], v[60:63]
    ds_read_b64_tr_b16 v[74:75], v4 offset:34816
    buffer_load_dwordx4 v[184:187], v25, s[8:11], s38 offen offset:0 sc1
    v_mfma_f32_16x16x32_bf16 v[56:59], v[120:123], v[188:191], v[56:59]
    ds_read_b64_tr_b16 v[88:89], v4 offset:36864
    v_mfma_f32_16x16x32_bf16 v[56:59], v[104:107], v[180:183], v[56:59]
    ds_read_b64_tr_b16 v[90:91], v4 offset:38912
    s_waitcnt vmcnt(11)
    ds_add_u32 v20, v22
    v_add_u32 v24, 1, v24
    v_mfma_f32_16x16x32_bf16 v[52:55], v[100:103], v[180:183], v[52:55]
    ds_read_b64_tr_b16 v[76:77], v5 offset:32768
    v_mfma_f32_16x16x32_bf16 v[52:55], v[116:119], v[188:191], v[52:55]
    ds_read_b64_tr_b16 v[78:79], v5 offset:34816
    v_mfma_f32_16x16x32_bf16 v[48:51], v[112:115], v[188:191], v[48:51]
    ds_read_b64_tr_b16 v[92:93], v5 offset:36864
    s_cmp_eq_u32 s45, 0x14000
    s_cselect_b32 s47, 0xfffec000, s57
    v_mfma_f32_16x16x32_bf16 v[48:51], v[96:99], v[180:183], v[48:51]
    ds_read_b64_tr_b16 v[94:95], v5 offset:38912
    buffer_load_dwordx4 v[180:183], v1, s[8:11], s38 offen offset:1024 sc1
    buffer_load_dwordx4 v[188:191], v25, s[8:11], s38 offen offset:1024 sc1
    s_add_u32 s38, s38, 0x40000
    v_add_u32 v2, s47, v2
    v_add_u32 v3, s47, v3
    v_add_u32 v4, s47, v4
    v_add_u32 v5, s47, v5
    s_waitcnt lgkmcnt(13)
    v_mfma_f32_16x16x32_bf16 v[32:35], v[64:67], v[192:195], v[32:35]
    s_add_u32 s45, s45, s47
    ds_read_b64_tr_b16 v[96:97], v2 offset:0
    ds_read_b32 v23, v21
    v_mfma_f32_16x16x32_bf16 v[32:35], v[80:83], v[200:203], v[32:35]
    ds_read_b64_tr_b16 v[98:99], v2 offset:2048
    s_waitcnt lgkmcnt(12)
    v_mfma_f32_16x16x32_bf16 v[36:39], v[84:87], v[200:203], v[36:39]
    ds_read_b64_tr_b16 v[112:113], v2 offset:4096
    v_mfma_f32_16x16x32_bf16 v[36:39], v[68:71], v[192:195], v[36:39]
    ds_read_b64_tr_b16 v[114:115], v2 offset:6144
    s_waitcnt lgkmcnt(3)
    v_cmp_gt_i32 vcc, v24, v23
    s_nop 0
    s_cbranch_vccnz p2_G_w27
p2_G_w27r:
    v_mfma_f32_16x16x32_bf16 v[40:43], v[72:75], v[192:195], v[40:43]
    ds_read_b64_tr_b16 v[100:101], v3 offset:0
    s_mov_b32 m0, s44
    s_add_u32 s44, s44, 8192
    buffer_load_dwordx4 v1, s[8:11], s43 offen sc1 lds
    v_mfma_f32_16x16x32_bf16 v[40:43], v[88:91], v[200:203], v[40:43]
    ds_read_b64_tr_b16 v[102:103], v3 offset:2048
    buffer_load_dwordx4 v1, s[8:11], s43 offen offset:1024 sc1 lds
    v_mfma_f32_16x16x32_bf16 v[44:47], v[92:95], v[200:203], v[44:47]
    ds_read_b64_tr_b16 v[116:117], v3 offset:4096
    s_add_u32 s43, s43, 8192
    s_and_b32 s44, s44, 0x27fff
    s_mov_b32 m0, s40
    v_mfma_f32_16x16x32_bf16 v[44:47], v[76:79], v[192:195], v[44:47]
    ds_read_b64_tr_b16 v[118:119], v3 offset:6144
    buffer_load_dwordx4 v6, s[12:15], s39 offen lds
    v_mfma_f32_16x16x32_bf16 v[60:63], v[76:79], v[196:199], v[60:63]
    ds_read_b64_tr_b16 v[104:105], v4 offset:0
    buffer_load_dwordx4 v[192:195], v1, s[8:11], s38 offen offset:0 sc1
    s_add_u32 m0, s40, 4096
    v_mfma_f32_16x16x32_bf16 v[60:63], v[92:95], v[204:207], v[60:63]
    ds_read_b64_tr_b16 v[106:107], v4 offset:2048
    buffer_load_dwordx4 v[200:203], v25, s[8:11], s38 offen offset:0 sc1
    buffer_load_dwordx4 v7, s[12:15], s39 offen lds
    v_mfma_f32_16x16x32_bf16 v[56:59], v[88:91], v[204:207], v[56:59]
    ds_read_b64_tr_b16 v[120:121], v4 offset:4096
    s_add_u32 m0, s40, 8192
    s_add_u32 s40, s40, 12288
    buffer_load_dwordx4 v8, s[12:15], s39 offen lds
    v_mfma_f32_16x16x32_bf16 v[56:59], v[72:75], v[196:199], v[56:59]
    ds_read_b64_tr_b16 v[122:123], v4 offset:6144
    s_add_u32 s39, s39, 0x30000
    s_cmp_eq_u32 s40, s41
    s_cselect_b32 s40, s42, s40
    v_mfma_f32_16x16x32_bf16 v[52:55], v[68:71], v[196:199], v[52:55]
    ds_read_b64_tr_b16 v[108:109], v5 offset:0
    v_mfma_f32_16x16x32_bf16 v[52:55], v[84:87], v[204:207], v[52:55]
    ds_read_b64_tr_b16 v[110:111], v5 offset:2048
    v_mfma_f32_16x16x32_bf16 v[48:51], v[80:83], v[204:207], v[48:51]
    ds_read_b64_tr_b16 v[124:125], v5 offset:4096
    v_mfma_f32_16x16x32_bf16 v[48:51], v[64:67], v[196:199], v[48:51]
    ds_read_b64_tr_b16 v[126:127], v5 offset:6144
    buffer_load_dwordx4 v[196:199], v1, s[8:11], s38 offen offset:1024 sc1
    buffer_load_dwordx4 v[204:207], v25, s[8:11], s38 offen offset:1024 sc1
    s_add_u32 s38, s38, 0x40000
    s_sub_u32 s37, s37, 1
    s_cbranch_scc0 p2_G_loop
    s_waitcnt vmcnt(11)
    ds_add_u32 v20, v22
    v_add_u32 v24, 1, v24
    s_waitcnt lgkmcnt(13)
    v_mfma_f32_16x16x32_bf16 v[32:35], v[96:99], v[128:131], v[32:35]
    ds_read_b64_tr_b16 v[64:65], v2 offset:8192
    v_mfma_f32_16x16x32_bf16 v[32:35], v[112:115], v[136:139], v[32:35]
    ds_read_b64_tr_b16 v[66:67], v2 offset:10240
    s_waitcnt lgkmcnt(11)
    v_mfma_f32_16x16x32_bf16 v[36:39], v[116:119], v[136:139], v[36:39]
    ds_read_b64_tr_b16 v[80:81], v2 offset:12288
    v_mfma_f32_16x16x32_bf16 v[36:39], v[100:103], v[128:131], v[36:39]
    ds_read_b64_tr_b16 v[82:83], v2 offset:14336
    s_waitcnt lgkmcnt(9)
    v_mfma_f32_16x16x32_bf16 v[40:43], v[104:107], v[128:131], v[40:43]
    ds_read_b64_tr_b16 v[68:69], v3 offset:8192
    ds_read_b32 v23, v21
    v_mfma_f32_16x16x32_bf16 v[40:43], v[120:123], v[136:139], v[40:43]
    ds_read_b64_tr_b16 v[70:71], v3 offset:10240
    s_waitcnt lgkmcnt(8)
    v_mfma_f32_16x16x32_bf16 v[44:47], v[124:127], v[136:139], v[44:47]
    ds_read_b64_tr_b16 v[84:85], v3 offset:12288
    v_mfma_f32_16x16x32_bf16 v[44:47], v[108:111], v[128:131], v[44:47]
    ds_read_b64_tr_b16 v[86:87], v3 offset:14336
    s_waitcnt lgkmcnt(3)
    v_cmp_gt_i32 vcc, v24, v23
    s_nop 0
    s_cbranch_vccnz p2_G_w28
p2_G_w28r:
    v_mfma_f32_16x16x32_bf16 v[60:63], v[108:111], v[132:135], v[60:63]
    ds_read_b64_tr_b16 v[72:73], v4 offset:8192
    buffer_load_dwordx4 v[128:131], v1, s[8:11], s38 offen offset:0 sc1
    s_mov_b32 m0, s44
    s_add_u32 s44, s44, 8192
    buffer_load_dwordx4 v1, s[8:11], s43 offen sc1 lds
    v_mfma_f32_16x16x32_bf16 v[60:63], v[124:127], v[140:143], v[60:63]
    ds_read_b64_tr_b16 v[74:75], v4 offset:10240
    buffer_load_dwordx4 v[136:139], v25, s[8:11], s38 offen offset:0 sc1
    buffer_load_dwordx4 v1, s[8:11], s43 offen offset:1024 sc1 lds
    v_mfma_f32_16x16x32_bf16 v[56:59], v[120:123], v[140:143], v[56:59]
    ds_read_b64_tr_b16 v[88:89], v4 offset:12288
    s_add_u32 s43, s43, 8192
    s_and_b32 s44, s44, 0x27fff
    s_mov_b32 m0, s40
    v_mfma_f32_16x16x32_bf16 v[56:59], v[104:107], v[132:135], v[56:59]
    ds_read_b64_tr_b16 v[90:91], v4 offset:14336
    buffer_load_dwordx4 v6, s[12:15], s39 offen lds
    v_mfma_f32_16x16x32_bf16 v[52:55], v[100:103], v[132:135], v[52:55]
    ds_read_b64_tr_b16 v[76:77], v5 offset:8192
    s_add_u32 m0, s40, 4096
    v_mfma_f32_16x16x32_bf16 v[52:55], v[116:119], v[140:143], v[52:55]
    ds_read_b64_tr_b16 v[78:79], v5 offset:10240
    buffer_load_dwordx4 v7, s[12:15], s39 offen lds
    v_mfma_f32_16x16x32_bf16 v[48:51], v[112:115], v[140:143], v[48:51]
    ds_read_b64_tr_b16 v[92:93], v5 offset:12288
    s_add_u32 m0, s40, 8192
    s_add_u32 s40, s40, 12288
    buffer_load_dwordx4 v8, s[12:15], s39 offen lds
    v_mfma_f32_16x16x32_bf16 v[48:51], v[96:99], v[132:135], v[48:51]
    ds_read_b64_tr_b16 v[94:95], v5 offset:14336
    buffer_load_dwordx4 v[132:135], v1, s[8:11], s38 offen offset:1024 sc1
    buffer_load_dwordx4 v[140:143], v25, s[8:11], s38 offen offset:1024 sc1
    s_add_u32 s38, s38, 0x40000
    s_add_u32 s39, s39, 0x30000
    s_cmp_eq_u32 s40, s41
    s_cselect_b32 s40, s42, s40
    v_mfma_f32_16x16x32_bf16 v[32:35], v[64:67], v[144:147], v[32:35]
    ds_read_b64_tr_b16 v[96:97], v2 offset:16384
    v_mfma_f32_16x16x32_bf16 v[32:35], v[80:83], v[152:155], v[32:35]
    ds_read_b64_tr_b16 v[98:99], v2 offset:18432
    s_waitcnt lgkmcnt(10)
    v_mfma_f32_16x16x32_bf16 v[36:39], v[84:87], v[152:155], v[36:39]
    ds_read_b64_tr_b16 v[112:113], v2 offset:20480
    v_mfma_f32_16x16x32_bf16 v[36:39], v[68:71], v[144:147], v[36:39]
    ds_read_b64_tr_b16 v[114:115], v2 offset:22528
    s_waitcnt vmcnt(5)
    ds_add_u32 v20, v26
    v_add_u32 v24, 3, v24
    v_and_b32 v21, 0xfffffbff, v21
    s_waitcnt lgkmcnt(9)
    v_mfma_f32_16x16x32_bf16 v[40:43], v[72:75], v[144:147], v[40:43]
    ds_read_b64_tr_b16 v[100:101], v3 offset:16384
    v_mfma_f32_16x16x32_bf16 v[40:43], v[88:91], v[152:155], v[40:43]
    ds_read_b64_tr_b16 v[102:103], v3 offset:18432
    s_waitcnt lgkmcnt(7)
    v_mfma_f32_16x16x32_bf16 v[44:47], v[92:95], v[152:155], v[44:47]
    ds_read_b64_tr_b16 v[116:117], v3 offset:20480
    v_mfma_f32_16x16x32_bf16 v[44:47], v[76:79], v[144:147], v[44:47]
    ds_read_b64_tr_b16 v[118:119], v3 offset:22528
    v_mfma_f32_16x16x32_bf16 v[60:63], v[76:79], v[148:151], v[60:63]
    ds_read_b64_tr_b16 v[104:105], v4 offset:16384
    buffer_load_dwordx4 v[144:147], v1, s[8:11], s38 offen offset:0 sc1
    ds_read_b32 v23, v21
    v_mfma_f32_16x16x32_bf16 v[60:63], v[92:95], v[156:159], v[60:63]
    ds_read_b64_tr_b16 v[106:107], v4 offset:18432
    buffer_load_dwordx4 v[152:155], v25, s[8:11], s38 offen offset:0 sc1
    v_mfma_f32_16x16x32_bf16 v[56:59], v[88:91], v[156:159], v[56:59]
    ds_read_b64_tr_b16 v[120:121], v4 offset:20480
    v_mfma_f32_16x16x32_bf16 v[56:59], v[72:75], v[148:151], v[56:59]
    ds_read_b64_tr_b16 v[122:123], v4 offset:22528
    s_waitcnt lgkmcnt(3)
    v_cmp_gt_i32 vcc, v24, v23
    s_nop 0
    s_cbranch_vccnz p2_G_w29
p2_G_w29r:
    v_mfma_f32_16x16x32_bf16 v[52:55], v[68:71], v[148:151], v[52:55]
    ds_read_b64_tr_b16 v[108:109], v5 offset:16384
    s_mov_b32 m0, s40
    v_mfma_f32_16x16x32_bf16 v[52:55], v[84:87], v[156:159], v[52:55]
    ds_read_b64_tr_b16 v[110:111], v5 offset:18432
    buffer_load_dwordx4 v6, s[12:15], s39 offen lds
    v_mfma_f32_16x16x32_bf16 v[48:51], v[80:83], v[156:159], v[48:51]
    ds_read_b64_tr_b16 v[124:125], v5 offset:20480
    s_add_u32 m0, s40, 4096
    v_mfma_f32_16x16x32_bf16 v[48:51], v[64:67], v[148:151], v[48:51]
    ds_read_b64_tr_b16 v[126:127], v5 offset:22528
    buffer_load_dwordx4 v[148:151], v1, s[8:11], s38 offen offset:1024 sc1
    buffer_load_dwordx4 v[156:159], v25, s[8:11], s38 offen offset:1024 sc1
    s_add_u32 s38, s38, 0x40000
    buffer_load_dwordx4 v7, s[12:15], s39 offen lds
    v_mfma_f32_16x16x32_bf16 v[32:35], v[96:99], v[160:163], v[32:35]
    ds_read_b64_tr_b16 v[64:65], v2 offset:24576
    s_add_u32 m0, s40, 8192
    s_add_u32 s40, s40, 12288
    buffer_load_dwordx4 v8, s[12:15], s39 offen lds
    v_mfma_f32_16x16x32_bf16 v[32:35], v[112:115], v[168:171], v[32:35]
    ds_read_b64_tr_b16 v[66:67], v2 offset:26624
    s_add_u32 s39, s39, 0x30000
    s_cmp_eq_u32 s40, s41
    s_cselect_b32 s40, s42, s40
    buffer_load_dword v9, v29, s[12:15], s61 offen
    v_mfma_f32_16x16x32_bf16 v[36:39], v[116:119], v[168:171], v[36:39]
    ds_read_b64_tr_b16 v[80:81], v2 offset:28672
    s_add_u32 s61, s61, 0xc0000
    buffer_load_dword v9, v31, s[16:19], s62 offen
    v_mfma_f32_16x16x32_bf16 v[36:39], v[100:103], v[160:163], v[36:39]
    ds_read_b64_tr_b16 v[82:83], v2 offset:30720
    s_add_u32 s62, s62, 0x40000
    s_waitcnt lgkmcnt(8)
    v_mfma_f32_16x16x32_bf16 v[40:43], v[104:107], v[160:163], v[40:43]
    ds_read_b64_tr_b16 v[68:69], v3 offset:24576
    v_mfma_f32_16x16x32_bf16 v[40:43], v[120:123], v[168:171], v[40:43]
    ds_read_b64_tr_b16 v[70:71], v3 offset:26624
    s_waitcnt lgkmcnt(6)
    v_mfma_f32_16x16x32_bf16 v[44:47], v[124:127], v[168:171], v[44:47]
    ds_read_b64_tr_b16 v[84:85], v3 offset:28672
    v_mfma_f32_16x16x32_bf16 v[44:47], v[108:111], v[160:163], v[44:47]
    ds_read_b64_tr_b16 v[86:87], v3 offset:30720
    v_mfma_f32_16x16x32_bf16 v[60:63], v[108:111], v[164:167], v[60:63]
    ds_read_b64_tr_b16 v[72:73], v4 offset:24576
    buffer_load_dwordx4 v[160:163], v1, s[8:11], s38 offen offset:0 sc1
    v_mfma_f32_16x16x32_bf16 v[60:63], v[124:127], v[172:175], v[60:63]
    ds_read_b64_tr_b16 v[74:75], v4 offset:26624
    buffer_load_dwordx4 v[168:171], v25, s[8:11], s38 offen offset:0 sc1
    v_mfma_f32_16x16x32_bf16 v[56:59], v[120:123], v[172:175], v[56:59]
    ds_read_b64_tr_b16 v[88:89], v4 offset:28672
    v_mfma_f32_16x16x32_bf16 v[56:59], v[104:107], v[164:167], v[56:59]
    ds_read_b64_tr_b16 v[90:91], v4 offset:30720
    v_mfma_f32_16x16x32_bf16 v[52:55], v[100:103], v[164:167], v[52:55]
    ds_read_b64_tr_b16 v[76:77], v5 offset:24576
    v_mfma_f32_16x16x32_bf16 v[52:55], v[116:119], v[172:175], v[52:55]
    ds_read_b64_tr_b16 v[78:79], v5 offset:26624
    v_mfma_f32_16x16x32_bf16 v[48:51], v[112:115], v[172:175], v[48:51]
    ds_read_b64_tr_b16 v[92:93], v5 offset:28672
    v_mfma_f32_16x16x32_bf16 v[48:51], v[96:99], v[164:167], v[48:51]
    ds_read_b64_tr_b16 v[94:95], v5 offset:30720
    buffer_load_dwordx4 v[164:167], v1, s[8:11], s38 offen offset:1024 sc1
    buffer_load_dwordx4 v[172:175], v25, s[8:11], s38 offen offset:1024 sc1
    s_add_u32 s38, s38, 0x40000
    s_waitcnt vmcnt(13)
    ds_add_u32 v20, v22
    v_add_u32 v24, 1, v24
    s_waitcnt lgkmcnt(13)
    v_mfma_f32_16x16x32_bf16 v[32:35], v[64:67], v[176:179], v[32:35]
    ds_read_b64_tr_b16 v[96:97], v2 offset:32768
    v_mfma_f32_16x16x32_bf16 v[32:35], v[80:83], v[184:187], v[32:35]
    ds_read_b64_tr_b16 v[98:99], v2 offset:34816
    s_waitcnt lgkmcnt(11)
    v_mfma_f32_16x16x32_bf16 v[36:39], v[84:87], v[184:187], v[36:39]
    ds_read_b64_tr_b16 v[112:113], v2 offset:36864
    v_mfma_f32_16x16x32_bf16 v[36:39], v[68:71], v[176:179], v[36:39]
    ds_read_b64_tr_b16 v[114:115], v2 offset:38912
    s_waitcnt lgkmcnt(9)
    v_mfma_f32_16x16x32_bf16 v[40:43], v[72:75], v[176:179], v[40:43]
    ds_read_b64_tr_b16 v[100:101], v3 offset:32768
    ds_read_b32 v23, v21
    v_mfma_f32_16x16x32_bf16 v[40:43], v[88:91], v[184:187], v[40:43]
    ds_read_b64_tr_b16 v[102:103], v3 offset:34816
    s_waitcnt lgkmcnt(8)
    v_mfma_f32_16x16x32_bf16 v[44:47], v[92:95], v[184:187], v[44:47]
    ds_read_b64_tr_b16 v[116:117], v3 offset:36864
    v_mfma_f32_16x16x32_bf16 v[44:47], v[76:79], v[176:179], v[44:47]
    ds_read_b64_tr_b16 v[118:119], v3 offset:38912
    s_waitcnt lgkmcnt(3)
    v_cmp_gt_i32 vcc, v24, v23
    s_nop 0
    s_cbranch_vccnz p2_G_w30
p2_G_w30r:
    v_mfma_f32_16x16x32_bf16 v[60:63], v[76:79], v[180:183], v[60:63]
    ds_read_b64_tr_b16 v[104:105], v4 offset:32768
    buffer_load_dwordx4 v[176:179], v1, s[8:11], s38 offen offset:0 sc1
    s_mov_b32 m0, s40
    v_mfma_f32_16x16x32_bf16 v[60:63], v[92:95], v[188:191], v[60:63]
    ds_read_b64_tr_b16 v[106:107], v4 offset:34816
    buffer_load_dwordx4 v[184:187], v25, s[8:11], s38 offen offset:0 sc1
    buffer_load_dwordx4 v6, s[12:15], s39 offen lds
    v_mfma_f32_16x16x32_bf16 v[56:59], v[88:91], v[188:191], v[56:59]
    ds_read_b64_tr_b16 v[120:121], v4 offset:36864
    s_add_u32 m0, s40, 4096
    v_mfma_f32_16x16x32_bf16 v[56:59], v[72:75], v[180:183], v[56:59]
    ds_read_b64_tr_b16 v[122:123], v4 offset:38912
    buffer_load_dwordx4 v7, s[12:15], s39 offen lds
    v_mfma_f32_16x16x32_bf16 v[52:55], v[68:71], v[180:183], v[52:55]
    ds_read_b64_tr_b16 v[108:109], v5 offset:32768
    s_add_u32 m0, s40, 8192
    s_add_u32 s40, s40, 12288
    buffer_load_dwordx4 v8, s[12:15], s39 offen lds
    v_mfma_f32_16x16x32_bf16 v[52:55], v[84:87], v[188:191], v[52:55]
    ds_read_b64_tr_b16 v[110:111], v5 offset:34816
    s_add_u32 s39, s39, 0x30000
    s_cmp_eq_u32 s40, s41
    s_cselect_b32 s40, s42, s40
    s_mov_b32 m0, s40
    v_mfma_f32_16x16x32_bf16 v[48:51], v[80:83], v[188:191], v[48:51]
    ds_read_b64_tr_b16 v[124:125], v5 offset:36864
    s_cmp_eq_u32 s45, 0x14000
    s_cselect_b32 s47, 0xfffec000, s57
    buffer_load_dwordx4 v6, s[12:15], s39 offen lds
    v_mfma_f32_16x16x32_bf16 v[48:51], v[64:67], v[180:183], v[48:51]
    ds_read_b64_tr_b16 v[126:127], v5 offset:38912
    buffer_load_dwordx4 v[180:183], v1, s[8:11], s38 offen offset:1024 sc1
    buffer_load_dwordx4 v[188:191], v25, s[8:11], s38 offen offset:1024 sc1
    s_add_u32 s38, s38, 0x40000
    v_add_u32 v2, s47, v2
    v_add_u32 v3, s47, v3
    v_add_u32 v4, s47, v4
    v_add_u32 v5, s47, v5
    s_add_u32 m0, s40, 4096
    v_mfma_f32_16x16x32_bf16 v[32:35], v[96:99], v[192:195], v[32:35]
    s_add_u32 s45, s45, s47
    ds_read_b64_tr_b16 v[64:65], v2 offset:0
    buffer_load_dwordx4 v7, s[12:15], s39 offen lds
    v_mfma_f32_16x16x32_bf16 v[32:35], v[112:115], v[200:203], v[32:35]
    ds_read_b64_tr_b16 v[66:67], v2 offset:2048
    s_add_u32 m0, s40, 8192
    s_add_u32 s40, s40, 12288
    buffer_load_dwordx4 v8, s[12:15], s39 offen lds
    s_waitcnt lgkmcnt(10)
    v_mfma_f32_16x16x32_bf16 v[36:39], v[116:119], v[200:203], v[36:39]
    ds_read_b64_tr_b16 v[80:81], v2 offset:4096
    s_add_u32 s39, s39, 0x30000
    s_cmp_eq_u32 s40, s41
    s_cselect_b32 s40, s42, s40
    v_mfma_f32_16x16x32_bf16 v[36:39], v[100:103], v[192:195], v[36:39]
    ds_read_b64_tr_b16 v[82:83], v2 offset:6144
    s_waitcnt lgkmcnt(8)
    v_mfma_f32_16x16x32_bf16 v[40:43], v[104:107], v[192:195], v[40:43]
    ds_read_b64_tr_b16 v[68:69], v3 offset:0
    v_mfma_f32_16x16x32_bf16 v[40:43], v[120:123], v[200:203], v[40:43]
    ds_read_b64_tr_b16 v[70:71], v3 offset:2048
    s_waitcnt lgkmcnt(6)
    v_mfma_f32_16x16x32_bf16 v[44:47], v[124:127], v[200:203], v[44:47]
    ds_read_b64_tr_b16 v[84:85], v3 offset:4096
    v_mfma_f32_16x16x32_bf16 v[44:47], v[108:111], v[192:195], v[44:47]
    ds_read_b64_tr_b16 v[86:87], v3 offset:6144
    v_mfma_f32_16x16x32_bf16 v[60:63], v[108:111], v[196:199], v[60:63]
    ds_read_b64_tr_b16 v[72:73], v4 offset:0
    buffer_load_dwordx4 v[192:195], v1, s[8:11], s38 offen offset:0 sc1
    v_mfma_f32_16x16x32_bf16 v[60:63], v[124:127], v[204:207], v[60:63]
    ds_read_b64_tr_b16 v[74:75], v4 offset:2048
    buffer_load_dwordx4 v[200:203], v25, s[8:11], s38 offen offset:0 sc1
    v_mfma_f32_16x16x32_bf16 v[56:59], v[120:123], v[204:207], v[56:59]
    ds_read_b64_tr_b16 v[88:89], v4 offset:4096
    v_mfma_f32_16x16x32_bf16 v[56:59], v[104:107], v[196:199], v[56:59]
    ds_read_b64_tr_b16 v[90:91], v4 offset:6144
    v_mfma_f32_16x16x32_bf16 v[52:55], v[100:103], v[196:199], v[52:55]
    ds_read_b64_tr_b16 v[76:77], v5 offset:0
    v_mfma_f32_16x16x32_bf16 v[52:55], v[116:119], v[204:207], v[52:55]
    ds_read_b64_tr_b16 v[78:79], v5 offset:2048
    v_mfma_f32_16x16x32_bf16 v[48:51], v[112:115], v[204:207], v[48:51]
    ds_read_b64_tr_b16 v[92:93], v5 offset:4096
    v_mfma_f32_16x16x32_bf16 v[48:51], v[96:99], v[196:199], v[48:51]
    ds_read_b64_tr_b16 v[94:95], v5 offset:6144
    buffer_load_dwordx4 v[196:199], v1, s[8:11], s38 offen offset:1024 sc1
    buffer_load_dwordx4 v[204:207], v25, s[8:11], s38 offen offset:1024 sc1
    s_add_u32 s38, s38, 0x40000
    s_waitcnt vmcnt(14)
    ds_add_u32 v20, v22
    v_add_u32 v24, 1, v24
    s_waitcnt lgkmcnt(13)
    v_mfma_f32_16x16x32_bf16 v[32:35], v[64:67], v[128:131], v[32:35]
    ds_read_b64_tr_b16 v[96:97], v2 offset:8192
    v_mfma_f32_16x16x32_bf16 v[32:35], v[80:83], v[136:139], v[32:35]
    ds_read_b64_tr_b16 v[98:99], v2 offset:10240
    s_waitcnt lgkmcnt(11)
    v_mfma_f32_16x16x32_bf16 v[36:39], v[84:87], v[136:139], v[36:39]
    ds_read_b64_tr_b16 v[112:113], v2 offset:12288
    v_mfma_f32_16x16x32_bf16 v[36:39], v[68:71], v[128:131], v[36:39]
    ds_read_b64_tr_b16 v[114:115], v2 offset:14336
    s_waitcnt lgkmcnt(9)
    v_mfma_f32_16x16x32_bf16 v[40:43], v[72:75], v[128:131], v[40:43]
    ds_read_b64_tr_b16 v[100:101], v3 offset:8192
    ds_read_b32 v23, v21
    v_mfma_f32_16x16x32_bf16 v[40:43], v[88:91], v[136:139], v[40:43]
    ds_read_b64_tr_b16 v[102:103], v3 offset:10240
    s_waitcnt lgkmcnt(8)
    v_mfma_f32_16x16x32_bf16 v[44:47], v[92:95], v[136:139], v[44:47]
    ds_read_b64_tr_b16 v[116:117], v3 offset:12288
    v_mfma_f32_16x16x32_bf16 v[44:47], v[76:79], v[128:131], v[44:47]
    ds_read_b64_tr_b16 v[118:119], v3 offset:14336
    s_waitcnt lgkmcnt(3)
    v_cmp_gt_i32 vcc, v24, v23
    s_nop 0
    s_cbranch_vccnz p2_G_w31
p2_G_w31r:
    v_mfma_f32_16x16x32_bf16 v[60:63], v[76:79], v[132:135], v[60:63]
    ds_read_b64_tr_b16 v[104:105], v4 offset:8192
    buffer_load_dwordx4 v[128:131], v1, s[8:11], s38 offen offset:0 sc1
    s_add_u32 m0, s42, 0x6000
    s_mov_b32 s39, 0x6a0000
    buffer_load_dwordx4 v6, s[12:15], s39 offen lds
    v_mfma_f32_16x16x32_bf16 v[60:63], v[92:95], v[140:143], v[60:63]
    ds_read_b64_tr_b16 v[106:107], v4 offset:10240
    buffer_load_dwordx4 v[136:139], v25, s[8:11], s38 offen offset:0 sc1
    v_mfma_f32_16x16x32_bf16 v[56:59], v[88:91], v[140:143], v[56:59]
    ds_read_b64_tr_b16 v[120:121], v4 offset:12288
    v_mfma_f32_16x16x32_bf16 v[56:59], v[72:75], v[132:135], v[56:59]
    ds_read_b64_tr_b16 v[122:123], v4 offset:14336
    v_mfma_f32_16x16x32_bf16 v[52:55], v[68:71], v[132:135], v[52:55]
    ds_read_b64_tr_b16 v[108:109], v5 offset:8192
    v_mfma_f32_16x16x32_bf16 v[52:55], v[84:87], v[140:143], v[52:55]
    ds_read_b64_tr_b16 v[110:111], v5 offset:10240
    s_add_u32 m0, s42, 0x7000
    s_mov_b32 s39, 0x6b0000
    buffer_load_dwordx4 v6, s[12:15], s39 offen lds
    v_mfma_f32_16x16x32_bf16 v[48:51], v[80:83], v[140:143], v[48:51]
    ds_read_b64_tr_b16 v[124:125], v5 offset:12288
    v_mfma_f32_16x16x32_bf16 v[48:51], v[64:67], v[132:135], v[48:51]
    ds_read_b64_tr_b16 v[126:127], v5 offset:14336
    buffer_load_dwordx4 v[132:135], v1, s[8:11], s38 offen offset:1024 sc1
    buffer_load_dwordx4 v[140:143], v25, s[8:11], s38 offen offset:1024 sc1
    s_add_u32 s38, s38, 0x40000
    v_mfma_f32_16x16x32_bf16 v[32:35], v[96:99], v[144:147], v[32:35]
    ds_read_b64_tr_b16 v[64:65], v2 offset:16384
    v_mfma_f32_16x16x32_bf16 v[32:35], v[112:115], v[152:155], v[32:35]
    ds_read_b64_tr_b16 v[66:67], v2 offset:18432
    s_waitcnt lgkmcnt(10)
    v_mfma_f32_16x16x32_bf16 v[36:39], v[116:119], v[152:155], v[36:39]
    ds_read_b64_tr_b16 v[80:81], v2 offset:20480
    s_add_u32 m0, s42, 0x8000
    s_mov_b32 s39, 0x6c0000
    buffer_load_dwordx4 v6, s[12:15], s39 offen lds
    v_mfma_f32_16x16x32_bf16 v[36:39], v[100:103], v[144:147], v[36:39]
    ds_read_b64_tr_b16 v[82:83], v2 offset:22528
    s_waitcnt lgkmcnt(8)
    v_mfma_f32_16x16x32_bf16 v[40:43], v[104:107], v[144:147], v[40:43]
    ds_read_b64_tr_b16 v[68:69], v3 offset:16384
    v_mfma_f32_16x16x32_bf16 v[40:43], v[120:123], v[152:155], v[40:43]
    ds_read_b64_tr_b16 v[70:71], v3 offset:18432
    s_waitcnt lgkmcnt(6)
    v_mfma_f32_16x16x32_bf16 v[44:47], v[124:127], v[152:155], v[44:47]
    ds_read_b64_tr_b16 v[84:85], v3 offset:20480
    v_mfma_f32_16x16x32_bf16 v[44:47], v[108:111], v[144:147], v[44:47]
    ds_read_b64_tr_b16 v[86:87], v3 offset:22528
    s_add_u32 m0, s42, 0x9000
    s_mov_b32 s39, 0x6d0000
    buffer_load_dwordx4 v6, s[12:15], s39 offen lds
    v_mfma_f32_16x16x32_bf16 v[60:63], v[108:111], v[148:151], v[60:63]
    ds_read_b64_tr_b16 v[72:73], v4 offset:16384
    buffer_load_dwordx4 v[144:147], v1, s[8:11], s38 offen offset:0 sc1
    v_mfma_f32_16x16x32_bf16 v[60:63], v[124:127], v[156:159], v[60:63]
    ds_read_b64_tr_b16 v[74:75], v4 offset:18432
    buffer_load_dwordx4 v[152:155], v25, s[8:11], s38 offen offset:0 sc1
    v_mfma_f32_16x16x32_bf16 v[56:59], v[120:123], v[156:159], v[56:59]
    ds_read_b64_tr_b16 v[88:89], v4 offset:20480
    v_mfma_f32_16x16x32_bf16 v[56:59], v[104:107], v[148:151], v[56:59]
    ds_read_b64_tr_b16 v[90:91], v4 offset:22528
    v_mfma_f32_16x16x32_bf16 v[52:55], v[100:103], v[148:151], v[52:55]
    ds_read_b64_tr_b16 v[76:77], v5 offset:16384
    v_mfma_f32_16x16x32_bf16 v[52:55], v[116:119], v[156:159], v[52:55]
    ds_read_b64_tr_b16 v[78:79], v5 offset:18432
    v_mfma_f32_16x16x32_bf16 v[48:51], v[112:115], v[156:159], v[48:51]
    ds_read_b64_tr_b16 v[92:93], v5 offset:20480
    v_mfma_f32_16x16x32_bf16 v[48:51], v[96:99], v[148:151], v[48:51]
    ds_read_b64_tr_b16 v[94:95], v5 offset:22528
    buffer_load_dwordx4 v[148:151], v1, s[8:11], s38 offen offset:1024 sc1
    buffer_load_dwordx4 v[156:159], v25, s[8:11], s38 offen offset:1024 sc1
    s_add_u32 s38, s38, 0x40000
    s_waitcnt lgkmcnt(12)
    v_mfma_f32_16x16x32_bf16 v[32:35], v[64:67], v[160:163], v[32:35]
    ds_read_b64_tr_b16 v[96:97], v2 offset:24576
    v_mfma_f32_16x16x32_bf16 v[32:35], v[80:83], v[168:171], v[32:35]
    ds_read_b64_tr_b16 v[98:99], v2 offset:26624
    s_waitcnt lgkmcnt(10)
    v_mfma_f32_16x16x32_bf16 v[36:39], v[84:87], v[168:171], v[36:39]
    ds_read_b64_tr_b16 v[112:113], v2 offset:28672
    v_mfma_f32_16x16x32_bf16 v[36:39], v[68:71], v[160:163], v[36:39]
    ds_read_b64_tr_b16 v[114:115], v2 offset:30720
    s_waitcnt lgkmcnt(8)
    v_mfma_f32_16x16x32_bf16 v[40:43], v[72:75], v[160:163], v[40:43]
    ds_read_b64_tr_b16 v[100:101], v3 offset:24576
    v_mfma_f32_16x16x32_bf16 v[40:43], v[88:91], v[168:171], v[40:43]
    ds_read_b64_tr_b16 v[102:103], v3 offset:26624
    s_waitcnt lgkmcnt(6)
    v_mfma_f32_16x16x32_bf16 v[44:47], v[92:95], v[168:171], v[44:47]
    ds_read_b64_tr_b16 v[116:117], v3 offset:28672
    v_mfma_f32_16x16x32_bf16 v[44:47], v[76:79], v[160:163], v[44:47]
    ds_read_b64_tr_b16 v[118:119], v3 offset:30720
    s_waitcnt vmcnt(12)
    ds_add_u32 v20, v22
    v_add_u32 v24, 1, v24
    v_mfma_f32_16x16x32_bf16 v[60:63], v[76:79], v[164:167], v[60:63]
    ds_read_b64_tr_b16 v[104:105], v4 offset:24576
    buffer_load_dwordx4 v[160:163], v1, s[8:11], s38 offen offset:0 sc1
    v_mfma_f32_16x16x32_bf16 v[60:63], v[92:95], v[172:175], v[60:63]
    ds_read_b64_tr_b16 v[106:107], v4 offset:26624
    buffer_load_dwordx4 v[168:171], v25, s[8:11], s38 offen offset:0 sc1
    v_mfma_f32_16x16x32_bf16 v[56:59], v[88:91], v[172:175], v[56:59]
    ds_read_b64_tr_b16 v[120:121], v4 offset:28672
    v_mfma_f32_16x16x32_bf16 v[56:59], v[72:75], v[164:167], v[56:59]
    ds_read_b64_tr_b16 v[122:123], v4 offset:30720
    v_mfma_f32_16x16x32_bf16 v[52:55], v[68:71], v[164:167], v[52:55]
    ds_read_b64_tr_b16 v[108:109], v5 offset:24576
    ds_read_b32 v23, v21
    v_mfma_f32_16x16x32_bf16 v[52:55], v[84:87], v[172:175], v[52:55]
    ds_read_b64_tr_b16 v[110:111], v5 offset:26624
    v_mfma_f32_16x16x32_bf16 v[48:51], v[80:83], v[172:175], v[48:51]
    ds_read_b64_tr_b16 v[124:125], v5 offset:28672
    v_mfma_f32_16x16x32_bf16 v[48:51], v[64:67], v[164:167], v[48:51]
    ds_read_b64_tr_b16 v[126:127], v5 offset:30720
    buffer_load_dwordx4 v[164:167], v1, s[8:11], s38 offen offset:1024 sc1
    buffer_load_dwordx4 v[172:175], v25, s[8:11], s38 offen offset:1024 sc1
    s_add_u32 s38, s38, 0x40000
    s_waitcnt lgkmcnt(3)
    v_cmp_gt_i32 vcc, v24, v23
    s_nop 0
    s_cbranch_vccnz p2_G_w32
p2_G_w32r:
    v_mfma_f32_16x16x32_bf16 v[32:35], v[96:99], v[176:179], v[32:35]
    ds_read_b64_tr_b16 v[64:65], v2 offset:32768
    s_add_u32 m0, s42, 0xa000
    s_mov_b32 s39, 0x6e0000
    buffer_load_dwordx4 v6, s[12:15], s39 offen lds
    v_mfma_f32_16x16x32_bf16 v[32:35], v[112:115], v[184:187], v[32:35]
    ds_read_b64_tr_b16 v[66:67], v2 offset:34816
    v_mfma_f32_16x16x32_bf16 v[36:39], v[116:119], v[184:187], v[36:39]
    ds_read_b64_tr_b16 v[80:81], v2 offset:36864
    v_mfma_f32_16x16x32_bf16 v[36:39], v[100:103], v[176:179], v[36:39]
    ds_read_b64_tr_b16 v[82:83], v2 offset:38912
    v_mfma_f32_16x16x32_bf16 v[40:43], v[104:107], v[176:179], v[40:43]
    ds_read_b64_tr_b16 v[68:69], v3 offset:32768
    v_mfma_f32_16x16x32_bf16 v[40:43], v[120:123], v[184:187], v[40:43]
    ds_read_b64_tr_b16 v[70:71], v3 offset:34816
    s_add_u32 m0, s42, 0xb000
    s_mov_b32 s39, 0x6f0000
    buffer_load_dwordx4 v6, s[12:15], s39 offen lds
    s_waitcnt lgkmcnt(6)
    v_mfma_f32_16x16x32_bf16 v[44:47], v[124:127], v[184:187], v[44:47]
    ds_read_b64_tr_b16 v[84:85], v3 offset:36864
    v_mfma_f32_16x16x32_bf16 v[44:47], v[108:111], v[176:179], v[44:47]
    ds_read_b64_tr_b16 v[86:87], v3 offset:38912
    v_mfma_f32_16x16x32_bf16 v[60:63], v[108:111], v[180:183], v[60:63]
    ds_read_b64_tr_b16 v[72:73], v4 offset:32768
    buffer_load_dwordx4 v[176:179], v1, s[8:11], s38 offen offset:0 sc1
    v_mfma_f32_16x16x32_bf16 v[60:63], v[124:127], v[188:191], v[60:63]
    ds_read_b64_tr_b16 v[74:75], v4 offset:34816
    buffer_load_dwordx4 v[184:187], v25, s[8:11], s38 offen offset:0 sc1
    v_mfma_f32_16x16x32_bf16 v[56:59], v[120:123], v[188:191], v[56:59]
    ds_read_b64_tr_b16 v[88:89], v4 offset:36864
    s_add_u32 m0, s42, 0xc000
    s_mov_b32 s39, 0x0
    buffer_load_dwordx4 v6, s[16:19], s39 offen lds
    v_mfma_f32_16x16x32_bf16 v[56:59], v[104:107], v[180:183], v[56:59]
    ds_read_b64_tr_b16 v[90:91], v4 offset:38912
    v_mfma_f32_16x16x32_bf16 v[52:55], v[100:103], v[180:183], v[52:55]
    ds_read_b64_tr_b16 v[76:77], v5 offset:32768
    v_mfma_f32_16x16x32_bf16 v[52:55], v[116:119], v[188:191], v[52:55]
    ds_read_b64_tr_b16 v[78:79], v5 offset:34816
    v_mfma_f32_16x16x32_bf16 v[48:51], v[112:115], v[188:191], v[48:51]
    ds_read_b64_tr_b16 v[92:93], v5 offset:36864
    s_cmp_eq_u32 s45, 0x14000
    s_cselect_b32 s47, 0xfffec000, s57
    v_mfma_f32_16x16x32_bf16 v[48:51], v[96:99], v[180:183], v[48:51]
    ds_read_b64_tr_b16 v[94:95], v5 offset:38912
    buffer_load_dwordx4 v[180:183], v1, s[8:11], s38 offen offset:1024 sc1
    buffer_load_dwordx4 v[188:191], v25, s[8:11], s38 offen offset:1024 sc1
    s_add_u32 s38, s38, 0x40000
    v_add_u32 v2, s47, v2
    v_add_u32 v3, s47, v3
    v_add_u32 v4, s47, v4
    v_add_u32 v5, s47, v5
    s_add_u32 m0, s42, 0xd000
    s_mov_b32 s39, 0x10000
    buffer_load_dwordx4 v6, s[16:19], s39 offen lds
    s_waitcnt lgkmcnt(12)
    v_mfma_f32_16x16x32_bf16 v[32:35], v[64:67], v[192:195], v[32:35]
    s_add_u32 s45, s45, s47
    ds_read_b64_tr_b16 v[96:97], v2 offset:0
    v_mfma_f32_16x16x32_bf16 v[32:35], v[80:83], v[200:203], v[32:35]
    ds_read_b64_tr_b16 v[98:99], v2 offset:2048
    s_waitcnt lgkmcnt(10)
    v_mfma_f32_16x16x32_bf16 v[36:39], v[84:87], v[200:203], v[36:39]
    ds_read_b64_tr_b16 v[112:113], v2 offset:4096
    v_mfma_f32_16x16x32_bf16 v[36:39], v[68:71], v[192:195], v[36:39]
    ds_read_b64_tr_b16 v[114:115], v2 offset:6144
    s_waitcnt lgkmcnt(8)
    v_mfma_f32_16x16x32_bf16 v[40:43], v[72:75], v[192:195], v[40:43]
    ds_read_b64_tr_b16 v[100:101], v3 offset:0
    s_add_u32 m0, s42, 0xe000
    s_mov_b32 s39, 0x20000
    buffer_load_dwordx4 v6, s[16:19], s39 offen lds
    v_mfma_f32_16x16x32_bf16 v[40:43], v[88:91], v[200:203], v[40:43]
    ds_read_b64_tr_b16 v[102:103], v3 offset:2048
    s_waitcnt lgkmcnt(6)
    v_mfma_f32_16x16x32_bf16 v[44:47], v[92:95], v[200:203], v[44:47]
    ds_read_b64_tr_b16 v[116:117], v3 offset:4096
    v_mfma_f32_16x16x32_bf16 v[44:47], v[76:79], v[192:195], v[44:47]
    ds_read_b64_tr_b16 v[118:119], v3 offset:6144
    v_mfma_f32_16x16x32_bf16 v[60:63], v[76:79], v[196:199], v[60:63]
    ds_read_b64_tr_b16 v[104:105], v4 offset:0
    buffer_load_dwordx4 v[192:195], v1, s[8:11], s38 offen offset:0 sc1
    v_mfma_f32_16x16x32_bf16 v[60:63], v[92:95], v[204:207], v[60:63]
    ds_read_b64_tr_b16 v[106:107], v4 offset:2048
    buffer_load_dwordx4 v[200:203], v25, s[8:11], s38 offen offset:0 sc1
    v_mfma_f32_16x16x32_bf16 v[56:59], v[88:91], v[204:207], v[56:59]
    ds_read_b64_tr_b16 v[120:121], v4 offset:4096
    v_mfma_f32_16x16x32_bf16 v[56:59], v[72:75], v[196:199], v[56:59]
    ds_read_b64_tr_b16 v[122:123], v4 offset:6144
    v_mfma_f32_16x16x32_bf16 v[52:55], v[68:71], v[196:199], v[52:55]
    ds_read_b64_tr_b16 v[108:109], v5 offset:0
    v_mfma_f32_16x16x32_bf16 v[52:55], v[84:87], v[204:207], v[52:55]
    ds_read_b64_tr_b16 v[110:111], v5 offset:2048
    v_mfma_f32_16x16x32_bf16 v[48:51], v[80:83], v[204:207], v[48:51]
    ds_read_b64_tr_b16 v[124:125], v5 offset:4096
    v_mfma_f32_16x16x32_bf16 v[48:51], v[64:67], v[196:199], v[48:51]
    ds_read_b64_tr_b16 v[126:127], v5 offset:6144
    buffer_load_dwordx4 v[196:199], v1, s[8:11], s38 offen offset:1024 sc1
    buffer_load_dwordx4 v[204:207], v25, s[8:11], s38 offen offset:1024 sc1
    s_add_u32 s38, s38, 0x40000
    s_waitcnt vmcnt(17)
    ds_add_u32 v20, v22
    v_add_u32 v24, 1, v24
    s_waitcnt lgkmcnt(13)
    v_mfma_f32_16x16x32_bf16 v[32:35], v[96:99], v[128:131], v[32:35]
    ds_read_b64_tr_b16 v[64:65], v2 offset:8192
    v_mfma_f32_16x16x32_bf16 v[32:35], v[112:115], v[136:139], v[32:35]
    ds_read_b64_tr_b16 v[66:67], v2 offset:10240
    s_waitcnt lgkmcnt(11)
    v_mfma_f32_16x16x32_bf16 v[36:39], v[116:119], v[136:139], v[36:39]
    ds_read_b64_tr_b16 v[80:81], v2 offset:12288
    v_mfma_f32_16x16x32_bf16 v[36:39], v[100:103], v[128:131], v[36:39]
    ds_read_b64_tr_b16 v[82:83], v2 offset:14336
    s_waitcnt lgkmcnt(9)
    v_mfma_f32_16x16x32_bf16 v[40:43], v[104:107], v[128:131], v[40:43]
    ds_read_b64_tr_b16 v[68:69], v3 offset:8192
    ds_read_b32 v23, v21
    v_mfma_f32_16x16x32_bf16 v[40:43], v[120:123], v[136:139], v[40:43]
    ds_read_b64_tr_b16 v[70:71], v3 offset:10240
    s_waitcnt lgkmcnt(8)
    v_mfma_f32_16x16x32_bf16 v[44:47], v[124:127], v[136:139], v[44:47]
    ds_read_b64_tr_b16 v[84:85], v3 offset:12288
    v_mfma_f32_16x16x32_bf16 v[44:47], v[108:111], v[128:131], v[44:47]
    ds_read_b64_tr_b16 v[86:87], v3 offset:14336
    s_waitcnt lgkmcnt(3)
    v_cmp_gt_i32 vcc, v24, v23
    s_nop 0
    s_cbranch_vccnz p2_G_w33
p2_G_w33r:
    v_mfma_f32_16x16x32_bf16 v[60:63], v[108:111], v[132:135], v[60:63]
    ds_read_b64_tr_b16 v[72:73], v4 offset:8192
    buffer_load_dwordx4 v[128:131], v1, s[8:11], s38 offen offset:0 sc1
    s_add_u32 m0, s42, 0xf000
    s_mov_b32 s39, 0x30000
    buffer_load_dwordx4 v6, s[16:19], s39 offen lds
    v_mfma_f32_16x16x32_bf16 v[60:63], v[124:127], v[140:143], v[60:63]
    ds_read_b64_tr_b16 v[74:75], v4 offset:10240
    buffer_load_dwordx4 v[136:139], v25, s[8:11], s38 offen offset:0 sc1
    v_mfma_f32_16x16x32_bf16 v[56:59], v[120:123], v[140:143], v[56:59]
    ds_read_b64_tr_b16 v[88:89], v4 offset:12288
    v_mfma_f32_16x16x32_bf16 v[56:59], v[104:107], v[132:135], v[56:59]
    ds_read_b64_tr_b16 v[90:91], v4 offset:14336
    v_mfma_f32_16x16x32_bf16 v[52:55], v[100:103], v[132:135], v[52:55]
    ds_read_b64_tr_b16 v[76:77], v5 offset:8192
    v_mfma_f32_16x16x32_bf16 v[52:55], v[116:119], v[140:143], v[52:55]
    ds_read_b64_tr_b16 v[78:79], v5 offset:10240
    s_add_u32 m0, s42, 0x10000
    s_mov_b32 s39, 0x40000
    buffer_load_dwordx4 v6, s[16:19], s39 offen lds
    v_mfma_f32_16x16x32_bf16 v[48:51], v[112:115], v[140:143], v[48:51]
    ds_read_b64_tr_b16 v[92:93], v5 offset:12288
    v_mfma_f32_16x16x32_bf16 v[48:51], v[96:99], v[132:135], v[48:51]
    ds_read_b64_tr_b16 v[94:95], v5 offset:14336
    buffer_load_dwordx4 v[132:135], v1, s[8:11], s38 offen offset:1024 sc1
    buffer_load_dwordx4 v[140:143], v25, s[8:11], s38 offen offset:1024 sc1
    s_add_u32 s38, s38, 0x40000
    v_mfma_f32_16x16x32_bf16 v[32:35], v[64:67], v[144:147], v[32:35]
    ds_read_b64_tr_b16 v[96:97], v2 offset:16384
    v_mfma_f32_16x16x32_bf16 v[32:35], v[80:83], v[152:155], v[32:35]
    ds_read_b64_tr_b16 v[98:99], v2 offset:18432
    s_waitcnt lgkmcnt(10)
    v_mfma_f32_16x16x32_bf16 v[36:39], v[84:87], v[152:155], v[36:39]
    ds_read_b64_tr_b16 v[112:113], v2 offset:20480
    s_add_u32 m0, s42, 0x11000
    s_mov_b32 s39, 0x50000
    buffer_load_dwordx4 v6, s[16:19], s39 offen lds
    v_mfma_f32_16x16x32_bf16 v[36:39], v[68:71], v[144:147], v[36:39]
    ds_read_b64_tr_b16 v[114:115], v2 offset:22528
    s_waitcnt lgkmcnt(8)
    v_mfma_f32_16x16x32_bf16 v[40:43], v[72:75], v[144:147], v[40:43]
    ds_read_b64_tr_b16 v[100:101], v3 offset:16384
    v_mfma_f32_16x16x32_bf16 v[40:43], v[88:91], v[152:155], v[40:43]
    ds_read_b64_tr_b16 v[102:103], v3 offset:18432
    s_waitcnt lgkmcnt(6)
    v_mfma_f32_16x16x32_bf16 v[44:47], v[92:95], v[152:155], v[44:47]
    ds_read_b64_tr_b16 v[116:117], v3 offset:20480
    v_mfma_f32_16x16x32_bf16 v[44:47], v[76:79], v[144:147], v[44:47]
    ds_read_b64_tr_b16 v[118:119], v3 offset:22528
    s_add_u32 m0, s42, 0x12000
    s_mov_b32 s39, 0x60000
    buffer_load_dwordx4 v6, s[16:19], s39 offen lds
    v_mfma_f32_16x16x32_bf16 v[60:63], v[76:79], v[148:151], v[60:63]
    ds_read_b64_tr_b16 v[104:105], v4 offset:16384
    buffer_load_dwordx4 v[144:147], v1, s[8:11], s38 offen offset:0 sc1
    v_mfma_f32_16x16x32_bf16 v[60:63], v[92:95], v[156:159], v[60:63]
    ds_read_b64_tr_b16 v[106:107], v4 offset:18432
    buffer_load_dwordx4 v[152:155], v25, s[8:11], s38 offen offset:0 sc1
    v_mfma_f32_16x16x32_bf16 v[56:59], v[88:91], v[156:159], v[56:59]
    ds_read_b64_tr_b16 v[120:121], v4 offset:20480
    v_mfma_f32_16x16x32_bf16 v[56:59], v[72:75], v[148:151], v[56:59]
    ds_read_b64_tr_b16 v[122:123], v4 offset:22528
    v_mfma_f32_16x16x32_bf16 v[52:55], v[68:71], v[148:151], v[52:55]
    ds_read_b64_tr_b16 v[108:109], v5 offset:16384
    s_add_u32 m0, s42, 0x13000
    s_mov_b32 s39, 0x70000
    buffer_load_dwordx4 v6, s[16:19], s39 offen lds
    v_mfma_f32_16x16x32_bf16 v[52:55], v[84:87], v[156:159], v[52:55]
    ds_read_b64_tr_b16 v[110:111], v5 offset:18432
    v_mfma_f32_16x16x32_bf16 v[48:51], v[80:83], v[156:159], v[48:51]
    ds_read_b64_tr_b16 v[124:125], v5 offset:20480
    v_mfma_f32_16x16x32_bf16 v[48:51], v[64:67], v[148:151], v[48:51]
    ds_read_b64_tr_b16 v[126:127], v5 offset:22528
    buffer_load_dwordx4 v[148:151], v1, s[8:11], s38 offen offset:1024 sc1
    buffer_load_dwordx4 v[156:159], v25, s[8:11], s38 offen offset:1024 sc1
    s_add_u32 s38, s38, 0x40000
    s_waitcnt vmcnt(29) lgkmcnt(12)
    v_mfma_f32_16x16x32_bf16 v[32:35], v[96:99], v[160:163], v[32:35]
    ds_read_b64_tr_b16 v[64:65], v2 offset:24576
    s_waitcnt vmcnt(28)
    v_mfma_f32_16x16x32_bf16 v[32:35], v[112:115], v[168:171], v[32:35]
    ds_read_b64_tr_b16 v[66:67], v2 offset:26624
    s_waitcnt lgkmcnt(10)
    v_mfma_f32_16x16x32_bf16 v[36:39], v[116:119], v[168:171], v[36:39]
    ds_read_b64_tr_b16 v[80:81], v2 offset:28672
    v_mfma_f32_16x16x32_bf16 v[36:39], v[100:103], v[160:163], v[36:39]
    ds_read_b64_tr_b16 v[82:83], v2 offset:30720
    s_waitcnt lgkmcnt(8)
    v_mfma_f32_16x16x32_bf16 v[40:43], v[104:107], v[160:163], v[40:43]
    ds_read_b64_tr_b16 v[68:69], v3 offset:24576
    v_mfma_f32_16x16x32_bf16 v[40:43], v[120:123], v[168:171], v[40:43]
    ds_read_b64_tr_b16 v[70:71], v3 offset:26624
    s_waitcnt lgkmcnt(6)
    v_mfma_f32_16x16x32_bf16 v[44:47], v[124:127], v[168:171], v[44:47]
    ds_read_b64_tr_b16 v[84:85], v3 offset:28672
    v_mfma_f32_16x16x32_bf16 v[44:47], v[108:111], v[160:163], v[44:47]
    ds_read_b64_tr_b16 v[86:87], v3 offset:30720
    s_waitcnt vmcnt(13)
    ds_add_u32 v20, v22
    v_add_u32 v24, 1, v24
    v_mfma_f32_16x16x32_bf16 v[60:63], v[108:111], v[164:167], v[60:63]
    ds_read_b64_tr_b16 v[72:73], v4 offset:24576
    buffer_load_dwordx4 v[160:163], v1, s[8:11], s38 offen offset:0 sc1
    v_mfma_f32_16x16x32_bf16 v[60:63], v[124:127], v[172:175], v[60:63]
    ds_read_b64_tr_b16 v[74:75], v4 offset:26624
    buffer_load_dwordx4 v[168:171], v25, s[8:11], s38 offen offset:0 sc1
    v_mfma_f32_16x16x32_bf16 v[56:59], v[120:123], v[172:175], v[56:59]
    ds_read_b64_tr_b16 v[88:89], v4 offset:28672
    v_mfma_f32_16x16x32_bf16 v[56:59], v[104:107], v[164:167], v[56:59]
    ds_read_b64_tr_b16 v[90:91], v4 offset:30720
    v_mfma_f32_16x16x32_bf16 v[52:55], v[100:103], v[164:167], v[52:55]
    ds_read_b64_tr_b16 v[76:77], v5 offset:24576
    ds_read_b32 v23, v21
    v_mfma_f32_16x16x32_bf16 v[52:55], v[116:119], v[172:175], v[52:55]
    ds_read_b64_tr_b16 v[78:79], v5 offset:26624
    v_mfma_f32_16x16x32_bf16 v[48:51], v[112:115], v[172:175], v[48:51]
    ds_read_b64_tr_b16 v[92:93], v5 offset:28672
    v_mfma_f32_16x16x32_bf16 v[48:51], v[96:99], v[164:167], v[48:51]
    ds_read_b64_tr_b16 v[94:95], v5 offset:30720
    buffer_load_dwordx4 v[164:167], v1, s[8:11], s38 offen offset:1024 sc1
    buffer_load_dwordx4 v[172:175], v25, s[8:11], s38 offen offset:1024 sc1
    s_add_u32 s38, s38, 0x40000
    s_waitcnt lgkmcnt(3)
    v_cmp_gt_i32 vcc, v24, v23
    s_nop 0
    s_cbranch_vccnz p2_G_w34
p2_G_w34r:
    v_mfma_f32_16x16x32_bf16 v[32:35], v[64:67], v[176:179], v[32:35]
    ds_read_b64_tr_b16 v[96:97], v2 offset:32768
    s_add_u32 m0, s42, 0x14000
    s_mov_b32 s39, 0x80000
    buffer_load_dwordx4 v6, s[16:19], s39 offen lds
    v_mfma_f32_16x16x32_bf16 v[32:35], v[80:83], v[184:187], v[32:35]
    ds_read_b64_tr_b16 v[98:99], v2 offset:34816
    v_mfma_f32_16x16x32_bf16 v[36:39], v[84:87], v[184:187], v[36:39]
    ds_read_b64_tr_b16 v[112:113], v2 offset:36864
    v_mfma_f32_16x16x32_bf16 v[36:39], v[68:71], v[176:179], v[36:39]
    ds_read_b64_tr_b16 v[114:115], v2 offset:38912
    v_mfma_f32_16x16x32_bf16 v[40:43], v[72:75], v[176:179], v[40:43]
    ds_read_b64_tr_b16 v[100:101], v3 offset:32768
    v_mfma_f32_16x16x32_bf16 v[40:43], v[88:91], v[184:187], v[40:43]
    ds_read_b64_tr_b16 v[102:103], v3 offset:34816
    s_add_u32 m0, s42, 0x15000
    s_mov_b32 s39, 0x90000
    buffer_load_dwordx4 v6, s[16:19], s39 offen lds
    s_waitcnt lgkmcnt(6)
    v_mfma_f32_16x16x32_bf16 v[44:47], v[92:95], v[184:187], v[44:47]
    ds_read_b64_tr_b16 v[116:117], v3 offset:36864
    v_mfma_f32_16x16x32_bf16 v[44:47], v[76:79], v[176:179], v[44:47]
    ds_read_b64_tr_b16 v[118:119], v3 offset:38912
    v_mfma_f32_16x16x32_bf16 v[60:63], v[76:79], v[180:183], v[60:63]
    ds_read_b64_tr_b16 v[104:105], v4 offset:32768
    buffer_load_dwordx4 v[176:179], v1, s[8:11], s38 offen offset:0 sc1
    v_mfma_f32_16x16x32_bf16 v[60:63], v[92:95], v[188:191], v[60:63]
    ds_read_b64_tr_b16 v[106:107], v4 offset:34816
    buffer_load_dwordx4 v[184:187], v25, s[8:11], s38 offen offset:0 sc1
    v_mfma_f32_16x16x32_bf16 v[56:59], v[88:91], v[188:191], v[56:59]
    ds_read_b64_tr_b16 v[120:121], v4 offset:36864
    s_add_u32 m0, s42, 0x16000
    s_mov_b32 s39, 0xa0000
    buffer_load_dwordx4 v6, s[16:19], s39 offen lds
    v_mfma_f32_16x16x32_bf16 v[56:59], v[72:75], v[180:183], v[56:59]
    ds_read_b64_tr_b16 v[122:123], v4 offset:38912
    v_mfma_f32_16x16x32_bf16 v[52:55], v[68:71], v[180:183], v[52:55]
    ds_read_b64_tr_b16 v[108:109], v5 offset:32768
    v_mfma_f32_16x16x32_bf16 v[52:55], v[84:87], v[188:191], v[52:55]
    ds_read_b64_tr_b16 v[110:111], v5 offset:34816
    v_mfma_f32_16x16x32_bf16 v[48:51], v[80:83], v[188:191], v[48:51]
    ds_read_b64_tr_b16 v[124:125], v5 offset:36864
    s_cmp_eq_u32 s45, 0x14000
    s_cselect_b32 s47, 0xfffec000, s57
    v_mfma_f32_16x16x32_bf16 v[48:51], v[64:67], v[180:183], v[48:51]
    ds_read_b64_tr_b16 v[126:127], v5 offset:38912
    buffer_load_dwordx4 v[180:183], v1, s[8:11], s38 offen offset:1024 sc1
    buffer_load_dwordx4 v[188:191], v25, s[8:11], s38 offen offset:1024 sc1
    s_add_u32 s38, s38, 0x40000
    v_add_u32 v2, s47, v2
    v_add_u32 v3, s47, v3
    v_add_u32 v4, s47, v4
    v_add_u32 v5, s47, v5
    s_add_u32 m0, s42, 0x17000
    s_mov_b32 s39, 0xb0000
    buffer_load_dwordx4 v6, s[16:19], s39 offen lds
    s_waitcnt lgkmcnt(12)
    v_mfma_f32_16x16x32_bf16 v[32:35], v[96:99], v[192:195], v[32:35]
    s_add_u32 s45, s45, s47
    ds_read_b64_tr_b16 v[64:65], v2 offset:0
    v_mfma_f32_16x16x32_bf16 v[32:35], v[112:115], v[200:203], v[32:35]
    ds_read_b64_tr_b16 v[66:67], v2 offset:2048
    s_waitcnt lgkmcnt(10)
    v_mfma_f32_16x16x32_bf16 v[36:39], v[116:119], v[200:203], v[36:39]
    ds_read_b64_tr_b16 v[80:81], v2 offset:4096
    v_mfma_f32_16x16x32_bf16 v[36:39], v[100:103], v[192:195], v[36:39]
    ds_read_b64_tr_b16 v[82:83], v2 offset:6144
    s_waitcnt lgkmcnt(8)
    v_mfma_f32_16x16x32_bf16 v[40:43], v[104:107], v[192:195], v[40:43]
    ds_read_b64_tr_b16 v[68:69], v3 offset:0
    s_add_u32 m0, s42, 0x18000
    s_mov_b32 s39, 0xc0000
    buffer_load_dwordx4 v6, s[16:19], s39 offen lds
    v_mfma_f32_16x16x32_bf16 v[40:43], v[120:123], v[200:203], v[40:43]
    ds_read_b64_tr_b16 v[70:71], v3 offset:2048
    s_waitcnt lgkmcnt(6)
    v_mfma_f32_16x16x32_bf16 v[44:47], v[124:127], v[200:203], v[44:47]
    ds_read_b64_tr_b16 v[84:85], v3 offset:4096
    v_mfma_f32_16x16x32_bf16 v[44:47], v[108:111], v[192:195], v[44:47]
    ds_read_b64_tr_b16 v[86:87], v3 offset:6144
    v_mfma_f32_16x16x32_bf16 v[60:63], v[108:111], v[196:199], v[60:63]
    ds_read_b64_tr_b16 v[72:73], v4 offset:0
    buffer_load_dwordx4 v[192:195], v1, s[8:11], s38 offen offset:0 sc1
    v_mfma_f32_16x16x32_bf16 v[60:63], v[124:127], v[204:207], v[60:63]
    ds_read_b64_tr_b16 v[74:75], v4 offset:2048
    buffer_load_dwordx4 v[200:203], v25, s[8:11], s38 offen offset:0 sc1
    v_mfma_f32_16x16x32_bf16 v[56:59], v[120:123], v[204:207], v[56:59]
    ds_read_b64_tr_b16 v[88:89], v4 offset:4096
    v_mfma_f32_16x16x32_bf16 v[56:59], v[104:107], v[196:199], v[56:59]
    ds_read_b64_tr_b16 v[90:91], v4 offset:6144
    v_mfma_f32_16x16x32_bf16 v[52:55], v[100:103], v[196:199], v[52:55]
    ds_read_b64_tr_b16 v[76:77], v5 offset:0
    v_mfma_f32_16x16x32_bf16 v[52:55], v[116:119], v[204:207], v[52:55]
    ds_read_b64_tr_b16 v[78:79], v5 offset:2048
    v_mfma_f32_16x16x32_bf16 v[48:51], v[112:115], v[204:207], v[48:51]
    ds_read_b64_tr_b16 v[92:93], v5 offset:4096
    v_mfma_f32_16x16x32_bf16 v[48:51], v[96:99], v[196:199], v[48:51]
    ds_read_b64_tr_b16 v[94:95], v5 offset:6144
    buffer_load_dwordx4 v[196:199], v1, s[8:11], s38 offen offset:1024 sc1
    buffer_load_dwordx4 v[204:207], v25, s[8:11], s38 offen offset:1024 sc1
    s_add_u32 s38, s38, 0x40000
    s_waitcnt vmcnt(17)
    ds_add_u32 v20, v22
    v_add_u32 v24, 1, v24
    s_waitcnt lgkmcnt(13)
    v_mfma_f32_16x16x32_bf16 v[32:35], v[64:67], v[128:131], v[32:35]
    ds_read_b64_tr_b16 v[96:97], v2 offset:8192
    v_mfma_f32_16x16x32_bf16 v[32:35], v[80:83], v[136:139], v[32:35]
    ds_read_b64_tr_b16 v[98:99], v2 offset:10240
    s_waitcnt lgkmcnt(11)
    v_mfma_f32_16x16x32_bf16 v[36:39], v[84:87], v[136:139], v[36:39]
    ds_read_b64_tr_b16 v[112:113], v2 offset:12288
    v_mfma_f32_16x16x32_bf16 v[36:39], v[68:71], v[128:131], v[36:39]
    ds_read_b64_tr_b16 v[114:115], v2 offset:14336
    s_waitcnt lgkmcnt(9)
    v_mfma_f32_16x16x32_bf16 v[40:43], v[72:75], v[128:131], v[40:43]
    ds_read_b64_tr_b16 v[100:101], v3 offset:8192
    ds_read_b32 v23, v21
    v_mfma_f32_16x16x32_bf16 v[40:43], v[88:91], v[136:139], v[40:43]
    ds_read_b64_tr_b16 v[102:103], v3 offset:10240
    s_waitcnt lgkmcnt(8)
    v_mfma_f32_16x16x32_bf16 v[44:47], v[92:95], v[136:139], v[44:47]
    ds_read_b64_tr_b16 v[116:117], v3 offset:12288
    v_mfma_f32_16x16x32_bf16 v[44:47], v[76:79], v[128:131], v[44:47]
    ds_read_b64_tr_b16 v[118:119], v3 offset:14336
    s_waitcnt lgkmcnt(3)
    v_cmp_gt_i32 vcc, v24, v23
    s_nop 0
    s_cbranch_vccnz p2_G_w35
p2_G_w35r:
    v_mfma_f32_16x16x32_bf16 v[60:63], v[76:79], v[132:135], v[60:63]
    ds_read_b64_tr_b16 v[104:105], v4 offset:8192
    buffer_load_dwordx4 v[128:131], v1, s[8:11], s38 offen offset:0 sc1
    s_add_u32 m0, s42, 0x19000
    s_mov_b32 s39, 0xd0000
    buffer_load_dwordx4 v6, s[16:19], s39 offen lds
    v_mfma_f32_16x16x32_bf16 v[60:63], v[92:95], v[140:143], v[60:63]
    ds_read_b64_tr_b16 v[106:107], v4 offset:10240
    buffer_load_dwordx4 v[136:139], v25, s[8:11], s38 offen offset:0 sc1
    v_mfma_f32_16x16x32_bf16 v[56:59], v[88:91], v[140:143], v[56:59]
    ds_read_b64_tr_b16 v[120:121], v4 offset:12288
    v_mfma_f32_16x16x32_bf16 v[56:59], v[72:75], v[132:135], v[56:59]
    ds_read_b64_tr_b16 v[122:123], v4 offset:14336
    v_mfma_f32_16x16x32_bf16 v[52:55], v[68:71], v[132:135], v[52:55]
    ds_read_b64_tr_b16 v[108:109], v5 offset:8192
    v_mfma_f32_16x16x32_bf16 v[52:55], v[84:87], v[140:143], v[52:55]
    ds_read_b64_tr_b16 v[110:111], v5 offset:10240
    s_add_u32 m0, s42, 0x1a000
    s_mov_b32 s39, 0xe0000
    buffer_load_dwordx4 v6, s[16:19], s39 offen lds
    v_mfma_f32_16x16x32_bf16 v[48:51], v[80:83], v[140:143], v[48:51]
    ds_read_b64_tr_b16 v[124:125], v5 offset:12288
    v_mfma_f32_16x16x32_bf16 v[48:51], v[64:67], v[132:135], v[48:51]
    ds_read_b64_tr_b16 v[126:127], v5 offset:14336
    buffer_load_dwordx4 v[132:135], v1, s[8:11], s38 offen offset:1024 sc1
    buffer_load_dwordx4 v[140:143], v25, s[8:11], s38 offen offset:1024 sc1
    s_add_u32 s38, s38, 0x40000
    v_mfma_f32_16x16x32_bf16 v[32:35], v[96:99], v[144:147], v[32:35]
    ds_read_b64_tr_b16 v[64:65], v2 offset:16384
    v_mfma_f32_16x16x32_bf16 v[32:35], v[112:115], v[152:155], v[32:35]
    ds_read_b64_tr_b16 v[66:67], v2 offset:18432
    s_waitcnt lgkmcnt(10)
    v_mfma_f32_16x16x32_bf16 v[36:39], v[116:119], v[152:155], v[36:39]
    ds_read_b64_tr_b16 v[80:81], v2 offset:20480
    s_add_u32 m0, s42, 0x1b000
    s_mov_b32 s39, 0xf0000
    buffer_load_dwordx4 v6, s[16:19], s39 offen lds
    buffer_load_dword v28, v27, s[8:11], 0 offen sc1
    v_mfma_f32_16x16x32_bf16 v[36:39], v[100:103], v[144:147], v[36:39]
    ds_read_b64_tr_b16 v[82:83], v2 offset:22528
    s_waitcnt lgkmcnt(8)
    v_mfma_f32_16x16x32_bf16 v[40:43], v[104:107], v[144:147], v[40:43]
    ds_read_b64_tr_b16 v[68:69], v3 offset:16384
    v_mfma_f32_16x16x32_bf16 v[40:43], v[120:123], v[152:155], v[40:43]
    ds_read_b64_tr_b16 v[70:71], v3 offset:18432
    s_waitcnt lgkmcnt(6)
    v_mfma_f32_16x16x32_bf16 v[44:47], v[124:127], v[152:155], v[44:47]
    ds_read_b64_tr_b16 v[84:85], v3 offset:20480
    v_mfma_f32_16x16x32_bf16 v[44:47], v[108:111], v[144:147], v[44:47]
    ds_read_b64_tr_b16 v[86:87], v3 offset:22528
    s_add_u32 m0, s42, 0x1c000
    s_mov_b32 s39, 0x100000
    buffer_load_dwordx4 v6, s[16:19], s39 offen lds
    v_mfma_f32_16x16x32_bf16 v[60:63], v[108:111], v[148:151], v[60:63]
    ds_read_b64_tr_b16 v[72:73], v4 offset:16384
    v_mfma_f32_16x16x32_bf16 v[60:63], v[124:127], v[156:159], v[60:63]
    ds_read_b64_tr_b16 v[74:75], v4 offset:18432
    v_mfma_f32_16x16x32_bf16 v[56:59], v[120:123], v[156:159], v[56:59]
    ds_read_b64_tr_b16 v[88:89], v4 offset:20480
    v_mfma_f32_16x16x32_bf16 v[56:59], v[104:107], v[148:151], v[56:59]
    ds_read_b64_tr_b16 v[90:91], v4 offset:22528
    v_mfma_f32_16x16x32_bf16 v[52:55], v[100:103], v[148:151], v[52:55]
    ds_read_b64_tr_b16 v[76:77], v5 offset:16384
    s_add_u32 m0, s42, 0x1d000
    s_mov_b32 s39, 0x110000
    buffer_load_dwordx4 v6, s[16:19], s39 offen lds
    v_mfma_f32_16x16x32_bf16 v[52:55], v[116:119], v[156:159], v[52:55]
    ds_read_b64_tr_b16 v[78:79], v5 offset:18432
    v_mfma_f32_16x16x32_bf16 v[48:51], v[112:115], v[156:159], v[48:51]
    ds_read_b64_tr_b16 v[92:93], v5 offset:20480
    v_mfma_f32_16x16x32_bf16 v[48:51], v[96:99], v[148:151], v[48:51]
    ds_read_b64_tr_b16 v[94:95], v5 offset:22528
    s_waitcnt vmcnt(26) lgkmcnt(12)
    v_mfma_f32_16x16x32_bf16 v[32:35], v[64:67], v[160:163], v[32:35]
    ds_read_b64_tr_b16 v[96:97], v2 offset:24576
    s_waitcnt vmcnt(25)
    v_mfma_f32_16x16x32_bf16 v[32:35], v[80:83], v[168:171], v[32:35]
    ds_read_b64_tr_b16 v[98:99], v2 offset:26624
    s_waitcnt lgkmcnt(10)
    v_mfma_f32_16x16x32_bf16 v[36:39], v[84:87], v[168:171], v[36:39]
    ds_read_b64_tr_b16 v[112:113], v2 offset:28672
    v_mfma_f32_16x16x32_bf16 v[36:39], v[68:71], v[160:163], v[36:39]
    ds_read_b64_tr_b16 v[114:115], v2 offset:30720
    s_waitcnt lgkmcnt(8)
    v_mfma_f32_16x16x32_bf16 v[40:43], v[72:75], v[160:163], v[40:43]
    ds_read_b64_tr_b16 v[100:101], v3 offset:24576
    v_mfma_f32_16x16x32_bf16 v[40:43], v[88:91], v[168:171], v[40:43]
    ds_read_b64_tr_b16 v[102:103], v3 offset:26624
    s_waitcnt lgkmcnt(6)
    v_mfma_f32_16x16x32_bf16 v[44:47], v[92:95], v[168:171], v[44:47]
    ds_read_b64_tr_b16 v[116:117], v3 offset:28672
    v_mfma_f32_16x16x32_bf16 v[44:47], v[76:79], v[160:163], v[44:47]
    ds_read_b64_tr_b16 v[118:119], v3 offset:30720
    s_waitcnt vmcnt(10)
    ds_add_u32 v20, v22
    v_add_u32 v24, 1, v24
    v_mfma_f32_16x16x32_bf16 v[60:63], v[76:79], v[164:167], v[60:63]
    ds_read_b64_tr_b16 v[104:105], v4 offset:24576
    v_mfma_f32_16x16x32_bf16 v[60:63], v[92:95], v[172:175], v[60:63]
    ds_read_b64_tr_b16 v[106:107], v4 offset:26624
    v_mfma_f32_16x16x32_bf16 v[56:59], v[88:91], v[172:175], v[56:59]
    ds_read_b64_tr_b16 v[120:121], v4 offset:28672
    v_mfma_f32_16x16x32_bf16 v[56:59], v[72:75], v[164:167], v[56:59]
    ds_read_b64_tr_b16 v[122:123], v4 offset:30720
    v_mfma_f32_16x16x32_bf16 v[52:55], v[68:71], v[164:167], v[52:55]
    ds_read_b64_tr_b16 v[108:109], v5 offset:24576
    ds_read_b32 v23, v21
    v_mfma_f32_16x16x32_bf16 v[52:55], v[84:87], v[172:175], v[52:55]
    ds_read_b64_tr_b16 v[110:111], v5 offset:26624
    v_mfma_f32_16x16x32_bf16 v[48:51], v[80:83], v[172:175], v[48:51]
    ds_read_b64_tr_b16 v[124:125], v5 offset:28672
    v_mfma_f32_16x16x32_bf16 v[48:51], v[64:67], v[164:167], v[48:51]
    ds_read_b64_tr_b16 v[126:127], v5 offset:30720
    s_waitcnt lgkmcnt(3)
    v_cmp_gt_i32 vcc, v24, v23
    s_nop 0
    s_cbranch_vccnz p2_G_w36
p2_G_w36r:
    s_waitcnt vmcnt(2)
    v_cmp_ne_u32 vcc, 0, v28
    s_lshl_b32 s38, s36, 11
    s_add_u32 s38, s38, 0x1800000
    s_cmp_eq_u64 vcc, -1
    s_cbranch_scc0 p2_G_poll
p2_G_go:
    buffer_load_dwordx4 v[144:147], v1, s[8:11], s38 offen offset:0 sc1
    buffer_load_dwordx4 v[148:151], v1, s[8:11], s38 offen offset:1024 sc1
    buffer_load_dwordx4 v[152:155], v25, s[8:11], s38 offen offset:0 sc1
    buffer_load_dwordx4 v[156:159], v25, s[8:11], s38 offen offset:1024 sc1
    s_add_u32 s38, s38, 0x40000
    buffer_load_dwordx4 v[160:163], v1, s[8:11], s38 offen offset:0 sc1
    buffer_load_dwordx4 v[164:167], v1, s[8:11], s38 offen offset:1024 sc1
    buffer_load_dwordx4 v[168:171], v25, s[8:11], s38 offen offset:0 sc1
    buffer_load_dwordx4 v[172:175], v25, s[8:11], s38 offen offset:1024 sc1
    s_add_u32 s38, s38, 0x40000
    v_mfma_f32_16x16x32_bf16 v[32:35], v[96:99], v[176:179], v[32:35]
    ds_read_b64_tr_b16 v[64:65], v2 offset:32768
    s_add_u32 m0, s42, 0x0
    s_mov_b32 s39, 0x120000
    buffer_load_dwordx4 v6, s[16:19], s39 offen lds
    v_mfma_f32_16x16x32_bf16 v[32:35], v[112:115], v[184:187], v[32:35]
    ds_read_b64_tr_b16 v[66:67], v2 offset:34816
    v_mfma_f32_16x16x32_bf16 v[36:39], v[116:119], v[184:187], v[36:39]
    ds_read_b64_tr_b16 v[80:81], v2 offset:36864
    v_mfma_f32_16x16x32_bf16 v[36:39], v[100:103], v[176:179], v[36:39]
    ds_read_b64_tr_b16 v[82:83], v2 offset:38912
    v_mfma_f32_16x16x32_bf16 v[40:43], v[104:107], v[176:179], v[40:43]
    ds_read_b64_tr_b16 v[68:69], v3 offset:32768
    v_mfma_f32_16x16x32_bf16 v[40:43], v[120:123], v[184:187], v[40:43]
    ds_read_b64_tr_b16 v[70:71], v3 offset:34816
    s_add_u32 m0, s42, 0x1000
    s_mov_b32 s39, 0x130000
    buffer_load_dwordx4 v6, s[16:19], s39 offen lds
    s_waitcnt lgkmcnt(6)
    v_mfma_f32_16x16x32_bf16 v[44:47], v[124:127], v[184:187], v[44:47]
    ds_read_b64_tr_b16 v[84:85], v3 offset:36864
    v_mfma_f32_16x16x32_bf16 v[44:47], v[108:111], v[176:179], v[44:47]
    ds_read_b64_tr_b16 v[86:87], v3 offset:38912
    v_mfma_f32_16x16x32_bf16 v[60:63], v[108:111], v[180:183], v[60:63]
    ds_read_b64_tr_b16 v[72:73], v4 offset:32768
    buffer_load_dwordx4 v[176:179], v1, s[8:11], s38 offen offset:0 sc1
    v_mfma_f32_16x16x32_bf16 v[60:63], v[124:127], v[188:191], v[60:63]
    ds_read_b64_tr_b16 v[74:75], v4 offset:34816
    buffer_load_dwordx4 v[184:187], v25, s[8:11], s38 offen offset:0 sc1
    v_mfma_f32_16x16x32_bf16 v[56:59], v[120:123], v[188:191], v[56:59]
    ds_read_b64_tr_b16 v[88:89], v4 offset:36864
    s_add_u32 m0, s42, 0x2000
    s_mov_b32 s39, 0x140000
    buffer_load_dwordx4 v6, s[16:19], s39 offen lds
    v_mfma_f32_16x16x32_bf16 v[56:59], v[104:107], v[180:183], v[56:59]
    ds_read_b64_tr_b16 v[90:91], v4 offset:38912
    v_mfma_f32_16x16x32_bf16 v[52:55], v[100:103], v[180:183], v[52:55]
    ds_read_b64_tr_b16 v[76:77], v5 offset:32768
    v_mfma_f32_16x16x32_bf16 v[52:55], v[116:119], v[188:191], v[52:55]
    ds_read_b64_tr_b16 v[78:79], v5 offset:34816
    v_mfma_f32_16x16x32_bf16 v[48:51], v[112:115], v[188:191], v[48:51]
    ds_read_b64_tr_b16 v[92:93], v5 offset:36864
    s_cmp_eq_u32 s45, 0x14000
    s_cselect_b32 s47, 0xfffec000, s57
    v_mfma_f32_16x16x32_bf16 v[48:51], v[96:99], v[180:183], v[48:51]
    ds_read_b64_tr_b16 v[94:95], v5 offset:38912
    buffer_load_dwordx4 v[180:183], v1, s[8:11], s38 offen offset:1024 sc1
    buffer_load_dwordx4 v[188:191], v25, s[8:11], s38 offen offset:1024 sc1
    s_add_u32 s38, s38, 0x40000
    v_add_u32 v2, s47, v2
    v_add_u32 v3, s47, v3
    v_add_u32 v4, s47, v4
    v_add_u32 v5, s47, v5
    s_add_u32 m0, s42, 0x3000
    s_mov_b32 s39, 0x150000
    buffer_load_dwordx4 v6, s[16:19], s39 offen lds
    s_waitcnt lgkmcnt(12)
    v_mfma_f32_16x16x32_bf16 v[32:35], v[64:67], v[192:195], v[32:35]
    s_add_u32 s45, s45, s47
    ds_read_b64_tr_b16 v[96:97], v2 offset:0
    v_mfma_f32_16x16x32_bf16 v[32:35], v[80:83], v[200:203], v[32:35]
    ds_read_b64_tr_b16 v[98:99], v2 offset:2048
    s_waitcnt lgkmcnt(10)
    v_mfma_f32_16x16x32_bf16 v[36:39], v[84:87], v[200:203], v[36:39]
    ds_read_b64_tr_b16 v[112:113], v2 offset:4096
    v_mfma_f32_16x16x32_bf16 v[36:39], v[68:71], v[192:195], v[36:39]
    ds_read_b64_tr_b16 v[114:115], v2 offset:6144
    s_waitcnt lgkmcnt(8)
    v_mfma_f32_16x16x32_bf16 v[40:43], v[72:75], v[192:195], v[40:43]
    ds_read_b64_tr_b16 v[100:101], v3 offset:0
    s_add_u32 m0, s42, 0x4000
    s_mov_b32 s39, 0x160000
    buffer_load_dwordx4 v6, s[16:19], s39 offen lds
    v_mfma_f32_16x16x32_bf16 v[40:43], v[88:91], v[200:203], v[40:43]
    ds_read_b64_tr_b16 v[102:103], v3 offset:2048
    s_waitcnt lgkmcnt(6)
    v_mfma_f32_16x16x32_bf16 v[44:47], v[92:95], v[200:203], v[44:47]
    ds_read_b64_tr_b16 v[116:117], v3 offset:4096
    v_mfma_f32_16x16x32_bf16 v[44:47], v[76:79], v[192:195], v[44:47]
    ds_read_b64_tr_b16 v[118:119], v3 offset:6144
    v_mfma_f32_16x16x32_bf16 v[60:63], v[76:79], v[196:199], v[60:63]
    ds_read_b64_tr_b16 v[104:105], v4 offset:0
    buffer_load_dwordx4 v[192:195], v1, s[8:11], s38 offen offset:0 sc1
    v_mfma_f32_16x16x32_bf16 v[60:63], v[92:95], v[204:207], v[60:63]
    ds_read_b64_tr_b16 v[106:107], v4 offset:2048
    buffer_load_dwordx4 v[200:203], v25, s[8:11], s38 offen offset:0 sc1
    v_mfma_f32_16x16x32_bf16 v[56:59], v[88:91], v[204:207], v[56:59]
    ds_read_b64_tr_b16 v[120:121], v4 offset:4096
    v_mfma_f32_16x16x32_bf16 v[56:59], v[72:75], v[196:199], v[56:59]
    ds_read_b64_tr_b16 v[122:123], v4 offset:6144
    v_mfma_f32_16x16x32_bf16 v[52:55], v[68:71], v[196:199], v[52:55]
    ds_read_b64_tr_b16 v[108:109], v5 offset:0
    v_mfma_f32_16x16x32_bf16 v[52:55], v[84:87], v[204:207], v[52:55]
    ds_read_b64_tr_b16 v[110:111], v5 offset:2048
    v_mfma_f32_16x16x32_bf16 v[48:51], v[80:83], v[204:207], v[48:51]
    ds_read_b64_tr_b16 v[124:125], v5 offset:4096
    v_mfma_f32_16x16x32_bf16 v[48:51], v[64:67], v[196:199], v[48:51]
    ds_read_b64_tr_b16 v[126:127], v5 offset:6144
    buffer_load_dwordx4 v[196:199], v1, s[8:11], s38 offen offset:1024 sc1
    buffer_load_dwordx4 v[204:207], v25, s[8:11], s38 offen offset:1024 sc1
    s_add_u32 s38, s38, 0x40000
    s_waitcnt vmcnt(21)
    ds_add_u32 v20, v22
    v_add_u32 v24, 1, v24
    s_waitcnt lgkmcnt(13)
    v_mfma_f32_16x16x32_bf16 v[32:35], v[96:99], v[128:131], v[32:35]
    ds_read_b64_tr_b16 v[64:65], v2 offset:8192
    v_mfma_f32_16x16x32_bf16 v[32:35], v[112:115], v[136:139], v[32:35]
    ds_read_b64_tr_b16 v[66:67], v2 offset:10240
    s_waitcnt lgkmcnt(11)
    v_mfma_f32_16x16x32_bf16 v[36:39], v[116:119], v[136:139], v[36:39]
    ds_read_b64_tr_b16 v[80:81], v2 offset:12288
    v_mfma_f32_16x16x32_bf16 v[36:39], v[100:103], v[128:131], v[36:39]
    ds_read_b64_tr_b16 v[82:83], v2 offset:14336
    s_waitcnt lgkmcnt(9)
    v_mfma_f32_16x16x32_bf16 v[40:43], v[104:107], v[128:131], v[40:43]
    ds_read_b64_tr_b16 v[68:69], v3 offset:8192
    ds_read_b32 v23, v21
    v_mfma_f32_16x16x32_bf16 v[40:43], v[120:123], v[136:139], v[40:43]
    ds_read_b64_tr_b16 v[70:71], v3 offset:10240
    s_waitcnt lgkmcnt(8)
    v_mfma_f32_16x16x32_bf16 v[44:47], v[124:127], v[136:139], v[44:47]
    ds_read_b64_tr_b16 v[84:85], v3 offset:12288
    v_mfma_f32_16x16x32_bf16 v[44:47], v[108:111], v[128:131], v[44:47]
    ds_read_b64_tr_b16 v[86:87], v3 offset:14336
    s_waitcnt lgkmcnt(3)
    v_cmp_gt_i32 vcc, v24, v23
    s_nop 0
    s_cbranch_vccnz p2_G_w37
p2_G_w37r:
    v_mfma_f32_16x16x32_bf16 v[60:63], v[108:111], v[132:135], v[60:63]
    ds_read_b64_tr_b16 v[72:73], v4 offset:8192
    buffer_load_dwordx4 v[128:131], v1, s[8:11], s38 offen offset:0 sc1
    s_add_u32 m0, s42, 0x5000
    s_mov_b32 s39, 0x170000
    buffer_load_dwordx4 v6, s[16:19], s39 offen lds
    v_mfma_f32_16x16x32_bf16 v[60:63], v[124:127], v[140:143], v[60:63]
    ds_read_b64_tr_b16 v[74:75], v4 offset:10240
    buffer_load_dwordx4 v[136:139], v25, s[8:11], s38 offen offset:0 sc1
    v_mfma_f32_16x16x32_bf16 v[56:59], v[120:123], v[140:143], v[56:59]
    ds_read_b64_tr_b16 v[88:89], v4 offset:12288
    v_mfma_f32_16x16x32_bf16 v[56:59], v[104:107], v[132:135], v[56:59]
    ds_read_b64_tr_b16 v[90:91], v4 offset:14336
    v_mfma_f32_16x16x32_bf16 v[52:55], v[100:103], v[132:135], v[52:55]
    ds_read_b64_tr_b16 v[76:77], v5 offset:8192
    v_mfma_f32_16x16x32_bf16 v[52:55], v[116:119], v[140:143], v[52:55]
    ds_read_b64_tr_b16 v[78:79], v5 offset:10240
    s_add_u32 m0, s42, 0x6000
    s_mov_b32 s39, 0x180000
    buffer_load_dwordx4 v6, s[16:19], s39 offen lds
    v_mfma_f32_16x16x32_bf16 v[48:51], v[112:115], v[140:143], v[48:51]
    ds_read_b64_tr_b16 v[92:93], v5 offset:12288
    v_mfma_f32_16x16x32_bf16 v[48:51], v[96:99], v[132:135], v[48:51]
    ds_read_b64_tr_b16 v[94:95], v5 offset:14336
    buffer_load_dwordx4 v[132:135], v1, s[8:11], s38 offen offset:1024 sc1
    buffer_load_dwordx4 v[140:143], v25, s[8:11], s38 offen offset:1024 sc1
    s_add_u32 s38, s38, 0x40000
    s_nop 7
    v_pk_mul_f32 v[32:33], v[32:33], v[10:11] op_sel_hi:[1,0]
    v_pk_mul_f32 v[34:35], v[34:35], v[10:11] op_sel_hi:[1,0]
    v_pk_mul_f32 v[36:37], v[36:37], v[10:11] op_sel_hi:[1,0]
    v_pk_mul_f32 v[38:39], v[38:39], v[10:11] op_sel_hi:[1,0]
    v_pk_mul_f32 v[40:41], v[40:41], v[10:11] op_sel_hi:[1,0]
    v_pk_mul_f32 v[42:43], v[42:43], v[10:11] op_sel_hi:[1,0]
    v_pk_mul_f32 v[44:45], v[44:45], v[10:11] op_sel_hi:[1,0]
    v_pk_mul_f32 v[46:47], v[46:47], v[10:11] op_sel_hi:[1,0]
    v_pk_mul_f32 v[48:49], v[48:49], v[12:13] op_sel_hi:[1,0]
    v_pk_mul_f32 v[50:51], v[50:51], v[12:13] op_sel_hi:[1,0]
    v_pk_mul_f32 v[52:53], v[52:53], v[12:13] op_sel_hi:[1,0]
    v_pk_mul_f32 v[54:55], v[54:55], v[12:13] op_sel_hi:[1,0]
    v_pk_mul_f32 v[56:57], v[56:57], v[12:13] op_sel_hi:[1,0]
    v_pk_mul_f32 v[58:59], v[58:59], v[12:13] op_sel_hi:[1,0]
    v_pk_mul_f32 v[60:61], v[60:61], v[12:13] op_sel_hi:[1,0]
    v_pk_mul_f32 v[62:63], v[62:63], v[12:13] op_sel_hi:[1,0]
    s_nop 1
    s_waitcnt vmcnt(26)
    v_mfma_f32_16x16x32_bf16 v[32:35], v[64:67], v[144:147], v[32:35]
    ds_read_b64_tr_b16 v[96:97], v2 offset:16384
    s_waitcnt vmcnt(24)
    v_mfma_f32_16x16x32_bf16 v[32:35], v[80:83], v[152:155], v[32:35]
    ds_read_b64_tr_b16 v[98:99], v2 offset:18432
    s_waitcnt lgkmcnt(10)
    v_mfma_f32_16x16x32_bf16 v[36:39], v[84:87], v[152:155], v[36:39]
    ds_read_b64_tr_b16 v[112:113], v2 offset:20480
    s_add_u32 m0, s42, 0x7000
    s_mov_b32 s39, 0x190000
    buffer_load_dwordx4 v6, s[16:19], s39 offen lds
    v_mfma_f32_16x16x32_bf16 v[36:39], v[68:71], v[144:147], v[36:39]
    ds_read_b64_tr_b16 v[114:115], v2 offset:22528
    s_waitcnt lgkmcnt(8)
    v_mfma_f32_16x16x32_bf16 v[40:43], v[72:75], v[144:147], v[40:43]
    ds_read_b64_tr_b16 v[100:101], v3 offset:16384
    v_mfma_f32_16x16x32_bf16 v[40:43], v[88:91], v[152:155], v[40:43]
    ds_read_b64_tr_b16 v[102:103], v3 offset:18432
    s_waitcnt lgkmcnt(6)
    v_mfma_f32_16x16x32_bf16 v[44:47], v[92:95], v[152:155], v[44:47]
    ds_read_b64_tr_b16 v[116:117], v3 offset:20480
    v_mfma_f32_16x16x32_bf16 v[44:47], v[76:79], v[144:147], v[44:47]
    ds_read_b64_tr_b16 v[118:119], v3 offset:22528
    s_add_u32 m0, s42, 0x8000
    s_mov_b32 s39, 0x1a0000
    buffer_load_dwordx4 v6, s[16:19], s39 offen lds
    v_mfma_f32_16x16x32_bf16 v[60:63], v[76:79], v[148:151], v[60:63]
    ds_read_b64_tr_b16 v[104:105], v4 offset:16384
    buffer_load_dwordx4 v[144:147], v1, s[8:11], s38 offen offset:0 sc1
    s_waitcnt vmcnt(26)
    v_mfma_f32_16x16x32_bf16 v[60:63], v[92:95], v[156:159], v[60:63]
    ds_read_b64_tr_b16 v[106:107], v4 offset:18432
    buffer_load_dwordx4 v[152:155], v25, s[8:11], s38 offen offset:0 sc1
    v_mfma_f32_16x16x32_bf16 v[56:59], v[88:91], v[156:159], v[56:59]
    ds_read_b64_tr_b16 v[120:121], v4 offset:20480
    v_mfma_f32_16x16x32_bf16 v[56:59], v[72:75], v[148:151], v[56:59]
    ds_read_b64_tr_b16 v[122:123], v4 offset:22528
    v_mfma_f32_16x16x32_bf16 v[52:55], v[68:71], v[148:151], v[52:55]
    ds_read_b64_tr_b16 v[108:109], v5 offset:16384
    s_add_u32 m0, s42, 0x9000
    s_mov_b32 s39, 0x1b0000
    buffer_load_dwordx4 v6, s[16:19], s39 offen lds
    v_mfma_f32_16x16x32_bf16 v[52:55], v[84:87], v[156:159], v[52:55]
    ds_read_b64_tr_b16 v[110:111], v5 offset:18432
    v_mfma_f32_16x16x32_bf16 v[48:51], v[80:83], v[156:159], v[48:51]
    ds_read_b64_tr_b16 v[124:125], v5 offset:20480
    v_mfma_f32_16x16x32_bf16 v[48:51], v[64:67], v[148:151], v[48:51]
    ds_read_b64_tr_b16 v[126:127], v5 offset:22528
    buffer_load_dwordx4 v[148:151], v1, s[8:11], s38 offen offset:1024 sc1
    buffer_load_dwordx4 v[156:159], v25, s[8:11], s38 offen offset:1024 sc1
    s_add_u32 s38, s38, 0x40000
    s_waitcnt vmcnt(29) lgkmcnt(12)
    v_mfma_f32_16x16x32_bf16 v[32:35], v[96:99], v[160:163], v[32:35]
    ds_read_b64_tr_b16 v[64:65], v2 offset:24576
    s_waitcnt vmcnt(27)
    v_mfma_f32_16x16x32_bf16 v[32:35], v[112:115], v[168:171], v[32:35]
    ds_read_b64_tr_b16 v[66:67], v2 offset:26624
    s_waitcnt lgkmcnt(10)
    v_mfma_f32_16x16x32_bf16 v[36:39], v[116:119], v[168:171], v[36:39]
    ds_read_b64_tr_b16 v[80:81], v2 offset:28672
    v_mfma_f32_16x16x32_bf16 v[36:39], v[100:103], v[160:163], v[36:39]
    ds_read_b64_tr_b16 v[82:83], v2 offset:30720
    s_waitcnt lgkmcnt(8)
    v_mfma_f32_16x16x32_bf16 v[40:43], v[104:107], v[160:163], v[40:43]
    ds_read_b64_tr_b16 v[68:69], v3 offset:24576
    v_mfma_f32_16x16x32_bf16 v[40:43], v[120:123], v[168:171], v[40:43]
    ds_read_b64_tr_b16 v[70:71], v3 offset:26624
    s_waitcnt lgkmcnt(6)
    v_mfma_f32_16x16x32_bf16 v[44:47], v[124:127], v[168:171], v[44:47]
    ds_read_b64_tr_b16 v[84:85], v3 offset:28672
    v_mfma_f32_16x16x32_bf16 v[44:47], v[108:111], v[160:163], v[44:47]
    ds_read_b64_tr_b16 v[86:87], v3 offset:30720
    s_waitcnt vmcnt(13)
    ds_add_u32 v20, v22
    v_add_u32 v24, 1, v24
    v_mfma_f32_16x16x32_bf16 v[60:63], v[108:111], v[164:167], v[60:63]
    ds_read_b64_tr_b16 v[72:73], v4 offset:24576
    buffer_load_dwordx4 v[160:163], v1, s[8:11], s38 offen offset:0 sc1
    v_mfma_f32_16x16x32_bf16 v[60:63], v[124:127], v[172:175], v[60:63]
    ds_read_b64_tr_b16 v[74:75], v4 offset:26624
    buffer_load_dwordx4 v[168:171], v25, s[8:11], s38 offen offset:0 sc1
    v_mfma_f32_16x16x32_bf16 v[56:59], v[120:123], v[172:175], v[56:59]
    ds_read_b64_tr_b16 v[88:89], v4 offset:28672
    v_mfma_f32_16x16x32_bf16 v[56:59], v[104:107], v[164:167], v[56:59]
    ds_read_b64_tr_b16 v[90:91], v4 offset:30720
    v_mfma_f32_16x16x32_bf16 v[52:55], v[100:103], v[164:167], v[52:55]
    ds_read_b64_tr_b16 v[76:77], v5 offset:24576
    ds_read_b32 v23, v21
    v_mfma_f32_16x16x32_bf16 v[52:55], v[116:119], v[172:175], v[52:55]
    ds_read_b64_tr_b16 v[78:79], v5 offset:26624
    v_mfma_f32_16x16x32_bf16 v[48:51], v[112:115], v[172:175], v[48:51]
    ds_read_b64_tr_b16 v[92:93], v5 offset:28672
    v_mfma_f32_16x16x32_bf16 v[48:51], v[96:99], v[164:167], v[48:51]
    ds_read_b64_tr_b16 v[94:95], v5 offset:30720
    buffer_load_dwordx4 v[164:167], v1, s[8:11], s38 offen offset:1024 sc1
    buffer_load_dwordx4 v[172:175], v25, s[8:11], s38 offen offset:1024 sc1
    s_add_u32 s38, s38, 0x40000
    s_waitcnt lgkmcnt(3)
    v_cmp_gt_i32 vcc, v24, v23
    s_nop 0
    s_cbranch_vccnz p2_G_w38
p2_G_w38r:
    v_mfma_f32_16x16x32_bf16 v[32:35], v[64:67], v[176:179], v[32:35]
    ds_read_b64_tr_b16 v[96:97], v2 offset:32768
    s_add_u32 m0, s42, 0xa000
    s_mov_b32 s39, 0x1c0000
    buffer_load_dwordx4 v6, s[16:19], s39 offen lds
    v_mfma_f32_16x16x32_bf16 v[32:35], v[80:83], v[184:187], v[32:35]
    ds_read_b64_tr_b16 v[98:99], v2 offset:34816
    v_mfma_f32_16x16x32_bf16 v[36:39], v[84:87], v[184:187], v[36:39]
    ds_read_b64_tr_b16 v[112:113], v2 offset:36864
    v_mfma_f32_16x16x32_bf16 v[36:39], v[68:71], v[176:179], v[36:39]
    ds_read_b64_tr_b16 v[114:115], v2 offset:38912
    v_mfma_f32_16x16x32_bf16 v[40:43], v[72:75], v[176:179], v[40:43]
    ds_read_b64_tr_b16 v[100:101], v3 offset:32768
    v_mfma_f32_16x16x32_bf16 v[40:43], v[88:91], v[184:187], v[40:43]
    ds_read_b64_tr_b16 v[102:103], v3 offset:34816
    s_add_u32 m0, s42, 0xb000
    s_mov_b32 s39, 0x1d0000
    buffer_load_dwordx4 v6, s[16:19], s39 offen lds
    s_waitcnt lgkmcnt(6)
    v_mfma_f32_16x16x32_bf16 v[44:47], v[92:95], v[184:187], v[44:47]
    ds_read_b64_tr_b16 v[116:117], v3 offset:36864
    v_mfma_f32_16x16x32_bf16 v[44:47], v[76:79], v[176:179], v[44:47]
    ds_read_b64_tr_b16 v[118:119], v3 offset:38912
    v_mfma_f32_16x16x32_bf16 v[60:63], v[76:79], v[180:183], v[60:63]
    ds_read_b64_tr_b16 v[104:105], v4 offset:32768
    buffer_load_dwordx4 v[176:179], v1, s[8:11], s38 offen offset:0 sc1
    v_mfma_f32_16x16x32_bf16 v[60:63], v[92:95], v[188:191], v[60:63]
    ds_read_b64_tr_b16 v[106:107], v4 offset:34816
    buffer_load_dwordx4 v[184:187], v25, s[8:11], s38 offen offset:0 sc1
    v_mfma_f32_16x16x32_bf16 v[56:59], v[88:91], v[188:191], v[56:59]
    ds_read_b64_tr_b16 v[120:121], v4 offset:36864
    s_add_u32 m0, s42, 0xc000
    s_mov_b32 s39, 0x1e0000
    buffer_load_dwordx4 v6, s[16:19], s39 offen lds
    v_mfma_f32_16x16x32_bf16 v[56:59], v[72:75], v[180:183], v[56:59]
    ds_read_b64_tr_b16 v[122:123], v4 offset:38912
    v_mfma_f32_16x16x32_bf16 v[52:55], v[68:71], v[180:183], v[52:55]
    ds_read_b64_tr_b16 v[108:109], v5 offset:32768
    v_mfma_f32_16x16x32_bf16 v[52:55], v[84:87], v[188:191], v[52:55]
    ds_read_b64_tr_b16 v[110:111], v5 offset:34816
    v_mfma_f32_16x16x32_bf16 v[48:51], v[80:83], v[188:191], v[48:51]
    ds_read_b64_tr_b16 v[124:125], v5 offset:36864
    s_cmp_eq_u32 s45, 0x14000
    s_cselect_b32 s47, 0xfffec000, s57
    v_mfma_f32_16x16x32_bf16 v[48:51], v[64:67], v[180:183], v[48:51]
    ds_read_b64_tr_b16 v[126:127], v5 offset:38912
    buffer_load_dwordx4 v[180:183], v1, s[8:11], s38 offen offset:1024 sc1
    buffer_load_dwordx4 v[188:191], v25, s[8:11], s38 offen offset:1024 sc1
    s_add_u32 s38, s38, 0x40000
    v_add_u32 v2, s47, v2
    v_add_u32 v3, s47, v3
    v_add_u32 v4, s47, v4
    v_add_u32 v5, s47, v5
    s_add_u32 m0, s42, 0xd000
    s_mov_b32 s39, 0x1f0000
    buffer_load_dwordx4 v6, s[16:19], s39 offen lds
    s_waitcnt lgkmcnt(12)
    v_mfma_f32_16x16x32_bf16 v[32:35], v[96:99], v[192:195], v[32:35]
    s_add_u32 s45, s45, s47
    ds_read_b64_tr_b16 v[64:65], v2 offset:0
    v_mfma_f32_16x16x32_bf16 v[32:35], v[112:115], v[200:203], v[32:35]
    ds_read_b64_tr_b16 v[66:67], v2 offset:2048
    s_waitcnt lgkmcnt(10)
    v_mfma_f32_16x16x32_bf16 v[36:39], v[116:119], v[200:203], v[36:39]
    ds_read_b64_tr_b16 v[80:81], v2 offset:4096
    v_mfma_f32_16x16x32_bf16 v[36:39], v[100:103], v[192:195], v[36:39]
    ds_read_b64_tr_b16 v[82:83], v2 offset:6144
    s_waitcnt lgkmcnt(8)
    v_mfma_f32_16x16x32_bf16 v[40:43], v[104:107], v[192:195], v[40:43]
    ds_read_b64_tr_b16 v[68:69], v3 offset:0
    v_mfma_f32_16x16x32_bf16 v[40:43], v[120:123], v[200:203], v[40:43]
    ds_read_b64_tr_b16 v[70:71], v3 offset:2048
    s_waitcnt lgkmcnt(6)
    v_mfma_f32_16x16x32_bf16 v[44:47], v[124:127], v[200:203], v[44:47]
    ds_read_b64_tr_b16 v[84:85], v3 offset:4096
    v_mfma_f32_16x16x32_bf16 v[44:47], v[108:111], v[192:195], v[44:47]
    ds_read_b64_tr_b16 v[86:87], v3 offset:6144
    v_mfma_f32_16x16x32_bf16 v[60:63], v[108:111], v[196:199], v[60:63]
    ds_read_b64_tr_b16 v[72:73], v4 offset:0
    buffer_load_dwordx4 v[192:195], v1, s[8:11], s38 offen offset:0 sc1
    v_mfma_f32_16x16x32_bf16 v[60:63], v[124:127], v[204:207], v[60:63]
    ds_read_b64_tr_b16 v[74:75], v4 offset:2048
    buffer_load_dwordx4 v[200:203], v25, s[8:11], s38 offen offset:0 sc1
    v_mfma_f32_16x16x32_bf16 v[56:59], v[120:123], v[204:207], v[56:59]
    ds_read_b64_tr_b16 v[88:89], v4 offset:4096
    v_mfma_f32_16x16x32_bf16 v[56:59], v[104:107], v[196:199], v[56:59]
    ds_read_b64_tr_b16 v[90:91], v4 offset:6144
    v_mfma_f32_16x16x32_bf16 v[52:55], v[100:103], v[196:199], v[52:55]
    ds_read_b64_tr_b16 v[76:77], v5 offset:0
    v_mfma_f32_16x16x32_bf16 v[52:55], v[116:119], v[204:207], v[52:55]
    ds_read_b64_tr_b16 v[78:79], v5 offset:2048
    v_mfma_f32_16x16x32_bf16 v[48:51], v[112:115], v[204:207], v[48:51]
    ds_read_b64_tr_b16 v[92:93], v5 offset:4096
    v_mfma_f32_16x16x32_bf16 v[48:51], v[96:99], v[196:199], v[48:51]
    ds_read_b64_tr_b16 v[94:95], v5 offset:6144
    buffer_load_dwordx4 v[196:199], v1, s[8:11], s38 offen offset:1024 sc1
    buffer_load_dwordx4 v[204:207], v25, s[8:11], s38 offen offset:1024 sc1
    s_add_u32 s38, s38, 0x40000
    s_waitcnt vmcnt(28) lgkmcnt(12)
    v_mfma_f32_16x16x32_bf16 v[32:35], v[64:67], v[128:131], v[32:35]
    ds_read_b64_tr_b16 v[96:97], v2 offset:8192
    s_waitcnt vmcnt(26)
    v_mfma_f32_16x16x32_bf16 v[32:35], v[80:83], v[136:139], v[32:35]
    ds_read_b64_tr_b16 v[98:99], v2 offset:10240
    s_waitcnt lgkmcnt(10)
    v_mfma_f32_16x16x32_bf16 v[36:39], v[84:87], v[136:139], v[36:39]
    ds_read_b64_tr_b16 v[112:113], v2 offset:12288
    v_mfma_f32_16x16x32_bf16 v[36:39], v[68:71], v[128:131], v[36:39]
    ds_read_b64_tr_b16 v[114:115], v2 offset:14336
    s_waitcnt lgkmcnt(8)
    v_mfma_f32_16x16x32_bf16 v[40:43], v[72:75], v[128:131], v[40:43]
    ds_read_b64_tr_b16 v[100:101], v3 offset:8192
    v_mfma_f32_16x16x32_bf16 v[40:43], v[88:91], v[136:139], v[40:43]
    ds_read_b64_tr_b16 v[102:103], v3 offset:10240
    s_waitcnt lgkmcnt(6)
    v_mfma_f32_16x16x32_bf16 v[44:47], v[92:95], v[136:139], v[44:47]
    ds_read_b64_tr_b16 v[116:117], v3 offset:12288
    v_mfma_f32_16x16x32_bf16 v[44:47], v[76:79], v[128:131], v[44:47]
    ds_read_b64_tr_b16 v[118:119], v3 offset:14336
    s_waitcnt vmcnt(24)
    v_mfma_f32_16x16x32_bf16 v[60:63], v[76:79], v[132:135], v[60:63]
    ds_read_b64_tr_b16 v[104:105], v4 offset:8192
    buffer_load_dwordx4 v[128:131], v1, s[8:11], s38 offen offset:0 sc1
    s_waitcnt vmcnt(24)
    v_mfma_f32_16x16x32_bf16 v[60:63], v[92:95], v[140:143], v[60:63]
    ds_read_b64_tr_b16 v[106:107], v4 offset:10240
    buffer_load_dwordx4 v[136:139], v25, s[8:11], s38 offen offset:0 sc1
    v_mfma_f32_16x16x32_bf16 v[56:59], v[88:91], v[140:143], v[56:59]
    ds_read_b64_tr_b16 v[120:121], v4 offset:12288
    v_mfma_f32_16x16x32_bf16 v[56:59], v[72:75], v[132:135], v[56:59]
    ds_read_b64_tr_b16 v[122:123], v4 offset:14336
    v_mfma_f32_16x16x32_bf16 v[52:55], v[68:71], v[132:135], v[52:55]
    ds_read_b64_tr_b16 v[108:109], v5 offset:8192
    v_mfma_f32_16x16x32_bf16 v[52:55], v[84:87], v[140:143], v[52:55]
    ds_read_b64_tr_b16 v[110:111], v5 offset:10240
    v_mfma_f32_16x16x32_bf16 v[48:51], v[80:83], v[140:143], v[48:51]
    ds_read_b64_tr_b16 v[124:125], v5 offset:12288
    v_mfma_f32_16x16x32_bf16 v[48:51], v[64:67], v[132:135], v[48:51]
    ds_read_b64_tr_b16 v[126:127], v5 offset:14336
    buffer_load_dwordx4 v[132:135], v1, s[8:11], s38 offen offset:1024 sc1
    buffer_load_dwordx4 v[140:143], v25, s[8:11], s38 offen offset:1024 sc1
    s_add_u32 s38, s38, 0x40000
    s_waitcnt vmcnt(8)
    ds_add_u32 v20, v22
    v_add_u32 v24, 1, v24
    s_waitcnt lgkmcnt(13)
    v_mfma_f32_16x16x32_bf16 v[32:35], v[96:99], v[144:147], v[32:35]
    ds_read_b64_tr_b16 v[64:65], v2 offset:16384
    v_mfma_f32_16x16x32_bf16 v[32:35], v[112:115], v[152:155], v[32:35]
    ds_read_b64_tr_b16 v[66:67], v2 offset:18432
    s_waitcnt lgkmcnt(11)
    v_mfma_f32_16x16x32_bf16 v[36:39], v[116:119], v[152:155], v[36:39]
    ds_read_b64_tr_b16 v[80:81], v2 offset:20480
    v_mfma_f32_16x16x32_bf16 v[36:39], v[100:103], v[144:147], v[36:39]
    ds_read_b64_tr_b16 v[82:83], v2 offset:22528
    s_waitcnt lgkmcnt(9)
    v_mfma_f32_16x16x32_bf16 v[40:43], v[104:107], v[144:147], v[40:43]
    ds_read_b64_tr_b16 v[68:69], v3 offset:16384
    ds_read_b32 v23, v21
    v_mfma_f32_16x16x32_bf16 v[40:43], v[120:123], v[152:155], v[40:43]
    ds_read_b64_tr_b16 v[70:71], v3 offset:18432
    s_waitcnt lgkmcnt(8)
    v_mfma_f32_16x16x32_bf16 v[44:47], v[124:127], v[152:155], v[44:47]
    ds_read_b64_tr_b16 v[84:85], v3 offset:20480
    v_mfma_f32_16x16x32_bf16 v[44:47], v[108:111], v[144:147], v[44:47]
    ds_read_b64_tr_b16 v[86:87], v3 offset:22528
    s_waitcnt lgkmcnt(3)
    v_cmp_gt_i32 vcc, v24, v23
    s_nop 0
    s_cbranch_vccnz p2_G_w39
p2_G_w39r:
    v_mfma_f32_16x16x32_bf16 v[60:63], v[108:111], v[148:151], v[60:63]
    ds_read_b64_tr_b16 v[72:73], v4 offset:16384
    buffer_load_dwordx4 v[144:147], v1, s[8:11], s38 offen offset:0 sc1
    v_mfma_f32_16x16x32_bf16 v[60:63], v[124:127], v[156:159], v[60:63]
    ds_read_b64_tr_b16 v[74:75], v4 offset:18432
    buffer_load_dwordx4 v[152:155], v25, s[8:11], s38 offen offset:0 sc1
    v_mfma_f32_16x16x32_bf16 v[56:59], v[120:123], v[156:159], v[56:59]
    ds_read_b64_tr_b16 v[88:89], v4 offset:20480
    v_mfma_f32_16x16x32_bf16 v[56:59], v[104:107], v[148:151], v[56:59]
    ds_read_b64_tr_b16 v[90:91], v4 offset:22528
    v_mfma_f32_16x16x32_bf16 v[52:55], v[100:103], v[148:151], v[52:55]
    ds_read_b64_tr_b16 v[76:77], v5 offset:16384
    v_mfma_f32_16x16x32_bf16 v[52:55], v[116:119], v[156:159], v[52:55]
    ds_read_b64_tr_b16 v[78:79], v5 offset:18432
    v_mfma_f32_16x16x32_bf16 v[48:51], v[112:115], v[156:159], v[48:51]
    ds_read_b64_tr_b16 v[92:93], v5 offset:20480
    v_mfma_f32_16x16x32_bf16 v[48:51], v[96:99], v[148:151], v[48:51]
    ds_read_b64_tr_b16 v[94:95], v5 offset:22528
    buffer_load_dwordx4 v[148:151], v1, s[8:11], s38 offen offset:1024 sc1
    buffer_load_dwordx4 v[156:159], v25, s[8:11], s38 offen offset:1024 sc1
    s_add_u32 s38, s38, 0x40000
    v_mfma_f32_16x16x32_bf16 v[32:35], v[64:67], v[160:163], v[32:35]
    ds_read_b64_tr_b16 v[96:97], v2 offset:24576
    v_mfma_f32_16x16x32_bf16 v[32:35], v[80:83], v[168:171], v[32:35]
    ds_read_b64_tr_b16 v[98:99], v2 offset:26624
    s_waitcnt lgkmcnt(10)
    v_mfma_f32_16x16x32_bf16 v[36:39], v[84:87], v[168:171], v[36:39]
    ds_read_b64_tr_b16 v[112:113], v2 offset:28672
    v_mfma_f32_16x16x32_bf16 v[36:39], v[68:71], v[160:163], v[36:39]
    ds_read_b64_tr_b16 v[114:115], v2 offset:30720
    s_waitcnt lgkmcnt(8)
    v_mfma_f32_16x16x32_bf16 v[40:43], v[72:75], v[160:163], v[40:43]
    ds_read_b64_tr_b16 v[100:101], v3 offset:24576
    v_mfma_f32_16x16x32_bf16 v[40:43], v[88:91], v[168:171], v[40:43]
    ds_read_b64_tr_b16 v[102:103], v3 offset:26624
    s_waitcnt lgkmcnt(6)
    v_mfma_f32_16x16x32_bf16 v[44:47], v[92:95], v[168:171], v[44:47]
    ds_read_b64_tr_b16 v[116:117], v3 offset:28672
    v_mfma_f32_16x16x32_bf16 v[44:47], v[76:79], v[160:163], v[44:47]
    ds_read_b64_tr_b16 v[118:119], v3 offset:30720
    v_mfma_f32_16x16x32_bf16 v[60:63], v[76:79], v[164:167], v[60:63]
    ds_read_b64_tr_b16 v[104:105], v4 offset:24576
    buffer_load_dwordx4 v[160:163], v1, s[8:11], s38 offen offset:0 sc1
    v_mfma_f32_16x16x32_bf16 v[60:63], v[92:95], v[172:175], v[60:63]
    ds_read_b64_tr_b16 v[106:107], v4 offset:26624
    buffer_load_dwordx4 v[168:171], v25, s[8:11], s38 offen offset:0 sc1
    v_mfma_f32_16x16x32_bf16 v[56:59], v[88:91], v[172:175], v[56:59]
    ds_read_b64_tr_b16 v[120:121], v4 offset:28672
    v_mfma_f32_16x16x32_bf16 v[56:59], v[72:75], v[164:167], v[56:59]
    ds_read_b64_tr_b16 v[122:123], v4 offset:30720
    v_mfma_f32_16x16x32_bf16 v[52:55], v[68:71], v[164:167], v[52:55]
    ds_read_b64_tr_b16 v[108:109], v5 offset:24576
    v_mfma_f32_16x16x32_bf16 v[52:55], v[84:87], v[172:175], v[52:55]
    ds_read_b64_tr_b16 v[110:111], v5 offset:26624
    v_mfma_f32_16x16x32_bf16 v[48:51], v[80:83], v[172:175], v[48:51]
    ds_read_b64_tr_b16 v[124:125], v5 offset:28672
    v_mfma_f32_16x16x32_bf16 v[48:51], v[64:67], v[164:167], v[48:51]
    ds_read_b64_tr_b16 v[126:127], v5 offset:30720
    buffer_load_dwordx4 v[164:167], v1, s[8:11], s38 offen offset:1024 sc1
    buffer_load_dwordx4 v[172:175], v25, s[8:11], s38 offen offset:1024 sc1
    s_add_u32 s38, s38, 0x40000
    s_waitcnt lgkmcnt(12)
    v_mfma_f32_16x16x32_bf16 v[32:35], v[96:99], v[176:179], v[32:35]
    ds_read_b64_tr_b16 v[64:65], v2 offset:32768
    v_mfma_f32_16x16x32_bf16 v[32:35], v[112:115], v[184:187], v[32:35]
    ds_read_b64_tr_b16 v[66:67], v2 offset:34816
    s_waitcnt lgkmcnt(10)
    v_mfma_f32_16x16x32_bf16 v[36:39], v[116:119], v[184:187], v[36:39]
    ds_read_b64_tr_b16 v[80:81], v2 offset:36864
    v_mfma_f32_16x16x32_bf16 v[36:39], v[100:103], v[176:179], v[36:39]
    ds_read_b64_tr_b16 v[82:83], v2 offset:38912
    s_waitcnt lgkmcnt(8)
    v_mfma_f32_16x16x32_bf16 v[40:43], v[104:107], v[176:179], v[40:43]
    ds_read_b64_tr_b16 v[68:69], v3 offset:32768
    v_mfma_f32_16x16x32_bf16 v[40:43], v[120:123], v[184:187], v[40:43]
    ds_read_b64_tr_b16 v[70:71], v3 offset:34816
    s_waitcnt lgkmcnt(6)
    v_mfma_f32_16x16x32_bf16 v[44:47], v[124:127], v[184:187], v[44:47]
    ds_read_b64_tr_b16 v[84:85], v3 offset:36864
    v_mfma_f32_16x16x32_bf16 v[44:47], v[108:111], v[176:179], v[44:47]
    ds_read_b64_tr_b16 v[86:87], v3 offset:38912
    v_mfma_f32_16x16x32_bf16 v[60:63], v[108:111], v[180:183], v[60:63]
    ds_read_b64_tr_b16 v[72:73], v4 offset:32768
    buffer_load_dwordx4 v[176:179], v1, s[8:11], s38 offen offset:0 sc1
    v_mfma_f32_16x16x32_bf16 v[60:63], v[124:127], v[188:191], v[60:63]
    ds_read_b64_tr_b16 v[74:75], v4 offset:34816
    buffer_load_dwordx4 v[184:187], v25, s[8:11], s38 offen offset:0 sc1
    v_mfma_f32_16x16x32_bf16 v[56:59], v[120:123], v[188:191], v[56:59]
    ds_read_b64_tr_b16 v[88:89], v4 offset:36864
    v_mfma_f32_16x16x32_bf16 v[56:59], v[104:107], v[180:183], v[56:59]
    ds_read_b64_tr_b16 v[90:91], v4 offset:38912
    v_mfma_f32_16x16x32_bf16 v[52:55], v[100:103], v[180:183], v[52:55]
    ds_read_b64_tr_b16 v[76:77], v5 offset:32768
    v_mfma_f32_16x16x32_bf16 v[52:55], v[116:119], v[188:191], v[52:55]
    ds_read_b64_tr_b16 v[78:79], v5 offset:34816
    v_mfma_f32_16x16x32_bf16 v[48:51], v[112:115], v[188:191], v[48:51]
    ds_read_b64_tr_b16 v[92:93], v5 offset:36864
    s_cmp_eq_u32 s45, 0x14000
    s_cselect_b32 s47, 0xfffec000, s57
    v_mfma_f32_16x16x32_bf16 v[48:51], v[96:99], v[180:183], v[48:51]
    ds_read_b64_tr_b16 v[94:95], v5 offset:38912
    buffer_load_dwordx4 v[180:183], v1, s[8:11], s38 offen offset:1024 sc1
    buffer_load_dwordx4 v[188:191], v25, s[8:11], s38 offen offset:1024 sc1
    s_add_u32 s38, s38, 0x40000
    v_add_u32 v2, s47, v2
    v_add_u32 v3, s47, v3
    v_add_u32 v4, s47, v4
    v_add_u32 v5, s47, v5
    s_waitcnt vmcnt(19) lgkmcnt(12)
    v_mfma_f32_16x16x32_bf16 v[32:35], v[64:67], v[192:195], v[32:35]
    s_add_u32 s45, s45, s47
    ds_read_b64_tr_b16 v[96:97], v2 offset:0
    s_waitcnt vmcnt(18)
    v_mfma_f32_16x16x32_bf16 v[32:35], v[80:83], v[200:203], v[32:35]
    ds_read_b64_tr_b16 v[98:99], v2 offset:2048
    s_waitcnt lgkmcnt(10)
    v_mfma_f32_16x16x32_bf16 v[36:39], v[84:87], v[200:203], v[36:39]
    ds_read_b64_tr_b16 v[112:113], v2 offset:4096
    v_mfma_f32_16x16x32_bf16 v[36:39], v[68:71], v[192:195], v[36:39]
    ds_read_b64_tr_b16 v[114:115], v2 offset:6144
    s_waitcnt lgkmcnt(8)
    v_mfma_f32_16x16x32_bf16 v[40:43], v[72:75], v[192:195], v[40:43]
    ds_read_b64_tr_b16 v[100:101], v3 offset:0
    v_mfma_f32_16x16x32_bf16 v[40:43], v[88:91], v[200:203], v[40:43]
    ds_read_b64_tr_b16 v[102:103], v3 offset:2048
    s_waitcnt lgkmcnt(6)
    v_mfma_f32_16x16x32_bf16 v[44:47], v[92:95], v[200:203], v[44:47]
    ds_read_b64_tr_b16 v[116:117], v3 offset:4096
    v_mfma_f32_16x16x32_bf16 v[44:47], v[76:79], v[192:195], v[44:47]
    ds_read_b64_tr_b16 v[118:119], v3 offset:6144
    s_waitcnt vmcnt(17)
    v_mfma_f32_16x16x32_bf16 v[60:63], v[76:79], v[196:199], v[60:63]
    ds_read_b64_tr_b16 v[104:105], v4 offset:0
    buffer_load_dwordx4 v[192:195], v1, s[8:11], s38 offen offset:0 sc1
    s_waitcnt vmcnt(17)
    v_mfma_f32_16x16x32_bf16 v[60:63], v[92:95], v[204:207], v[60:63]
    ds_read_b64_tr_b16 v[106:107], v4 offset:2048
    buffer_load_dwordx4 v[200:203], v25, s[8:11], s38 offen offset:0 sc1
    v_mfma_f32_16x16x32_bf16 v[56:59], v[88:91], v[204:207], v[56:59]
    ds_read_b64_tr_b16 v[120:121], v4 offset:4096
    v_mfma_f32_16x16x32_bf16 v[56:59], v[72:75], v[196:199], v[56:59]
    ds_read_b64_tr_b16 v[122:123], v4 offset:6144
    v_mfma_f32_16x16x32_bf16 v[52:55], v[68:71], v[196:199], v[52:55]
    ds_read_b64_tr_b16 v[108:109], v5 offset:0
    v_mfma_f32_16x16x32_bf16 v[52:55], v[84:87], v[204:207], v[52:55]
    ds_read_b64_tr_b16 v[110:111], v5 offset:2048
    v_mfma_f32_16x16x32_bf16 v[48:51], v[80:83], v[204:207], v[48:51]
    ds_read_b64_tr_b16 v[124:125], v5 offset:4096
    v_mfma_f32_16x16x32_bf16 v[48:51], v[64:67], v[196:199], v[48:51]
    ds_read_b64_tr_b16 v[126:127], v5 offset:6144
    buffer_load_dwordx4 v[196:199], v1, s[8:11], s38 offen offset:1024 sc1
    buffer_load_dwordx4 v[204:207], v25, s[8:11], s38 offen offset:1024 sc1
    s_add_u32 s38, s38, 0x40000
    s_waitcnt vmcnt(19) lgkmcnt(12)
    v_mfma_f32_16x16x32_bf16 v[32:35], v[96:99], v[128:131], v[32:35]
    ds_read_b64_tr_b16 v[64:65], v2 offset:8192
    s_waitcnt vmcnt(18)
    v_mfma_f32_16x16x32_bf16 v[32:35], v[112:115], v[136:139], v[32:35]
    ds_read_b64_tr_b16 v[66:67], v2 offset:10240
    s_waitcnt lgkmcnt(10)
    v_mfma_f32_16x16x32_bf16 v[36:39], v[116:119], v[136:139], v[36:39]
    ds_read_b64_tr_b16 v[80:81], v2 offset:12288
    v_mfma_f32_16x16x32_bf16 v[36:39], v[100:103], v[128:131], v[36:39]
    ds_read_b64_tr_b16 v[82:83], v2 offset:14336
    s_waitcnt lgkmcnt(8)
    v_mfma_f32_16x16x32_bf16 v[40:43], v[104:107], v[128:131], v[40:43]
    ds_read_b64_tr_b16 v[68:69], v3 offset:8192
    v_mfma_f32_16x16x32_bf16 v[40:43], v[120:123], v[136:139], v[40:43]
    ds_read_b64_tr_b16 v[70:71], v3 offset:10240
    s_waitcnt lgkmcnt(6)
    v_mfma_f32_16x16x32_bf16 v[44:47], v[124:127], v[136:139], v[44:47]
    ds_read_b64_tr_b16 v[84:85], v3 offset:12288
    v_mfma_f32_16x16x32_bf16 v[44:47], v[108:111], v[128:131], v[44:47]
    ds_read_b64_tr_b16 v[86:87], v3 offset:14336
    s_waitcnt vmcnt(17)
    v_mfma_f32_16x16x32_bf16 v[60:63], v[108:111], v[132:135], v[60:63]
    ds_read_b64_tr_b16 v[72:73], v4 offset:8192
    buffer_load_dwordx4 v[128:131], v1, s[8:11], s38 offen offset:0 sc1
    s_waitcnt vmcnt(17)
    v_mfma_f32_16x16x32_bf16 v[60:63], v[124:127], v[140:143], v[60:63]
    ds_read_b64_tr_b16 v[74:75], v4 offset:10240
    buffer_load_dwordx4 v[136:139], v25, s[8:11], s38 offen offset:0 sc1
    v_mfma_f32_16x16x32_bf16 v[56:59], v[120:123], v[140:143], v[56:59]
    ds_read_b64_tr_b16 v[88:89], v4 offset:12288
    v_mfma_f32_16x16x32_bf16 v[56:59], v[104:107], v[132:135], v[56:59]
    ds_read_b64_tr_b16 v[90:91], v4 offset:14336
    v_mfma_f32_16x16x32_bf16 v[52:55], v[100:103], v[132:135], v[52:55]
    ds_read_b64_tr_b16 v[76:77], v5 offset:8192
    v_mfma_f32_16x16x32_bf16 v[52:55], v[116:119], v[140:143], v[52:55]
    ds_read_b64_tr_b16 v[78:79], v5 offset:10240
    v_mfma_f32_16x16x32_bf16 v[48:51], v[112:115], v[140:143], v[48:51]
    ds_read_b64_tr_b16 v[92:93], v5 offset:12288
    v_mfma_f32_16x16x32_bf16 v[48:51], v[96:99], v[132:135], v[48:51]
    ds_read_b64_tr_b16 v[94:95], v5 offset:14336
    buffer_load_dwordx4 v[132:135], v1, s[8:11], s38 offen offset:1024 sc1
    buffer_load_dwordx4 v[140:143], v25, s[8:11], s38 offen offset:1024 sc1
    s_add_u32 s38, s38, 0x40000
    s_waitcnt vmcnt(19) lgkmcnt(12)
    v_mfma_f32_16x16x32_bf16 v[32:35], v[64:67], v[144:147], v[32:35]
    ds_read_b64_tr_b16 v[96:97], v2 offset:16384
    s_waitcnt vmcnt(18)
    v_mfma_f32_16x16x32_bf16 v[32:35], v[80:83], v[152:155], v[32:35]
    ds_read_b64_tr_b16 v[98:99], v2 offset:18432
    s_waitcnt lgkmcnt(10)
    v_mfma_f32_16x16x32_bf16 v[36:39], v[84:87], v[152:155], v[36:39]
    ds_read_b64_tr_b16 v[112:113], v2 offset:20480
    v_mfma_f32_16x16x32_bf16 v[36:39], v[68:71], v[144:147], v[36:39]
    ds_read_b64_tr_b16 v[114:115], v2 offset:22528
    s_waitcnt lgkmcnt(8)
    v_mfma_f32_16x16x32_bf16 v[40:43], v[72:75], v[144:147], v[40:43]
    ds_read_b64_tr_b16 v[100:101], v3 offset:16384
    v_mfma_f32_16x16x32_bf16 v[40:43], v[88:91], v[152:155], v[40:43]
    ds_read_b64_tr_b16 v[102:103], v3 offset:18432
    s_waitcnt lgkmcnt(6)
    v_mfma_f32_16x16x32_bf16 v[44:47], v[92:95], v[152:155], v[44:47]
    ds_read_b64_tr_b16 v[116:117], v3 offset:20480
    v_mfma_f32_16x16x32_bf16 v[44:47], v[76:79], v[144:147], v[44:47]
    ds_read_b64_tr_b16 v[118:119], v3 offset:22528
    s_waitcnt vmcnt(17)
    v_mfma_f32_16x16x32_bf16 v[60:63], v[76:79], v[148:151], v[60:63]
    ds_read_b64_tr_b16 v[104:105], v4 offset:16384
    buffer_load_dwordx4 v[144:147], v1, s[8:11], s38 offen offset:0 sc1
    s_waitcnt vmcnt(17)
    v_mfma_f32_16x16x32_bf16 v[60:63], v[92:95], v[156:159], v[60:63]
    ds_read_b64_tr_b16 v[106:107], v4 offset:18432
    buffer_load_dwordx4 v[152:155], v25, s[8:11], s38 offen offset:0 sc1
    v_mfma_f32_16x16x32_bf16 v[56:59], v[88:91], v[156:159], v[56:59]
    ds_read_b64_tr_b16 v[120:121], v4 offset:20480
    v_mfma_f32_16x16x32_bf16 v[56:59], v[72:75], v[148:151], v[56:59]
    ds_read_b64_tr_b16 v[122:123], v4 offset:22528
    v_mfma_f32_16x16x32_bf16 v[52:55], v[68:71], v[148:151], v[52:55]
    ds_read_b64_tr_b16 v[108:109], v5 offset:16384
    v_mfma_f32_16x16x32_bf16 v[52:55], v[84:87], v[156:159], v[52:55]
    ds_read_b64_tr_b16 v[110:111], v5 offset:18432
    v_mfma_f32_16x16x32_bf16 v[48:51], v[80:83], v[156:159], v[48:51]
    ds_read_b64_tr_b16 v[124:125], v5 offset:20480
    v_mfma_f32_16x16x32_bf16 v[48:51], v[64:67], v[148:151], v[48:51]
    ds_read_b64_tr_b16 v[126:127], v5 offset:22528
    buffer_load_dwordx4 v[148:151], v1, s[8:11], s38 offen offset:1024 sc1
    buffer_load_dwordx4 v[156:159], v25, s[8:11], s38 offen offset:1024 sc1
    s_add_u32 s38, s38, 0x40000
    s_waitcnt vmcnt(19) lgkmcnt(12)
    v_mfma_f32_16x16x32_bf16 v[32:35], v[96:99], v[160:163], v[32:35]
    ds_read_b64_tr_b16 v[64:65], v2 offset:24576
    s_waitcnt vmcnt(18)
    v_mfma_f32_16x16x32_bf16 v[32:35], v[112:115], v[168:171], v[32:35]
    ds_read_b64_tr_b16 v[66:67], v2 offset:26624
    s_waitcnt lgkmcnt(10)
    v_mfma_f32_16x16x32_bf16 v[36:39], v[116:119], v[168:171], v[36:39]
    ds_read_b64_tr_b16 v[80:81], v2 offset:28672
    v_mfma_f32_16x16x32_bf16 v[36:39], v[100:103], v[160:163], v[36:39]
    ds_read_b64_tr_b16 v[82:83], v2 offset:30720
    s_waitcnt lgkmcnt(8)
    v_mfma_f32_16x16x32_bf16 v[40:43], v[104:107], v[160:163], v[40:43]
    ds_read_b64_tr_b16 v[68:69], v3 offset:24576
    v_mfma_f32_16x16x32_bf16 v[40:43], v[120:123], v[168:171], v[40:43]
    ds_read_b64_tr_b16 v[70:71], v3 offset:26624
    s_waitcnt lgkmcnt(6)
    v_mfma_f32_16x16x32_bf16 v[44:47], v[124:127], v[168:171], v[44:47]
    ds_read_b64_tr_b16 v[84:85], v3 offset:28672
    v_mfma_f32_16x16x32_bf16 v[44:47], v[108:111], v[160:163], v[44:47]
    ds_read_b64_tr_b16 v[86:87], v3 offset:30720
    s_waitcnt vmcnt(17)
    v_mfma_f32_16x16x32_bf16 v[60:63], v[108:111], v[164:167], v[60:63]
    ds_read_b64_tr_b16 v[72:73], v4 offset:24576
    s_waitcnt vmcnt(16)
    v_mfma_f32_16x16x32_bf16 v[60:63], v[124:127], v[172:175], v[60:63]
    ds_read_b64_tr_b16 v[74:75], v4 offset:26624
    v_mfma_f32_16x16x32_bf16 v[56:59], v[120:123], v[172:175], v[56:59]
    ds_read_b64_tr_b16 v[88:89], v4 offset:28672
    v_mfma_f32_16x16x32_bf16 v[56:59], v[104:107], v[164:167], v[56:59]
    ds_read_b64_tr_b16 v[90:91], v4 offset:30720
    v_mfma_f32_16x16x32_bf16 v[52:55], v[100:103], v[164:167], v[52:55]
    ds_read_b64_tr_b16 v[76:77], v5 offset:24576
    v_mfma_f32_16x16x32_bf16 v[52:55], v[116:119], v[172:175], v[52:55]
    ds_read_b64_tr_b16 v[78:79], v5 offset:26624
    v_mfma_f32_16x16x32_bf16 v[48:51], v[112:115], v[172:175], v[48:51]
    ds_read_b64_tr_b16 v[92:93], v5 offset:28672
    v_mfma_f32_16x16x32_bf16 v[48:51], v[96:99], v[164:167], v[48:51]
    ds_read_b64_tr_b16 v[94:95], v5 offset:30720
    s_waitcnt vmcnt(15) lgkmcnt(12)
    v_mfma_f32_16x16x32_bf16 v[32:35], v[64:67], v[176:179], v[32:35]
    ds_read_b64_tr_b16 v[96:97], v2 offset:32768
    s_waitcnt vmcnt(14)
    v_mfma_f32_16x16x32_bf16 v[32:35], v[80:83], v[184:187], v[32:35]
    ds_read_b64_tr_b16 v[98:99], v2 offset:34816
    s_waitcnt lgkmcnt(10)
    v_mfma_f32_16x16x32_bf16 v[36:39], v[84:87], v[184:187], v[36:39]
    ds_read_b64_tr_b16 v[112:113], v2 offset:36864
    v_mfma_f32_16x16x32_bf16 v[36:39], v[68:71], v[176:179], v[36:39]
    ds_read_b64_tr_b16 v[114:115], v2 offset:38912
    s_waitcnt lgkmcnt(8)
    v_mfma_f32_16x16x32_bf16 v[40:43], v[72:75], v[176:179], v[40:43]
    ds_read_b64_tr_b16 v[100:101], v3 offset:32768
    v_mfma_f32_16x16x32_bf16 v[40:43], v[88:91], v[184:187], v[40:43]
    ds_read_b64_tr_b16 v[102:103], v3 offset:34816
    s_waitcnt lgkmcnt(6)
    v_mfma_f32_16x16x32_bf16 v[44:47], v[92:95], v[184:187], v[44:47]
    ds_read_b64_tr_b16 v[116:117], v3 offset:36864
    v_mfma_f32_16x16x32_bf16 v[44:47], v[76:79], v[176:179], v[44:47]
    ds_read_b64_tr_b16 v[118:119], v3 offset:38912
    s_waitcnt vmcnt(13)
    v_mfma_f32_16x16x32_bf16 v[60:63], v[76:79], v[180:183], v[60:63]
    ds_read_b64_tr_b16 v[104:105], v4 offset:32768
    s_waitcnt vmcnt(12)
    v_mfma_f32_16x16x32_bf16 v[60:63], v[92:95], v[188:191], v[60:63]
    ds_read_b64_tr_b16 v[106:107], v4 offset:34816
    v_mfma_f32_16x16x32_bf16 v[56:59], v[88:91], v[188:191], v[56:59]
    ds_read_b64_tr_b16 v[120:121], v4 offset:36864
    v_mfma_f32_16x16x32_bf16 v[56:59], v[72:75], v[180:183], v[56:59]
    ds_read_b64_tr_b16 v[122:123], v4 offset:38912
    v_mfma_f32_16x16x32_bf16 v[52:55], v[68:71], v[180:183], v[52:55]
    ds_read_b64_tr_b16 v[108:109], v5 offset:32768
    v_mfma_f32_16x16x32_bf16 v[52:55], v[84:87], v[188:191], v[52:55]
    ds_read_b64_tr_b16 v[110:111], v5 offset:34816
    v_mfma_f32_16x16x32_bf16 v[48:51], v[80:83], v[188:191], v[48:51]
    ds_read_b64_tr_b16 v[124:125], v5 offset:36864
    s_cmp_eq_u32 s45, 0x14000
    s_cselect_b32 s47, 0xfffec000, s57
    v_mfma_f32_16x16x32_bf16 v[48:51], v[64:67], v[180:183], v[48:51]
    ds_read_b64_tr_b16 v[126:127], v5 offset:38912
    v_add_u32 v2, s47, v2
    v_add_u32 v3, s47, v3
    v_add_u32 v4, s47, v4
    v_add_u32 v5, s47, v5
    s_waitcnt vmcnt(11) lgkmcnt(12)
    v_mfma_f32_16x16x32_bf16 v[32:35], v[96:99], v[192:195], v[32:35]
    s_add_u32 s45, s45, s47
    ds_read_b64_tr_b16 v[64:65], v2 offset:0
    s_waitcnt vmcnt(10)
    v_mfma_f32_16x16x32_bf16 v[32:35], v[112:115], v[200:203], v[32:35]
    ds_read_b64_tr_b16 v[66:67], v2 offset:2048
    s_waitcnt lgkmcnt(10)
    v_mfma_f32_16x16x32_bf16 v[36:39], v[116:119], v[200:203], v[36:39]
    ds_read_b64_tr_b16 v[80:81], v2 offset:4096
    v_mfma_f32_16x16x32_bf16 v[36:39], v[100:103], v[192:195], v[36:39]
    ds_read_b64_tr_b16 v[82:83], v2 offset:6144
    s_waitcnt lgkmcnt(8)
    v_mfma_f32_16x16x32_bf16 v[40:43], v[104:107], v[192:195], v[40:43]
    ds_read_b64_tr_b16 v[68:69], v3 offset:0
    v_mfma_f32_16x16x32_bf16 v[40:43], v[120:123], v[200:203], v[40:43]
    ds_read_b64_tr_b16 v[70:71], v3 offset:2048
    s_waitcnt lgkmcnt(6)
    v_mfma_f32_16x16x32_bf16 v[44:47], v[124:127], v[200:203], v[44:47]
    ds_read_b64_tr_b16 v[84:85], v3 offset:4096
    v_mfma_f32_16x16x32_bf16 v[44:47], v[108:111], v[192:195], v[44:47]
    ds_read_b64_tr_b16 v[86:87], v3 offset:6144
    s_waitcnt vmcnt(9)
    v_mfma_f32_16x16x32_bf16 v[60:63], v[108:111], v[196:199], v[60:63]
    ds_read_b64_tr_b16 v[72:73], v4 offset:0
    s_waitcnt vmcnt(8)
    v_mfma_f32_16x16x32_bf16 v[60:63], v[124:127], v[204:207], v[60:63]
    ds_read_b64_tr_b16 v[74:75], v4 offset:2048
    v_mfma_f32_16x16x32_bf16 v[56:59], v[120:123], v[204:207], v[56:59]
    ds_read_b64_tr_b16 v[88:89], v4 offset:4096
    v_mfma_f32_16x16x32_bf16 v[56:59], v[104:107], v[196:199], v[56:59]
    ds_read_b64_tr_b16 v[90:91], v4 offset:6144
    v_mfma_f32_16x16x32_bf16 v[52:55], v[100:103], v[196:199], v[52:55]
    ds_read_b64_tr_b16 v[76:77], v5 offset:0
    v_mfma_f32_16x16x32_bf16 v[52:55], v[116:119], v[204:207], v[52:55]
    ds_read_b64_tr_b16 v[78:79], v5 offset:2048
    v_mfma_f32_16x16x32_bf16 v[48:51], v[112:115], v[204:207], v[48:51]
    ds_read_b64_tr_b16 v[92:93], v5 offset:4096
    v_mfma_f32_16x16x32_bf16 v[48:51], v[96:99], v[196:199], v[48:51]
    ds_read_b64_tr_b16 v[94:95], v5 offset:6144
    s_waitcnt vmcnt(7) lgkmcnt(12)
    v_mfma_f32_16x16x32_bf16 v[32:35], v[64:67], v[128:131], v[32:35]
    ds_read_b64_tr_b16 v[96:97], v2 offset:8192
    s_waitcnt vmcnt(6)
    v_mfma_f32_16x16x32_bf16 v[32:35], v[80:83], v[136:139], v[32:35]
    ds_read_b64_tr_b16 v[98:99], v2 offset:10240
    s_waitcnt lgkmcnt(10)
    v_mfma_f32_16x16x32_bf16 v[36:39], v[84:87], v[136:139], v[36:39]
    ds_read_b64_tr_b16 v[112:113], v2 offset:12288
    v_mfma_f32_16x16x32_bf16 v[36:39], v[68:71], v[128:131], v[36:39]
    ds_read_b64_tr_b16 v[114:115], v2 offset:14336
    s_waitcnt lgkmcnt(8)
    v_mfma_f32_16x16x32_bf16 v[40:43], v[72:75], v[128:131], v[40:43]
    ds_read_b64_tr_b16 v[100:101], v3 offset:8192
    v_mfma_f32_16x16x32_bf16 v[40:43], v[88:91], v[136:139], v[40:43]
    ds_read_b64_tr_b16 v[102:103], v3 offset:10240
    s_waitcnt lgkmcnt(6)
    v_mfma_f32_16x16x32_bf16 v[44:47], v[92:95], v[136:139], v[44:47]
    ds_read_b64_tr_b16 v[116:117], v3 offset:12288
    v_mfma_f32_16x16x32_bf16 v[44:47], v[76:79], v[128:131], v[44:47]
    ds_read_b64_tr_b16 v[118:119], v3 offset:14336
    s_waitcnt vmcnt(5)
    v_mfma_f32_16x16x32_bf16 v[60:63], v[76:79], v[132:135], v[60:63]
    ds_read_b64_tr_b16 v[104:105], v4 offset:8192
    s_waitcnt vmcnt(4)
    v_mfma_f32_16x16x32_bf16 v[60:63], v[92:95], v[140:143], v[60:63]
    ds_read_b64_tr_b16 v[106:107], v4 offset:10240
    v_mfma_f32_16x16x32_bf16 v[56:59], v[88:91], v[140:143], v[56:59]
    ds_read_b64_tr_b16 v[120:121], v4 offset:12288
    v_mfma_f32_16x16x32_bf16 v[56:59], v[72:75], v[132:135], v[56:59]
    ds_read_b64_tr_b16 v[122:123], v4 offset:14336
    v_mfma_f32_16x16x32_bf16 v[52:55], v[68:71], v[132:135], v[52:55]
    ds_read_b64_tr_b16 v[108:109], v5 offset:8192
    v_mfma_f32_16x16x32_bf16 v[52:55], v[84:87], v[140:143], v[52:55]
    ds_read_b64_tr_b16 v[110:111], v5 offset:10240
    v_mfma_f32_16x16x32_bf16 v[48:51], v[80:83], v[140:143], v[48:51]
    ds_read_b64_tr_b16 v[124:125], v5 offset:12288
    v_mfma_f32_16x16x32_bf16 v[48:51], v[64:67], v[132:135], v[48:51]
    ds_read_b64_tr_b16 v[126:127], v5 offset:14336
    s_waitcnt vmcnt(3) lgkmcnt(12)
    v_mfma_f32_16x16x32_bf16 v[32:35], v[96:99], v[144:147], v[32:35]
    s_waitcnt vmcnt(2)
    v_mfma_f32_16x16x32_bf16 v[32:35], v[112:115], v[152:155], v[32:35]
    s_waitcnt lgkmcnt(8)
    v_mfma_f32_16x16x32_bf16 v[36:39], v[116:119], v[152:155], v[36:39]
    v_mfma_f32_16x16x32_bf16 v[36:39], v[100:103], v[144:147], v[36:39]
    s_waitcnt lgkmcnt(4)
    v_mfma_f32_16x16x32_bf16 v[40:43], v[104:107], v[144:147], v[40:43]
    v_mfma_f32_16x16x32_bf16 v[40:43], v[120:123], v[152:155], v[40:43]
    s_waitcnt lgkmcnt(0)
    v_mfma_f32_16x16x32_bf16 v[44:47], v[124:127], v[152:155], v[44:47]
    v_mfma_f32_16x16x32_bf16 v[44:47], v[108:111], v[144:147], v[44:47]
    s_waitcnt vmcnt(1)
    v_mfma_f32_16x16x32_bf16 v[60:63], v[108:111], v[148:151], v[60:63]
    s_waitcnt vmcnt(0)
    v_mfma_f32_16x16x32_bf16 v[60:63], v[124:127], v[156:159], v[60:63]
    v_mfma_f32_16x16x32_bf16 v[56:59], v[120:123], v[156:159], v[56:59]
    v_mfma_f32_16x16x32_bf16 v[56:59], v[104:107], v[148:151], v[56:59]
    v_mfma_f32_16x16x32_bf16 v[52:55], v[100:103], v[148:151], v[52:55]
    v_mfma_f32_16x16x32_bf16 v[52:55], v[116:119], v[156:159], v[52:55]
    v_mfma_f32_16x16x32_bf16 v[48:51], v[112:115], v[156:159], v[48:51]
    v_mfma_f32_16x16x32_bf16 v[48:51], v[96:99], v[148:151], v[48:51]
    v_and_b32 v14, 15, v0
    v_lshlrev_b32 v14, 11, v14
    v_bfe_u32 v15, v0, 4, 1
    v_lshl_add_u32 v14, v15, 5, v14
    v_lshrrev_b32 v15, 5, v0
    v_lshl_add_u32 v14, v15, 4, v14
    v_add_u32 v15, 0x8000, v14
    s_lshl_b32 s4, s36, 16
    s_lshl_b32 s5, s35, 7
    s_add_u32 s4, s4, s5
    v_cvt_pk_bf16_f32 v76, v56, v57
    v_cvt_pk_bf16_f32 v77, v58, v59
    v_cvt_pk_bf16_f32 v78, v60, v61
    v_cvt_pk_bf16_f32 v79, v62, v63
    s_nop 1
    v_permlane16_swap_b32 v76, v78
    v_permlane16_swap_b32 v77, v79
    buffer_store_dwordx4 v[76:79], v15, s[20:23], s4 offen offset:64
    v_cvt_pk_bf16_f32 v72, v48, v49
    v_cvt_pk_bf16_f32 v73, v50, v51
    v_cvt_pk_bf16_f32 v74, v52, v53
    v_cvt_pk_bf16_f32 v75, v54, v55
    s_nop 1
    v_permlane16_swap_b32 v72, v74
    v_permlane16_swap_b32 v73, v75
    buffer_store_dwordx4 v[72:75], v15, s[20:23], s4 offen offset:0
    v_cvt_pk_bf16_f32 v68, v40, v41
    v_cvt_pk_bf16_f32 v69, v42, v43
    v_cvt_pk_bf16_f32 v70, v44, v45
    v_cvt_pk_bf16_f32 v71, v46, v47
    s_nop 1
    v_permlane16_swap_b32 v68, v70
    v_permlane16_swap_b32 v69, v71
    buffer_store_dwordx4 v[68:71], v14, s[20:23], s4 offen offset:64
    v_cvt_pk_bf16_f32 v64, v32, v33
    v_cvt_pk_bf16_f32 v65, v34, v35
    v_cvt_pk_bf16_f32 v66, v36, v37
    v_cvt_pk_bf16_f32 v67, v38, v39
    s_nop 1
    v_permlane16_swap_b32 v64, v66
    v_permlane16_swap_b32 v65, v67
    buffer_store_dwordx4 v[64:67], v14, s[20:23], s4 offen offset:0
    s_branch p2_fin
p2_G_w0:
    s_sleep 1
    ds_read_b32 v23, v21
    s_waitcnt lgkmcnt(0)
    v_cmp_gt_i32 vcc, v24, v23
    s_nop 4
    s_cbranch_vccnz p2_G_w0
    s_branch p2_G_w0r
p2_G_w1:
    s_sleep 1
    ds_read_b32 v23, v21
    s_waitcnt lgkmcnt(0)
    v_cmp_gt_i32 vcc, v24, v23
    s_nop 4
    s_cbranch_vccnz p2_G_w1
    s_branch p2_G_w1r
p2_G_w2:
    s_sleep 1
    ds_read_b32 v23, v21
    s_waitcnt lgkmcnt(0)
    v_cmp_gt_i32 vcc, v24, v23
    s_nop 4
    s_cbranch_vccnz p2_G_w2
    s_branch p2_G_w2r
p2_G_w3:
    s_sleep 1
    ds_read_b32 v23, v21
    s_waitcnt lgkmcnt(0)
    v_cmp_gt_i32 vcc, v24, v23
    s_nop 4
    s_cbranch_vccnz p2_G_w3
    s_branch p2_G_w3r
p2_G_w20:
    s_sleep 1
    ds_read_b32 v23, v21
    s_waitcnt lgkmcnt(0)
    v_cmp_gt_i32 vcc, v24, v23
    s_nop 4
    s_cbranch_vccnz p2_G_w20
    s_branch p2_G_w20r
p2_G_w21:
    s_sleep 1
    ds_read_b32 v23, v21
    s_waitcnt lgkmcnt(0)
    v_cmp_gt_i32 vcc, v24, v23
    s_nop 4
    s_cbranch_vccnz p2_G_w21
    s_branch p2_G_w21r
p2_G_w22:
    s_sleep 1
    ds_read_b32 v23, v21
    s_waitcnt lgkmcnt(0)
    v_cmp_gt_i32 vcc, v24, v23
    s_nop 4
    s_cbranch_vccnz p2_G_w22
    s_branch p2_G_w22r
p2_G_w23:
    s_sleep 1
    ds_read_b32 v23, v21
    s_waitcnt lgkmcnt(0)
    v_cmp_gt_i32 vcc, v24, v23
    s_nop 4
    s_cbranch_vccnz p2_G_w23
    s_branch p2_G_w23r
p2_G_w24:
    s_sleep 1
    ds_read_b32 v23, v21
    s_waitcnt lgkmcnt(0)
    v_cmp_gt_i32 vcc, v24, v23
    s_nop 4
    s_cbranch_vccnz p2_G_w24
    s_branch p2_G_w24r
p2_G_w25:
    s_sleep 1
    ds_read_b32 v23, v21
    s_waitcnt lgkmcnt(0)
    v_cmp_gt_i32 vcc, v24, v23
    s_nop 4
    s_cbranch_vccnz p2_G_w25
    s_branch p2_G_w25r
p2_G_w26:
    s_sleep 1
    ds_read_b32 v23, v21
    s_waitcnt lgkmcnt(0)
    v_cmp_gt_i32 vcc, v24, v23
    s_nop 4
    s_cbranch_vccnz p2_G_w26
    s_branch p2_G_w26r
p2_G_w27:
    s_sleep 1
    ds_read_b32 v23, v21
    s_waitcnt lgkmcnt(0)
    v_cmp_gt_i32 vcc, v24, v23
    s_nop 4
    s_cbranch_vccnz p2_G_w27
    s_branch p2_G_w27r
p2_G_w28:
    s_sleep 1
    ds_read_b32 v23, v21
    s_waitcnt lgkmcnt(0)
    v_cmp_gt_i32 vcc, v24, v23
    s_nop 4
    s_cbranch_vccnz p2_G_w28
    s_branch p2_G_w28r
p2_G_w29:
    s_sleep 1
    ds_read_b32 v23, v21
    s_waitcnt lgkmcnt(0)
    v_cmp_gt_i32 vcc, v24, v23
    s_nop 4
    s_cbranch_vccnz p2_G_w29
    s_branch p2_G_w29r
p2_G_w30:
    s_sleep 1
    ds_read_b32 v23, v21
    s_waitcnt lgkmcnt(0)
    v_cmp_gt_i32 vcc, v24, v23
    s_nop 4
    s_cbranch_vccnz p2_G_w30
    s_branch p2_G_w30r
p2_G_w31:
    s_sleep 1
    ds_read_b32 v23, v21
    s_waitcnt lgkmcnt(0)
    v_cmp_gt_i32 vcc, v24, v23
    s_nop 4
    s_cbranch_vccnz p2_G_w31
    s_branch p2_G_w31r
p2_G_w32:
    s_sleep 1
    ds_read_b32 v23, v21
    s_waitcnt lgkmcnt(0)
    v_cmp_gt_i32 vcc, v24, v23
    s_nop 4
    s_cbranch_vccnz p2_G_w32
    s_branch p2_G_w32r
p2_G_w33:
    s_sleep 1
    ds_read_b32 v23, v21
    s_waitcnt lgkmcnt(0)
    v_cmp_gt_i32 vcc, v24, v23
    s_nop 4
    s_cbranch_vccnz p2_G_w33
    s_branch p2_G_w33r
p2_G_w34:
    s_sleep 1
    ds_read_b32 v23, v21
    s_waitcnt lgkmcnt(0)
    v_cmp_gt_i32 vcc, v24, v23
    s_nop 4
    s_cbranch_vccnz p2_G_w34
    s_branch p2_G_w34r
p2_G_w35:
    s_sleep 1
    ds_read_b32 v23, v21
    s_waitcnt lgkmcnt(0)
    v_cmp_gt_i32 vcc, v24, v23
    s_nop 4
    s_cbranch_vccnz p2_G_w35
    s_branch p2_G_w35r
p2_G_w36:
    s_sleep 1
    ds_read_b32 v23, v21
    s_waitcnt lgkmcnt(0)
    v_cmp_gt_i32 vcc, v24, v23
    s_nop 4
    s_cbranch_vccnz p2_G_w36
    s_branch p2_G_w36r
p2_G_poll:
    s_mov_b32 s5, 0x20000
p2_G_poll1:
    buffer_load_dword v28, v27, s[8:11], 0 offen sc1
    s_waitcnt vmcnt(0)
    v_cmp_ne_u32 vcc, 0, v28
    s_sub_u32 s5, s5, 1
    s_cbranch_scc1 p2_G_go
    s_cmp_eq_u64 vcc, -1
    s_cbranch_scc1 p2_G_go
    s_sleep 1
    s_branch p2_G_poll1
p2_G_w37:
    s_sleep 1
    ds_read_b32 v23, v21
    s_waitcnt lgkmcnt(0)
    v_cmp_gt_i32 vcc, v24, v23
    s_nop 4
    s_cbranch_vccnz p2_G_w37
    s_branch p2_G_w37r
p2_G_w38:
    s_sleep 1
    ds_read_b32 v23, v21
    s_waitcnt lgkmcnt(0)
    v_cmp_gt_i32 vcc, v24, v23
    s_nop 4
    s_cbranch_vccnz p2_G_w38
    s_branch p2_G_w38r
p2_G_w39:
    s_sleep 1
    ds_read_b32 v23, v21
    s_waitcnt lgkmcnt(0)
    v_cmp_gt_i32 vcc, v24, v23
    s_nop 4
    s_cbranch_vccnz p2_G_w39
    s_branch p2_G_w39r
p2_fin:
p2_end:
    s_endpgm
.section .rodata,"a"
.p2align 6
.amdhsa_kernel gated_mix__grouped_kv_mqa__glu_gated_glu__prompt_kernel
  .amdhsa_next_free_vgpr 256
  .amdhsa_next_free_sgpr 102
  .amdhsa_accum_offset 256
  .amdhsa_group_segment_fixed_size 0
  .amdhsa_kernarg_size 104
  .amdhsa_user_sgpr_count 2
  .amdhsa_user_sgpr_kernarg_segment_ptr 1
  .amdhsa_system_sgpr_workgroup_id_x 1
.end_amdhsa_kernel
```
